```python
import torch

def _softmax(x, axis=-1):
    return torch.softmax(x, dim=axis)
def _gelu(x):
    return torch.nn.functional.gelu(x, approximate="tanh")
def _silu(x):
    return torch.nn.functional.silu(x)
def _sigmoid(x):
    return torch.sigmoid(x)
def _layernorm(x, axis=-1, eps=1e-5):
    m = x.mean(dim=axis, keepdim=True)
    v = x.var(dim=axis, keepdim=True, unbiased=False)
    return (x - m) / torch.sqrt(v + eps)
def _scatter_add(tgt, idx, src, axis=0):
    return tgt.clone().index_add_(axis, idx, src)
def _segment_sum(src, seg, n):
    out = torch.zeros((n,) + src.shape[1:], dtype=src.dtype)
    return out.index_add_(0, seg, src)
def _pad(x, pw):
    flat = tuple(v for pair in reversed(pw) for v in pair)
    return torch.nn.functional.pad(x, flat)

kernel_name = 'recurrent_scan__gqa_block_cached__glu_gated_reglu__prompt'

def setup_inputs():

    _w = (lambda a: (lambda t: t.to(torch.bfloat16) if t.is_floating_point() else t)(torch.as_tensor(a)))
    def _A_setup():
        B, Sq, D = 1, 2048, 576
        Hq, Hkv, Sk, Dh = 32, 16, 2048, 128
        assert Hq % Hkv == 0, (Hq, Hkv)
        return {
            "x": _w((lambda *s: torch.randn(*s, dtype=torch.bfloat16) * 0.05)(B, Sq, D)),
            "k_cache": _w((lambda *s: torch.randn(*s, dtype=torch.bfloat16) * 1.6)(B, Hkv, Sk, Dh)),
            "v_cache": _w((lambda *s: torch.randn(*s, dtype=torch.bfloat16) * 1.6)(B, Hkv, Sk, Dh)),
            "wq": _w((lambda *s: torch.randn(*s, dtype=torch.bfloat16) * 1.6)(D, Hq * Dh) * (D ** -0.5)),
            "wo": _w((lambda *s: torch.randn(*s, dtype=torch.bfloat16) * 1.6)(Hq * Dh, D) * ((Hq * Dh) ** -0.5)),
        }
    _A_in = _A_setup()

    def _B_setup():
        B, S, D, F = 1, 2048, 576, 4608
        return {
            "x": _w((lambda *s: torch.randn(*s, dtype=torch.bfloat16) * 0.05)(B, S, D)),
            "W_gate": _w((lambda *s: torch.randn(*s, dtype=torch.bfloat16) * 0.2)(D, F) * (2.0 / D) ** 0.5),
            "W_up": _w((lambda *s: torch.randn(*s, dtype=torch.bfloat16) * 0.2)(D, F) * (2.0 / D) ** 0.5),
            "W_down": _w((lambda *s: torch.randn(*s, dtype=torch.bfloat16) * 0.2)(F, D) * (1.0 / F) ** 0.5),
        }
    _B_in = _B_setup()

    return {
        "A_x": _A_in["x"],
        "A_k_cache": _A_in["k_cache"],
        "A_v_cache": _A_in["v_cache"],
        "A_wq": _A_in["wq"],
        "A_wo": _A_in["wo"],
        "B_x": _B_in["x"],
        "B_W_gate": _B_in["W_gate"],
        "B_W_up": _B_in["W_up"],
        "B_W_down": _B_in["W_down"],
    }

def reference(A_x, A_k_cache, A_v_cache, A_wq, A_wo, B_x, B_W_gate, B_W_up, B_W_down):
    def _A_ref(x, k_cache, v_cache, wq, wo):
        B, Sq, D = x.shape
        Hq, Dh = 32, 128
        Hkv = k_cache.shape[1]
        rep = Hq // Hkv
        q = (lambda x, *d: x.permute(*d))((x @ wq).reshape(B, Sq, Hq, Dh), 0, 2, 1, 3)
        k = (lambda x, n, axis: torch.repeat_interleave(x, n, dim=axis))(k_cache, rep, axis=1)
        v = (lambda x, n, axis: torch.repeat_interleave(x, n, dim=axis))(v_cache, rep, axis=1)
        scores = torch.einsum("bhqd,bhkd->bhqk", q, k) * (Dh ** -0.5)
        p = _softmax(scores, axis=-1)
        o = torch.einsum("bhqk,bhkd->bhqd", p, v)
        return (lambda x, *d: x.permute(*d))(o, 0, 2, 1, 3).reshape(B, Sq, Hq * Dh) @ wo

    def _B_ref(x, W_gate, W_up, W_down):
        gate = torch.einsum("bsd,df->bsf", x, W_gate)
        up = torch.einsum("bsd,df->bsf", x, W_up)
        gate = gate * (lambda x, dt: x.to(dt))(gate > 0, gate.dtype)
        h = gate * up
        return torch.einsum("bsf,fd->bsd", h, W_down)

    x = A_x
    xn = _layernorm(x, axis=-1)
    s = _A_ref(xn, A_k_cache, A_v_cache, A_wq, A_wo)
    g = _silu(_B_ref(xn, B_W_gate, B_W_up, B_W_down))
    return x + s * g
```

```asm
; @launch grid=(256,1,1) block=(256,1,1) lds=163840
.amdgcn_target "amdgcn-amd-amdhsa--gfx950"
.text
.globl recurrent_scan__gqa_block_cached__glu_gated_reglu__prompt_kernel
.p2align 8
.type recurrent_scan__gqa_block_cached__glu_gated_reglu__prompt_kernel,@function
recurrent_scan__gqa_block_cached__glu_gated_reglu__prompt_kernel:
s_cmp_ge_u32 s2, 0x100
s_cbranch_scc1 recurrent_scan__gqa_block_cached__glu_gated_reglu__prompt_kernel_end
s_load_dwordx2 s[62:63], s[0:1], 0x0
s_load_dwordx2 s[14:15], s[0:1], 0x58
s_load_dwordx2 s[10:11], s[0:1], 0x30
s_load_dwordx2 s[12:13], s[0:1], 0x38
s_load_dwordx2 s[8:9], s[0:1], 0x18
s_load_dwordx2 s[70:71], s[0:1], 0x50
s_load_dwordx2 s[4:5], s[0:1], 0x8
s_load_dwordx2 s[6:7], s[0:1], 0x10
s_load_dwordx2 s[64:65], s[0:1], 0x20
s_load_dwordx2 s[66:67], s[0:1], 0x40
s_load_dwordx2 s[68:69], s[0:1], 0x48
v_lshrrev_b32 v1, 6, v0
s_nop 0
v_readfirstlane_b32 s44, v1
s_nop 3
v_and_b32 v1, 63, v0
s_and_b32 s55, s2, 7
s_lshl_b32 s55, s55, 2
s_bfe_u32 s56, s2, 0x20003
s_add_u32 s45, s55, s56
s_lshr_b32 s46, s2, 5
s_mul_i32 s51, s44, 0x2400
s_lshl_b32 s52, s44, 10
s_waitcnt lgkmcnt(0)
s_mov_b32 s76, s62
s_mov_b32 s77, s63
s_mov_b32 s78, 0x240000
s_mov_b32 s79, 0x20000
s_add_u32 s32, s14, 0
s_addc_u32 s33, s15, 0
s_mov_b32 s34, 0x240000
s_mov_b32 s35, 0x20000
s_mov_b32 s72, s70
s_mov_b32 s73, s71
s_mov_b32 s74, 0x100
s_mov_b32 s75, 0x20000
v_lshrrev_b32 v19, 4, v1
s_lshl_b32 s56, s44, 2
v_add_u32 v19, s56, v19
v_and_b32 v20, 3, v1
v_bfe_u32 v21, v1, 2, 2
v_mul_u32_u24 v44, 0x480, v19
v_lshl_add_u32 v44, v20, 3, v44
v_lshl_add_u32 v44, v21, 6, v44
v_cmp_gt_u32 vcc, 2, v21
v_mov_b32 v49, 0x7fff0000
s_nop 0
v_cndmask_b32 v48, v49, v44, vcc
s_cmp_ge_u32 s2, 0x80
s_cbranch_scc1 recurrent_scan__gqa_block_cached__glu_gated_reglu__prompt_kernel_lnskip1
s_mul_i32 s55, s2, 0x4800
buffer_load_dwordx2 v[24:25], v44, s[76:79], s55 offen
buffer_load_dwordx2 v[26:27], v44, s[76:79], s55 offen offset:32
buffer_load_dwordx2 v[28:29], v44, s[76:79], s55 offen offset:256
buffer_load_dwordx2 v[30:31], v44, s[76:79], s55 offen offset:288
buffer_load_dwordx2 v[32:33], v44, s[76:79], s55 offen offset:512
buffer_load_dwordx2 v[34:35], v44, s[76:79], s55 offen offset:544
buffer_load_dwordx2 v[36:37], v44, s[76:79], s55 offen offset:768
buffer_load_dwordx2 v[38:39], v44, s[76:79], s55 offen offset:800
buffer_load_dwordx2 v[40:41], v48, s[76:79], s55 offen offset:1024
buffer_load_dwordx2 v[42:43], v48, s[76:79], s55 offen offset:1056
recurrent_scan__gqa_block_cached__glu_gated_reglu__prompt_kernel_lnskip1:
v_lshlrev_b32 v45, 17, v21
v_lshl_add_u32 v45, v19, 4, v45
v_lshl_add_u32 v45, v20, 8, v45
v_cndmask_b32 v50, v49, v45, vcc
v_cndmask_b32_e64 v52, 0, 1.0, vcc
v_mov_b32 v53, v52
v_lshlrev_b32 v18, 4, v1
s_cmp_lt_u32 s44, 2
s_cselect_b32 s16, s10, s12
s_cselect_b32 s17, s11, s13
s_mov_b32 s18, 0x510000
s_mov_b32 s19, 0x20000
s_and_b32 s55, s44, 1
s_mul_i32 s47, s55, 0x48000
s_mul_i32 s55, s45, 0x120
s_add_u32 s47, s47, s55
s_mov_b32 s55, 0xe39
v_add_u32 v19, 0, v1
v_mul_u32_u24 v20, s55, v19
v_lshrrev_b32 v20, 16, v20
v_mul_u32_u24 v21, 18, v20
v_sub_u32 v21, v19, v21
v_mul_u32_u24 v20, 0x2400, v20
v_lshl_add_u32 v2, v21, 4, v20
v_add_u32 v19, 64, v1
v_mul_u32_u24 v20, s55, v19
v_lshrrev_b32 v20, 16, v20
v_mul_u32_u24 v21, 18, v20
v_sub_u32 v21, v19, v21
v_mul_u32_u24 v20, 0x2400, v20
v_lshl_add_u32 v3, v21, 4, v20
v_add_u32 v19, 0x80, v1
v_mul_u32_u24 v20, s55, v19
v_lshrrev_b32 v20, 16, v20
v_mul_u32_u24 v21, 18, v20
v_sub_u32 v21, v19, v21
v_mul_u32_u24 v20, 0x2400, v20
v_lshl_add_u32 v4, v21, 4, v20
v_add_u32 v19, 0xc0, v1
v_mul_u32_u24 v20, s55, v19
v_lshrrev_b32 v20, 16, v20
v_mul_u32_u24 v21, 18, v20
v_sub_u32 v21, v19, v21
v_mul_u32_u24 v20, 0x2400, v20
v_lshl_add_u32 v5, v21, 4, v20
v_add_u32 v19, 0x100, v1
v_mul_u32_u24 v20, s55, v19
v_lshrrev_b32 v20, 16, v20
v_mul_u32_u24 v21, 18, v20
v_sub_u32 v21, v19, v21
v_mul_u32_u24 v20, 0x2400, v20
v_lshl_add_u32 v6, v21, 4, v20
v_add_u32 v19, 0x140, v1
v_mul_u32_u24 v20, s55, v19
v_lshrrev_b32 v20, 16, v20
v_mul_u32_u24 v21, 18, v20
v_sub_u32 v21, v19, v21
v_mul_u32_u24 v20, 0x2400, v20
v_lshl_add_u32 v7, v21, 4, v20
v_add_u32 v19, 0x180, v1
v_mul_u32_u24 v20, s55, v19
v_lshrrev_b32 v20, 16, v20
v_mul_u32_u24 v21, 18, v20
v_sub_u32 v21, v19, v21
v_mul_u32_u24 v20, 0x2400, v20
v_lshl_add_u32 v8, v21, 4, v20
v_add_u32 v19, 0x1c0, v1
v_mul_u32_u24 v20, s55, v19
v_lshrrev_b32 v20, 16, v20
v_mul_u32_u24 v21, 18, v20
v_sub_u32 v21, v19, v21
v_mul_u32_u24 v20, 0x2400, v20
v_lshl_add_u32 v9, v21, 4, v20
v_add_u32 v19, 0x200, v1
v_mul_u32_u24 v20, s55, v19
v_lshrrev_b32 v20, 16, v20
v_mul_u32_u24 v21, 18, v20
v_sub_u32 v21, v19, v21
v_mul_u32_u24 v20, 0x2400, v20
v_lshl_add_u32 v10, v21, 4, v20
s_mov_b32 s20, s8
s_mov_b32 s21, s9
s_mov_b32 s22, 0x480000
s_mov_b32 s23, 0x20000
v_lshrrev_b32 v19, 2, v1
v_mul_u32_u24 v11, 0x120, v19
v_and_b32 v20, 3, v1
v_lshl_add_u32 v11, v20, 3, v11
v_add_u32 v12, 0x9000, v11
v_add_u32 v13, 0x12000, v11
v_add_u32 v14, 0, v18
v_add_u32 v15, 0x20000, v18
v_add_u32 v16, 0x40000, v18
s_lshl_b32 s55, s46, 4
s_lshl_b32 s56, s44, 2
s_add_u32 s55, s55, s56
s_lshl_b32 s48, s55, 10
s_mov_b32 s53, s48
s_mov_b32 s54, s48
s_add_u32 s36, s14, 0x240000
s_addc_u32 s37, s15, 0
s_mov_b32 s38, 0x1200000
s_mov_b32 s39, 0x20000
s_add_u32 s40, s14, 0x1440000
s_addc_u32 s41, s15, 0
s_mov_b32 s42, 0x1000000
s_mov_b32 s43, 0x20000
s_lshr_b32 s55, s45, 1
s_lshl_b32 s55, s55, 19
s_add_u32 s24, s4, s55
s_addc_u32 s25, s5, 0
s_mov_b32 s26, 0x80000
s_mov_b32 s27, 0x20000
s_add_u32 s28, s6, s55
s_addc_u32 s29, s7, 0
s_mov_b32 s30, 0x80000
s_mov_b32 s31, 0x20000
v_lshrrev_b32 v19, 4, v1
s_lshl_b32 s55, s44, 2
v_add_u32 v19, s55, v19
v_and_b32 v20, 7, v19
v_lshlrev_b32 v20, 1, v20
v_and_b32 v21, 15, v1
v_xor_b32 v20, v20, v21
v_lshlrev_b32 v20, 4, v20
v_lshl_add_u32 v23, v19, 13, v20
s_lshl_b32 s49, s45, 8
s_lshl_b32 s55, s45, 19
s_add_u32 s54, s54, s55
s_and_b32 s84, s2, 7
s_lshr_b32 s85, s2, 5
s_bfe_u32 s86, s2, 0x20003
s_cmp_ge_u32 s2, 0x80
s_cbranch_scc1 recurrent_scan__gqa_block_cached__glu_gated_reglu__prompt_kernel_lnskip2
s_mov_b32 s55, 0xffff0000
s_waitcnt vmcnt(0)
v_lshlrev_b32 v56, 16, v24
v_and_b32 v57, s55, v24
v_lshlrev_b32 v58, 16, v25
v_and_b32 v59, s55, v25
v_lshlrev_b32 v60, 16, v26
v_and_b32 v61, s55, v26
v_lshlrev_b32 v62, 16, v27
v_and_b32 v63, s55, v27
v_lshlrev_b32 v64, 16, v28
v_and_b32 v65, s55, v28
v_lshlrev_b32 v66, 16, v29
v_and_b32 v67, s55, v29
v_lshlrev_b32 v68, 16, v30
v_and_b32 v69, s55, v30
v_lshlrev_b32 v70, 16, v31
v_and_b32 v71, s55, v31
v_lshlrev_b32 v72, 16, v32
v_and_b32 v73, s55, v32
v_lshlrev_b32 v74, 16, v33
v_and_b32 v75, s55, v33
v_lshlrev_b32 v76, 16, v34
v_and_b32 v77, s55, v34
v_lshlrev_b32 v78, 16, v35
v_and_b32 v79, s55, v35
v_lshlrev_b32 v80, 16, v36
v_and_b32 v81, s55, v36
v_lshlrev_b32 v82, 16, v37
v_and_b32 v83, s55, v37
v_lshlrev_b32 v84, 16, v38
v_and_b32 v85, s55, v38
v_lshlrev_b32 v86, 16, v39
v_and_b32 v87, s55, v39
v_lshlrev_b32 v88, 16, v40
v_and_b32 v89, s55, v40
v_lshlrev_b32 v90, 16, v41
v_and_b32 v91, s55, v41
v_lshlrev_b32 v92, 16, v42
v_and_b32 v93, s55, v42
v_lshlrev_b32 v94, 16, v43
v_and_b32 v95, s55, v43
v_pk_add_f32 v[96:97], v[56:57], v[58:59]
v_pk_add_f32 v[98:99], v[60:61], v[62:63]
v_pk_add_f32 v[96:97], v[96:97], v[64:65]
v_pk_add_f32 v[98:99], v[98:99], v[66:67]
v_pk_add_f32 v[96:97], v[96:97], v[68:69]
v_pk_add_f32 v[98:99], v[98:99], v[70:71]
v_pk_add_f32 v[96:97], v[96:97], v[72:73]
v_pk_add_f32 v[98:99], v[98:99], v[74:75]
v_pk_add_f32 v[96:97], v[96:97], v[76:77]
v_pk_add_f32 v[98:99], v[98:99], v[78:79]
v_pk_add_f32 v[96:97], v[96:97], v[80:81]
v_pk_add_f32 v[98:99], v[98:99], v[82:83]
v_pk_add_f32 v[96:97], v[96:97], v[84:85]
v_pk_add_f32 v[98:99], v[98:99], v[86:87]
v_pk_add_f32 v[96:97], v[96:97], v[88:89]
v_pk_add_f32 v[98:99], v[98:99], v[90:91]
v_pk_add_f32 v[96:97], v[96:97], v[92:93]
v_pk_add_f32 v[98:99], v[98:99], v[94:95]
v_pk_add_f32 v[96:97], v[96:97], v[98:99]
s_nop 0
v_add_f32 v96, v96, v97
s_nop 1
v_add_f32_dpp v96, v96, v96 row_ror:8 row_mask:0xf bank_mask:0xf
s_nop 1
v_add_f32_dpp v96, v96, v96 row_ror:4 row_mask:0xf bank_mask:0xf
s_nop 1
v_add_f32_dpp v96, v96, v96 row_ror:2 row_mask:0xf bank_mask:0xf
s_nop 1
v_add_f32_dpp v96, v96, v96 row_ror:1 row_mask:0xf bank_mask:0xf
v_mul_f32 v100, 0xbae38e39, v96
v_mov_b32 v101, v100
s_nop 0
v_pk_add_f32 v[56:57], v[56:57], v[100:101]
v_pk_add_f32 v[58:59], v[58:59], v[100:101]
v_pk_add_f32 v[60:61], v[60:61], v[100:101]
v_pk_add_f32 v[62:63], v[62:63], v[100:101]
v_pk_add_f32 v[64:65], v[64:65], v[100:101]
v_pk_add_f32 v[66:67], v[66:67], v[100:101]
v_pk_add_f32 v[68:69], v[68:69], v[100:101]
v_pk_add_f32 v[70:71], v[70:71], v[100:101]
v_pk_add_f32 v[72:73], v[72:73], v[100:101]
v_pk_add_f32 v[74:75], v[74:75], v[100:101]
v_pk_add_f32 v[76:77], v[76:77], v[100:101]
v_pk_add_f32 v[78:79], v[78:79], v[100:101]
v_pk_add_f32 v[80:81], v[80:81], v[100:101]
v_pk_add_f32 v[82:83], v[82:83], v[100:101]
v_pk_add_f32 v[84:85], v[84:85], v[100:101]
v_pk_add_f32 v[86:87], v[86:87], v[100:101]
v_pk_add_f32 v[88:89], v[88:89], v[100:101]
v_pk_add_f32 v[90:91], v[90:91], v[100:101]
v_pk_add_f32 v[92:93], v[92:93], v[100:101]
v_pk_add_f32 v[94:95], v[94:95], v[100:101]
v_pk_mul_f32 v[88:89], v[88:89], v[52:53]
v_pk_mul_f32 v[90:91], v[90:91], v[52:53]
v_pk_mul_f32 v[92:93], v[92:93], v[52:53]
v_pk_mul_f32 v[94:95], v[94:95], v[52:53]
v_pk_mul_f32 v[96:97], v[56:57], v[56:57]
v_pk_mul_f32 v[98:99], v[58:59], v[58:59]
v_pk_fma_f32 v[96:97], v[60:61], v[60:61], v[96:97]
v_pk_fma_f32 v[98:99], v[62:63], v[62:63], v[98:99]
v_pk_fma_f32 v[96:97], v[64:65], v[64:65], v[96:97]
v_pk_fma_f32 v[98:99], v[66:67], v[66:67], v[98:99]
v_pk_fma_f32 v[96:97], v[68:69], v[68:69], v[96:97]
v_pk_fma_f32 v[98:99], v[70:71], v[70:71], v[98:99]
v_pk_fma_f32 v[96:97], v[72:73], v[72:73], v[96:97]
v_pk_fma_f32 v[98:99], v[74:75], v[74:75], v[98:99]
v_pk_fma_f32 v[96:97], v[76:77], v[76:77], v[96:97]
v_pk_fma_f32 v[98:99], v[78:79], v[78:79], v[98:99]
v_pk_fma_f32 v[96:97], v[80:81], v[80:81], v[96:97]
v_pk_fma_f32 v[98:99], v[82:83], v[82:83], v[98:99]
v_pk_fma_f32 v[96:97], v[84:85], v[84:85], v[96:97]
v_pk_fma_f32 v[98:99], v[86:87], v[86:87], v[98:99]
v_pk_fma_f32 v[96:97], v[88:89], v[88:89], v[96:97]
v_pk_fma_f32 v[98:99], v[90:91], v[90:91], v[98:99]
v_pk_fma_f32 v[96:97], v[92:93], v[92:93], v[96:97]
v_pk_fma_f32 v[98:99], v[94:95], v[94:95], v[98:99]
v_pk_add_f32 v[96:97], v[96:97], v[98:99]
s_nop 0
v_add_f32 v96, v96, v97
s_nop 1
v_add_f32_dpp v96, v96, v96 row_ror:8 row_mask:0xf bank_mask:0xf
s_nop 1
v_add_f32_dpp v96, v96, v96 row_ror:4 row_mask:0xf bank_mask:0xf
s_nop 1
v_add_f32_dpp v96, v96, v96 row_ror:2 row_mask:0xf bank_mask:0xf
s_nop 1
v_add_f32_dpp v96, v96, v96 row_ror:1 row_mask:0xf bank_mask:0xf
v_mov_b32 v97, 0x3727c5ac
v_fmac_f32 v97, 0x3ae38e39, v96
v_sqrt_f32 v98, v97
s_nop 0
v_rcp_f32 v100, v98
s_nop 0
v_mov_b32 v101, v100
s_nop 0
v_pk_mul_f32 v[56:57], v[56:57], v[100:101]
v_pk_mul_f32 v[58:59], v[58:59], v[100:101]
v_pk_mul_f32 v[60:61], v[60:61], v[100:101]
v_pk_mul_f32 v[62:63], v[62:63], v[100:101]
v_pk_mul_f32 v[64:65], v[64:65], v[100:101]
v_pk_mul_f32 v[66:67], v[66:67], v[100:101]
v_pk_mul_f32 v[68:69], v[68:69], v[100:101]
v_pk_mul_f32 v[70:71], v[70:71], v[100:101]
v_pk_mul_f32 v[72:73], v[72:73], v[100:101]
v_pk_mul_f32 v[74:75], v[74:75], v[100:101]
v_pk_mul_f32 v[76:77], v[76:77], v[100:101]
v_pk_mul_f32 v[78:79], v[78:79], v[100:101]
v_pk_mul_f32 v[80:81], v[80:81], v[100:101]
v_pk_mul_f32 v[82:83], v[82:83], v[100:101]
v_pk_mul_f32 v[84:85], v[84:85], v[100:101]
v_pk_mul_f32 v[86:87], v[86:87], v[100:101]
v_pk_mul_f32 v[88:89], v[88:89], v[100:101]
v_pk_mul_f32 v[90:91], v[90:91], v[100:101]
v_pk_mul_f32 v[92:93], v[92:93], v[100:101]
v_pk_mul_f32 v[94:95], v[94:95], v[100:101]
v_cvt_pk_bf16_f32 v104, v56, v57
v_cvt_pk_bf16_f32 v105, v58, v59
v_cvt_pk_bf16_f32 v106, v60, v61
v_cvt_pk_bf16_f32 v107, v62, v63
v_cvt_pk_bf16_f32 v108, v64, v65
v_cvt_pk_bf16_f32 v109, v66, v67
v_cvt_pk_bf16_f32 v110, v68, v69
v_cvt_pk_bf16_f32 v111, v70, v71
v_cvt_pk_bf16_f32 v112, v72, v73
v_cvt_pk_bf16_f32 v113, v74, v75
v_cvt_pk_bf16_f32 v114, v76, v77
v_cvt_pk_bf16_f32 v115, v78, v79
v_cvt_pk_bf16_f32 v116, v80, v81
v_cvt_pk_bf16_f32 v117, v82, v83
v_cvt_pk_bf16_f32 v118, v84, v85
v_cvt_pk_bf16_f32 v119, v86, v87
v_cvt_pk_bf16_f32 v120, v88, v89
v_cvt_pk_bf16_f32 v121, v90, v91
v_cvt_pk_bf16_f32 v122, v92, v93
v_cvt_pk_bf16_f32 v123, v94, v95
s_lshl_b32 s55, s2, 10
buffer_store_dwordx4 v[104:107], v45, s[32:35], s55 offen sc1
s_add_u32 s55, s55, 0x80000
buffer_store_dwordx4 v[108:111], v45, s[32:35], s55 offen sc1
s_add_u32 s55, s55, 0x80000
buffer_store_dwordx4 v[112:115], v45, s[32:35], s55 offen sc1
s_add_u32 s55, s55, 0x80000
buffer_store_dwordx4 v[116:119], v45, s[32:35], s55 offen sc1
s_add_u32 s55, s55, 0x80000
buffer_store_dwordx4 v[120:123], v50, s[32:35], s55 offen sc1
s_waitcnt vmcnt(0)
s_barrier
s_lshr_b32 s56, s2, 4
s_cmp_lg_u32 s44, 0
s_cbranch_scc1 recurrent_scan__gqa_block_cached__glu_gated_reglu__prompt_kernel_sig3
s_lshl_b32 s90, s56, 3
s_add_u32 s90, s90, 0
s_lshl_b32 s90, s90, 2
v_mov_b32 v46, s90
v_mov_b32 v47, 1
s_mov_b64 exec, 1
buffer_atomic_add v47, v46, s[72:75], 0 offen sc1
s_mov_b64 exec, -1
recurrent_scan__gqa_block_cached__glu_gated_reglu__prompt_kernel_sig3:
recurrent_scan__gqa_block_cached__glu_gated_reglu__prompt_kernel_lnskip2:
s_cmp_lt_u32 s2, 0x80
s_cbranch_scc1 recurrent_scan__gqa_block_cached__glu_gated_reglu__prompt_kernel_cw4
s_sub_u32 s56, s2, 0x80
s_lshr_b32 s56, s56, 3
s_lshl_b32 s56, s56, 2
s_add_u32 s56, s56, s44
s_getpc_b64 s[96:97]
recurrent_scan__gqa_block_cached__glu_gated_reglu__prompt_kernel_pc5:
s_sub_u32 s96, s96, recurrent_scan__gqa_block_cached__glu_gated_reglu__prompt_kernel_pc5-recurrent_scan__gqa_block_cached__glu_gated_reglu__prompt_kernel
s_subb_u32 s97, s97, 0
s_mul_i32 s55, s56, (((recurrent_scan__gqa_block_cached__glu_gated_reglu__prompt_kernel_aloop-recurrent_scan__gqa_block_cached__glu_gated_reglu__prompt_kernel)+127)/128+63)/64
v_min_u32 v62, (((recurrent_scan__gqa_block_cached__glu_gated_reglu__prompt_kernel_aloop-recurrent_scan__gqa_block_cached__glu_gated_reglu__prompt_kernel)+127)/128+63)/64-1, v1
v_add_u32 v62, s55, v62
v_lshlrev_b32 v62, 7, v62
v_min_u32 v62, recurrent_scan__gqa_block_cached__glu_gated_reglu__prompt_kernel_aloop-recurrent_scan__gqa_block_cached__glu_gated_reglu__prompt_kernel-4, v62
v_mov_b32 v63, s97
v_add_co_u32 v62, vcc, s96, v62
s_nop 1
v_addc_co_u32 v63, vcc, 0, v63, vcc
global_load_dword a197, v[62:63], off
recurrent_scan__gqa_block_cached__glu_gated_reglu__prompt_kernel_cw4:
s_add_u32 m0, s51, 0
s_nop 0
buffer_load_dwordx4 v2, s[16:19], s47 offen lds
s_add_u32 m0, s51, 0x400
s_nop 0
buffer_load_dwordx4 v3, s[16:19], s47 offen lds
s_add_u32 m0, s51, 0x800
s_nop 0
buffer_load_dwordx4 v4, s[16:19], s47 offen lds
s_add_u32 m0, s51, 0xc00
s_nop 0
buffer_load_dwordx4 v5, s[16:19], s47 offen lds
s_add_u32 m0, s51, 0x1000
s_nop 0
buffer_load_dwordx4 v6, s[16:19], s47 offen lds
s_add_u32 m0, s51, 0x1400
s_nop 0
buffer_load_dwordx4 v7, s[16:19], s47 offen lds
s_add_u32 m0, s51, 0x1800
s_nop 0
buffer_load_dwordx4 v8, s[16:19], s47 offen lds
s_add_u32 m0, s51, 0x1c00
s_nop 0
buffer_load_dwordx4 v9, s[16:19], s47 offen lds
s_add_u32 m0, s51, 0x2000
s_nop 0
buffer_load_dwordx4 v10, s[16:19], s47 offen lds
s_add_u32 s47, s47, 0x90000
s_add_u32 m0, s51, 0x9000
s_nop 0
buffer_load_dwordx4 v2, s[16:19], s47 offen lds
s_add_u32 m0, s51, 0x9400
s_nop 0
buffer_load_dwordx4 v3, s[16:19], s47 offen lds
s_add_u32 m0, s51, 0x9800
s_nop 0
buffer_load_dwordx4 v4, s[16:19], s47 offen lds
s_add_u32 m0, s51, 0x9c00
s_nop 0
buffer_load_dwordx4 v5, s[16:19], s47 offen lds
s_add_u32 m0, s51, 0xa000
s_nop 0
buffer_load_dwordx4 v6, s[16:19], s47 offen lds
s_add_u32 m0, s51, 0xa400
s_nop 0
buffer_load_dwordx4 v7, s[16:19], s47 offen lds
s_add_u32 m0, s51, 0xa800
s_nop 0
buffer_load_dwordx4 v8, s[16:19], s47 offen lds
s_add_u32 m0, s51, 0xac00
s_nop 0
buffer_load_dwordx4 v9, s[16:19], s47 offen lds
s_add_u32 m0, s51, 0xb000
s_nop 0
buffer_load_dwordx4 v10, s[16:19], s47 offen lds
s_add_u32 s47, s47, 0x90000
s_cmp_lg_u32 s44, 0
s_cbranch_scc1 recurrent_scan__gqa_block_cached__glu_gated_reglu__prompt_kernel_got8
s_lshl_b32 s90, s46, 3
s_add_u32 s90, s90, 0
s_lshl_b32 s90, s90, 2
v_mov_b32 v46, s90
s_mov_b32 s90, 262144
recurrent_scan__gqa_block_cached__glu_gated_reglu__prompt_kernel_poll6:
buffer_load_dword v47, v46, s[72:75], 0 offen sc1
s_waitcnt vmcnt(0)
recurrent_scan__gqa_block_cached__glu_gated_reglu__prompt_kernel_pchk7:
v_readfirstlane_b32 s55, v47
s_nop 3
s_cmp_ge_u32 s55, 16
s_cbranch_scc1 recurrent_scan__gqa_block_cached__glu_gated_reglu__prompt_kernel_got8
s_sleep 1
s_sub_u32 s90, s90, 1
s_cmp_lg_u32 s90, 0
s_cbranch_scc1 recurrent_scan__gqa_block_cached__glu_gated_reglu__prompt_kernel_poll6
recurrent_scan__gqa_block_cached__glu_gated_reglu__prompt_kernel_got8:
s_barrier
buffer_load_dwordx4 a[64:67], v14, s[32:35], s48 offen sc1
buffer_load_dwordx4 a[72:75], v14, s[32:35], s48 offen offset:1024 sc1
buffer_load_dwordx4 a[80:83], v14, s[32:35], s48 offen offset:2048 sc1
buffer_load_dwordx4 a[88:91], v14, s[32:35], s48 offen offset:3072 sc1
buffer_load_dwordx4 a[68:71], v15, s[32:35], s48 offen sc1
buffer_load_dwordx4 a[76:79], v15, s[32:35], s48 offen offset:1024 sc1
buffer_load_dwordx4 a[84:87], v15, s[32:35], s48 offen offset:2048 sc1
buffer_load_dwordx4 a[92:95], v15, s[32:35], s48 offen offset:3072 sc1
s_add_u32 s48, s48, 0x40000
buffer_load_dwordx4 a[96:99], v14, s[32:35], s48 offen sc1
buffer_load_dwordx4 a[104:107], v14, s[32:35], s48 offen offset:1024 sc1
buffer_load_dwordx4 a[112:115], v14, s[32:35], s48 offen offset:2048 sc1
buffer_load_dwordx4 a[120:123], v14, s[32:35], s48 offen offset:3072 sc1
buffer_load_dwordx4 a[100:103], v15, s[32:35], s48 offen sc1
buffer_load_dwordx4 a[108:111], v15, s[32:35], s48 offen offset:1024 sc1
buffer_load_dwordx4 a[116:119], v15, s[32:35], s48 offen offset:2048 sc1
buffer_load_dwordx4 a[124:127], v15, s[32:35], s48 offen offset:3072 sc1
s_add_u32 s48, s48, 0x40000
s_waitcnt vmcnt(8)
s_barrier
ds_read_b64_tr_b16 a[160:161], v11
ds_read_b64_tr_b16 a[162:163], v11 offset:4608
ds_read_b64_tr_b16 a[164:165], v11 offset:9216
ds_read_b64_tr_b16 a[166:167], v11 offset:13824
ds_read_b64_tr_b16 a[168:169], v11 offset:18432
ds_read_b64_tr_b16 a[170:171], v11 offset:23040
ds_read_b64_tr_b16 a[172:173], v11 offset:27648
ds_read_b64_tr_b16 a[174:175], v11 offset:32256
s_waitcnt lgkmcnt(0)
v_mfma_f32_16x16x32_bf16 v[24:27], a[160:163], a[64:67], 0
ds_read_b64_tr_b16 a[176:177], v11 offset:32
ds_read_b64_tr_b16 a[178:179], v11 offset:4640
v_mfma_f32_16x16x32_bf16 v[24:27], a[164:167], a[68:71], v[24:27]
ds_read_b64_tr_b16 a[180:181], v11 offset:9248
ds_read_b64_tr_b16 a[182:183], v11 offset:13856
v_mfma_f32_16x16x32_bf16 v[28:31], a[160:163], a[72:75], 0
ds_read_b64_tr_b16 a[184:185], v11 offset:18464
ds_read_b64_tr_b16 a[186:187], v11 offset:23072
v_mfma_f32_16x16x32_bf16 v[28:31], a[164:167], a[76:79], v[28:31]
ds_read_b64_tr_b16 a[188:189], v11 offset:27680
ds_read_b64_tr_b16 a[190:191], v11 offset:32288
v_mfma_f32_16x16x32_bf16 v[32:35], a[160:163], a[80:83], 0
v_mfma_f32_16x16x32_bf16 v[32:35], a[164:167], a[84:87], v[32:35]
v_mfma_f32_16x16x32_bf16 v[36:39], a[160:163], a[88:91], 0
s_add_u32 m0, s51, 0x12000
v_mfma_f32_16x16x32_bf16 v[36:39], a[164:167], a[92:95], v[36:39]
buffer_load_dwordx4 v2, s[16:19], s47 offen lds
v_mfma_f32_16x16x32_bf16 v[40:43], a[168:171], a[64:67], 0
v_mfma_f32_16x16x32_bf16 v[40:43], a[172:175], a[68:71], v[40:43]
v_mfma_f32_16x16x32_bf16 v[44:47], a[168:171], a[72:75], 0
buffer_load_dwordx4 a[128:131], v14, s[32:35], s48 offen sc1
v_mfma_f32_16x16x32_bf16 v[44:47], a[172:175], a[76:79], v[44:47]
v_mfma_f32_16x16x32_bf16 v[48:51], a[168:171], a[80:83], 0
v_mfma_f32_16x16x32_bf16 v[48:51], a[172:175], a[84:87], v[48:51]
v_mfma_f32_16x16x32_bf16 v[52:55], a[168:171], a[88:91], 0
v_mfma_f32_16x16x32_bf16 v[52:55], a[172:175], a[92:95], v[52:55]
s_waitcnt lgkmcnt(0)
v_mfma_f32_16x16x32_bf16 v[56:59], a[176:179], a[64:67], 0
ds_read_b64_tr_b16 a[160:161], v11 offset:64
ds_read_b64_tr_b16 a[162:163], v11 offset:4672
v_mfma_f32_16x16x32_bf16 v[56:59], a[180:183], a[68:71], v[56:59]
ds_read_b64_tr_b16 a[164:165], v11 offset:9280
ds_read_b64_tr_b16 a[166:167], v11 offset:13888
v_mfma_f32_16x16x32_bf16 v[60:63], a[176:179], a[72:75], 0
ds_read_b64_tr_b16 a[168:169], v11 offset:18496
ds_read_b64_tr_b16 a[170:171], v11 offset:23104
v_mfma_f32_16x16x32_bf16 v[60:63], a[180:183], a[76:79], v[60:63]
ds_read_b64_tr_b16 a[172:173], v11 offset:27712
ds_read_b64_tr_b16 a[174:175], v11 offset:32320
v_mfma_f32_16x16x32_bf16 v[64:67], a[176:179], a[80:83], 0
v_mfma_f32_16x16x32_bf16 v[64:67], a[180:183], a[84:87], v[64:67]
v_mfma_f32_16x16x32_bf16 v[68:71], a[176:179], a[88:91], 0
s_add_u32 m0, s51, 0x12400
v_mfma_f32_16x16x32_bf16 v[68:71], a[180:183], a[92:95], v[68:71]
buffer_load_dwordx4 v3, s[16:19], s47 offen lds
v_mfma_f32_16x16x32_bf16 v[72:75], a[184:187], a[64:67], 0
v_mfma_f32_16x16x32_bf16 v[72:75], a[188:191], a[68:71], v[72:75]
v_mfma_f32_16x16x32_bf16 v[76:79], a[184:187], a[72:75], 0
buffer_load_dwordx4 a[136:139], v14, s[32:35], s48 offen offset:1024 sc1
v_mfma_f32_16x16x32_bf16 v[76:79], a[188:191], a[76:79], v[76:79]
v_mfma_f32_16x16x32_bf16 v[80:83], a[184:187], a[80:83], 0
v_mfma_f32_16x16x32_bf16 v[80:83], a[188:191], a[84:87], v[80:83]
v_mfma_f32_16x16x32_bf16 v[84:87], a[184:187], a[88:91], 0
v_mfma_f32_16x16x32_bf16 v[84:87], a[188:191], a[92:95], v[84:87]
s_waitcnt lgkmcnt(0)
v_mfma_f32_16x16x32_bf16 v[88:91], a[160:163], a[64:67], 0
ds_read_b64_tr_b16 a[176:177], v11 offset:96
ds_read_b64_tr_b16 a[178:179], v11 offset:4704
v_mfma_f32_16x16x32_bf16 v[88:91], a[164:167], a[68:71], v[88:91]
ds_read_b64_tr_b16 a[180:181], v11 offset:9312
ds_read_b64_tr_b16 a[182:183], v11 offset:13920
v_mfma_f32_16x16x32_bf16 v[92:95], a[160:163], a[72:75], 0
ds_read_b64_tr_b16 a[184:185], v11 offset:18528
ds_read_b64_tr_b16 a[186:187], v11 offset:23136
v_mfma_f32_16x16x32_bf16 v[92:95], a[164:167], a[76:79], v[92:95]
ds_read_b64_tr_b16 a[188:189], v11 offset:27744
ds_read_b64_tr_b16 a[190:191], v11 offset:32352
v_mfma_f32_16x16x32_bf16 v[96:99], a[160:163], a[80:83], 0
v_mfma_f32_16x16x32_bf16 v[96:99], a[164:167], a[84:87], v[96:99]
v_mfma_f32_16x16x32_bf16 v[100:103], a[160:163], a[88:91], 0
s_add_u32 m0, s51, 0x12800
v_mfma_f32_16x16x32_bf16 v[100:103], a[164:167], a[92:95], v[100:103]
buffer_load_dwordx4 v4, s[16:19], s47 offen lds
v_mfma_f32_16x16x32_bf16 v[104:107], a[168:171], a[64:67], 0
v_mfma_f32_16x16x32_bf16 v[104:107], a[172:175], a[68:71], v[104:107]
v_mfma_f32_16x16x32_bf16 v[108:111], a[168:171], a[72:75], 0
buffer_load_dwordx4 a[144:147], v14, s[32:35], s48 offen offset:2048 sc1
v_mfma_f32_16x16x32_bf16 v[108:111], a[172:175], a[76:79], v[108:111]
v_mfma_f32_16x16x32_bf16 v[112:115], a[168:171], a[80:83], 0
v_mfma_f32_16x16x32_bf16 v[112:115], a[172:175], a[84:87], v[112:115]
v_mfma_f32_16x16x32_bf16 v[116:119], a[168:171], a[88:91], 0
v_mfma_f32_16x16x32_bf16 v[116:119], a[172:175], a[92:95], v[116:119]
s_waitcnt lgkmcnt(0)
v_mfma_f32_16x16x32_bf16 v[120:123], a[176:179], a[64:67], 0
ds_read_b64_tr_b16 a[160:161], v11 offset:128
ds_read_b64_tr_b16 a[162:163], v11 offset:4736
v_mfma_f32_16x16x32_bf16 v[120:123], a[180:183], a[68:71], v[120:123]
ds_read_b64_tr_b16 a[164:165], v11 offset:9344
ds_read_b64_tr_b16 a[166:167], v11 offset:13952
v_mfma_f32_16x16x32_bf16 v[124:127], a[176:179], a[72:75], 0
ds_read_b64_tr_b16 a[168:169], v11 offset:18560
ds_read_b64_tr_b16 a[170:171], v11 offset:23168
v_mfma_f32_16x16x32_bf16 v[124:127], a[180:183], a[76:79], v[124:127]
ds_read_b64_tr_b16 a[172:173], v11 offset:27776
ds_read_b64_tr_b16 a[174:175], v11 offset:32384
v_mfma_f32_16x16x32_bf16 v[128:131], a[176:179], a[80:83], 0
v_mfma_f32_16x16x32_bf16 v[128:131], a[180:183], a[84:87], v[128:131]
v_mfma_f32_16x16x32_bf16 v[132:135], a[176:179], a[88:91], 0
s_add_u32 m0, s51, 0x12c00
v_mfma_f32_16x16x32_bf16 v[132:135], a[180:183], a[92:95], v[132:135]
buffer_load_dwordx4 v5, s[16:19], s47 offen lds
v_mfma_f32_16x16x32_bf16 v[136:139], a[184:187], a[64:67], 0
v_mfma_f32_16x16x32_bf16 v[136:139], a[188:191], a[68:71], v[136:139]
v_mfma_f32_16x16x32_bf16 v[140:143], a[184:187], a[72:75], 0
buffer_load_dwordx4 a[152:155], v14, s[32:35], s48 offen offset:3072 sc1
v_mfma_f32_16x16x32_bf16 v[140:143], a[188:191], a[76:79], v[140:143]
v_mfma_f32_16x16x32_bf16 v[144:147], a[184:187], a[80:83], 0
v_mfma_f32_16x16x32_bf16 v[144:147], a[188:191], a[84:87], v[144:147]
v_mfma_f32_16x16x32_bf16 v[148:151], a[184:187], a[88:91], 0
v_mfma_f32_16x16x32_bf16 v[148:151], a[188:191], a[92:95], v[148:151]
s_waitcnt lgkmcnt(0)
v_mfma_f32_16x16x32_bf16 v[152:155], a[160:163], a[64:67], 0
ds_read_b64_tr_b16 a[176:177], v11 offset:160
ds_read_b64_tr_b16 a[178:179], v11 offset:4768
v_mfma_f32_16x16x32_bf16 v[152:155], a[164:167], a[68:71], v[152:155]
ds_read_b64_tr_b16 a[180:181], v11 offset:9376
ds_read_b64_tr_b16 a[182:183], v11 offset:13984
v_mfma_f32_16x16x32_bf16 v[156:159], a[160:163], a[72:75], 0
ds_read_b64_tr_b16 a[184:185], v11 offset:18592
ds_read_b64_tr_b16 a[186:187], v11 offset:23200
v_mfma_f32_16x16x32_bf16 v[156:159], a[164:167], a[76:79], v[156:159]
ds_read_b64_tr_b16 a[188:189], v11 offset:27808
ds_read_b64_tr_b16 a[190:191], v11 offset:32416
v_mfma_f32_16x16x32_bf16 v[160:163], a[160:163], a[80:83], 0
v_mfma_f32_16x16x32_bf16 v[160:163], a[164:167], a[84:87], v[160:163]
v_mfma_f32_16x16x32_bf16 v[164:167], a[160:163], a[88:91], 0
s_add_u32 m0, s51, 0x13000
v_mfma_f32_16x16x32_bf16 v[164:167], a[164:167], a[92:95], v[164:167]
buffer_load_dwordx4 v6, s[16:19], s47 offen lds
v_mfma_f32_16x16x32_bf16 v[168:171], a[168:171], a[64:67], 0
v_mfma_f32_16x16x32_bf16 v[168:171], a[172:175], a[68:71], v[168:171]
v_mfma_f32_16x16x32_bf16 v[172:175], a[168:171], a[72:75], 0
buffer_load_dwordx4 a[132:135], v15, s[32:35], s48 offen sc1
v_mfma_f32_16x16x32_bf16 v[172:175], a[172:175], a[76:79], v[172:175]
v_mfma_f32_16x16x32_bf16 v[176:179], a[168:171], a[80:83], 0
v_mfma_f32_16x16x32_bf16 v[176:179], a[172:175], a[84:87], v[176:179]
v_mfma_f32_16x16x32_bf16 v[180:183], a[168:171], a[88:91], 0
v_mfma_f32_16x16x32_bf16 v[180:183], a[172:175], a[92:95], v[180:183]
s_waitcnt lgkmcnt(0)
v_mfma_f32_16x16x32_bf16 v[184:187], a[176:179], a[64:67], 0
ds_read_b64_tr_b16 a[160:161], v11 offset:192
ds_read_b64_tr_b16 a[162:163], v11 offset:4800
v_mfma_f32_16x16x32_bf16 v[184:187], a[180:183], a[68:71], v[184:187]
ds_read_b64_tr_b16 a[164:165], v11 offset:9408
ds_read_b64_tr_b16 a[166:167], v11 offset:14016
v_mfma_f32_16x16x32_bf16 v[188:191], a[176:179], a[72:75], 0
ds_read_b64_tr_b16 a[168:169], v11 offset:18624
ds_read_b64_tr_b16 a[170:171], v11 offset:23232
v_mfma_f32_16x16x32_bf16 v[188:191], a[180:183], a[76:79], v[188:191]
ds_read_b64_tr_b16 a[172:173], v11 offset:27840
ds_read_b64_tr_b16 a[174:175], v11 offset:32448
v_mfma_f32_16x16x32_bf16 v[192:195], a[176:179], a[80:83], 0
v_mfma_f32_16x16x32_bf16 v[192:195], a[180:183], a[84:87], v[192:195]
v_mfma_f32_16x16x32_bf16 v[196:199], a[176:179], a[88:91], 0
s_add_u32 m0, s51, 0x13400
v_mfma_f32_16x16x32_bf16 v[196:199], a[180:183], a[92:95], v[196:199]
buffer_load_dwordx4 v7, s[16:19], s47 offen lds
v_mfma_f32_16x16x32_bf16 v[200:203], a[184:187], a[64:67], 0
v_mfma_f32_16x16x32_bf16 v[200:203], a[188:191], a[68:71], v[200:203]
v_mfma_f32_16x16x32_bf16 v[204:207], a[184:187], a[72:75], 0
buffer_load_dwordx4 a[140:143], v15, s[32:35], s48 offen offset:1024 sc1
v_mfma_f32_16x16x32_bf16 v[204:207], a[188:191], a[76:79], v[204:207]
v_mfma_f32_16x16x32_bf16 v[208:211], a[184:187], a[80:83], 0
v_mfma_f32_16x16x32_bf16 v[208:211], a[188:191], a[84:87], v[208:211]
v_mfma_f32_16x16x32_bf16 v[212:215], a[184:187], a[88:91], 0
v_mfma_f32_16x16x32_bf16 v[212:215], a[188:191], a[92:95], v[212:215]
s_waitcnt lgkmcnt(0)
v_mfma_f32_16x16x32_bf16 v[216:219], a[160:163], a[64:67], 0
ds_read_b64_tr_b16 a[176:177], v11 offset:224
ds_read_b64_tr_b16 a[178:179], v11 offset:4832
v_mfma_f32_16x16x32_bf16 v[216:219], a[164:167], a[68:71], v[216:219]
ds_read_b64_tr_b16 a[180:181], v11 offset:9440
ds_read_b64_tr_b16 a[182:183], v11 offset:14048
v_mfma_f32_16x16x32_bf16 v[220:223], a[160:163], a[72:75], 0
ds_read_b64_tr_b16 a[184:185], v11 offset:18656
ds_read_b64_tr_b16 a[186:187], v11 offset:23264
v_mfma_f32_16x16x32_bf16 v[220:223], a[164:167], a[76:79], v[220:223]
ds_read_b64_tr_b16 a[188:189], v11 offset:27872
ds_read_b64_tr_b16 a[190:191], v11 offset:32480
v_mfma_f32_16x16x32_bf16 v[224:227], a[160:163], a[80:83], 0
v_mfma_f32_16x16x32_bf16 v[224:227], a[164:167], a[84:87], v[224:227]
v_mfma_f32_16x16x32_bf16 v[228:231], a[160:163], a[88:91], 0
s_add_u32 m0, s51, 0x13800
v_mfma_f32_16x16x32_bf16 v[228:231], a[164:167], a[92:95], v[228:231]
buffer_load_dwordx4 v8, s[16:19], s47 offen lds
v_mfma_f32_16x16x32_bf16 v[232:235], a[168:171], a[64:67], 0
v_mfma_f32_16x16x32_bf16 v[232:235], a[172:175], a[68:71], v[232:235]
v_mfma_f32_16x16x32_bf16 v[236:239], a[168:171], a[72:75], 0
buffer_load_dwordx4 a[148:151], v15, s[32:35], s48 offen offset:2048 sc1
v_mfma_f32_16x16x32_bf16 v[236:239], a[172:175], a[76:79], v[236:239]
v_mfma_f32_16x16x32_bf16 v[240:243], a[168:171], a[80:83], 0
v_mfma_f32_16x16x32_bf16 v[240:243], a[172:175], a[84:87], v[240:243]
v_mfma_f32_16x16x32_bf16 v[244:247], a[168:171], a[88:91], 0
v_mfma_f32_16x16x32_bf16 v[244:247], a[172:175], a[92:95], v[244:247]
s_waitcnt lgkmcnt(0)
v_mfma_f32_16x16x32_bf16 a[0:3], a[176:179], a[64:67], 0
ds_read_b64_tr_b16 a[160:161], v11 offset:256
ds_read_b64_tr_b16 a[162:163], v11 offset:4864
v_mfma_f32_16x16x32_bf16 a[0:3], a[180:183], a[68:71], a[0:3]
ds_read_b64_tr_b16 a[164:165], v11 offset:9472
ds_read_b64_tr_b16 a[166:167], v11 offset:14080
v_mfma_f32_16x16x32_bf16 a[4:7], a[176:179], a[72:75], 0
ds_read_b64_tr_b16 a[168:169], v11 offset:18688
ds_read_b64_tr_b16 a[170:171], v11 offset:23296
v_mfma_f32_16x16x32_bf16 a[4:7], a[180:183], a[76:79], a[4:7]
ds_read_b64_tr_b16 a[172:173], v11 offset:27904
ds_read_b64_tr_b16 a[174:175], v11 offset:32512
v_mfma_f32_16x16x32_bf16 a[8:11], a[176:179], a[80:83], 0
v_mfma_f32_16x16x32_bf16 a[8:11], a[180:183], a[84:87], a[8:11]
v_mfma_f32_16x16x32_bf16 a[12:15], a[176:179], a[88:91], 0
s_add_u32 m0, s51, 0x13c00
v_mfma_f32_16x16x32_bf16 a[12:15], a[180:183], a[92:95], a[12:15]
buffer_load_dwordx4 v9, s[16:19], s47 offen lds
v_mfma_f32_16x16x32_bf16 a[16:19], a[184:187], a[64:67], 0
v_mfma_f32_16x16x32_bf16 a[16:19], a[188:191], a[68:71], a[16:19]
v_mfma_f32_16x16x32_bf16 a[20:23], a[184:187], a[72:75], 0
buffer_load_dwordx4 a[156:159], v15, s[32:35], s48 offen offset:3072 sc1
s_add_u32 s48, s48, 0x40000
v_mfma_f32_16x16x32_bf16 a[20:23], a[188:191], a[76:79], a[20:23]
v_mfma_f32_16x16x32_bf16 a[24:27], a[184:187], a[80:83], 0
v_mfma_f32_16x16x32_bf16 a[24:27], a[188:191], a[84:87], a[24:27]
v_mfma_f32_16x16x32_bf16 a[28:31], a[184:187], a[88:91], 0
v_mfma_f32_16x16x32_bf16 a[28:31], a[188:191], a[92:95], a[28:31]
s_waitcnt lgkmcnt(0)
v_mfma_f32_16x16x32_bf16 a[32:35], a[160:163], a[64:67], 0
s_waitcnt vmcnt(16)
s_barrier
v_mfma_f32_16x16x32_bf16 a[32:35], a[164:167], a[68:71], a[32:35]
ds_read_b64_tr_b16 a[176:177], v12
ds_read_b64_tr_b16 a[178:179], v12 offset:4608
v_mfma_f32_16x16x32_bf16 a[36:39], a[160:163], a[72:75], 0
ds_read_b64_tr_b16 a[180:181], v12 offset:9216
ds_read_b64_tr_b16 a[182:183], v12 offset:13824
v_mfma_f32_16x16x32_bf16 a[36:39], a[164:167], a[76:79], a[36:39]
ds_read_b64_tr_b16 a[184:185], v12 offset:18432
ds_read_b64_tr_b16 a[186:187], v12 offset:23040
v_mfma_f32_16x16x32_bf16 a[40:43], a[160:163], a[80:83], 0
ds_read_b64_tr_b16 a[188:189], v12 offset:27648
ds_read_b64_tr_b16 a[190:191], v12 offset:32256
v_mfma_f32_16x16x32_bf16 a[40:43], a[164:167], a[84:87], a[40:43]
v_mfma_f32_16x16x32_bf16 a[44:47], a[160:163], a[88:91], 0
s_add_u32 m0, s51, 0x14000
v_mfma_f32_16x16x32_bf16 a[44:47], a[164:167], a[92:95], a[44:47]
buffer_load_dwordx4 v10, s[16:19], s47 offen lds
s_add_u32 s47, s47, 0x90000
v_mfma_f32_16x16x32_bf16 a[48:51], a[168:171], a[64:67], 0
v_mfma_f32_16x16x32_bf16 a[48:51], a[172:175], a[68:71], a[48:51]
v_mfma_f32_16x16x32_bf16 a[52:55], a[168:171], a[72:75], 0
v_mfma_f32_16x16x32_bf16 a[52:55], a[172:175], a[76:79], a[52:55]
v_mfma_f32_16x16x32_bf16 a[56:59], a[168:171], a[80:83], 0
v_mfma_f32_16x16x32_bf16 a[56:59], a[172:175], a[84:87], a[56:59]
v_mfma_f32_16x16x32_bf16 a[60:63], a[168:171], a[88:91], 0
v_mfma_f32_16x16x32_bf16 a[60:63], a[172:175], a[92:95], a[60:63]
s_waitcnt lgkmcnt(0)
v_mfma_f32_16x16x32_bf16 v[24:27], a[176:179], a[96:99], v[24:27]
ds_read_b64_tr_b16 a[160:161], v12 offset:32
ds_read_b64_tr_b16 a[162:163], v12 offset:4640
v_mfma_f32_16x16x32_bf16 v[24:27], a[180:183], a[100:103], v[24:27]
ds_read_b64_tr_b16 a[164:165], v12 offset:9248
ds_read_b64_tr_b16 a[166:167], v12 offset:13856
v_mfma_f32_16x16x32_bf16 v[28:31], a[176:179], a[104:107], v[28:31]
ds_read_b64_tr_b16 a[168:169], v12 offset:18464
ds_read_b64_tr_b16 a[170:171], v12 offset:23072
v_mfma_f32_16x16x32_bf16 v[28:31], a[180:183], a[108:111], v[28:31]
ds_read_b64_tr_b16 a[172:173], v12 offset:27680
ds_read_b64_tr_b16 a[174:175], v12 offset:32288
v_mfma_f32_16x16x32_bf16 v[32:35], a[176:179], a[112:115], v[32:35]
v_mfma_f32_16x16x32_bf16 v[32:35], a[180:183], a[116:119], v[32:35]
v_mfma_f32_16x16x32_bf16 v[36:39], a[176:179], a[120:123], v[36:39]
s_add_u32 m0, s51, 0
v_mfma_f32_16x16x32_bf16 v[36:39], a[180:183], a[124:127], v[36:39]
buffer_load_dwordx4 v2, s[16:19], s47 offen lds
v_mfma_f32_16x16x32_bf16 v[40:43], a[184:187], a[96:99], v[40:43]
v_mfma_f32_16x16x32_bf16 v[40:43], a[188:191], a[100:103], v[40:43]
v_mfma_f32_16x16x32_bf16 v[44:47], a[184:187], a[104:107], v[44:47]
buffer_load_dwordx4 a[64:67], v14, s[32:35], s48 offen sc1
v_mfma_f32_16x16x32_bf16 v[44:47], a[188:191], a[108:111], v[44:47]
v_mfma_f32_16x16x32_bf16 v[48:51], a[184:187], a[112:115], v[48:51]
v_mfma_f32_16x16x32_bf16 v[48:51], a[188:191], a[116:119], v[48:51]
v_mfma_f32_16x16x32_bf16 v[52:55], a[184:187], a[120:123], v[52:55]
v_mfma_f32_16x16x32_bf16 v[52:55], a[188:191], a[124:127], v[52:55]
s_waitcnt lgkmcnt(0)
v_mfma_f32_16x16x32_bf16 v[56:59], a[160:163], a[96:99], v[56:59]
ds_read_b64_tr_b16 a[176:177], v12 offset:64
ds_read_b64_tr_b16 a[178:179], v12 offset:4672
v_mfma_f32_16x16x32_bf16 v[56:59], a[164:167], a[100:103], v[56:59]
ds_read_b64_tr_b16 a[180:181], v12 offset:9280
ds_read_b64_tr_b16 a[182:183], v12 offset:13888
v_mfma_f32_16x16x32_bf16 v[60:63], a[160:163], a[104:107], v[60:63]
ds_read_b64_tr_b16 a[184:185], v12 offset:18496
ds_read_b64_tr_b16 a[186:187], v12 offset:23104
v_mfma_f32_16x16x32_bf16 v[60:63], a[164:167], a[108:111], v[60:63]
ds_read_b64_tr_b16 a[188:189], v12 offset:27712
ds_read_b64_tr_b16 a[190:191], v12 offset:32320
v_mfma_f32_16x16x32_bf16 v[64:67], a[160:163], a[112:115], v[64:67]
v_mfma_f32_16x16x32_bf16 v[64:67], a[164:167], a[116:119], v[64:67]
v_mfma_f32_16x16x32_bf16 v[68:71], a[160:163], a[120:123], v[68:71]
s_add_u32 m0, s51, 0x400
v_mfma_f32_16x16x32_bf16 v[68:71], a[164:167], a[124:127], v[68:71]
buffer_load_dwordx4 v3, s[16:19], s47 offen lds
v_mfma_f32_16x16x32_bf16 v[72:75], a[168:171], a[96:99], v[72:75]
v_mfma_f32_16x16x32_bf16 v[72:75], a[172:175], a[100:103], v[72:75]
v_mfma_f32_16x16x32_bf16 v[76:79], a[168:171], a[104:107], v[76:79]
buffer_load_dwordx4 a[72:75], v14, s[32:35], s48 offen offset:1024 sc1
v_mfma_f32_16x16x32_bf16 v[76:79], a[172:175], a[108:111], v[76:79]
v_mfma_f32_16x16x32_bf16 v[80:83], a[168:171], a[112:115], v[80:83]
v_mfma_f32_16x16x32_bf16 v[80:83], a[172:175], a[116:119], v[80:83]
v_mfma_f32_16x16x32_bf16 v[84:87], a[168:171], a[120:123], v[84:87]
v_mfma_f32_16x16x32_bf16 v[84:87], a[172:175], a[124:127], v[84:87]
s_waitcnt lgkmcnt(0)
v_mfma_f32_16x16x32_bf16 v[88:91], a[176:179], a[96:99], v[88:91]
ds_read_b64_tr_b16 a[160:161], v12 offset:96
ds_read_b64_tr_b16 a[162:163], v12 offset:4704
v_mfma_f32_16x16x32_bf16 v[88:91], a[180:183], a[100:103], v[88:91]
ds_read_b64_tr_b16 a[164:165], v12 offset:9312
ds_read_b64_tr_b16 a[166:167], v12 offset:13920
v_mfma_f32_16x16x32_bf16 v[92:95], a[176:179], a[104:107], v[92:95]
ds_read_b64_tr_b16 a[168:169], v12 offset:18528
ds_read_b64_tr_b16 a[170:171], v12 offset:23136
v_mfma_f32_16x16x32_bf16 v[92:95], a[180:183], a[108:111], v[92:95]
ds_read_b64_tr_b16 a[172:173], v12 offset:27744
ds_read_b64_tr_b16 a[174:175], v12 offset:32352
v_mfma_f32_16x16x32_bf16 v[96:99], a[176:179], a[112:115], v[96:99]
v_mfma_f32_16x16x32_bf16 v[96:99], a[180:183], a[116:119], v[96:99]
v_mfma_f32_16x16x32_bf16 v[100:103], a[176:179], a[120:123], v[100:103]
s_add_u32 m0, s51, 0x800
v_mfma_f32_16x16x32_bf16 v[100:103], a[180:183], a[124:127], v[100:103]
buffer_load_dwordx4 v4, s[16:19], s47 offen lds
v_mfma_f32_16x16x32_bf16 v[104:107], a[184:187], a[96:99], v[104:107]
v_mfma_f32_16x16x32_bf16 v[104:107], a[188:191], a[100:103], v[104:107]
v_mfma_f32_16x16x32_bf16 v[108:111], a[184:187], a[104:107], v[108:111]
buffer_load_dwordx4 a[80:83], v14, s[32:35], s48 offen offset:2048 sc1
v_mfma_f32_16x16x32_bf16 v[108:111], a[188:191], a[108:111], v[108:111]
v_mfma_f32_16x16x32_bf16 v[112:115], a[184:187], a[112:115], v[112:115]
v_mfma_f32_16x16x32_bf16 v[112:115], a[188:191], a[116:119], v[112:115]
v_mfma_f32_16x16x32_bf16 v[116:119], a[184:187], a[120:123], v[116:119]
v_mfma_f32_16x16x32_bf16 v[116:119], a[188:191], a[124:127], v[116:119]
s_waitcnt lgkmcnt(0)
v_mfma_f32_16x16x32_bf16 v[120:123], a[160:163], a[96:99], v[120:123]
ds_read_b64_tr_b16 a[176:177], v12 offset:128
ds_read_b64_tr_b16 a[178:179], v12 offset:4736
v_mfma_f32_16x16x32_bf16 v[120:123], a[164:167], a[100:103], v[120:123]
ds_read_b64_tr_b16 a[180:181], v12 offset:9344
ds_read_b64_tr_b16 a[182:183], v12 offset:13952
v_mfma_f32_16x16x32_bf16 v[124:127], a[160:163], a[104:107], v[124:127]
ds_read_b64_tr_b16 a[184:185], v12 offset:18560
ds_read_b64_tr_b16 a[186:187], v12 offset:23168
v_mfma_f32_16x16x32_bf16 v[124:127], a[164:167], a[108:111], v[124:127]
ds_read_b64_tr_b16 a[188:189], v12 offset:27776
ds_read_b64_tr_b16 a[190:191], v12 offset:32384
v_mfma_f32_16x16x32_bf16 v[128:131], a[160:163], a[112:115], v[128:131]
v_mfma_f32_16x16x32_bf16 v[128:131], a[164:167], a[116:119], v[128:131]
v_mfma_f32_16x16x32_bf16 v[132:135], a[160:163], a[120:123], v[132:135]
s_add_u32 m0, s51, 0xc00
v_mfma_f32_16x16x32_bf16 v[132:135], a[164:167], a[124:127], v[132:135]
buffer_load_dwordx4 v5, s[16:19], s47 offen lds
v_mfma_f32_16x16x32_bf16 v[136:139], a[168:171], a[96:99], v[136:139]
v_mfma_f32_16x16x32_bf16 v[136:139], a[172:175], a[100:103], v[136:139]
v_mfma_f32_16x16x32_bf16 v[140:143], a[168:171], a[104:107], v[140:143]
buffer_load_dwordx4 a[88:91], v14, s[32:35], s48 offen offset:3072 sc1
v_mfma_f32_16x16x32_bf16 v[140:143], a[172:175], a[108:111], v[140:143]
v_mfma_f32_16x16x32_bf16 v[144:147], a[168:171], a[112:115], v[144:147]
v_mfma_f32_16x16x32_bf16 v[144:147], a[172:175], a[116:119], v[144:147]
v_mfma_f32_16x16x32_bf16 v[148:151], a[168:171], a[120:123], v[148:151]
v_mfma_f32_16x16x32_bf16 v[148:151], a[172:175], a[124:127], v[148:151]
s_waitcnt lgkmcnt(0)
v_mfma_f32_16x16x32_bf16 v[152:155], a[176:179], a[96:99], v[152:155]
ds_read_b64_tr_b16 a[160:161], v12 offset:160
ds_read_b64_tr_b16 a[162:163], v12 offset:4768
v_mfma_f32_16x16x32_bf16 v[152:155], a[180:183], a[100:103], v[152:155]
ds_read_b64_tr_b16 a[164:165], v12 offset:9376
ds_read_b64_tr_b16 a[166:167], v12 offset:13984
v_mfma_f32_16x16x32_bf16 v[156:159], a[176:179], a[104:107], v[156:159]
ds_read_b64_tr_b16 a[168:169], v12 offset:18592
ds_read_b64_tr_b16 a[170:171], v12 offset:23200
v_mfma_f32_16x16x32_bf16 v[156:159], a[180:183], a[108:111], v[156:159]
ds_read_b64_tr_b16 a[172:173], v12 offset:27808
ds_read_b64_tr_b16 a[174:175], v12 offset:32416
v_mfma_f32_16x16x32_bf16 v[160:163], a[176:179], a[112:115], v[160:163]
v_mfma_f32_16x16x32_bf16 v[160:163], a[180:183], a[116:119], v[160:163]
v_mfma_f32_16x16x32_bf16 v[164:167], a[176:179], a[120:123], v[164:167]
s_add_u32 m0, s51, 0x1000
v_mfma_f32_16x16x32_bf16 v[164:167], a[180:183], a[124:127], v[164:167]
buffer_load_dwordx4 v6, s[16:19], s47 offen lds
v_mfma_f32_16x16x32_bf16 v[168:171], a[184:187], a[96:99], v[168:171]
v_mfma_f32_16x16x32_bf16 v[168:171], a[188:191], a[100:103], v[168:171]
v_mfma_f32_16x16x32_bf16 v[172:175], a[184:187], a[104:107], v[172:175]
buffer_load_dwordx4 a[68:71], v15, s[32:35], s48 offen sc1
v_mfma_f32_16x16x32_bf16 v[172:175], a[188:191], a[108:111], v[172:175]
v_mfma_f32_16x16x32_bf16 v[176:179], a[184:187], a[112:115], v[176:179]
v_mfma_f32_16x16x32_bf16 v[176:179], a[188:191], a[116:119], v[176:179]
v_mfma_f32_16x16x32_bf16 v[180:183], a[184:187], a[120:123], v[180:183]
v_mfma_f32_16x16x32_bf16 v[180:183], a[188:191], a[124:127], v[180:183]
s_waitcnt lgkmcnt(0)
v_mfma_f32_16x16x32_bf16 v[184:187], a[160:163], a[96:99], v[184:187]
ds_read_b64_tr_b16 a[176:177], v12 offset:192
ds_read_b64_tr_b16 a[178:179], v12 offset:4800
v_mfma_f32_16x16x32_bf16 v[184:187], a[164:167], a[100:103], v[184:187]
ds_read_b64_tr_b16 a[180:181], v12 offset:9408
ds_read_b64_tr_b16 a[182:183], v12 offset:14016
v_mfma_f32_16x16x32_bf16 v[188:191], a[160:163], a[104:107], v[188:191]
ds_read_b64_tr_b16 a[184:185], v12 offset:18624
ds_read_b64_tr_b16 a[186:187], v12 offset:23232
v_mfma_f32_16x16x32_bf16 v[188:191], a[164:167], a[108:111], v[188:191]
ds_read_b64_tr_b16 a[188:189], v12 offset:27840
ds_read_b64_tr_b16 a[190:191], v12 offset:32448
v_mfma_f32_16x16x32_bf16 v[192:195], a[160:163], a[112:115], v[192:195]
v_mfma_f32_16x16x32_bf16 v[192:195], a[164:167], a[116:119], v[192:195]
v_mfma_f32_16x16x32_bf16 v[196:199], a[160:163], a[120:123], v[196:199]
s_add_u32 m0, s51, 0x1400
v_mfma_f32_16x16x32_bf16 v[196:199], a[164:167], a[124:127], v[196:199]
buffer_load_dwordx4 v7, s[16:19], s47 offen lds
v_mfma_f32_16x16x32_bf16 v[200:203], a[168:171], a[96:99], v[200:203]
v_mfma_f32_16x16x32_bf16 v[200:203], a[172:175], a[100:103], v[200:203]
v_mfma_f32_16x16x32_bf16 v[204:207], a[168:171], a[104:107], v[204:207]
buffer_load_dwordx4 a[76:79], v15, s[32:35], s48 offen offset:1024 sc1
v_mfma_f32_16x16x32_bf16 v[204:207], a[172:175], a[108:111], v[204:207]
v_mfma_f32_16x16x32_bf16 v[208:211], a[168:171], a[112:115], v[208:211]
v_mfma_f32_16x16x32_bf16 v[208:211], a[172:175], a[116:119], v[208:211]
v_mfma_f32_16x16x32_bf16 v[212:215], a[168:171], a[120:123], v[212:215]
v_mfma_f32_16x16x32_bf16 v[212:215], a[172:175], a[124:127], v[212:215]
s_waitcnt lgkmcnt(0)
v_mfma_f32_16x16x32_bf16 v[216:219], a[176:179], a[96:99], v[216:219]
ds_read_b64_tr_b16 a[160:161], v12 offset:224
ds_read_b64_tr_b16 a[162:163], v12 offset:4832
v_mfma_f32_16x16x32_bf16 v[216:219], a[180:183], a[100:103], v[216:219]
ds_read_b64_tr_b16 a[164:165], v12 offset:9440
ds_read_b64_tr_b16 a[166:167], v12 offset:14048
v_mfma_f32_16x16x32_bf16 v[220:223], a[176:179], a[104:107], v[220:223]
ds_read_b64_tr_b16 a[168:169], v12 offset:18656
ds_read_b64_tr_b16 a[170:171], v12 offset:23264
v_mfma_f32_16x16x32_bf16 v[220:223], a[180:183], a[108:111], v[220:223]
ds_read_b64_tr_b16 a[172:173], v12 offset:27872
ds_read_b64_tr_b16 a[174:175], v12 offset:32480
v_mfma_f32_16x16x32_bf16 v[224:227], a[176:179], a[112:115], v[224:227]
v_mfma_f32_16x16x32_bf16 v[224:227], a[180:183], a[116:119], v[224:227]
v_mfma_f32_16x16x32_bf16 v[228:231], a[176:179], a[120:123], v[228:231]
s_add_u32 m0, s51, 0x1800
v_mfma_f32_16x16x32_bf16 v[228:231], a[180:183], a[124:127], v[228:231]
buffer_load_dwordx4 v8, s[16:19], s47 offen lds
v_mfma_f32_16x16x32_bf16 v[232:235], a[184:187], a[96:99], v[232:235]
v_mfma_f32_16x16x32_bf16 v[232:235], a[188:191], a[100:103], v[232:235]
v_mfma_f32_16x16x32_bf16 v[236:239], a[184:187], a[104:107], v[236:239]
buffer_load_dwordx4 a[84:87], v15, s[32:35], s48 offen offset:2048 sc1
v_mfma_f32_16x16x32_bf16 v[236:239], a[188:191], a[108:111], v[236:239]
v_mfma_f32_16x16x32_bf16 v[240:243], a[184:187], a[112:115], v[240:243]
v_mfma_f32_16x16x32_bf16 v[240:243], a[188:191], a[116:119], v[240:243]
v_mfma_f32_16x16x32_bf16 v[244:247], a[184:187], a[120:123], v[244:247]
v_mfma_f32_16x16x32_bf16 v[244:247], a[188:191], a[124:127], v[244:247]
s_waitcnt lgkmcnt(0)
v_mfma_f32_16x16x32_bf16 a[0:3], a[160:163], a[96:99], a[0:3]
ds_read_b64_tr_b16 a[176:177], v12 offset:256
ds_read_b64_tr_b16 a[178:179], v12 offset:4864
v_mfma_f32_16x16x32_bf16 a[0:3], a[164:167], a[100:103], a[0:3]
ds_read_b64_tr_b16 a[180:181], v12 offset:9472
ds_read_b64_tr_b16 a[182:183], v12 offset:14080
v_mfma_f32_16x16x32_bf16 a[4:7], a[160:163], a[104:107], a[4:7]
ds_read_b64_tr_b16 a[184:185], v12 offset:18688
ds_read_b64_tr_b16 a[186:187], v12 offset:23296
v_mfma_f32_16x16x32_bf16 a[4:7], a[164:167], a[108:111], a[4:7]
ds_read_b64_tr_b16 a[188:189], v12 offset:27904
ds_read_b64_tr_b16 a[190:191], v12 offset:32512
v_mfma_f32_16x16x32_bf16 a[8:11], a[160:163], a[112:115], a[8:11]
v_mfma_f32_16x16x32_bf16 a[8:11], a[164:167], a[116:119], a[8:11]
v_mfma_f32_16x16x32_bf16 a[12:15], a[160:163], a[120:123], a[12:15]
s_add_u32 m0, s51, 0x1c00
v_mfma_f32_16x16x32_bf16 a[12:15], a[164:167], a[124:127], a[12:15]
buffer_load_dwordx4 v9, s[16:19], s47 offen lds
v_mfma_f32_16x16x32_bf16 a[16:19], a[168:171], a[96:99], a[16:19]
v_mfma_f32_16x16x32_bf16 a[16:19], a[172:175], a[100:103], a[16:19]
v_mfma_f32_16x16x32_bf16 a[20:23], a[168:171], a[104:107], a[20:23]
buffer_load_dwordx4 a[92:95], v15, s[32:35], s48 offen offset:3072 sc1
s_add_u32 s48, s48, 0x40000
v_mfma_f32_16x16x32_bf16 a[20:23], a[172:175], a[108:111], a[20:23]
v_mfma_f32_16x16x32_bf16 a[24:27], a[168:171], a[112:115], a[24:27]
v_mfma_f32_16x16x32_bf16 a[24:27], a[172:175], a[116:119], a[24:27]
v_mfma_f32_16x16x32_bf16 a[28:31], a[168:171], a[120:123], a[28:31]
v_mfma_f32_16x16x32_bf16 a[28:31], a[172:175], a[124:127], a[28:31]
s_waitcnt lgkmcnt(0)
v_mfma_f32_16x16x32_bf16 a[32:35], a[176:179], a[96:99], a[32:35]
s_waitcnt vmcnt(16)
s_barrier
v_mfma_f32_16x16x32_bf16 a[32:35], a[180:183], a[100:103], a[32:35]
ds_read_b64_tr_b16 a[160:161], v13
ds_read_b64_tr_b16 a[162:163], v13 offset:4608
v_mfma_f32_16x16x32_bf16 a[36:39], a[176:179], a[104:107], a[36:39]
ds_read_b64_tr_b16 a[164:165], v13 offset:9216
ds_read_b64_tr_b16 a[166:167], v13 offset:13824
v_mfma_f32_16x16x32_bf16 a[36:39], a[180:183], a[108:111], a[36:39]
ds_read_b64_tr_b16 a[168:169], v13 offset:18432
ds_read_b64_tr_b16 a[170:171], v13 offset:23040
v_mfma_f32_16x16x32_bf16 a[40:43], a[176:179], a[112:115], a[40:43]
ds_read_b64_tr_b16 a[172:173], v13 offset:27648
ds_read_b64_tr_b16 a[174:175], v13 offset:32256
v_mfma_f32_16x16x32_bf16 a[40:43], a[180:183], a[116:119], a[40:43]
v_mfma_f32_16x16x32_bf16 a[44:47], a[176:179], a[120:123], a[44:47]
s_add_u32 m0, s51, 0x2000
v_mfma_f32_16x16x32_bf16 a[44:47], a[180:183], a[124:127], a[44:47]
buffer_load_dwordx4 v10, s[16:19], s47 offen lds
s_add_u32 s47, s47, 0x90000
v_mfma_f32_16x16x32_bf16 a[48:51], a[184:187], a[96:99], a[48:51]
v_mfma_f32_16x16x32_bf16 a[48:51], a[188:191], a[100:103], a[48:51]
v_mfma_f32_16x16x32_bf16 a[52:55], a[184:187], a[104:107], a[52:55]
v_mfma_f32_16x16x32_bf16 a[52:55], a[188:191], a[108:111], a[52:55]
v_mfma_f32_16x16x32_bf16 a[56:59], a[184:187], a[112:115], a[56:59]
v_mfma_f32_16x16x32_bf16 a[56:59], a[188:191], a[116:119], a[56:59]
v_mfma_f32_16x16x32_bf16 a[60:63], a[184:187], a[120:123], a[60:63]
v_mfma_f32_16x16x32_bf16 a[60:63], a[188:191], a[124:127], a[60:63]
s_waitcnt lgkmcnt(0)
v_mfma_f32_16x16x32_bf16 v[24:27], a[160:163], a[128:131], v[24:27]
ds_read_b64_tr_b16 a[176:177], v13 offset:32
ds_read_b64_tr_b16 a[178:179], v13 offset:4640
v_mfma_f32_16x16x32_bf16 v[24:27], a[164:167], a[132:135], v[24:27]
ds_read_b64_tr_b16 a[180:181], v13 offset:9248
ds_read_b64_tr_b16 a[182:183], v13 offset:13856
v_mfma_f32_16x16x32_bf16 v[28:31], a[160:163], a[136:139], v[28:31]
ds_read_b64_tr_b16 a[184:185], v13 offset:18464
ds_read_b64_tr_b16 a[186:187], v13 offset:23072
v_mfma_f32_16x16x32_bf16 v[28:31], a[164:167], a[140:143], v[28:31]
ds_read_b64_tr_b16 a[188:189], v13 offset:27680
ds_read_b64_tr_b16 a[190:191], v13 offset:32288
v_mfma_f32_16x16x32_bf16 v[32:35], a[160:163], a[144:147], v[32:35]
v_mfma_f32_16x16x32_bf16 v[32:35], a[164:167], a[148:151], v[32:35]
v_mfma_f32_16x16x32_bf16 v[36:39], a[160:163], a[152:155], v[36:39]
s_add_u32 m0, s51, 0x9000
v_mfma_f32_16x16x32_bf16 v[36:39], a[164:167], a[156:159], v[36:39]
buffer_load_dwordx4 v2, s[16:19], s47 offen lds
v_mfma_f32_16x16x32_bf16 v[40:43], a[168:171], a[128:131], v[40:43]
v_mfma_f32_16x16x32_bf16 v[40:43], a[172:175], a[132:135], v[40:43]
v_mfma_f32_16x16x32_bf16 v[44:47], a[168:171], a[136:139], v[44:47]
buffer_load_dwordx4 a[96:99], v14, s[32:35], s48 offen sc1
v_mfma_f32_16x16x32_bf16 v[44:47], a[172:175], a[140:143], v[44:47]
v_mfma_f32_16x16x32_bf16 v[48:51], a[168:171], a[144:147], v[48:51]
v_mfma_f32_16x16x32_bf16 v[48:51], a[172:175], a[148:151], v[48:51]
v_mfma_f32_16x16x32_bf16 v[52:55], a[168:171], a[152:155], v[52:55]
v_mfma_f32_16x16x32_bf16 v[52:55], a[172:175], a[156:159], v[52:55]
s_waitcnt lgkmcnt(0)
v_mfma_f32_16x16x32_bf16 v[56:59], a[176:179], a[128:131], v[56:59]
ds_read_b64_tr_b16 a[160:161], v13 offset:64
ds_read_b64_tr_b16 a[162:163], v13 offset:4672
v_mfma_f32_16x16x32_bf16 v[56:59], a[180:183], a[132:135], v[56:59]
ds_read_b64_tr_b16 a[164:165], v13 offset:9280
ds_read_b64_tr_b16 a[166:167], v13 offset:13888
v_mfma_f32_16x16x32_bf16 v[60:63], a[176:179], a[136:139], v[60:63]
ds_read_b64_tr_b16 a[168:169], v13 offset:18496
ds_read_b64_tr_b16 a[170:171], v13 offset:23104
v_mfma_f32_16x16x32_bf16 v[60:63], a[180:183], a[140:143], v[60:63]
ds_read_b64_tr_b16 a[172:173], v13 offset:27712
ds_read_b64_tr_b16 a[174:175], v13 offset:32320
v_mfma_f32_16x16x32_bf16 v[64:67], a[176:179], a[144:147], v[64:67]
v_mfma_f32_16x16x32_bf16 v[64:67], a[180:183], a[148:151], v[64:67]
v_mfma_f32_16x16x32_bf16 v[68:71], a[176:179], a[152:155], v[68:71]
s_add_u32 m0, s51, 0x9400
v_mfma_f32_16x16x32_bf16 v[68:71], a[180:183], a[156:159], v[68:71]
buffer_load_dwordx4 v3, s[16:19], s47 offen lds
v_mfma_f32_16x16x32_bf16 v[72:75], a[184:187], a[128:131], v[72:75]
v_mfma_f32_16x16x32_bf16 v[72:75], a[188:191], a[132:135], v[72:75]
v_mfma_f32_16x16x32_bf16 v[76:79], a[184:187], a[136:139], v[76:79]
buffer_load_dwordx4 a[104:107], v14, s[32:35], s48 offen offset:1024 sc1
v_mfma_f32_16x16x32_bf16 v[76:79], a[188:191], a[140:143], v[76:79]
v_mfma_f32_16x16x32_bf16 v[80:83], a[184:187], a[144:147], v[80:83]
v_mfma_f32_16x16x32_bf16 v[80:83], a[188:191], a[148:151], v[80:83]
v_mfma_f32_16x16x32_bf16 v[84:87], a[184:187], a[152:155], v[84:87]
v_mfma_f32_16x16x32_bf16 v[84:87], a[188:191], a[156:159], v[84:87]
s_waitcnt lgkmcnt(0)
v_mfma_f32_16x16x32_bf16 v[88:91], a[160:163], a[128:131], v[88:91]
ds_read_b64_tr_b16 a[176:177], v13 offset:96
ds_read_b64_tr_b16 a[178:179], v13 offset:4704
v_mfma_f32_16x16x32_bf16 v[88:91], a[164:167], a[132:135], v[88:91]
ds_read_b64_tr_b16 a[180:181], v13 offset:9312
ds_read_b64_tr_b16 a[182:183], v13 offset:13920
v_mfma_f32_16x16x32_bf16 v[92:95], a[160:163], a[136:139], v[92:95]
ds_read_b64_tr_b16 a[184:185], v13 offset:18528
ds_read_b64_tr_b16 a[186:187], v13 offset:23136
v_mfma_f32_16x16x32_bf16 v[92:95], a[164:167], a[140:143], v[92:95]
ds_read_b64_tr_b16 a[188:189], v13 offset:27744
ds_read_b64_tr_b16 a[190:191], v13 offset:32352
v_mfma_f32_16x16x32_bf16 v[96:99], a[160:163], a[144:147], v[96:99]
v_mfma_f32_16x16x32_bf16 v[96:99], a[164:167], a[148:151], v[96:99]
v_mfma_f32_16x16x32_bf16 v[100:103], a[160:163], a[152:155], v[100:103]
s_add_u32 m0, s51, 0x9800
v_mfma_f32_16x16x32_bf16 v[100:103], a[164:167], a[156:159], v[100:103]
buffer_load_dwordx4 v4, s[16:19], s47 offen lds
v_mfma_f32_16x16x32_bf16 v[104:107], a[168:171], a[128:131], v[104:107]
v_mfma_f32_16x16x32_bf16 v[104:107], a[172:175], a[132:135], v[104:107]
v_mfma_f32_16x16x32_bf16 v[108:111], a[168:171], a[136:139], v[108:111]
buffer_load_dwordx4 a[112:115], v14, s[32:35], s48 offen offset:2048 sc1
v_mfma_f32_16x16x32_bf16 v[108:111], a[172:175], a[140:143], v[108:111]
v_mfma_f32_16x16x32_bf16 v[112:115], a[168:171], a[144:147], v[112:115]
v_mfma_f32_16x16x32_bf16 v[112:115], a[172:175], a[148:151], v[112:115]
v_mfma_f32_16x16x32_bf16 v[116:119], a[168:171], a[152:155], v[116:119]
v_mfma_f32_16x16x32_bf16 v[116:119], a[172:175], a[156:159], v[116:119]
s_waitcnt lgkmcnt(0)
v_mfma_f32_16x16x32_bf16 v[120:123], a[176:179], a[128:131], v[120:123]
ds_read_b64_tr_b16 a[160:161], v13 offset:128
ds_read_b64_tr_b16 a[162:163], v13 offset:4736
v_mfma_f32_16x16x32_bf16 v[120:123], a[180:183], a[132:135], v[120:123]
ds_read_b64_tr_b16 a[164:165], v13 offset:9344
ds_read_b64_tr_b16 a[166:167], v13 offset:13952
v_mfma_f32_16x16x32_bf16 v[124:127], a[176:179], a[136:139], v[124:127]
ds_read_b64_tr_b16 a[168:169], v13 offset:18560
ds_read_b64_tr_b16 a[170:171], v13 offset:23168
v_mfma_f32_16x16x32_bf16 v[124:127], a[180:183], a[140:143], v[124:127]
ds_read_b64_tr_b16 a[172:173], v13 offset:27776
ds_read_b64_tr_b16 a[174:175], v13 offset:32384
v_mfma_f32_16x16x32_bf16 v[128:131], a[176:179], a[144:147], v[128:131]
v_mfma_f32_16x16x32_bf16 v[128:131], a[180:183], a[148:151], v[128:131]
v_mfma_f32_16x16x32_bf16 v[132:135], a[176:179], a[152:155], v[132:135]
s_add_u32 m0, s51, 0x9c00
v_mfma_f32_16x16x32_bf16 v[132:135], a[180:183], a[156:159], v[132:135]
buffer_load_dwordx4 v5, s[16:19], s47 offen lds
v_mfma_f32_16x16x32_bf16 v[136:139], a[184:187], a[128:131], v[136:139]
v_mfma_f32_16x16x32_bf16 v[136:139], a[188:191], a[132:135], v[136:139]
v_mfma_f32_16x16x32_bf16 v[140:143], a[184:187], a[136:139], v[140:143]
buffer_load_dwordx4 a[120:123], v14, s[32:35], s48 offen offset:3072 sc1
v_mfma_f32_16x16x32_bf16 v[140:143], a[188:191], a[140:143], v[140:143]
v_mfma_f32_16x16x32_bf16 v[144:147], a[184:187], a[144:147], v[144:147]
v_mfma_f32_16x16x32_bf16 v[144:147], a[188:191], a[148:151], v[144:147]
v_mfma_f32_16x16x32_bf16 v[148:151], a[184:187], a[152:155], v[148:151]
v_mfma_f32_16x16x32_bf16 v[148:151], a[188:191], a[156:159], v[148:151]
s_waitcnt lgkmcnt(0)
v_mfma_f32_16x16x32_bf16 v[152:155], a[160:163], a[128:131], v[152:155]
ds_read_b64_tr_b16 a[176:177], v13 offset:160
ds_read_b64_tr_b16 a[178:179], v13 offset:4768
v_mfma_f32_16x16x32_bf16 v[152:155], a[164:167], a[132:135], v[152:155]
ds_read_b64_tr_b16 a[180:181], v13 offset:9376
ds_read_b64_tr_b16 a[182:183], v13 offset:13984
v_mfma_f32_16x16x32_bf16 v[156:159], a[160:163], a[136:139], v[156:159]
ds_read_b64_tr_b16 a[184:185], v13 offset:18592
ds_read_b64_tr_b16 a[186:187], v13 offset:23200
v_mfma_f32_16x16x32_bf16 v[156:159], a[164:167], a[140:143], v[156:159]
ds_read_b64_tr_b16 a[188:189], v13 offset:27808
ds_read_b64_tr_b16 a[190:191], v13 offset:32416
v_mfma_f32_16x16x32_bf16 v[160:163], a[160:163], a[144:147], v[160:163]
v_mfma_f32_16x16x32_bf16 v[160:163], a[164:167], a[148:151], v[160:163]
v_mfma_f32_16x16x32_bf16 v[164:167], a[160:163], a[152:155], v[164:167]
s_add_u32 m0, s51, 0xa000
v_mfma_f32_16x16x32_bf16 v[164:167], a[164:167], a[156:159], v[164:167]
buffer_load_dwordx4 v6, s[16:19], s47 offen lds
v_mfma_f32_16x16x32_bf16 v[168:171], a[168:171], a[128:131], v[168:171]
v_mfma_f32_16x16x32_bf16 v[168:171], a[172:175], a[132:135], v[168:171]
v_mfma_f32_16x16x32_bf16 v[172:175], a[168:171], a[136:139], v[172:175]
buffer_load_dwordx4 a[100:103], v15, s[32:35], s48 offen sc1
v_mfma_f32_16x16x32_bf16 v[172:175], a[172:175], a[140:143], v[172:175]
v_mfma_f32_16x16x32_bf16 v[176:179], a[168:171], a[144:147], v[176:179]
v_mfma_f32_16x16x32_bf16 v[176:179], a[172:175], a[148:151], v[176:179]
v_mfma_f32_16x16x32_bf16 v[180:183], a[168:171], a[152:155], v[180:183]
v_mfma_f32_16x16x32_bf16 v[180:183], a[172:175], a[156:159], v[180:183]
s_waitcnt lgkmcnt(0)
v_mfma_f32_16x16x32_bf16 v[184:187], a[176:179], a[128:131], v[184:187]
ds_read_b64_tr_b16 a[160:161], v13 offset:192
ds_read_b64_tr_b16 a[162:163], v13 offset:4800
v_mfma_f32_16x16x32_bf16 v[184:187], a[180:183], a[132:135], v[184:187]
ds_read_b64_tr_b16 a[164:165], v13 offset:9408
ds_read_b64_tr_b16 a[166:167], v13 offset:14016
v_mfma_f32_16x16x32_bf16 v[188:191], a[176:179], a[136:139], v[188:191]
ds_read_b64_tr_b16 a[168:169], v13 offset:18624
ds_read_b64_tr_b16 a[170:171], v13 offset:23232
v_mfma_f32_16x16x32_bf16 v[188:191], a[180:183], a[140:143], v[188:191]
ds_read_b64_tr_b16 a[172:173], v13 offset:27840
ds_read_b64_tr_b16 a[174:175], v13 offset:32448
v_mfma_f32_16x16x32_bf16 v[192:195], a[176:179], a[144:147], v[192:195]
v_mfma_f32_16x16x32_bf16 v[192:195], a[180:183], a[148:151], v[192:195]
v_mfma_f32_16x16x32_bf16 v[196:199], a[176:179], a[152:155], v[196:199]
s_add_u32 m0, s51, 0xa400
v_mfma_f32_16x16x32_bf16 v[196:199], a[180:183], a[156:159], v[196:199]
buffer_load_dwordx4 v7, s[16:19], s47 offen lds
v_mfma_f32_16x16x32_bf16 v[200:203], a[184:187], a[128:131], v[200:203]
v_mfma_f32_16x16x32_bf16 v[200:203], a[188:191], a[132:135], v[200:203]
v_mfma_f32_16x16x32_bf16 v[204:207], a[184:187], a[136:139], v[204:207]
buffer_load_dwordx4 a[108:111], v15, s[32:35], s48 offen offset:1024 sc1
v_mfma_f32_16x16x32_bf16 v[204:207], a[188:191], a[140:143], v[204:207]
v_mfma_f32_16x16x32_bf16 v[208:211], a[184:187], a[144:147], v[208:211]
v_mfma_f32_16x16x32_bf16 v[208:211], a[188:191], a[148:151], v[208:211]
v_mfma_f32_16x16x32_bf16 v[212:215], a[184:187], a[152:155], v[212:215]
v_mfma_f32_16x16x32_bf16 v[212:215], a[188:191], a[156:159], v[212:215]
s_waitcnt lgkmcnt(0)
v_mfma_f32_16x16x32_bf16 v[216:219], a[160:163], a[128:131], v[216:219]
ds_read_b64_tr_b16 a[176:177], v13 offset:224
ds_read_b64_tr_b16 a[178:179], v13 offset:4832
v_mfma_f32_16x16x32_bf16 v[216:219], a[164:167], a[132:135], v[216:219]
ds_read_b64_tr_b16 a[180:181], v13 offset:9440
ds_read_b64_tr_b16 a[182:183], v13 offset:14048
v_mfma_f32_16x16x32_bf16 v[220:223], a[160:163], a[136:139], v[220:223]
ds_read_b64_tr_b16 a[184:185], v13 offset:18656
ds_read_b64_tr_b16 a[186:187], v13 offset:23264
v_mfma_f32_16x16x32_bf16 v[220:223], a[164:167], a[140:143], v[220:223]
ds_read_b64_tr_b16 a[188:189], v13 offset:27872
ds_read_b64_tr_b16 a[190:191], v13 offset:32480
v_mfma_f32_16x16x32_bf16 v[224:227], a[160:163], a[144:147], v[224:227]
v_mfma_f32_16x16x32_bf16 v[224:227], a[164:167], a[148:151], v[224:227]
v_mfma_f32_16x16x32_bf16 v[228:231], a[160:163], a[152:155], v[228:231]
s_add_u32 m0, s51, 0xa800
v_mfma_f32_16x16x32_bf16 v[228:231], a[164:167], a[156:159], v[228:231]
buffer_load_dwordx4 v8, s[16:19], s47 offen lds
v_mfma_f32_16x16x32_bf16 v[232:235], a[168:171], a[128:131], v[232:235]
v_mfma_f32_16x16x32_bf16 v[232:235], a[172:175], a[132:135], v[232:235]
v_mfma_f32_16x16x32_bf16 v[236:239], a[168:171], a[136:139], v[236:239]
buffer_load_dwordx4 a[116:119], v15, s[32:35], s48 offen offset:2048 sc1
v_mfma_f32_16x16x32_bf16 v[236:239], a[172:175], a[140:143], v[236:239]
v_mfma_f32_16x16x32_bf16 v[240:243], a[168:171], a[144:147], v[240:243]
v_mfma_f32_16x16x32_bf16 v[240:243], a[172:175], a[148:151], v[240:243]
v_mfma_f32_16x16x32_bf16 v[244:247], a[168:171], a[152:155], v[244:247]
v_mfma_f32_16x16x32_bf16 v[244:247], a[172:175], a[156:159], v[244:247]
s_waitcnt lgkmcnt(0)
v_mfma_f32_16x16x32_bf16 a[0:3], a[176:179], a[128:131], a[0:3]
ds_read_b64_tr_b16 a[160:161], v13 offset:256
ds_read_b64_tr_b16 a[162:163], v13 offset:4864
v_mfma_f32_16x16x32_bf16 a[0:3], a[180:183], a[132:135], a[0:3]
ds_read_b64_tr_b16 a[164:165], v13 offset:9472
ds_read_b64_tr_b16 a[166:167], v13 offset:14080
v_mfma_f32_16x16x32_bf16 a[4:7], a[176:179], a[136:139], a[4:7]
ds_read_b64_tr_b16 a[168:169], v13 offset:18688
ds_read_b64_tr_b16 a[170:171], v13 offset:23296
v_mfma_f32_16x16x32_bf16 a[4:7], a[180:183], a[140:143], a[4:7]
ds_read_b64_tr_b16 a[172:173], v13 offset:27904
ds_read_b64_tr_b16 a[174:175], v13 offset:32512
v_mfma_f32_16x16x32_bf16 a[8:11], a[176:179], a[144:147], a[8:11]
v_mfma_f32_16x16x32_bf16 a[8:11], a[180:183], a[148:151], a[8:11]
v_mfma_f32_16x16x32_bf16 a[12:15], a[176:179], a[152:155], a[12:15]
s_add_u32 m0, s51, 0xac00
v_mfma_f32_16x16x32_bf16 a[12:15], a[180:183], a[156:159], a[12:15]
buffer_load_dwordx4 v9, s[16:19], s47 offen lds
v_mfma_f32_16x16x32_bf16 a[16:19], a[184:187], a[128:131], a[16:19]
v_mfma_f32_16x16x32_bf16 a[16:19], a[188:191], a[132:135], a[16:19]
v_mfma_f32_16x16x32_bf16 a[20:23], a[184:187], a[136:139], a[20:23]
buffer_load_dwordx4 a[124:127], v15, s[32:35], s48 offen offset:3072 sc1
s_add_u32 s48, s48, 0x40000
v_mfma_f32_16x16x32_bf16 a[20:23], a[188:191], a[140:143], a[20:23]
v_mfma_f32_16x16x32_bf16 a[24:27], a[184:187], a[144:147], a[24:27]
v_mfma_f32_16x16x32_bf16 a[24:27], a[188:191], a[148:151], a[24:27]
v_mfma_f32_16x16x32_bf16 a[28:31], a[184:187], a[152:155], a[28:31]
v_mfma_f32_16x16x32_bf16 a[28:31], a[188:191], a[156:159], a[28:31]
s_waitcnt lgkmcnt(0)
v_mfma_f32_16x16x32_bf16 a[32:35], a[160:163], a[128:131], a[32:35]
s_waitcnt vmcnt(16)
s_barrier
v_mfma_f32_16x16x32_bf16 a[32:35], a[164:167], a[132:135], a[32:35]
ds_read_b64_tr_b16 a[176:177], v11
ds_read_b64_tr_b16 a[178:179], v11 offset:4608
v_mfma_f32_16x16x32_bf16 a[36:39], a[160:163], a[136:139], a[36:39]
ds_read_b64_tr_b16 a[180:181], v11 offset:9216
ds_read_b64_tr_b16 a[182:183], v11 offset:13824
v_mfma_f32_16x16x32_bf16 a[36:39], a[164:167], a[140:143], a[36:39]
ds_read_b64_tr_b16 a[184:185], v11 offset:18432
ds_read_b64_tr_b16 a[186:187], v11 offset:23040
v_mfma_f32_16x16x32_bf16 a[40:43], a[160:163], a[144:147], a[40:43]
ds_read_b64_tr_b16 a[188:189], v11 offset:27648
ds_read_b64_tr_b16 a[190:191], v11 offset:32256
v_mfma_f32_16x16x32_bf16 a[40:43], a[164:167], a[148:151], a[40:43]
v_mfma_f32_16x16x32_bf16 a[44:47], a[160:163], a[152:155], a[44:47]
s_add_u32 m0, s51, 0xb000
v_mfma_f32_16x16x32_bf16 a[44:47], a[164:167], a[156:159], a[44:47]
buffer_load_dwordx4 v10, s[16:19], s47 offen lds
s_add_u32 s47, s47, 0x90000
v_mfma_f32_16x16x32_bf16 a[48:51], a[168:171], a[128:131], a[48:51]
v_mfma_f32_16x16x32_bf16 a[48:51], a[172:175], a[132:135], a[48:51]
v_mfma_f32_16x16x32_bf16 a[52:55], a[168:171], a[136:139], a[52:55]
v_mfma_f32_16x16x32_bf16 a[52:55], a[172:175], a[140:143], a[52:55]
v_mfma_f32_16x16x32_bf16 a[56:59], a[168:171], a[144:147], a[56:59]
v_mfma_f32_16x16x32_bf16 a[56:59], a[172:175], a[148:151], a[56:59]
v_mfma_f32_16x16x32_bf16 a[60:63], a[168:171], a[152:155], a[60:63]
v_mfma_f32_16x16x32_bf16 a[60:63], a[172:175], a[156:159], a[60:63]
s_waitcnt lgkmcnt(0)
v_mfma_f32_16x16x32_bf16 v[24:27], a[176:179], a[64:67], v[24:27]
ds_read_b64_tr_b16 a[160:161], v11 offset:32
ds_read_b64_tr_b16 a[162:163], v11 offset:4640
v_mfma_f32_16x16x32_bf16 v[24:27], a[180:183], a[68:71], v[24:27]
ds_read_b64_tr_b16 a[164:165], v11 offset:9248
ds_read_b64_tr_b16 a[166:167], v11 offset:13856
v_mfma_f32_16x16x32_bf16 v[28:31], a[176:179], a[72:75], v[28:31]
ds_read_b64_tr_b16 a[168:169], v11 offset:18464
ds_read_b64_tr_b16 a[170:171], v11 offset:23072
v_mfma_f32_16x16x32_bf16 v[28:31], a[180:183], a[76:79], v[28:31]
ds_read_b64_tr_b16 a[172:173], v11 offset:27680
ds_read_b64_tr_b16 a[174:175], v11 offset:32288
v_mfma_f32_16x16x32_bf16 v[32:35], a[176:179], a[80:83], v[32:35]
v_mfma_f32_16x16x32_bf16 v[32:35], a[180:183], a[84:87], v[32:35]
v_mfma_f32_16x16x32_bf16 v[36:39], a[176:179], a[88:91], v[36:39]
s_add_u32 m0, s51, 0x12000
v_mfma_f32_16x16x32_bf16 v[36:39], a[180:183], a[92:95], v[36:39]
buffer_load_dwordx4 v2, s[16:19], s47 offen lds
v_mfma_f32_16x16x32_bf16 v[40:43], a[184:187], a[64:67], v[40:43]
v_mfma_f32_16x16x32_bf16 v[40:43], a[188:191], a[68:71], v[40:43]
v_mfma_f32_16x16x32_bf16 v[44:47], a[184:187], a[72:75], v[44:47]
buffer_load_dwordx4 a[128:131], v14, s[32:35], s48 offen sc1
v_mfma_f32_16x16x32_bf16 v[44:47], a[188:191], a[76:79], v[44:47]
v_mfma_f32_16x16x32_bf16 v[48:51], a[184:187], a[80:83], v[48:51]
v_mfma_f32_16x16x32_bf16 v[48:51], a[188:191], a[84:87], v[48:51]
v_mfma_f32_16x16x32_bf16 v[52:55], a[184:187], a[88:91], v[52:55]
v_mfma_f32_16x16x32_bf16 v[52:55], a[188:191], a[92:95], v[52:55]
s_waitcnt lgkmcnt(0)
v_mfma_f32_16x16x32_bf16 v[56:59], a[160:163], a[64:67], v[56:59]
ds_read_b64_tr_b16 a[176:177], v11 offset:64
ds_read_b64_tr_b16 a[178:179], v11 offset:4672
v_mfma_f32_16x16x32_bf16 v[56:59], a[164:167], a[68:71], v[56:59]
ds_read_b64_tr_b16 a[180:181], v11 offset:9280
ds_read_b64_tr_b16 a[182:183], v11 offset:13888
v_mfma_f32_16x16x32_bf16 v[60:63], a[160:163], a[72:75], v[60:63]
ds_read_b64_tr_b16 a[184:185], v11 offset:18496
ds_read_b64_tr_b16 a[186:187], v11 offset:23104
v_mfma_f32_16x16x32_bf16 v[60:63], a[164:167], a[76:79], v[60:63]
ds_read_b64_tr_b16 a[188:189], v11 offset:27712
ds_read_b64_tr_b16 a[190:191], v11 offset:32320
v_mfma_f32_16x16x32_bf16 v[64:67], a[160:163], a[80:83], v[64:67]
v_mfma_f32_16x16x32_bf16 v[64:67], a[164:167], a[84:87], v[64:67]
v_mfma_f32_16x16x32_bf16 v[68:71], a[160:163], a[88:91], v[68:71]
s_add_u32 m0, s51, 0x12400
v_mfma_f32_16x16x32_bf16 v[68:71], a[164:167], a[92:95], v[68:71]
buffer_load_dwordx4 v3, s[16:19], s47 offen lds
v_mfma_f32_16x16x32_bf16 v[72:75], a[168:171], a[64:67], v[72:75]
v_mfma_f32_16x16x32_bf16 v[72:75], a[172:175], a[68:71], v[72:75]
v_mfma_f32_16x16x32_bf16 v[76:79], a[168:171], a[72:75], v[76:79]
buffer_load_dwordx4 a[136:139], v14, s[32:35], s48 offen offset:1024 sc1
v_mfma_f32_16x16x32_bf16 v[76:79], a[172:175], a[76:79], v[76:79]
v_mfma_f32_16x16x32_bf16 v[80:83], a[168:171], a[80:83], v[80:83]
v_mfma_f32_16x16x32_bf16 v[80:83], a[172:175], a[84:87], v[80:83]
v_mfma_f32_16x16x32_bf16 v[84:87], a[168:171], a[88:91], v[84:87]
v_mfma_f32_16x16x32_bf16 v[84:87], a[172:175], a[92:95], v[84:87]
s_waitcnt lgkmcnt(0)
v_mfma_f32_16x16x32_bf16 v[88:91], a[176:179], a[64:67], v[88:91]
ds_read_b64_tr_b16 a[160:161], v11 offset:96
ds_read_b64_tr_b16 a[162:163], v11 offset:4704
v_mfma_f32_16x16x32_bf16 v[88:91], a[180:183], a[68:71], v[88:91]
ds_read_b64_tr_b16 a[164:165], v11 offset:9312
ds_read_b64_tr_b16 a[166:167], v11 offset:13920
v_mfma_f32_16x16x32_bf16 v[92:95], a[176:179], a[72:75], v[92:95]
ds_read_b64_tr_b16 a[168:169], v11 offset:18528
ds_read_b64_tr_b16 a[170:171], v11 offset:23136
v_mfma_f32_16x16x32_bf16 v[92:95], a[180:183], a[76:79], v[92:95]
ds_read_b64_tr_b16 a[172:173], v11 offset:27744
ds_read_b64_tr_b16 a[174:175], v11 offset:32352
v_mfma_f32_16x16x32_bf16 v[96:99], a[176:179], a[80:83], v[96:99]
v_mfma_f32_16x16x32_bf16 v[96:99], a[180:183], a[84:87], v[96:99]
v_mfma_f32_16x16x32_bf16 v[100:103], a[176:179], a[88:91], v[100:103]
s_add_u32 m0, s51, 0x12800
v_mfma_f32_16x16x32_bf16 v[100:103], a[180:183], a[92:95], v[100:103]
buffer_load_dwordx4 v4, s[16:19], s47 offen lds
v_mfma_f32_16x16x32_bf16 v[104:107], a[184:187], a[64:67], v[104:107]
v_mfma_f32_16x16x32_bf16 v[104:107], a[188:191], a[68:71], v[104:107]
v_mfma_f32_16x16x32_bf16 v[108:111], a[184:187], a[72:75], v[108:111]
buffer_load_dwordx4 a[144:147], v14, s[32:35], s48 offen offset:2048 sc1
v_mfma_f32_16x16x32_bf16 v[108:111], a[188:191], a[76:79], v[108:111]
v_mfma_f32_16x16x32_bf16 v[112:115], a[184:187], a[80:83], v[112:115]
v_mfma_f32_16x16x32_bf16 v[112:115], a[188:191], a[84:87], v[112:115]
v_mfma_f32_16x16x32_bf16 v[116:119], a[184:187], a[88:91], v[116:119]
v_mfma_f32_16x16x32_bf16 v[116:119], a[188:191], a[92:95], v[116:119]
s_waitcnt lgkmcnt(0)
v_mfma_f32_16x16x32_bf16 v[120:123], a[160:163], a[64:67], v[120:123]
ds_read_b64_tr_b16 a[176:177], v11 offset:128
ds_read_b64_tr_b16 a[178:179], v11 offset:4736
v_mfma_f32_16x16x32_bf16 v[120:123], a[164:167], a[68:71], v[120:123]
ds_read_b64_tr_b16 a[180:181], v11 offset:9344
ds_read_b64_tr_b16 a[182:183], v11 offset:13952
v_mfma_f32_16x16x32_bf16 v[124:127], a[160:163], a[72:75], v[124:127]
ds_read_b64_tr_b16 a[184:185], v11 offset:18560
ds_read_b64_tr_b16 a[186:187], v11 offset:23168
v_mfma_f32_16x16x32_bf16 v[124:127], a[164:167], a[76:79], v[124:127]
ds_read_b64_tr_b16 a[188:189], v11 offset:27776
ds_read_b64_tr_b16 a[190:191], v11 offset:32384
v_mfma_f32_16x16x32_bf16 v[128:131], a[160:163], a[80:83], v[128:131]
v_mfma_f32_16x16x32_bf16 v[128:131], a[164:167], a[84:87], v[128:131]
v_mfma_f32_16x16x32_bf16 v[132:135], a[160:163], a[88:91], v[132:135]
s_add_u32 m0, s51, 0x12c00
v_mfma_f32_16x16x32_bf16 v[132:135], a[164:167], a[92:95], v[132:135]
buffer_load_dwordx4 v5, s[16:19], s47 offen lds
v_mfma_f32_16x16x32_bf16 v[136:139], a[168:171], a[64:67], v[136:139]
v_mfma_f32_16x16x32_bf16 v[136:139], a[172:175], a[68:71], v[136:139]
v_mfma_f32_16x16x32_bf16 v[140:143], a[168:171], a[72:75], v[140:143]
buffer_load_dwordx4 a[152:155], v14, s[32:35], s48 offen offset:3072 sc1
v_mfma_f32_16x16x32_bf16 v[140:143], a[172:175], a[76:79], v[140:143]
v_mfma_f32_16x16x32_bf16 v[144:147], a[168:171], a[80:83], v[144:147]
v_mfma_f32_16x16x32_bf16 v[144:147], a[172:175], a[84:87], v[144:147]
v_mfma_f32_16x16x32_bf16 v[148:151], a[168:171], a[88:91], v[148:151]
v_mfma_f32_16x16x32_bf16 v[148:151], a[172:175], a[92:95], v[148:151]
s_waitcnt lgkmcnt(0)
v_mfma_f32_16x16x32_bf16 v[152:155], a[176:179], a[64:67], v[152:155]
ds_read_b64_tr_b16 a[160:161], v11 offset:160
ds_read_b64_tr_b16 a[162:163], v11 offset:4768
v_mfma_f32_16x16x32_bf16 v[152:155], a[180:183], a[68:71], v[152:155]
ds_read_b64_tr_b16 a[164:165], v11 offset:9376
ds_read_b64_tr_b16 a[166:167], v11 offset:13984
v_mfma_f32_16x16x32_bf16 v[156:159], a[176:179], a[72:75], v[156:159]
ds_read_b64_tr_b16 a[168:169], v11 offset:18592
ds_read_b64_tr_b16 a[170:171], v11 offset:23200
v_mfma_f32_16x16x32_bf16 v[156:159], a[180:183], a[76:79], v[156:159]
ds_read_b64_tr_b16 a[172:173], v11 offset:27808
ds_read_b64_tr_b16 a[174:175], v11 offset:32416
v_mfma_f32_16x16x32_bf16 v[160:163], a[176:179], a[80:83], v[160:163]
v_mfma_f32_16x16x32_bf16 v[160:163], a[180:183], a[84:87], v[160:163]
v_mfma_f32_16x16x32_bf16 v[164:167], a[176:179], a[88:91], v[164:167]
s_add_u32 m0, s51, 0x13000
v_mfma_f32_16x16x32_bf16 v[164:167], a[180:183], a[92:95], v[164:167]
buffer_load_dwordx4 v6, s[16:19], s47 offen lds
v_mfma_f32_16x16x32_bf16 v[168:171], a[184:187], a[64:67], v[168:171]
v_mfma_f32_16x16x32_bf16 v[168:171], a[188:191], a[68:71], v[168:171]
v_mfma_f32_16x16x32_bf16 v[172:175], a[184:187], a[72:75], v[172:175]
buffer_load_dwordx4 a[132:135], v15, s[32:35], s48 offen sc1
v_mfma_f32_16x16x32_bf16 v[172:175], a[188:191], a[76:79], v[172:175]
v_mfma_f32_16x16x32_bf16 v[176:179], a[184:187], a[80:83], v[176:179]
v_mfma_f32_16x16x32_bf16 v[176:179], a[188:191], a[84:87], v[176:179]
v_mfma_f32_16x16x32_bf16 v[180:183], a[184:187], a[88:91], v[180:183]
v_mfma_f32_16x16x32_bf16 v[180:183], a[188:191], a[92:95], v[180:183]
s_waitcnt lgkmcnt(0)
v_mfma_f32_16x16x32_bf16 v[184:187], a[160:163], a[64:67], v[184:187]
ds_read_b64_tr_b16 a[176:177], v11 offset:192
ds_read_b64_tr_b16 a[178:179], v11 offset:4800
v_mfma_f32_16x16x32_bf16 v[184:187], a[164:167], a[68:71], v[184:187]
ds_read_b64_tr_b16 a[180:181], v11 offset:9408
ds_read_b64_tr_b16 a[182:183], v11 offset:14016
v_mfma_f32_16x16x32_bf16 v[188:191], a[160:163], a[72:75], v[188:191]
ds_read_b64_tr_b16 a[184:185], v11 offset:18624
ds_read_b64_tr_b16 a[186:187], v11 offset:23232
v_mfma_f32_16x16x32_bf16 v[188:191], a[164:167], a[76:79], v[188:191]
ds_read_b64_tr_b16 a[188:189], v11 offset:27840
ds_read_b64_tr_b16 a[190:191], v11 offset:32448
v_mfma_f32_16x16x32_bf16 v[192:195], a[160:163], a[80:83], v[192:195]
v_mfma_f32_16x16x32_bf16 v[192:195], a[164:167], a[84:87], v[192:195]
v_mfma_f32_16x16x32_bf16 v[196:199], a[160:163], a[88:91], v[196:199]
s_add_u32 m0, s51, 0x13400
v_mfma_f32_16x16x32_bf16 v[196:199], a[164:167], a[92:95], v[196:199]
buffer_load_dwordx4 v7, s[16:19], s47 offen lds
v_mfma_f32_16x16x32_bf16 v[200:203], a[168:171], a[64:67], v[200:203]
v_mfma_f32_16x16x32_bf16 v[200:203], a[172:175], a[68:71], v[200:203]
v_mfma_f32_16x16x32_bf16 v[204:207], a[168:171], a[72:75], v[204:207]
buffer_load_dwordx4 a[140:143], v15, s[32:35], s48 offen offset:1024 sc1
v_mfma_f32_16x16x32_bf16 v[204:207], a[172:175], a[76:79], v[204:207]
v_mfma_f32_16x16x32_bf16 v[208:211], a[168:171], a[80:83], v[208:211]
v_mfma_f32_16x16x32_bf16 v[208:211], a[172:175], a[84:87], v[208:211]
v_mfma_f32_16x16x32_bf16 v[212:215], a[168:171], a[88:91], v[212:215]
v_mfma_f32_16x16x32_bf16 v[212:215], a[172:175], a[92:95], v[212:215]
s_waitcnt lgkmcnt(0)
v_mfma_f32_16x16x32_bf16 v[216:219], a[176:179], a[64:67], v[216:219]
ds_read_b64_tr_b16 a[160:161], v11 offset:224
ds_read_b64_tr_b16 a[162:163], v11 offset:4832
v_mfma_f32_16x16x32_bf16 v[216:219], a[180:183], a[68:71], v[216:219]
ds_read_b64_tr_b16 a[164:165], v11 offset:9440
ds_read_b64_tr_b16 a[166:167], v11 offset:14048
v_mfma_f32_16x16x32_bf16 v[220:223], a[176:179], a[72:75], v[220:223]
ds_read_b64_tr_b16 a[168:169], v11 offset:18656
ds_read_b64_tr_b16 a[170:171], v11 offset:23264
v_mfma_f32_16x16x32_bf16 v[220:223], a[180:183], a[76:79], v[220:223]
ds_read_b64_tr_b16 a[172:173], v11 offset:27872
ds_read_b64_tr_b16 a[174:175], v11 offset:32480
v_mfma_f32_16x16x32_bf16 v[224:227], a[176:179], a[80:83], v[224:227]
v_mfma_f32_16x16x32_bf16 v[224:227], a[180:183], a[84:87], v[224:227]
v_mfma_f32_16x16x32_bf16 v[228:231], a[176:179], a[88:91], v[228:231]
s_add_u32 m0, s51, 0x13800
v_mfma_f32_16x16x32_bf16 v[228:231], a[180:183], a[92:95], v[228:231]
buffer_load_dwordx4 v8, s[16:19], s47 offen lds
v_mfma_f32_16x16x32_bf16 v[232:235], a[184:187], a[64:67], v[232:235]
v_mfma_f32_16x16x32_bf16 v[232:235], a[188:191], a[68:71], v[232:235]
v_mfma_f32_16x16x32_bf16 v[236:239], a[184:187], a[72:75], v[236:239]
buffer_load_dwordx4 a[148:151], v15, s[32:35], s48 offen offset:2048 sc1
v_mfma_f32_16x16x32_bf16 v[236:239], a[188:191], a[76:79], v[236:239]
v_mfma_f32_16x16x32_bf16 v[240:243], a[184:187], a[80:83], v[240:243]
v_mfma_f32_16x16x32_bf16 v[240:243], a[188:191], a[84:87], v[240:243]
v_mfma_f32_16x16x32_bf16 v[244:247], a[184:187], a[88:91], v[244:247]
v_mfma_f32_16x16x32_bf16 v[244:247], a[188:191], a[92:95], v[244:247]
s_waitcnt lgkmcnt(0)
v_mfma_f32_16x16x32_bf16 a[0:3], a[160:163], a[64:67], a[0:3]
ds_read_b64_tr_b16 a[176:177], v11 offset:256
ds_read_b64_tr_b16 a[178:179], v11 offset:4864
v_mfma_f32_16x16x32_bf16 a[0:3], a[164:167], a[68:71], a[0:3]
ds_read_b64_tr_b16 a[180:181], v11 offset:9472
ds_read_b64_tr_b16 a[182:183], v11 offset:14080
v_mfma_f32_16x16x32_bf16 a[4:7], a[160:163], a[72:75], a[4:7]
ds_read_b64_tr_b16 a[184:185], v11 offset:18688
ds_read_b64_tr_b16 a[186:187], v11 offset:23296
v_mfma_f32_16x16x32_bf16 a[4:7], a[164:167], a[76:79], a[4:7]
ds_read_b64_tr_b16 a[188:189], v11 offset:27904
ds_read_b64_tr_b16 a[190:191], v11 offset:32512
v_mfma_f32_16x16x32_bf16 a[8:11], a[160:163], a[80:83], a[8:11]
v_mfma_f32_16x16x32_bf16 a[8:11], a[164:167], a[84:87], a[8:11]
v_mfma_f32_16x16x32_bf16 a[12:15], a[160:163], a[88:91], a[12:15]
s_add_u32 m0, s51, 0x13c00
v_mfma_f32_16x16x32_bf16 a[12:15], a[164:167], a[92:95], a[12:15]
buffer_load_dwordx4 v9, s[16:19], s47 offen lds
v_mfma_f32_16x16x32_bf16 a[16:19], a[168:171], a[64:67], a[16:19]
v_mfma_f32_16x16x32_bf16 a[16:19], a[172:175], a[68:71], a[16:19]
v_mfma_f32_16x16x32_bf16 a[20:23], a[168:171], a[72:75], a[20:23]
buffer_load_dwordx4 a[156:159], v15, s[32:35], s48 offen offset:3072 sc1
s_add_u32 s48, s48, 0x40000
v_mfma_f32_16x16x32_bf16 a[20:23], a[172:175], a[76:79], a[20:23]
v_mfma_f32_16x16x32_bf16 a[24:27], a[168:171], a[80:83], a[24:27]
v_mfma_f32_16x16x32_bf16 a[24:27], a[172:175], a[84:87], a[24:27]
v_mfma_f32_16x16x32_bf16 a[28:31], a[168:171], a[88:91], a[28:31]
v_mfma_f32_16x16x32_bf16 a[28:31], a[172:175], a[92:95], a[28:31]
s_waitcnt lgkmcnt(0)
v_mfma_f32_16x16x32_bf16 a[32:35], a[176:179], a[64:67], a[32:35]
s_waitcnt vmcnt(16)
s_barrier
v_mfma_f32_16x16x32_bf16 a[32:35], a[180:183], a[68:71], a[32:35]
ds_read_b64_tr_b16 a[160:161], v12
ds_read_b64_tr_b16 a[162:163], v12 offset:4608
v_mfma_f32_16x16x32_bf16 a[36:39], a[176:179], a[72:75], a[36:39]
ds_read_b64_tr_b16 a[164:165], v12 offset:9216
ds_read_b64_tr_b16 a[166:167], v12 offset:13824
v_mfma_f32_16x16x32_bf16 a[36:39], a[180:183], a[76:79], a[36:39]
ds_read_b64_tr_b16 a[168:169], v12 offset:18432
ds_read_b64_tr_b16 a[170:171], v12 offset:23040
v_mfma_f32_16x16x32_bf16 a[40:43], a[176:179], a[80:83], a[40:43]
ds_read_b64_tr_b16 a[172:173], v12 offset:27648
ds_read_b64_tr_b16 a[174:175], v12 offset:32256
v_mfma_f32_16x16x32_bf16 a[40:43], a[180:183], a[84:87], a[40:43]
v_mfma_f32_16x16x32_bf16 a[44:47], a[176:179], a[88:91], a[44:47]
s_add_u32 m0, s51, 0x14000
v_mfma_f32_16x16x32_bf16 a[44:47], a[180:183], a[92:95], a[44:47]
buffer_load_dwordx4 v10, s[16:19], s47 offen lds
s_add_u32 s47, s47, 0x90000
v_mfma_f32_16x16x32_bf16 a[48:51], a[184:187], a[64:67], a[48:51]
v_mfma_f32_16x16x32_bf16 a[48:51], a[188:191], a[68:71], a[48:51]
v_mfma_f32_16x16x32_bf16 a[52:55], a[184:187], a[72:75], a[52:55]
v_mfma_f32_16x16x32_bf16 a[52:55], a[188:191], a[76:79], a[52:55]
v_mfma_f32_16x16x32_bf16 a[56:59], a[184:187], a[80:83], a[56:59]
v_mfma_f32_16x16x32_bf16 a[56:59], a[188:191], a[84:87], a[56:59]
v_mfma_f32_16x16x32_bf16 a[60:63], a[184:187], a[88:91], a[60:63]
v_mfma_f32_16x16x32_bf16 a[60:63], a[188:191], a[92:95], a[60:63]
s_waitcnt lgkmcnt(0)
v_mfma_f32_16x16x32_bf16 v[24:27], a[160:163], a[96:99], v[24:27]
ds_read_b64_tr_b16 a[176:177], v12 offset:32
ds_read_b64_tr_b16 a[178:179], v12 offset:4640
v_mfma_f32_16x16x32_bf16 v[24:27], a[164:167], a[100:103], v[24:27]
ds_read_b64_tr_b16 a[180:181], v12 offset:9248
ds_read_b64_tr_b16 a[182:183], v12 offset:13856
v_mfma_f32_16x16x32_bf16 v[28:31], a[160:163], a[104:107], v[28:31]
ds_read_b64_tr_b16 a[184:185], v12 offset:18464
ds_read_b64_tr_b16 a[186:187], v12 offset:23072
v_mfma_f32_16x16x32_bf16 v[28:31], a[164:167], a[108:111], v[28:31]
ds_read_b64_tr_b16 a[188:189], v12 offset:27680
ds_read_b64_tr_b16 a[190:191], v12 offset:32288
v_mfma_f32_16x16x32_bf16 v[32:35], a[160:163], a[112:115], v[32:35]
v_mfma_f32_16x16x32_bf16 v[32:35], a[164:167], a[116:119], v[32:35]
v_mfma_f32_16x16x32_bf16 v[36:39], a[160:163], a[120:123], v[36:39]
s_add_u32 m0, s51, 0
v_mfma_f32_16x16x32_bf16 v[36:39], a[164:167], a[124:127], v[36:39]
buffer_load_dwordx4 v2, s[16:19], s47 offen lds
v_mfma_f32_16x16x32_bf16 v[40:43], a[168:171], a[96:99], v[40:43]
v_mfma_f32_16x16x32_bf16 v[40:43], a[172:175], a[100:103], v[40:43]
v_mfma_f32_16x16x32_bf16 v[44:47], a[168:171], a[104:107], v[44:47]
buffer_load_dwordx4 a[64:67], v14, s[32:35], s48 offen sc1
v_mfma_f32_16x16x32_bf16 v[44:47], a[172:175], a[108:111], v[44:47]
v_mfma_f32_16x16x32_bf16 v[48:51], a[168:171], a[112:115], v[48:51]
v_mfma_f32_16x16x32_bf16 v[48:51], a[172:175], a[116:119], v[48:51]
v_mfma_f32_16x16x32_bf16 v[52:55], a[168:171], a[120:123], v[52:55]
v_mfma_f32_16x16x32_bf16 v[52:55], a[172:175], a[124:127], v[52:55]
s_waitcnt lgkmcnt(0)
v_mfma_f32_16x16x32_bf16 v[56:59], a[176:179], a[96:99], v[56:59]
ds_read_b64_tr_b16 a[160:161], v12 offset:64
ds_read_b64_tr_b16 a[162:163], v12 offset:4672
v_mfma_f32_16x16x32_bf16 v[56:59], a[180:183], a[100:103], v[56:59]
ds_read_b64_tr_b16 a[164:165], v12 offset:9280
ds_read_b64_tr_b16 a[166:167], v12 offset:13888
v_mfma_f32_16x16x32_bf16 v[60:63], a[176:179], a[104:107], v[60:63]
ds_read_b64_tr_b16 a[168:169], v12 offset:18496
ds_read_b64_tr_b16 a[170:171], v12 offset:23104
v_mfma_f32_16x16x32_bf16 v[60:63], a[180:183], a[108:111], v[60:63]
ds_read_b64_tr_b16 a[172:173], v12 offset:27712
ds_read_b64_tr_b16 a[174:175], v12 offset:32320
v_mfma_f32_16x16x32_bf16 v[64:67], a[176:179], a[112:115], v[64:67]
v_mfma_f32_16x16x32_bf16 v[64:67], a[180:183], a[116:119], v[64:67]
v_mfma_f32_16x16x32_bf16 v[68:71], a[176:179], a[120:123], v[68:71]
s_add_u32 m0, s51, 0x400
v_mfma_f32_16x16x32_bf16 v[68:71], a[180:183], a[124:127], v[68:71]
buffer_load_dwordx4 v3, s[16:19], s47 offen lds
v_mfma_f32_16x16x32_bf16 v[72:75], a[184:187], a[96:99], v[72:75]
v_mfma_f32_16x16x32_bf16 v[72:75], a[188:191], a[100:103], v[72:75]
v_mfma_f32_16x16x32_bf16 v[76:79], a[184:187], a[104:107], v[76:79]
buffer_load_dwordx4 a[72:75], v14, s[32:35], s48 offen offset:1024 sc1
v_mfma_f32_16x16x32_bf16 v[76:79], a[188:191], a[108:111], v[76:79]
v_mfma_f32_16x16x32_bf16 v[80:83], a[184:187], a[112:115], v[80:83]
v_mfma_f32_16x16x32_bf16 v[80:83], a[188:191], a[116:119], v[80:83]
v_mfma_f32_16x16x32_bf16 v[84:87], a[184:187], a[120:123], v[84:87]
v_mfma_f32_16x16x32_bf16 v[84:87], a[188:191], a[124:127], v[84:87]
s_waitcnt lgkmcnt(0)
v_mfma_f32_16x16x32_bf16 v[88:91], a[160:163], a[96:99], v[88:91]
ds_read_b64_tr_b16 a[176:177], v12 offset:96
ds_read_b64_tr_b16 a[178:179], v12 offset:4704
v_mfma_f32_16x16x32_bf16 v[88:91], a[164:167], a[100:103], v[88:91]
ds_read_b64_tr_b16 a[180:181], v12 offset:9312
ds_read_b64_tr_b16 a[182:183], v12 offset:13920
v_mfma_f32_16x16x32_bf16 v[92:95], a[160:163], a[104:107], v[92:95]
ds_read_b64_tr_b16 a[184:185], v12 offset:18528
ds_read_b64_tr_b16 a[186:187], v12 offset:23136
v_mfma_f32_16x16x32_bf16 v[92:95], a[164:167], a[108:111], v[92:95]
ds_read_b64_tr_b16 a[188:189], v12 offset:27744
ds_read_b64_tr_b16 a[190:191], v12 offset:32352
v_mfma_f32_16x16x32_bf16 v[96:99], a[160:163], a[112:115], v[96:99]
v_mfma_f32_16x16x32_bf16 v[96:99], a[164:167], a[116:119], v[96:99]
v_mfma_f32_16x16x32_bf16 v[100:103], a[160:163], a[120:123], v[100:103]
s_add_u32 m0, s51, 0x800
v_mfma_f32_16x16x32_bf16 v[100:103], a[164:167], a[124:127], v[100:103]
buffer_load_dwordx4 v4, s[16:19], s47 offen lds
v_mfma_f32_16x16x32_bf16 v[104:107], a[168:171], a[96:99], v[104:107]
v_mfma_f32_16x16x32_bf16 v[104:107], a[172:175], a[100:103], v[104:107]
v_mfma_f32_16x16x32_bf16 v[108:111], a[168:171], a[104:107], v[108:111]
buffer_load_dwordx4 a[80:83], v14, s[32:35], s48 offen offset:2048 sc1
v_mfma_f32_16x16x32_bf16 v[108:111], a[172:175], a[108:111], v[108:111]
v_mfma_f32_16x16x32_bf16 v[112:115], a[168:171], a[112:115], v[112:115]
v_mfma_f32_16x16x32_bf16 v[112:115], a[172:175], a[116:119], v[112:115]
v_mfma_f32_16x16x32_bf16 v[116:119], a[168:171], a[120:123], v[116:119]
v_mfma_f32_16x16x32_bf16 v[116:119], a[172:175], a[124:127], v[116:119]
s_waitcnt lgkmcnt(0)
v_mfma_f32_16x16x32_bf16 v[120:123], a[176:179], a[96:99], v[120:123]
ds_read_b64_tr_b16 a[160:161], v12 offset:128
ds_read_b64_tr_b16 a[162:163], v12 offset:4736
v_mfma_f32_16x16x32_bf16 v[120:123], a[180:183], a[100:103], v[120:123]
ds_read_b64_tr_b16 a[164:165], v12 offset:9344
ds_read_b64_tr_b16 a[166:167], v12 offset:13952
v_mfma_f32_16x16x32_bf16 v[124:127], a[176:179], a[104:107], v[124:127]
ds_read_b64_tr_b16 a[168:169], v12 offset:18560
ds_read_b64_tr_b16 a[170:171], v12 offset:23168
v_mfma_f32_16x16x32_bf16 v[124:127], a[180:183], a[108:111], v[124:127]
ds_read_b64_tr_b16 a[172:173], v12 offset:27776
ds_read_b64_tr_b16 a[174:175], v12 offset:32384
v_mfma_f32_16x16x32_bf16 v[128:131], a[176:179], a[112:115], v[128:131]
v_mfma_f32_16x16x32_bf16 v[128:131], a[180:183], a[116:119], v[128:131]
v_mfma_f32_16x16x32_bf16 v[132:135], a[176:179], a[120:123], v[132:135]
s_add_u32 m0, s51, 0xc00
v_mfma_f32_16x16x32_bf16 v[132:135], a[180:183], a[124:127], v[132:135]
buffer_load_dwordx4 v5, s[16:19], s47 offen lds
v_mfma_f32_16x16x32_bf16 v[136:139], a[184:187], a[96:99], v[136:139]
v_mfma_f32_16x16x32_bf16 v[136:139], a[188:191], a[100:103], v[136:139]
v_mfma_f32_16x16x32_bf16 v[140:143], a[184:187], a[104:107], v[140:143]
buffer_load_dwordx4 a[88:91], v14, s[32:35], s48 offen offset:3072 sc1
v_mfma_f32_16x16x32_bf16 v[140:143], a[188:191], a[108:111], v[140:143]
v_mfma_f32_16x16x32_bf16 v[144:147], a[184:187], a[112:115], v[144:147]
v_mfma_f32_16x16x32_bf16 v[144:147], a[188:191], a[116:119], v[144:147]
v_mfma_f32_16x16x32_bf16 v[148:151], a[184:187], a[120:123], v[148:151]
v_mfma_f32_16x16x32_bf16 v[148:151], a[188:191], a[124:127], v[148:151]
s_waitcnt lgkmcnt(0)
v_mfma_f32_16x16x32_bf16 v[152:155], a[160:163], a[96:99], v[152:155]
ds_read_b64_tr_b16 a[176:177], v12 offset:160
ds_read_b64_tr_b16 a[178:179], v12 offset:4768
v_mfma_f32_16x16x32_bf16 v[152:155], a[164:167], a[100:103], v[152:155]
ds_read_b64_tr_b16 a[180:181], v12 offset:9376
ds_read_b64_tr_b16 a[182:183], v12 offset:13984
v_mfma_f32_16x16x32_bf16 v[156:159], a[160:163], a[104:107], v[156:159]
ds_read_b64_tr_b16 a[184:185], v12 offset:18592
ds_read_b64_tr_b16 a[186:187], v12 offset:23200
v_mfma_f32_16x16x32_bf16 v[156:159], a[164:167], a[108:111], v[156:159]
ds_read_b64_tr_b16 a[188:189], v12 offset:27808
ds_read_b64_tr_b16 a[190:191], v12 offset:32416
v_mfma_f32_16x16x32_bf16 v[160:163], a[160:163], a[112:115], v[160:163]
v_mfma_f32_16x16x32_bf16 v[160:163], a[164:167], a[116:119], v[160:163]
v_mfma_f32_16x16x32_bf16 v[164:167], a[160:163], a[120:123], v[164:167]
s_add_u32 m0, s51, 0x1000
v_mfma_f32_16x16x32_bf16 v[164:167], a[164:167], a[124:127], v[164:167]
buffer_load_dwordx4 v6, s[16:19], s47 offen lds
v_mfma_f32_16x16x32_bf16 v[168:171], a[168:171], a[96:99], v[168:171]
v_mfma_f32_16x16x32_bf16 v[168:171], a[172:175], a[100:103], v[168:171]
v_mfma_f32_16x16x32_bf16 v[172:175], a[168:171], a[104:107], v[172:175]
buffer_load_dwordx4 a[68:71], v15, s[32:35], s48 offen sc1
v_mfma_f32_16x16x32_bf16 v[172:175], a[172:175], a[108:111], v[172:175]
v_mfma_f32_16x16x32_bf16 v[176:179], a[168:171], a[112:115], v[176:179]
v_mfma_f32_16x16x32_bf16 v[176:179], a[172:175], a[116:119], v[176:179]
v_mfma_f32_16x16x32_bf16 v[180:183], a[168:171], a[120:123], v[180:183]
v_mfma_f32_16x16x32_bf16 v[180:183], a[172:175], a[124:127], v[180:183]
s_waitcnt lgkmcnt(0)
v_mfma_f32_16x16x32_bf16 v[184:187], a[176:179], a[96:99], v[184:187]
ds_read_b64_tr_b16 a[160:161], v12 offset:192
ds_read_b64_tr_b16 a[162:163], v12 offset:4800
v_mfma_f32_16x16x32_bf16 v[184:187], a[180:183], a[100:103], v[184:187]
ds_read_b64_tr_b16 a[164:165], v12 offset:9408
ds_read_b64_tr_b16 a[166:167], v12 offset:14016
v_mfma_f32_16x16x32_bf16 v[188:191], a[176:179], a[104:107], v[188:191]
ds_read_b64_tr_b16 a[168:169], v12 offset:18624
ds_read_b64_tr_b16 a[170:171], v12 offset:23232
v_mfma_f32_16x16x32_bf16 v[188:191], a[180:183], a[108:111], v[188:191]
ds_read_b64_tr_b16 a[172:173], v12 offset:27840
ds_read_b64_tr_b16 a[174:175], v12 offset:32448
v_mfma_f32_16x16x32_bf16 v[192:195], a[176:179], a[112:115], v[192:195]
v_mfma_f32_16x16x32_bf16 v[192:195], a[180:183], a[116:119], v[192:195]
v_mfma_f32_16x16x32_bf16 v[196:199], a[176:179], a[120:123], v[196:199]
s_add_u32 m0, s51, 0x1400
v_mfma_f32_16x16x32_bf16 v[196:199], a[180:183], a[124:127], v[196:199]
buffer_load_dwordx4 v7, s[16:19], s47 offen lds
v_mfma_f32_16x16x32_bf16 v[200:203], a[184:187], a[96:99], v[200:203]
v_mfma_f32_16x16x32_bf16 v[200:203], a[188:191], a[100:103], v[200:203]
v_mfma_f32_16x16x32_bf16 v[204:207], a[184:187], a[104:107], v[204:207]
buffer_load_dwordx4 a[76:79], v15, s[32:35], s48 offen offset:1024 sc1
v_mfma_f32_16x16x32_bf16 v[204:207], a[188:191], a[108:111], v[204:207]
v_mfma_f32_16x16x32_bf16 v[208:211], a[184:187], a[112:115], v[208:211]
v_mfma_f32_16x16x32_bf16 v[208:211], a[188:191], a[116:119], v[208:211]
v_mfma_f32_16x16x32_bf16 v[212:215], a[184:187], a[120:123], v[212:215]
v_mfma_f32_16x16x32_bf16 v[212:215], a[188:191], a[124:127], v[212:215]
s_waitcnt lgkmcnt(0)
v_mfma_f32_16x16x32_bf16 v[216:219], a[160:163], a[96:99], v[216:219]
ds_read_b64_tr_b16 a[176:177], v12 offset:224
ds_read_b64_tr_b16 a[178:179], v12 offset:4832
v_mfma_f32_16x16x32_bf16 v[216:219], a[164:167], a[100:103], v[216:219]
ds_read_b64_tr_b16 a[180:181], v12 offset:9440
ds_read_b64_tr_b16 a[182:183], v12 offset:14048
v_mfma_f32_16x16x32_bf16 v[220:223], a[160:163], a[104:107], v[220:223]
ds_read_b64_tr_b16 a[184:185], v12 offset:18656
ds_read_b64_tr_b16 a[186:187], v12 offset:23264
v_mfma_f32_16x16x32_bf16 v[220:223], a[164:167], a[108:111], v[220:223]
ds_read_b64_tr_b16 a[188:189], v12 offset:27872
ds_read_b64_tr_b16 a[190:191], v12 offset:32480
v_mfma_f32_16x16x32_bf16 v[224:227], a[160:163], a[112:115], v[224:227]
v_mfma_f32_16x16x32_bf16 v[224:227], a[164:167], a[116:119], v[224:227]
v_mfma_f32_16x16x32_bf16 v[228:231], a[160:163], a[120:123], v[228:231]
s_add_u32 m0, s51, 0x1800
v_mfma_f32_16x16x32_bf16 v[228:231], a[164:167], a[124:127], v[228:231]
buffer_load_dwordx4 v8, s[16:19], s47 offen lds
v_mfma_f32_16x16x32_bf16 v[232:235], a[168:171], a[96:99], v[232:235]
v_mfma_f32_16x16x32_bf16 v[232:235], a[172:175], a[100:103], v[232:235]
v_mfma_f32_16x16x32_bf16 v[236:239], a[168:171], a[104:107], v[236:239]
buffer_load_dwordx4 a[84:87], v15, s[32:35], s48 offen offset:2048 sc1
v_mfma_f32_16x16x32_bf16 v[236:239], a[172:175], a[108:111], v[236:239]
v_mfma_f32_16x16x32_bf16 v[240:243], a[168:171], a[112:115], v[240:243]
v_mfma_f32_16x16x32_bf16 v[240:243], a[172:175], a[116:119], v[240:243]
v_mfma_f32_16x16x32_bf16 v[244:247], a[168:171], a[120:123], v[244:247]
v_mfma_f32_16x16x32_bf16 v[244:247], a[172:175], a[124:127], v[244:247]
s_waitcnt lgkmcnt(0)
v_mfma_f32_16x16x32_bf16 a[0:3], a[176:179], a[96:99], a[0:3]
ds_read_b64_tr_b16 a[160:161], v12 offset:256
ds_read_b64_tr_b16 a[162:163], v12 offset:4864
v_mfma_f32_16x16x32_bf16 a[0:3], a[180:183], a[100:103], a[0:3]
ds_read_b64_tr_b16 a[164:165], v12 offset:9472
ds_read_b64_tr_b16 a[166:167], v12 offset:14080
v_mfma_f32_16x16x32_bf16 a[4:7], a[176:179], a[104:107], a[4:7]
ds_read_b64_tr_b16 a[168:169], v12 offset:18688
ds_read_b64_tr_b16 a[170:171], v12 offset:23296
v_mfma_f32_16x16x32_bf16 a[4:7], a[180:183], a[108:111], a[4:7]
ds_read_b64_tr_b16 a[172:173], v12 offset:27904
ds_read_b64_tr_b16 a[174:175], v12 offset:32512
v_mfma_f32_16x16x32_bf16 a[8:11], a[176:179], a[112:115], a[8:11]
v_mfma_f32_16x16x32_bf16 a[8:11], a[180:183], a[116:119], a[8:11]
v_lshrrev_b32 v249, 1, v1
v_min_u32 v249, 17, v249
v_mfma_f32_16x16x32_bf16 a[12:15], a[176:179], a[120:123], a[12:15]
s_add_u32 m0, s51, 0x1c00
v_add_u32 v249, 0, v249
v_min_u32 v249, 17, v249
v_mfma_f32_16x16x32_bf16 a[12:15], a[180:183], a[124:127], a[12:15]
buffer_load_dwordx4 v9, s[16:19], s47 offen lds
v_mfma_f32_16x16x32_bf16 a[16:19], a[184:187], a[96:99], a[16:19]
v_lshlrev_b32 v249, 13, v249
v_and_b32 v250, 1, v1
v_mfma_f32_16x16x32_bf16 a[16:19], a[188:191], a[100:103], a[16:19]
v_lshl_add_u32 v249, v250, 7, v249
s_mul_i32 s55, s46, 0x48
v_mfma_f32_16x16x32_bf16 a[20:23], a[184:187], a[104:107], a[20:23]
buffer_load_dwordx4 a[92:95], v15, s[32:35], s48 offen offset:3072 sc1
s_add_u32 s48, s48, 0x40000
s_mul_i32 s56, s44, 18
s_add_u32 s55, s55, s56
v_mfma_f32_16x16x32_bf16 a[20:23], a[188:191], a[108:111], a[20:23]
s_lshl_b32 s55, s55, 13
s_lshl_b32 s56, s45, 8
v_mfma_f32_16x16x32_bf16 a[24:27], a[184:187], a[112:115], a[24:27]
s_add_u32 s61, s55, s56
v_mfma_f32_16x16x32_bf16 a[24:27], a[188:191], a[116:119], a[24:27]
v_mfma_f32_16x16x32_bf16 a[28:31], a[184:187], a[120:123], a[28:31]
v_mfma_f32_16x16x32_bf16 a[28:31], a[188:191], a[124:127], a[28:31]
s_waitcnt lgkmcnt(0)
v_mfma_f32_16x16x32_bf16 a[32:35], a[160:163], a[96:99], a[32:35]
s_waitcnt vmcnt(16)
s_barrier
v_mfma_f32_16x16x32_bf16 a[32:35], a[164:167], a[100:103], a[32:35]
ds_read_b64_tr_b16 a[176:177], v13
ds_read_b64_tr_b16 a[178:179], v13 offset:4608
v_mfma_f32_16x16x32_bf16 a[36:39], a[160:163], a[104:107], a[36:39]
ds_read_b64_tr_b16 a[180:181], v13 offset:9216
ds_read_b64_tr_b16 a[182:183], v13 offset:13824
v_mfma_f32_16x16x32_bf16 a[36:39], a[164:167], a[108:111], a[36:39]
ds_read_b64_tr_b16 a[184:185], v13 offset:18432
ds_read_b64_tr_b16 a[186:187], v13 offset:23040
v_mfma_f32_16x16x32_bf16 a[40:43], a[160:163], a[112:115], a[40:43]
ds_read_b64_tr_b16 a[188:189], v13 offset:27648
ds_read_b64_tr_b16 a[190:191], v13 offset:32256
v_mfma_f32_16x16x32_bf16 a[40:43], a[164:167], a[116:119], a[40:43]
v_mfma_f32_16x16x32_bf16 a[44:47], a[160:163], a[120:123], a[44:47]
s_add_u32 m0, s51, 0x2000
v_mfma_f32_16x16x32_bf16 a[44:47], a[164:167], a[124:127], a[44:47]
buffer_load_dwordx4 v10, s[16:19], s47 offen lds
s_add_u32 s47, s47, 0x90000
v_mfma_f32_16x16x32_bf16 a[48:51], a[168:171], a[96:99], a[48:51]
v_mfma_f32_16x16x32_bf16 a[48:51], a[172:175], a[100:103], a[48:51]
v_mfma_f32_16x16x32_bf16 a[52:55], a[168:171], a[104:107], a[52:55]
v_mfma_f32_16x16x32_bf16 a[52:55], a[172:175], a[108:111], a[52:55]
v_mfma_f32_16x16x32_bf16 a[56:59], a[168:171], a[112:115], a[56:59]
v_mfma_f32_16x16x32_bf16 a[56:59], a[172:175], a[116:119], a[56:59]
buffer_load_dword v251, v249, s[20:23], s61 offen
v_mfma_f32_16x16x32_bf16 a[60:63], a[168:171], a[120:123], a[60:63]
v_mfma_f32_16x16x32_bf16 a[60:63], a[172:175], a[124:127], a[60:63]
s_waitcnt lgkmcnt(0)
v_mfma_f32_16x16x32_bf16 v[24:27], a[176:179], a[128:131], v[24:27]
ds_read_b64_tr_b16 a[160:161], v13 offset:32
ds_read_b64_tr_b16 a[162:163], v13 offset:4640
v_mfma_f32_16x16x32_bf16 v[24:27], a[180:183], a[132:135], v[24:27]
ds_read_b64_tr_b16 a[164:165], v13 offset:9248
ds_read_b64_tr_b16 a[166:167], v13 offset:13856
v_mfma_f32_16x16x32_bf16 v[28:31], a[176:179], a[136:139], v[28:31]
ds_read_b64_tr_b16 a[168:169], v13 offset:18464
ds_read_b64_tr_b16 a[170:171], v13 offset:23072
v_mfma_f32_16x16x32_bf16 v[28:31], a[180:183], a[140:143], v[28:31]
ds_read_b64_tr_b16 a[172:173], v13 offset:27680
ds_read_b64_tr_b16 a[174:175], v13 offset:32288
v_mfma_f32_16x16x32_bf16 v[32:35], a[176:179], a[144:147], v[32:35]
v_mfma_f32_16x16x32_bf16 v[32:35], a[180:183], a[148:151], v[32:35]
v_mfma_f32_16x16x32_bf16 v[36:39], a[176:179], a[152:155], v[36:39]
s_add_u32 m0, s51, 0x9000
v_mfma_f32_16x16x32_bf16 v[36:39], a[180:183], a[156:159], v[36:39]
buffer_load_dwordx4 v2, s[16:19], s47 offen lds
v_mfma_f32_16x16x32_bf16 v[40:43], a[184:187], a[128:131], v[40:43]
v_mfma_f32_16x16x32_bf16 v[40:43], a[188:191], a[132:135], v[40:43]
v_mfma_f32_16x16x32_bf16 v[44:47], a[184:187], a[136:139], v[44:47]
buffer_load_dwordx4 a[96:99], v14, s[32:35], s48 offen sc1
v_mfma_f32_16x16x32_bf16 v[44:47], a[188:191], a[140:143], v[44:47]
v_mfma_f32_16x16x32_bf16 v[48:51], a[184:187], a[144:147], v[48:51]
v_mfma_f32_16x16x32_bf16 v[48:51], a[188:191], a[148:151], v[48:51]
v_mfma_f32_16x16x32_bf16 v[52:55], a[184:187], a[152:155], v[52:55]
v_mfma_f32_16x16x32_bf16 v[52:55], a[188:191], a[156:159], v[52:55]
s_waitcnt lgkmcnt(0)
v_mfma_f32_16x16x32_bf16 v[56:59], a[160:163], a[128:131], v[56:59]
ds_read_b64_tr_b16 a[176:177], v13 offset:64
ds_read_b64_tr_b16 a[178:179], v13 offset:4672
v_mfma_f32_16x16x32_bf16 v[56:59], a[164:167], a[132:135], v[56:59]
ds_read_b64_tr_b16 a[180:181], v13 offset:9280
ds_read_b64_tr_b16 a[182:183], v13 offset:13888
v_mfma_f32_16x16x32_bf16 v[60:63], a[160:163], a[136:139], v[60:63]
ds_read_b64_tr_b16 a[184:185], v13 offset:18496
ds_read_b64_tr_b16 a[186:187], v13 offset:23104
v_mfma_f32_16x16x32_bf16 v[60:63], a[164:167], a[140:143], v[60:63]
ds_read_b64_tr_b16 a[188:189], v13 offset:27712
ds_read_b64_tr_b16 a[190:191], v13 offset:32320
v_mfma_f32_16x16x32_bf16 v[64:67], a[160:163], a[144:147], v[64:67]
v_mfma_f32_16x16x32_bf16 v[64:67], a[164:167], a[148:151], v[64:67]
v_mfma_f32_16x16x32_bf16 v[68:71], a[160:163], a[152:155], v[68:71]
s_add_u32 m0, s51, 0x9400
v_mfma_f32_16x16x32_bf16 v[68:71], a[164:167], a[156:159], v[68:71]
buffer_load_dwordx4 v3, s[16:19], s47 offen lds
v_mfma_f32_16x16x32_bf16 v[72:75], a[168:171], a[128:131], v[72:75]
v_mfma_f32_16x16x32_bf16 v[72:75], a[172:175], a[132:135], v[72:75]
v_mfma_f32_16x16x32_bf16 v[76:79], a[168:171], a[136:139], v[76:79]
buffer_load_dwordx4 a[104:107], v14, s[32:35], s48 offen offset:1024 sc1
v_mfma_f32_16x16x32_bf16 v[76:79], a[172:175], a[140:143], v[76:79]
v_mfma_f32_16x16x32_bf16 v[80:83], a[168:171], a[144:147], v[80:83]
v_mfma_f32_16x16x32_bf16 v[80:83], a[172:175], a[148:151], v[80:83]
v_mfma_f32_16x16x32_bf16 v[84:87], a[168:171], a[152:155], v[84:87]
v_mfma_f32_16x16x32_bf16 v[84:87], a[172:175], a[156:159], v[84:87]
s_waitcnt lgkmcnt(0)
v_mfma_f32_16x16x32_bf16 v[88:91], a[176:179], a[128:131], v[88:91]
ds_read_b64_tr_b16 a[160:161], v13 offset:96
ds_read_b64_tr_b16 a[162:163], v13 offset:4704
v_mfma_f32_16x16x32_bf16 v[88:91], a[180:183], a[132:135], v[88:91]
ds_read_b64_tr_b16 a[164:165], v13 offset:9312
ds_read_b64_tr_b16 a[166:167], v13 offset:13920
v_mfma_f32_16x16x32_bf16 v[92:95], a[176:179], a[136:139], v[92:95]
ds_read_b64_tr_b16 a[168:169], v13 offset:18528
ds_read_b64_tr_b16 a[170:171], v13 offset:23136
v_mfma_f32_16x16x32_bf16 v[92:95], a[180:183], a[140:143], v[92:95]
ds_read_b64_tr_b16 a[172:173], v13 offset:27744
ds_read_b64_tr_b16 a[174:175], v13 offset:32352
v_mfma_f32_16x16x32_bf16 v[96:99], a[176:179], a[144:147], v[96:99]
v_mfma_f32_16x16x32_bf16 v[96:99], a[180:183], a[148:151], v[96:99]
v_mfma_f32_16x16x32_bf16 v[100:103], a[176:179], a[152:155], v[100:103]
s_add_u32 m0, s51, 0x9800
v_mfma_f32_16x16x32_bf16 v[100:103], a[180:183], a[156:159], v[100:103]
buffer_load_dwordx4 v4, s[16:19], s47 offen lds
v_mfma_f32_16x16x32_bf16 v[104:107], a[184:187], a[128:131], v[104:107]
v_mfma_f32_16x16x32_bf16 v[104:107], a[188:191], a[132:135], v[104:107]
v_mfma_f32_16x16x32_bf16 v[108:111], a[184:187], a[136:139], v[108:111]
buffer_load_dwordx4 a[112:115], v14, s[32:35], s48 offen offset:2048 sc1
v_mfma_f32_16x16x32_bf16 v[108:111], a[188:191], a[140:143], v[108:111]
v_mfma_f32_16x16x32_bf16 v[112:115], a[184:187], a[144:147], v[112:115]
v_mfma_f32_16x16x32_bf16 v[112:115], a[188:191], a[148:151], v[112:115]
v_mfma_f32_16x16x32_bf16 v[116:119], a[184:187], a[152:155], v[116:119]
v_mfma_f32_16x16x32_bf16 v[116:119], a[188:191], a[156:159], v[116:119]
s_waitcnt lgkmcnt(0)
v_mfma_f32_16x16x32_bf16 v[120:123], a[160:163], a[128:131], v[120:123]
ds_read_b64_tr_b16 a[176:177], v13 offset:128
ds_read_b64_tr_b16 a[178:179], v13 offset:4736
v_mfma_f32_16x16x32_bf16 v[120:123], a[164:167], a[132:135], v[120:123]
ds_read_b64_tr_b16 a[180:181], v13 offset:9344
ds_read_b64_tr_b16 a[182:183], v13 offset:13952
v_mfma_f32_16x16x32_bf16 v[124:127], a[160:163], a[136:139], v[124:127]
ds_read_b64_tr_b16 a[184:185], v13 offset:18560
ds_read_b64_tr_b16 a[186:187], v13 offset:23168
v_mfma_f32_16x16x32_bf16 v[124:127], a[164:167], a[140:143], v[124:127]
ds_read_b64_tr_b16 a[188:189], v13 offset:27776
ds_read_b64_tr_b16 a[190:191], v13 offset:32384
v_mfma_f32_16x16x32_bf16 v[128:131], a[160:163], a[144:147], v[128:131]
v_mfma_f32_16x16x32_bf16 v[128:131], a[164:167], a[148:151], v[128:131]
v_mfma_f32_16x16x32_bf16 v[132:135], a[160:163], a[152:155], v[132:135]
s_add_u32 m0, s51, 0x9c00
v_mfma_f32_16x16x32_bf16 v[132:135], a[164:167], a[156:159], v[132:135]
buffer_load_dwordx4 v5, s[16:19], s47 offen lds
v_mfma_f32_16x16x32_bf16 v[136:139], a[168:171], a[128:131], v[136:139]
v_mfma_f32_16x16x32_bf16 v[136:139], a[172:175], a[132:135], v[136:139]
v_mfma_f32_16x16x32_bf16 v[140:143], a[168:171], a[136:139], v[140:143]
buffer_load_dwordx4 a[120:123], v14, s[32:35], s48 offen offset:3072 sc1
v_mfma_f32_16x16x32_bf16 v[140:143], a[172:175], a[140:143], v[140:143]
v_mfma_f32_16x16x32_bf16 v[144:147], a[168:171], a[144:147], v[144:147]
v_mfma_f32_16x16x32_bf16 v[144:147], a[172:175], a[148:151], v[144:147]
v_mfma_f32_16x16x32_bf16 v[148:151], a[168:171], a[152:155], v[148:151]
v_mfma_f32_16x16x32_bf16 v[148:151], a[172:175], a[156:159], v[148:151]
s_waitcnt lgkmcnt(0)
v_mfma_f32_16x16x32_bf16 v[152:155], a[176:179], a[128:131], v[152:155]
ds_read_b64_tr_b16 a[160:161], v13 offset:160
ds_read_b64_tr_b16 a[162:163], v13 offset:4768
v_mfma_f32_16x16x32_bf16 v[152:155], a[180:183], a[132:135], v[152:155]
ds_read_b64_tr_b16 a[164:165], v13 offset:9376
ds_read_b64_tr_b16 a[166:167], v13 offset:13984
v_mfma_f32_16x16x32_bf16 v[156:159], a[176:179], a[136:139], v[156:159]
ds_read_b64_tr_b16 a[168:169], v13 offset:18592
ds_read_b64_tr_b16 a[170:171], v13 offset:23200
v_mfma_f32_16x16x32_bf16 v[156:159], a[180:183], a[140:143], v[156:159]
ds_read_b64_tr_b16 a[172:173], v13 offset:27808
ds_read_b64_tr_b16 a[174:175], v13 offset:32416
v_mfma_f32_16x16x32_bf16 v[160:163], a[176:179], a[144:147], v[160:163]
v_mfma_f32_16x16x32_bf16 v[160:163], a[180:183], a[148:151], v[160:163]
v_mfma_f32_16x16x32_bf16 v[164:167], a[176:179], a[152:155], v[164:167]
s_add_u32 m0, s51, 0xa000
v_mfma_f32_16x16x32_bf16 v[164:167], a[180:183], a[156:159], v[164:167]
buffer_load_dwordx4 v6, s[16:19], s47 offen lds
v_mfma_f32_16x16x32_bf16 v[168:171], a[184:187], a[128:131], v[168:171]
v_mfma_f32_16x16x32_bf16 v[168:171], a[188:191], a[132:135], v[168:171]
v_mfma_f32_16x16x32_bf16 v[172:175], a[184:187], a[136:139], v[172:175]
buffer_load_dwordx4 a[100:103], v15, s[32:35], s48 offen sc1
v_mfma_f32_16x16x32_bf16 v[172:175], a[188:191], a[140:143], v[172:175]
v_mfma_f32_16x16x32_bf16 v[176:179], a[184:187], a[144:147], v[176:179]
v_mfma_f32_16x16x32_bf16 v[176:179], a[188:191], a[148:151], v[176:179]
v_mfma_f32_16x16x32_bf16 v[180:183], a[184:187], a[152:155], v[180:183]
v_mfma_f32_16x16x32_bf16 v[180:183], a[188:191], a[156:159], v[180:183]
s_waitcnt lgkmcnt(0)
v_mfma_f32_16x16x32_bf16 v[184:187], a[160:163], a[128:131], v[184:187]
ds_read_b64_tr_b16 a[176:177], v13 offset:192
ds_read_b64_tr_b16 a[178:179], v13 offset:4800
v_mfma_f32_16x16x32_bf16 v[184:187], a[164:167], a[132:135], v[184:187]
ds_read_b64_tr_b16 a[180:181], v13 offset:9408
ds_read_b64_tr_b16 a[182:183], v13 offset:14016
v_mfma_f32_16x16x32_bf16 v[188:191], a[160:163], a[136:139], v[188:191]
ds_read_b64_tr_b16 a[184:185], v13 offset:18624
ds_read_b64_tr_b16 a[186:187], v13 offset:23232
v_mfma_f32_16x16x32_bf16 v[188:191], a[164:167], a[140:143], v[188:191]
ds_read_b64_tr_b16 a[188:189], v13 offset:27840
ds_read_b64_tr_b16 a[190:191], v13 offset:32448
v_mfma_f32_16x16x32_bf16 v[192:195], a[160:163], a[144:147], v[192:195]
v_mfma_f32_16x16x32_bf16 v[192:195], a[164:167], a[148:151], v[192:195]
v_mfma_f32_16x16x32_bf16 v[196:199], a[160:163], a[152:155], v[196:199]
s_add_u32 m0, s51, 0xa400
v_mfma_f32_16x16x32_bf16 v[196:199], a[164:167], a[156:159], v[196:199]
buffer_load_dwordx4 v7, s[16:19], s47 offen lds
v_mfma_f32_16x16x32_bf16 v[200:203], a[168:171], a[128:131], v[200:203]
v_mfma_f32_16x16x32_bf16 v[200:203], a[172:175], a[132:135], v[200:203]
v_mfma_f32_16x16x32_bf16 v[204:207], a[168:171], a[136:139], v[204:207]
buffer_load_dwordx4 a[108:111], v15, s[32:35], s48 offen offset:1024 sc1
v_mfma_f32_16x16x32_bf16 v[204:207], a[172:175], a[140:143], v[204:207]
v_mfma_f32_16x16x32_bf16 v[208:211], a[168:171], a[144:147], v[208:211]
v_mfma_f32_16x16x32_bf16 v[208:211], a[172:175], a[148:151], v[208:211]
v_mfma_f32_16x16x32_bf16 v[212:215], a[168:171], a[152:155], v[212:215]
v_mfma_f32_16x16x32_bf16 v[212:215], a[172:175], a[156:159], v[212:215]
s_waitcnt lgkmcnt(0)
v_mfma_f32_16x16x32_bf16 v[216:219], a[176:179], a[128:131], v[216:219]
ds_read_b64_tr_b16 a[160:161], v13 offset:224
ds_read_b64_tr_b16 a[162:163], v13 offset:4832
v_mfma_f32_16x16x32_bf16 v[216:219], a[180:183], a[132:135], v[216:219]
ds_read_b64_tr_b16 a[164:165], v13 offset:9440
ds_read_b64_tr_b16 a[166:167], v13 offset:14048
v_mfma_f32_16x16x32_bf16 v[220:223], a[176:179], a[136:139], v[220:223]
ds_read_b64_tr_b16 a[168:169], v13 offset:18656
ds_read_b64_tr_b16 a[170:171], v13 offset:23264
v_mfma_f32_16x16x32_bf16 v[220:223], a[180:183], a[140:143], v[220:223]
ds_read_b64_tr_b16 a[172:173], v13 offset:27872
ds_read_b64_tr_b16 a[174:175], v13 offset:32480
v_mfma_f32_16x16x32_bf16 v[224:227], a[176:179], a[144:147], v[224:227]
v_mfma_f32_16x16x32_bf16 v[224:227], a[180:183], a[148:151], v[224:227]
v_mfma_f32_16x16x32_bf16 v[228:231], a[176:179], a[152:155], v[228:231]
s_add_u32 m0, s51, 0xa800
v_mfma_f32_16x16x32_bf16 v[228:231], a[180:183], a[156:159], v[228:231]
buffer_load_dwordx4 v8, s[16:19], s47 offen lds
v_mfma_f32_16x16x32_bf16 v[232:235], a[184:187], a[128:131], v[232:235]
v_mfma_f32_16x16x32_bf16 v[232:235], a[188:191], a[132:135], v[232:235]
v_mfma_f32_16x16x32_bf16 v[236:239], a[184:187], a[136:139], v[236:239]
buffer_load_dwordx4 a[116:119], v15, s[32:35], s48 offen offset:2048 sc1
v_mfma_f32_16x16x32_bf16 v[236:239], a[188:191], a[140:143], v[236:239]
v_mfma_f32_16x16x32_bf16 v[240:243], a[184:187], a[144:147], v[240:243]
v_mfma_f32_16x16x32_bf16 v[240:243], a[188:191], a[148:151], v[240:243]
v_mfma_f32_16x16x32_bf16 v[244:247], a[184:187], a[152:155], v[244:247]
v_mfma_f32_16x16x32_bf16 v[244:247], a[188:191], a[156:159], v[244:247]
s_waitcnt lgkmcnt(0)
v_mfma_f32_16x16x32_bf16 a[0:3], a[160:163], a[128:131], a[0:3]
ds_read_b64_tr_b16 a[176:177], v13 offset:256
ds_read_b64_tr_b16 a[178:179], v13 offset:4864
v_mfma_f32_16x16x32_bf16 a[0:3], a[164:167], a[132:135], a[0:3]
ds_read_b64_tr_b16 a[180:181], v13 offset:9472
ds_read_b64_tr_b16 a[182:183], v13 offset:14080
v_mfma_f32_16x16x32_bf16 a[4:7], a[160:163], a[136:139], a[4:7]
ds_read_b64_tr_b16 a[184:185], v13 offset:18688
ds_read_b64_tr_b16 a[186:187], v13 offset:23296
v_mfma_f32_16x16x32_bf16 a[4:7], a[164:167], a[140:143], a[4:7]
ds_read_b64_tr_b16 a[188:189], v13 offset:27904
ds_read_b64_tr_b16 a[190:191], v13 offset:32512
v_mfma_f32_16x16x32_bf16 a[8:11], a[160:163], a[144:147], a[8:11]
v_mfma_f32_16x16x32_bf16 a[8:11], a[164:167], a[148:151], a[8:11]
v_mfma_f32_16x16x32_bf16 a[12:15], a[160:163], a[152:155], a[12:15]
s_add_u32 m0, s51, 0xac00
v_mfma_f32_16x16x32_bf16 a[12:15], a[164:167], a[156:159], a[12:15]
buffer_load_dwordx4 v9, s[16:19], s47 offen lds
v_mfma_f32_16x16x32_bf16 a[16:19], a[168:171], a[128:131], a[16:19]
v_mfma_f32_16x16x32_bf16 a[16:19], a[172:175], a[132:135], a[16:19]
v_mfma_f32_16x16x32_bf16 a[20:23], a[168:171], a[136:139], a[20:23]
buffer_load_dwordx4 a[124:127], v15, s[32:35], s48 offen offset:3072 sc1
s_add_u32 s48, s48, 0x40000
v_mfma_f32_16x16x32_bf16 a[20:23], a[172:175], a[140:143], a[20:23]
v_mfma_f32_16x16x32_bf16 a[24:27], a[168:171], a[144:147], a[24:27]
v_mfma_f32_16x16x32_bf16 a[24:27], a[172:175], a[148:151], a[24:27]
v_mfma_f32_16x16x32_bf16 a[28:31], a[168:171], a[152:155], a[28:31]
v_mfma_f32_16x16x32_bf16 a[28:31], a[172:175], a[156:159], a[28:31]
s_waitcnt lgkmcnt(0)
v_mfma_f32_16x16x32_bf16 a[32:35], a[176:179], a[128:131], a[32:35]
s_waitcnt vmcnt(17)
s_barrier
v_mfma_f32_16x16x32_bf16 a[32:35], a[180:183], a[132:135], a[32:35]
ds_read_b64_tr_b16 a[160:161], v11
ds_read_b64_tr_b16 a[162:163], v11 offset:4608
v_mfma_f32_16x16x32_bf16 a[36:39], a[176:179], a[136:139], a[36:39]
ds_read_b64_tr_b16 a[164:165], v11 offset:9216
ds_read_b64_tr_b16 a[166:167], v11 offset:13824
v_mfma_f32_16x16x32_bf16 a[36:39], a[180:183], a[140:143], a[36:39]
ds_read_b64_tr_b16 a[168:169], v11 offset:18432
ds_read_b64_tr_b16 a[170:171], v11 offset:23040
v_mfma_f32_16x16x32_bf16 a[40:43], a[176:179], a[144:147], a[40:43]
ds_read_b64_tr_b16 a[172:173], v11 offset:27648
ds_read_b64_tr_b16 a[174:175], v11 offset:32256
v_mfma_f32_16x16x32_bf16 a[40:43], a[180:183], a[148:151], a[40:43]
v_mfma_f32_16x16x32_bf16 a[44:47], a[176:179], a[152:155], a[44:47]
s_add_u32 m0, s51, 0xb000
v_mfma_f32_16x16x32_bf16 a[44:47], a[180:183], a[156:159], a[44:47]
buffer_load_dwordx4 v10, s[16:19], s47 offen lds
s_add_u32 s47, s47, 0x90000
v_mfma_f32_16x16x32_bf16 a[48:51], a[184:187], a[128:131], a[48:51]
v_mfma_f32_16x16x32_bf16 a[48:51], a[188:191], a[132:135], a[48:51]
v_mfma_f32_16x16x32_bf16 a[52:55], a[184:187], a[136:139], a[52:55]
v_mfma_f32_16x16x32_bf16 a[52:55], a[188:191], a[140:143], a[52:55]
v_mfma_f32_16x16x32_bf16 a[56:59], a[184:187], a[144:147], a[56:59]
v_mfma_f32_16x16x32_bf16 a[56:59], a[188:191], a[148:151], a[56:59]
v_mfma_f32_16x16x32_bf16 a[60:63], a[184:187], a[152:155], a[60:63]
v_mfma_f32_16x16x32_bf16 a[60:63], a[188:191], a[156:159], a[60:63]
s_waitcnt lgkmcnt(0)
v_mfma_f32_16x16x32_bf16 v[24:27], a[160:163], a[64:67], v[24:27]
ds_read_b64_tr_b16 a[176:177], v11 offset:32
ds_read_b64_tr_b16 a[178:179], v11 offset:4640
v_mfma_f32_16x16x32_bf16 v[24:27], a[164:167], a[68:71], v[24:27]
ds_read_b64_tr_b16 a[180:181], v11 offset:9248
ds_read_b64_tr_b16 a[182:183], v11 offset:13856
v_mfma_f32_16x16x32_bf16 v[28:31], a[160:163], a[72:75], v[28:31]
ds_read_b64_tr_b16 a[184:185], v11 offset:18464
ds_read_b64_tr_b16 a[186:187], v11 offset:23072
v_mfma_f32_16x16x32_bf16 v[28:31], a[164:167], a[76:79], v[28:31]
ds_read_b64_tr_b16 a[188:189], v11 offset:27680
ds_read_b64_tr_b16 a[190:191], v11 offset:32288
v_mfma_f32_16x16x32_bf16 v[32:35], a[160:163], a[80:83], v[32:35]
v_mfma_f32_16x16x32_bf16 v[32:35], a[164:167], a[84:87], v[32:35]
v_mfma_f32_16x16x32_bf16 v[36:39], a[160:163], a[88:91], v[36:39]
s_add_u32 m0, s51, 0x12000
v_mfma_f32_16x16x32_bf16 v[36:39], a[164:167], a[92:95], v[36:39]
buffer_load_dwordx4 v2, s[16:19], s47 offen lds
v_mfma_f32_16x16x32_bf16 v[40:43], a[168:171], a[64:67], v[40:43]
v_mfma_f32_16x16x32_bf16 v[40:43], a[172:175], a[68:71], v[40:43]
v_mfma_f32_16x16x32_bf16 v[44:47], a[168:171], a[72:75], v[44:47]
buffer_load_dwordx4 a[128:131], v14, s[32:35], s48 offen sc1
v_mfma_f32_16x16x32_bf16 v[44:47], a[172:175], a[76:79], v[44:47]
v_mfma_f32_16x16x32_bf16 v[48:51], a[168:171], a[80:83], v[48:51]
v_mfma_f32_16x16x32_bf16 v[48:51], a[172:175], a[84:87], v[48:51]
v_mfma_f32_16x16x32_bf16 v[52:55], a[168:171], a[88:91], v[52:55]
v_mfma_f32_16x16x32_bf16 v[52:55], a[172:175], a[92:95], v[52:55]
s_waitcnt lgkmcnt(0)
v_mfma_f32_16x16x32_bf16 v[56:59], a[176:179], a[64:67], v[56:59]
ds_read_b64_tr_b16 a[160:161], v11 offset:64
ds_read_b64_tr_b16 a[162:163], v11 offset:4672
v_mfma_f32_16x16x32_bf16 v[56:59], a[180:183], a[68:71], v[56:59]
ds_read_b64_tr_b16 a[164:165], v11 offset:9280
ds_read_b64_tr_b16 a[166:167], v11 offset:13888
v_mfma_f32_16x16x32_bf16 v[60:63], a[176:179], a[72:75], v[60:63]
ds_read_b64_tr_b16 a[168:169], v11 offset:18496
ds_read_b64_tr_b16 a[170:171], v11 offset:23104
v_mfma_f32_16x16x32_bf16 v[60:63], a[180:183], a[76:79], v[60:63]
ds_read_b64_tr_b16 a[172:173], v11 offset:27712
ds_read_b64_tr_b16 a[174:175], v11 offset:32320
v_mfma_f32_16x16x32_bf16 v[64:67], a[176:179], a[80:83], v[64:67]
v_mfma_f32_16x16x32_bf16 v[64:67], a[180:183], a[84:87], v[64:67]
v_mfma_f32_16x16x32_bf16 v[68:71], a[176:179], a[88:91], v[68:71]
s_add_u32 m0, s51, 0x12400
v_mfma_f32_16x16x32_bf16 v[68:71], a[180:183], a[92:95], v[68:71]
buffer_load_dwordx4 v3, s[16:19], s47 offen lds
v_mfma_f32_16x16x32_bf16 v[72:75], a[184:187], a[64:67], v[72:75]
v_mfma_f32_16x16x32_bf16 v[72:75], a[188:191], a[68:71], v[72:75]
v_mfma_f32_16x16x32_bf16 v[76:79], a[184:187], a[72:75], v[76:79]
buffer_load_dwordx4 a[136:139], v14, s[32:35], s48 offen offset:1024 sc1
v_mfma_f32_16x16x32_bf16 v[76:79], a[188:191], a[76:79], v[76:79]
v_mfma_f32_16x16x32_bf16 v[80:83], a[184:187], a[80:83], v[80:83]
v_mfma_f32_16x16x32_bf16 v[80:83], a[188:191], a[84:87], v[80:83]
v_mfma_f32_16x16x32_bf16 v[84:87], a[184:187], a[88:91], v[84:87]
v_mfma_f32_16x16x32_bf16 v[84:87], a[188:191], a[92:95], v[84:87]
s_waitcnt lgkmcnt(0)
v_mfma_f32_16x16x32_bf16 v[88:91], a[160:163], a[64:67], v[88:91]
ds_read_b64_tr_b16 a[176:177], v11 offset:96
ds_read_b64_tr_b16 a[178:179], v11 offset:4704
v_mfma_f32_16x16x32_bf16 v[88:91], a[164:167], a[68:71], v[88:91]
ds_read_b64_tr_b16 a[180:181], v11 offset:9312
ds_read_b64_tr_b16 a[182:183], v11 offset:13920
v_mfma_f32_16x16x32_bf16 v[92:95], a[160:163], a[72:75], v[92:95]
ds_read_b64_tr_b16 a[184:185], v11 offset:18528
ds_read_b64_tr_b16 a[186:187], v11 offset:23136
v_mfma_f32_16x16x32_bf16 v[92:95], a[164:167], a[76:79], v[92:95]
ds_read_b64_tr_b16 a[188:189], v11 offset:27744
ds_read_b64_tr_b16 a[190:191], v11 offset:32352
v_mfma_f32_16x16x32_bf16 v[96:99], a[160:163], a[80:83], v[96:99]
v_mfma_f32_16x16x32_bf16 v[96:99], a[164:167], a[84:87], v[96:99]
v_mfma_f32_16x16x32_bf16 v[100:103], a[160:163], a[88:91], v[100:103]
s_add_u32 m0, s51, 0x12800
v_mfma_f32_16x16x32_bf16 v[100:103], a[164:167], a[92:95], v[100:103]
buffer_load_dwordx4 v4, s[16:19], s47 offen lds
v_mfma_f32_16x16x32_bf16 v[104:107], a[168:171], a[64:67], v[104:107]
v_mfma_f32_16x16x32_bf16 v[104:107], a[172:175], a[68:71], v[104:107]
v_mfma_f32_16x16x32_bf16 v[108:111], a[168:171], a[72:75], v[108:111]
buffer_load_dwordx4 a[144:147], v14, s[32:35], s48 offen offset:2048 sc1
v_mfma_f32_16x16x32_bf16 v[108:111], a[172:175], a[76:79], v[108:111]
v_mfma_f32_16x16x32_bf16 v[112:115], a[168:171], a[80:83], v[112:115]
v_mfma_f32_16x16x32_bf16 v[112:115], a[172:175], a[84:87], v[112:115]
v_mfma_f32_16x16x32_bf16 v[116:119], a[168:171], a[88:91], v[116:119]
v_mfma_f32_16x16x32_bf16 v[116:119], a[172:175], a[92:95], v[116:119]
s_waitcnt lgkmcnt(0)
v_mfma_f32_16x16x32_bf16 v[120:123], a[176:179], a[64:67], v[120:123]
ds_read_b64_tr_b16 a[160:161], v11 offset:128
ds_read_b64_tr_b16 a[162:163], v11 offset:4736
v_mfma_f32_16x16x32_bf16 v[120:123], a[180:183], a[68:71], v[120:123]
ds_read_b64_tr_b16 a[164:165], v11 offset:9344
ds_read_b64_tr_b16 a[166:167], v11 offset:13952
v_mfma_f32_16x16x32_bf16 v[124:127], a[176:179], a[72:75], v[124:127]
ds_read_b64_tr_b16 a[168:169], v11 offset:18560
ds_read_b64_tr_b16 a[170:171], v11 offset:23168
v_mfma_f32_16x16x32_bf16 v[124:127], a[180:183], a[76:79], v[124:127]
ds_read_b64_tr_b16 a[172:173], v11 offset:27776
ds_read_b64_tr_b16 a[174:175], v11 offset:32384
v_mfma_f32_16x16x32_bf16 v[128:131], a[176:179], a[80:83], v[128:131]
v_mfma_f32_16x16x32_bf16 v[128:131], a[180:183], a[84:87], v[128:131]
v_mfma_f32_16x16x32_bf16 v[132:135], a[176:179], a[88:91], v[132:135]
s_add_u32 m0, s51, 0x12c00
v_mfma_f32_16x16x32_bf16 v[132:135], a[180:183], a[92:95], v[132:135]
buffer_load_dwordx4 v5, s[16:19], s47 offen lds
v_mfma_f32_16x16x32_bf16 v[136:139], a[184:187], a[64:67], v[136:139]
v_mfma_f32_16x16x32_bf16 v[136:139], a[188:191], a[68:71], v[136:139]
v_mfma_f32_16x16x32_bf16 v[140:143], a[184:187], a[72:75], v[140:143]
buffer_load_dwordx4 a[152:155], v14, s[32:35], s48 offen offset:3072 sc1
v_mfma_f32_16x16x32_bf16 v[140:143], a[188:191], a[76:79], v[140:143]
v_mfma_f32_16x16x32_bf16 v[144:147], a[184:187], a[80:83], v[144:147]
v_mfma_f32_16x16x32_bf16 v[144:147], a[188:191], a[84:87], v[144:147]
v_mfma_f32_16x16x32_bf16 v[148:151], a[184:187], a[88:91], v[148:151]
v_mfma_f32_16x16x32_bf16 v[148:151], a[188:191], a[92:95], v[148:151]
s_waitcnt lgkmcnt(0)
v_mfma_f32_16x16x32_bf16 v[152:155], a[160:163], a[64:67], v[152:155]
ds_read_b64_tr_b16 a[176:177], v11 offset:160
ds_read_b64_tr_b16 a[178:179], v11 offset:4768
v_mfma_f32_16x16x32_bf16 v[152:155], a[164:167], a[68:71], v[152:155]
ds_read_b64_tr_b16 a[180:181], v11 offset:9376
ds_read_b64_tr_b16 a[182:183], v11 offset:13984
v_mfma_f32_16x16x32_bf16 v[156:159], a[160:163], a[72:75], v[156:159]
ds_read_b64_tr_b16 a[184:185], v11 offset:18592
ds_read_b64_tr_b16 a[186:187], v11 offset:23200
v_mfma_f32_16x16x32_bf16 v[156:159], a[164:167], a[76:79], v[156:159]
ds_read_b64_tr_b16 a[188:189], v11 offset:27808
ds_read_b64_tr_b16 a[190:191], v11 offset:32416
v_mfma_f32_16x16x32_bf16 v[160:163], a[160:163], a[80:83], v[160:163]
v_mfma_f32_16x16x32_bf16 v[160:163], a[164:167], a[84:87], v[160:163]
v_mfma_f32_16x16x32_bf16 v[164:167], a[160:163], a[88:91], v[164:167]
s_add_u32 m0, s51, 0x13000
v_mfma_f32_16x16x32_bf16 v[164:167], a[164:167], a[92:95], v[164:167]
buffer_load_dwordx4 v6, s[16:19], s47 offen lds
v_mfma_f32_16x16x32_bf16 v[168:171], a[168:171], a[64:67], v[168:171]
v_mfma_f32_16x16x32_bf16 v[168:171], a[172:175], a[68:71], v[168:171]
v_mfma_f32_16x16x32_bf16 v[172:175], a[168:171], a[72:75], v[172:175]
buffer_load_dwordx4 a[132:135], v15, s[32:35], s48 offen sc1
v_mfma_f32_16x16x32_bf16 v[172:175], a[172:175], a[76:79], v[172:175]
v_mfma_f32_16x16x32_bf16 v[176:179], a[168:171], a[80:83], v[176:179]
v_mfma_f32_16x16x32_bf16 v[176:179], a[172:175], a[84:87], v[176:179]
v_mfma_f32_16x16x32_bf16 v[180:183], a[168:171], a[88:91], v[180:183]
v_mfma_f32_16x16x32_bf16 v[180:183], a[172:175], a[92:95], v[180:183]
s_waitcnt lgkmcnt(0)
v_mfma_f32_16x16x32_bf16 v[184:187], a[176:179], a[64:67], v[184:187]
ds_read_b64_tr_b16 a[160:161], v11 offset:192
ds_read_b64_tr_b16 a[162:163], v11 offset:4800
v_mfma_f32_16x16x32_bf16 v[184:187], a[180:183], a[68:71], v[184:187]
ds_read_b64_tr_b16 a[164:165], v11 offset:9408
ds_read_b64_tr_b16 a[166:167], v11 offset:14016
v_mfma_f32_16x16x32_bf16 v[188:191], a[176:179], a[72:75], v[188:191]
ds_read_b64_tr_b16 a[168:169], v11 offset:18624
ds_read_b64_tr_b16 a[170:171], v11 offset:23232
v_mfma_f32_16x16x32_bf16 v[188:191], a[180:183], a[76:79], v[188:191]
ds_read_b64_tr_b16 a[172:173], v11 offset:27840
ds_read_b64_tr_b16 a[174:175], v11 offset:32448
v_mfma_f32_16x16x32_bf16 v[192:195], a[176:179], a[80:83], v[192:195]
v_mfma_f32_16x16x32_bf16 v[192:195], a[180:183], a[84:87], v[192:195]
v_mfma_f32_16x16x32_bf16 v[196:199], a[176:179], a[88:91], v[196:199]
s_add_u32 m0, s51, 0x13400
v_mfma_f32_16x16x32_bf16 v[196:199], a[180:183], a[92:95], v[196:199]
buffer_load_dwordx4 v7, s[16:19], s47 offen lds
v_mfma_f32_16x16x32_bf16 v[200:203], a[184:187], a[64:67], v[200:203]
v_mfma_f32_16x16x32_bf16 v[200:203], a[188:191], a[68:71], v[200:203]
v_mfma_f32_16x16x32_bf16 v[204:207], a[184:187], a[72:75], v[204:207]
buffer_load_dwordx4 a[140:143], v15, s[32:35], s48 offen offset:1024 sc1
v_mfma_f32_16x16x32_bf16 v[204:207], a[188:191], a[76:79], v[204:207]
v_mfma_f32_16x16x32_bf16 v[208:211], a[184:187], a[80:83], v[208:211]
v_mfma_f32_16x16x32_bf16 v[208:211], a[188:191], a[84:87], v[208:211]
v_mfma_f32_16x16x32_bf16 v[212:215], a[184:187], a[88:91], v[212:215]
v_mfma_f32_16x16x32_bf16 v[212:215], a[188:191], a[92:95], v[212:215]
s_waitcnt lgkmcnt(0)
v_mfma_f32_16x16x32_bf16 v[216:219], a[160:163], a[64:67], v[216:219]
ds_read_b64_tr_b16 a[176:177], v11 offset:224
ds_read_b64_tr_b16 a[178:179], v11 offset:4832
v_mfma_f32_16x16x32_bf16 v[216:219], a[164:167], a[68:71], v[216:219]
ds_read_b64_tr_b16 a[180:181], v11 offset:9440
ds_read_b64_tr_b16 a[182:183], v11 offset:14048
v_mfma_f32_16x16x32_bf16 v[220:223], a[160:163], a[72:75], v[220:223]
ds_read_b64_tr_b16 a[184:185], v11 offset:18656
ds_read_b64_tr_b16 a[186:187], v11 offset:23264
v_mfma_f32_16x16x32_bf16 v[220:223], a[164:167], a[76:79], v[220:223]
ds_read_b64_tr_b16 a[188:189], v11 offset:27872
ds_read_b64_tr_b16 a[190:191], v11 offset:32480
v_mfma_f32_16x16x32_bf16 v[224:227], a[160:163], a[80:83], v[224:227]
v_mfma_f32_16x16x32_bf16 v[224:227], a[164:167], a[84:87], v[224:227]
v_mfma_f32_16x16x32_bf16 v[228:231], a[160:163], a[88:91], v[228:231]
s_add_u32 m0, s51, 0x13800
v_mfma_f32_16x16x32_bf16 v[228:231], a[164:167], a[92:95], v[228:231]
buffer_load_dwordx4 v8, s[16:19], s47 offen lds
v_mfma_f32_16x16x32_bf16 v[232:235], a[168:171], a[64:67], v[232:235]
v_mfma_f32_16x16x32_bf16 v[232:235], a[172:175], a[68:71], v[232:235]
v_mfma_f32_16x16x32_bf16 v[236:239], a[168:171], a[72:75], v[236:239]
buffer_load_dwordx4 a[148:151], v15, s[32:35], s48 offen offset:2048 sc1
v_mfma_f32_16x16x32_bf16 v[236:239], a[172:175], a[76:79], v[236:239]
v_mfma_f32_16x16x32_bf16 v[240:243], a[168:171], a[80:83], v[240:243]
v_mfma_f32_16x16x32_bf16 v[240:243], a[172:175], a[84:87], v[240:243]
v_mfma_f32_16x16x32_bf16 v[244:247], a[168:171], a[88:91], v[244:247]
v_mfma_f32_16x16x32_bf16 v[244:247], a[172:175], a[92:95], v[244:247]
s_waitcnt lgkmcnt(0)
v_mfma_f32_16x16x32_bf16 a[0:3], a[176:179], a[64:67], a[0:3]
ds_read_b64_tr_b16 a[160:161], v11 offset:256
ds_read_b64_tr_b16 a[162:163], v11 offset:4864
v_mfma_f32_16x16x32_bf16 a[0:3], a[180:183], a[68:71], a[0:3]
ds_read_b64_tr_b16 a[164:165], v11 offset:9472
ds_read_b64_tr_b16 a[166:167], v11 offset:14080
v_mfma_f32_16x16x32_bf16 a[4:7], a[176:179], a[72:75], a[4:7]
ds_read_b64_tr_b16 a[168:169], v11 offset:18688
ds_read_b64_tr_b16 a[170:171], v11 offset:23296
v_mfma_f32_16x16x32_bf16 a[4:7], a[180:183], a[76:79], a[4:7]
ds_read_b64_tr_b16 a[172:173], v11 offset:27904
ds_read_b64_tr_b16 a[174:175], v11 offset:32512
v_mfma_f32_16x16x32_bf16 a[8:11], a[176:179], a[80:83], a[8:11]
v_mfma_f32_16x16x32_bf16 a[8:11], a[180:183], a[84:87], a[8:11]
v_mfma_f32_16x16x32_bf16 a[12:15], a[176:179], a[88:91], a[12:15]
s_add_u32 m0, s51, 0x13c00
v_mfma_f32_16x16x32_bf16 a[12:15], a[180:183], a[92:95], a[12:15]
buffer_load_dwordx4 v9, s[16:19], s47 offen lds
v_mfma_f32_16x16x32_bf16 a[16:19], a[184:187], a[64:67], a[16:19]
v_mfma_f32_16x16x32_bf16 a[16:19], a[188:191], a[68:71], a[16:19]
v_mfma_f32_16x16x32_bf16 a[20:23], a[184:187], a[72:75], a[20:23]
buffer_load_dwordx4 a[156:159], v15, s[32:35], s48 offen offset:3072 sc1
s_add_u32 s48, s48, 0x40000
v_mfma_f32_16x16x32_bf16 a[20:23], a[188:191], a[76:79], a[20:23]
v_mfma_f32_16x16x32_bf16 a[24:27], a[184:187], a[80:83], a[24:27]
v_mfma_f32_16x16x32_bf16 a[24:27], a[188:191], a[84:87], a[24:27]
v_mfma_f32_16x16x32_bf16 a[28:31], a[184:187], a[88:91], a[28:31]
v_mfma_f32_16x16x32_bf16 a[28:31], a[188:191], a[92:95], a[28:31]
s_waitcnt lgkmcnt(0)
v_mfma_f32_16x16x32_bf16 a[32:35], a[160:163], a[64:67], a[32:35]
s_waitcnt vmcnt(16)
s_barrier
v_mfma_f32_16x16x32_bf16 a[32:35], a[164:167], a[68:71], a[32:35]
ds_read_b64_tr_b16 a[176:177], v12
ds_read_b64_tr_b16 a[178:179], v12 offset:4608
v_mfma_f32_16x16x32_bf16 a[36:39], a[160:163], a[72:75], a[36:39]
ds_read_b64_tr_b16 a[180:181], v12 offset:9216
ds_read_b64_tr_b16 a[182:183], v12 offset:13824
v_mfma_f32_16x16x32_bf16 a[36:39], a[164:167], a[76:79], a[36:39]
ds_read_b64_tr_b16 a[184:185], v12 offset:18432
ds_read_b64_tr_b16 a[186:187], v12 offset:23040
v_mfma_f32_16x16x32_bf16 a[40:43], a[160:163], a[80:83], a[40:43]
ds_read_b64_tr_b16 a[188:189], v12 offset:27648
ds_read_b64_tr_b16 a[190:191], v12 offset:32256
v_mfma_f32_16x16x32_bf16 a[40:43], a[164:167], a[84:87], a[40:43]
v_mfma_f32_16x16x32_bf16 a[44:47], a[160:163], a[88:91], a[44:47]
s_add_u32 m0, s51, 0x14000
v_mfma_f32_16x16x32_bf16 a[44:47], a[164:167], a[92:95], a[44:47]
buffer_load_dwordx4 v10, s[16:19], s47 offen lds
s_add_u32 s47, s47, 0x90000
v_mfma_f32_16x16x32_bf16 a[48:51], a[168:171], a[64:67], a[48:51]
v_mfma_f32_16x16x32_bf16 a[48:51], a[172:175], a[68:71], a[48:51]
v_mfma_f32_16x16x32_bf16 a[52:55], a[168:171], a[72:75], a[52:55]
v_mfma_f32_16x16x32_bf16 a[52:55], a[172:175], a[76:79], a[52:55]
v_mfma_f32_16x16x32_bf16 a[56:59], a[168:171], a[80:83], a[56:59]
v_mfma_f32_16x16x32_bf16 a[56:59], a[172:175], a[84:87], a[56:59]
v_mfma_f32_16x16x32_bf16 a[60:63], a[168:171], a[88:91], a[60:63]
v_mfma_f32_16x16x32_bf16 a[60:63], a[172:175], a[92:95], a[60:63]
s_waitcnt lgkmcnt(0)
v_mfma_f32_16x16x32_bf16 v[24:27], a[176:179], a[96:99], v[24:27]
ds_read_b64_tr_b16 a[160:161], v12 offset:32
ds_read_b64_tr_b16 a[162:163], v12 offset:4640
v_mfma_f32_16x16x32_bf16 v[24:27], a[180:183], a[100:103], v[24:27]
ds_read_b64_tr_b16 a[164:165], v12 offset:9248
ds_read_b64_tr_b16 a[166:167], v12 offset:13856
v_mfma_f32_16x16x32_bf16 v[28:31], a[176:179], a[104:107], v[28:31]
ds_read_b64_tr_b16 a[168:169], v12 offset:18464
ds_read_b64_tr_b16 a[170:171], v12 offset:23072
v_mfma_f32_16x16x32_bf16 v[28:31], a[180:183], a[108:111], v[28:31]
ds_read_b64_tr_b16 a[172:173], v12 offset:27680
ds_read_b64_tr_b16 a[174:175], v12 offset:32288
v_mfma_f32_16x16x32_bf16 v[32:35], a[176:179], a[112:115], v[32:35]
v_mfma_f32_16x16x32_bf16 v[32:35], a[180:183], a[116:119], v[32:35]
v_mfma_f32_16x16x32_bf16 v[36:39], a[176:179], a[120:123], v[36:39]
s_add_u32 m0, s52, 0x1b000
v_mfma_f32_16x16x32_bf16 v[36:39], a[180:183], a[124:127], v[36:39]
buffer_load_dwordx4 v23, s[20:23], s49 offen lds
s_add_u32 s49, s49, 0x20000
v_mfma_f32_16x16x32_bf16 v[40:43], a[184:187], a[96:99], v[40:43]
v_mfma_f32_16x16x32_bf16 v[40:43], a[188:191], a[100:103], v[40:43]
v_mfma_f32_16x16x32_bf16 v[44:47], a[184:187], a[104:107], v[44:47]
s_sub_u32 s48, s48, 0x240000
v_mfma_f32_16x16x32_bf16 v[44:47], a[188:191], a[108:111], v[44:47]
v_mfma_f32_16x16x32_bf16 v[48:51], a[184:187], a[112:115], v[48:51]
v_mfma_f32_16x16x32_bf16 v[48:51], a[188:191], a[116:119], v[48:51]
v_mfma_f32_16x16x32_bf16 v[52:55], a[184:187], a[120:123], v[52:55]
v_mfma_f32_16x16x32_bf16 v[52:55], a[188:191], a[124:127], v[52:55]
s_waitcnt lgkmcnt(0)
v_mfma_f32_16x16x32_bf16 v[56:59], a[160:163], a[96:99], v[56:59]
ds_read_b64_tr_b16 a[176:177], v12 offset:64
ds_read_b64_tr_b16 a[178:179], v12 offset:4672
v_mfma_f32_16x16x32_bf16 v[56:59], a[164:167], a[100:103], v[56:59]
ds_read_b64_tr_b16 a[180:181], v12 offset:9280
ds_read_b64_tr_b16 a[182:183], v12 offset:13888
v_mfma_f32_16x16x32_bf16 v[60:63], a[160:163], a[104:107], v[60:63]
ds_read_b64_tr_b16 a[184:185], v12 offset:18496
ds_read_b64_tr_b16 a[186:187], v12 offset:23104
v_mfma_f32_16x16x32_bf16 v[60:63], a[164:167], a[108:111], v[60:63]
ds_read_b64_tr_b16 a[188:189], v12 offset:27712
ds_read_b64_tr_b16 a[190:191], v12 offset:32320
v_mfma_f32_16x16x32_bf16 v[64:67], a[160:163], a[112:115], v[64:67]
v_mfma_f32_16x16x32_bf16 v[64:67], a[164:167], a[116:119], v[64:67]
v_mfma_f32_16x16x32_bf16 v[68:71], a[160:163], a[120:123], v[68:71]
s_add_u32 m0, s52, 0x1c000
v_mfma_f32_16x16x32_bf16 v[68:71], a[164:167], a[124:127], v[68:71]
buffer_load_dwordx4 v23, s[20:23], s49 offen lds
s_add_u32 s49, s49, 0x20000
v_mfma_f32_16x16x32_bf16 v[72:75], a[168:171], a[96:99], v[72:75]
v_mfma_f32_16x16x32_bf16 v[72:75], a[172:175], a[100:103], v[72:75]
v_mfma_f32_16x16x32_bf16 v[76:79], a[168:171], a[104:107], v[76:79]
v_mfma_f32_16x16x32_bf16 v[76:79], a[172:175], a[108:111], v[76:79]
v_mfma_f32_16x16x32_bf16 v[80:83], a[168:171], a[112:115], v[80:83]
v_mfma_f32_16x16x32_bf16 v[80:83], a[172:175], a[116:119], v[80:83]
v_mfma_f32_16x16x32_bf16 v[84:87], a[168:171], a[120:123], v[84:87]
v_mfma_f32_16x16x32_bf16 v[84:87], a[172:175], a[124:127], v[84:87]
s_waitcnt lgkmcnt(0)
v_mfma_f32_16x16x32_bf16 v[88:91], a[176:179], a[96:99], v[88:91]
ds_read_b64_tr_b16 a[160:161], v12 offset:96
ds_read_b64_tr_b16 a[162:163], v12 offset:4704
v_mfma_f32_16x16x32_bf16 v[88:91], a[180:183], a[100:103], v[88:91]
ds_read_b64_tr_b16 a[164:165], v12 offset:9312
ds_read_b64_tr_b16 a[166:167], v12 offset:13920
v_mfma_f32_16x16x32_bf16 v[92:95], a[176:179], a[104:107], v[92:95]
ds_read_b64_tr_b16 a[168:169], v12 offset:18528
ds_read_b64_tr_b16 a[170:171], v12 offset:23136
v_mfma_f32_16x16x32_bf16 v[92:95], a[180:183], a[108:111], v[92:95]
ds_read_b64_tr_b16 a[172:173], v12 offset:27744
ds_read_b64_tr_b16 a[174:175], v12 offset:32352
v_mfma_f32_16x16x32_bf16 v[96:99], a[176:179], a[112:115], v[96:99]
v_mfma_f32_16x16x32_bf16 v[96:99], a[180:183], a[116:119], v[96:99]
v_mfma_f32_16x16x32_bf16 v[100:103], a[176:179], a[120:123], v[100:103]
s_add_u32 m0, s52, 0x1d000
v_mfma_f32_16x16x32_bf16 v[100:103], a[180:183], a[124:127], v[100:103]
buffer_load_dwordx4 v23, s[20:23], s49 offen lds
s_add_u32 s49, s49, 0x20000
v_mfma_f32_16x16x32_bf16 v[104:107], a[184:187], a[96:99], v[104:107]
v_mfma_f32_16x16x32_bf16 v[104:107], a[188:191], a[100:103], v[104:107]
v_mfma_f32_16x16x32_bf16 v[108:111], a[184:187], a[104:107], v[108:111]
v_mfma_f32_16x16x32_bf16 v[108:111], a[188:191], a[108:111], v[108:111]
v_mfma_f32_16x16x32_bf16 v[112:115], a[184:187], a[112:115], v[112:115]
v_mfma_f32_16x16x32_bf16 v[112:115], a[188:191], a[116:119], v[112:115]
v_mfma_f32_16x16x32_bf16 v[116:119], a[184:187], a[120:123], v[116:119]
v_mfma_f32_16x16x32_bf16 v[116:119], a[188:191], a[124:127], v[116:119]
s_waitcnt lgkmcnt(0)
v_mfma_f32_16x16x32_bf16 v[120:123], a[160:163], a[96:99], v[120:123]
ds_read_b64_tr_b16 a[176:177], v12 offset:128
ds_read_b64_tr_b16 a[178:179], v12 offset:4736
v_mfma_f32_16x16x32_bf16 v[120:123], a[164:167], a[100:103], v[120:123]
ds_read_b64_tr_b16 a[180:181], v12 offset:9344
ds_read_b64_tr_b16 a[182:183], v12 offset:13952
v_mfma_f32_16x16x32_bf16 v[124:127], a[160:163], a[104:107], v[124:127]
ds_read_b64_tr_b16 a[184:185], v12 offset:18560
ds_read_b64_tr_b16 a[186:187], v12 offset:23168
v_mfma_f32_16x16x32_bf16 v[124:127], a[164:167], a[108:111], v[124:127]
ds_read_b64_tr_b16 a[188:189], v12 offset:27776
ds_read_b64_tr_b16 a[190:191], v12 offset:32384
v_mfma_f32_16x16x32_bf16 v[128:131], a[160:163], a[112:115], v[128:131]
v_mfma_f32_16x16x32_bf16 v[128:131], a[164:167], a[116:119], v[128:131]
v_mfma_f32_16x16x32_bf16 v[132:135], a[160:163], a[120:123], v[132:135]
s_add_u32 m0, s52, 0x1e000
v_mfma_f32_16x16x32_bf16 v[132:135], a[164:167], a[124:127], v[132:135]
buffer_load_dwordx4 v23, s[20:23], s49 offen lds
s_add_u32 s49, s49, 0x20000
v_mfma_f32_16x16x32_bf16 v[136:139], a[168:171], a[96:99], v[136:139]
v_mfma_f32_16x16x32_bf16 v[136:139], a[172:175], a[100:103], v[136:139]
v_mfma_f32_16x16x32_bf16 v[140:143], a[168:171], a[104:107], v[140:143]
v_mfma_f32_16x16x32_bf16 v[140:143], a[172:175], a[108:111], v[140:143]
v_mfma_f32_16x16x32_bf16 v[144:147], a[168:171], a[112:115], v[144:147]
v_mfma_f32_16x16x32_bf16 v[144:147], a[172:175], a[116:119], v[144:147]
v_mfma_f32_16x16x32_bf16 v[148:151], a[168:171], a[120:123], v[148:151]
v_mfma_f32_16x16x32_bf16 v[148:151], a[172:175], a[124:127], v[148:151]
s_waitcnt lgkmcnt(0)
v_mfma_f32_16x16x32_bf16 v[152:155], a[176:179], a[96:99], v[152:155]
ds_read_b64_tr_b16 a[160:161], v12 offset:160
ds_read_b64_tr_b16 a[162:163], v12 offset:4768
v_mfma_f32_16x16x32_bf16 v[152:155], a[180:183], a[100:103], v[152:155]
ds_read_b64_tr_b16 a[164:165], v12 offset:9376
ds_read_b64_tr_b16 a[166:167], v12 offset:13984
v_mfma_f32_16x16x32_bf16 v[156:159], a[176:179], a[104:107], v[156:159]
ds_read_b64_tr_b16 a[168:169], v12 offset:18592
ds_read_b64_tr_b16 a[170:171], v12 offset:23200
v_mfma_f32_16x16x32_bf16 v[156:159], a[180:183], a[108:111], v[156:159]
ds_read_b64_tr_b16 a[172:173], v12 offset:27808
ds_read_b64_tr_b16 a[174:175], v12 offset:32416
v_mfma_f32_16x16x32_bf16 v[160:163], a[176:179], a[112:115], v[160:163]
v_mfma_f32_16x16x32_bf16 v[160:163], a[180:183], a[116:119], v[160:163]
v_mfma_f32_16x16x32_bf16 v[164:167], a[176:179], a[120:123], v[164:167]
s_add_u32 m0, s52, 0x1f000
v_mfma_f32_16x16x32_bf16 v[164:167], a[180:183], a[124:127], v[164:167]
buffer_load_dwordx4 v23, s[20:23], s49 offen lds
s_add_u32 s49, s49, 0x20000
v_mfma_f32_16x16x32_bf16 v[168:171], a[184:187], a[96:99], v[168:171]
v_mfma_f32_16x16x32_bf16 v[168:171], a[188:191], a[100:103], v[168:171]
v_mfma_f32_16x16x32_bf16 v[172:175], a[184:187], a[104:107], v[172:175]
v_mfma_f32_16x16x32_bf16 v[172:175], a[188:191], a[108:111], v[172:175]
v_mfma_f32_16x16x32_bf16 v[176:179], a[184:187], a[112:115], v[176:179]
v_mfma_f32_16x16x32_bf16 v[176:179], a[188:191], a[116:119], v[176:179]
v_mfma_f32_16x16x32_bf16 v[180:183], a[184:187], a[120:123], v[180:183]
v_mfma_f32_16x16x32_bf16 v[180:183], a[188:191], a[124:127], v[180:183]
s_waitcnt lgkmcnt(0)
v_mfma_f32_16x16x32_bf16 v[184:187], a[160:163], a[96:99], v[184:187]
ds_read_b64_tr_b16 a[176:177], v12 offset:192
ds_read_b64_tr_b16 a[178:179], v12 offset:4800
v_mfma_f32_16x16x32_bf16 v[184:187], a[164:167], a[100:103], v[184:187]
ds_read_b64_tr_b16 a[180:181], v12 offset:9408
ds_read_b64_tr_b16 a[182:183], v12 offset:14016
v_mfma_f32_16x16x32_bf16 v[188:191], a[160:163], a[104:107], v[188:191]
ds_read_b64_tr_b16 a[184:185], v12 offset:18624
ds_read_b64_tr_b16 a[186:187], v12 offset:23232
v_mfma_f32_16x16x32_bf16 v[188:191], a[164:167], a[108:111], v[188:191]
ds_read_b64_tr_b16 a[188:189], v12 offset:27840
ds_read_b64_tr_b16 a[190:191], v12 offset:32448
v_mfma_f32_16x16x32_bf16 v[192:195], a[160:163], a[112:115], v[192:195]
v_mfma_f32_16x16x32_bf16 v[192:195], a[164:167], a[116:119], v[192:195]
v_mfma_f32_16x16x32_bf16 v[196:199], a[160:163], a[120:123], v[196:199]
s_add_u32 m0, s52, 0x20000
v_mfma_f32_16x16x32_bf16 v[196:199], a[164:167], a[124:127], v[196:199]
buffer_load_dwordx4 v23, s[20:23], s49 offen lds
s_add_u32 s49, s49, 0x20000
v_mfma_f32_16x16x32_bf16 v[200:203], a[168:171], a[96:99], v[200:203]
v_mfma_f32_16x16x32_bf16 v[200:203], a[172:175], a[100:103], v[200:203]
v_mfma_f32_16x16x32_bf16 v[204:207], a[168:171], a[104:107], v[204:207]
v_mfma_f32_16x16x32_bf16 v[204:207], a[172:175], a[108:111], v[204:207]
v_mfma_f32_16x16x32_bf16 v[208:211], a[168:171], a[112:115], v[208:211]
v_mfma_f32_16x16x32_bf16 v[208:211], a[172:175], a[116:119], v[208:211]
v_mfma_f32_16x16x32_bf16 v[212:215], a[168:171], a[120:123], v[212:215]
v_mfma_f32_16x16x32_bf16 v[212:215], a[172:175], a[124:127], v[212:215]
s_waitcnt lgkmcnt(0)
v_mfma_f32_16x16x32_bf16 v[216:219], a[176:179], a[96:99], v[216:219]
ds_read_b64_tr_b16 a[160:161], v12 offset:224
ds_read_b64_tr_b16 a[162:163], v12 offset:4832
v_mfma_f32_16x16x32_bf16 v[216:219], a[180:183], a[100:103], v[216:219]
ds_read_b64_tr_b16 a[164:165], v12 offset:9440
ds_read_b64_tr_b16 a[166:167], v12 offset:14048
v_mfma_f32_16x16x32_bf16 v[220:223], a[176:179], a[104:107], v[220:223]
ds_read_b64_tr_b16 a[168:169], v12 offset:18656
ds_read_b64_tr_b16 a[170:171], v12 offset:23264
v_mfma_f32_16x16x32_bf16 v[220:223], a[180:183], a[108:111], v[220:223]
ds_read_b64_tr_b16 a[172:173], v12 offset:27872
ds_read_b64_tr_b16 a[174:175], v12 offset:32480
v_mfma_f32_16x16x32_bf16 v[224:227], a[176:179], a[112:115], v[224:227]
v_mfma_f32_16x16x32_bf16 v[224:227], a[180:183], a[116:119], v[224:227]
v_mfma_f32_16x16x32_bf16 v[228:231], a[176:179], a[120:123], v[228:231]
v_mfma_f32_16x16x32_bf16 v[228:231], a[180:183], a[124:127], v[228:231]
v_mfma_f32_16x16x32_bf16 v[232:235], a[184:187], a[96:99], v[232:235]
v_mfma_f32_16x16x32_bf16 v[232:235], a[188:191], a[100:103], v[232:235]
v_mfma_f32_16x16x32_bf16 v[236:239], a[184:187], a[104:107], v[236:239]
v_mfma_f32_16x16x32_bf16 v[236:239], a[188:191], a[108:111], v[236:239]
v_mfma_f32_16x16x32_bf16 v[240:243], a[184:187], a[112:115], v[240:243]
v_mfma_f32_16x16x32_bf16 v[240:243], a[188:191], a[116:119], v[240:243]
v_mfma_f32_16x16x32_bf16 v[244:247], a[184:187], a[120:123], v[244:247]
v_mfma_f32_16x16x32_bf16 v[244:247], a[188:191], a[124:127], v[244:247]
s_waitcnt lgkmcnt(0)
v_mfma_f32_16x16x32_bf16 a[0:3], a[160:163], a[96:99], a[0:3]
ds_read_b64_tr_b16 a[176:177], v12 offset:256
ds_read_b64_tr_b16 a[178:179], v12 offset:4864
v_mfma_f32_16x16x32_bf16 a[0:3], a[164:167], a[100:103], a[0:3]
ds_read_b64_tr_b16 a[180:181], v12 offset:9472
ds_read_b64_tr_b16 a[182:183], v12 offset:14080
v_mfma_f32_16x16x32_bf16 a[4:7], a[160:163], a[104:107], a[4:7]
ds_read_b64_tr_b16 a[184:185], v12 offset:18688
ds_read_b64_tr_b16 a[186:187], v12 offset:23296
v_mfma_f32_16x16x32_bf16 a[4:7], a[164:167], a[108:111], a[4:7]
ds_read_b64_tr_b16 a[188:189], v12 offset:27904
ds_read_b64_tr_b16 a[190:191], v12 offset:32512
v_mfma_f32_16x16x32_bf16 a[8:11], a[160:163], a[112:115], a[8:11]
v_mfma_f32_16x16x32_bf16 a[8:11], a[164:167], a[116:119], a[8:11]
v_mfma_f32_16x16x32_bf16 a[12:15], a[160:163], a[120:123], a[12:15]
v_mfma_f32_16x16x32_bf16 a[12:15], a[164:167], a[124:127], a[12:15]
v_mfma_f32_16x16x32_bf16 a[16:19], a[168:171], a[96:99], a[16:19]
v_mfma_f32_16x16x32_bf16 a[16:19], a[172:175], a[100:103], a[16:19]
v_mfma_f32_16x16x32_bf16 a[20:23], a[168:171], a[104:107], a[20:23]
v_mfma_f32_16x16x32_bf16 a[20:23], a[172:175], a[108:111], a[20:23]
v_mfma_f32_16x16x32_bf16 a[24:27], a[168:171], a[112:115], a[24:27]
v_mfma_f32_16x16x32_bf16 a[24:27], a[172:175], a[116:119], a[24:27]
v_mfma_f32_16x16x32_bf16 a[28:31], a[168:171], a[120:123], a[28:31]
v_mfma_f32_16x16x32_bf16 a[28:31], a[172:175], a[124:127], a[28:31]
s_waitcnt lgkmcnt(0)
v_mfma_f32_16x16x32_bf16 a[32:35], a[176:179], a[96:99], a[32:35]
s_waitcnt vmcnt(6)
s_barrier
v_mfma_f32_16x16x32_bf16 a[32:35], a[180:183], a[100:103], a[32:35]
ds_read_b64_tr_b16 a[160:161], v13
ds_read_b64_tr_b16 a[162:163], v13 offset:4608
v_mfma_f32_16x16x32_bf16 a[36:39], a[176:179], a[104:107], a[36:39]
ds_read_b64_tr_b16 a[164:165], v13 offset:9216
ds_read_b64_tr_b16 a[166:167], v13 offset:13824
v_mfma_f32_16x16x32_bf16 a[36:39], a[180:183], a[108:111], a[36:39]
ds_read_b64_tr_b16 a[168:169], v13 offset:18432
ds_read_b64_tr_b16 a[170:171], v13 offset:23040
v_mfma_f32_16x16x32_bf16 a[40:43], a[176:179], a[112:115], a[40:43]
ds_read_b64_tr_b16 a[172:173], v13 offset:27648
ds_read_b64_tr_b16 a[174:175], v13 offset:32256
v_mfma_f32_16x16x32_bf16 a[40:43], a[180:183], a[116:119], a[40:43]
v_mfma_f32_16x16x32_bf16 a[44:47], a[176:179], a[120:123], a[44:47]
v_mfma_f32_16x16x32_bf16 a[44:47], a[180:183], a[124:127], a[44:47]
v_mfma_f32_16x16x32_bf16 a[48:51], a[184:187], a[96:99], a[48:51]
v_mfma_f32_16x16x32_bf16 a[48:51], a[188:191], a[100:103], a[48:51]
v_mfma_f32_16x16x32_bf16 a[52:55], a[184:187], a[104:107], a[52:55]
v_mfma_f32_16x16x32_bf16 a[52:55], a[188:191], a[108:111], a[52:55]
v_mfma_f32_16x16x32_bf16 a[56:59], a[184:187], a[112:115], a[56:59]
v_mfma_f32_16x16x32_bf16 a[56:59], a[188:191], a[116:119], a[56:59]
v_mfma_f32_16x16x32_bf16 a[60:63], a[184:187], a[120:123], a[60:63]
v_mfma_f32_16x16x32_bf16 a[60:63], a[188:191], a[124:127], a[60:63]
s_waitcnt lgkmcnt(0)
v_mfma_f32_16x16x32_bf16 v[24:27], a[160:163], a[128:131], v[24:27]
ds_read_b64_tr_b16 a[176:177], v13 offset:32
ds_read_b64_tr_b16 a[178:179], v13 offset:4640
v_mfma_f32_16x16x32_bf16 v[24:27], a[164:167], a[132:135], v[24:27]
ds_read_b64_tr_b16 a[180:181], v13 offset:9248
ds_read_b64_tr_b16 a[182:183], v13 offset:13856
v_mfma_f32_16x16x32_bf16 v[28:31], a[160:163], a[136:139], v[28:31]
ds_read_b64_tr_b16 a[184:185], v13 offset:18464
ds_read_b64_tr_b16 a[186:187], v13 offset:23072
v_mfma_f32_16x16x32_bf16 v[28:31], a[164:167], a[140:143], v[28:31]
ds_read_b64_tr_b16 a[188:189], v13 offset:27680
ds_read_b64_tr_b16 a[190:191], v13 offset:32288
v_mfma_f32_16x16x32_bf16 v[32:35], a[160:163], a[144:147], v[32:35]
v_mfma_f32_16x16x32_bf16 v[32:35], a[164:167], a[148:151], v[32:35]
v_mfma_f32_16x16x32_bf16 v[36:39], a[160:163], a[152:155], v[36:39]
s_add_u32 m0, s52, 0x21000
v_mfma_f32_16x16x32_bf16 v[36:39], a[164:167], a[156:159], v[36:39]
buffer_load_dwordx4 v23, s[20:23], s49 offen lds
s_add_u32 s49, s49, 0x20000
v_mfma_f32_16x16x32_bf16 v[40:43], a[168:171], a[128:131], v[40:43]
v_mfma_f32_16x16x32_bf16 v[40:43], a[172:175], a[132:135], v[40:43]
v_mfma_f32_16x16x32_bf16 v[44:47], a[168:171], a[136:139], v[44:47]
buffer_load_dwordx4 a[64:67], v14, s[32:35], s48 offen sc1
v_mfma_f32_16x16x32_bf16 v[44:47], a[172:175], a[140:143], v[44:47]
v_mfma_f32_16x16x32_bf16 v[48:51], a[168:171], a[144:147], v[48:51]
v_mfma_f32_16x16x32_bf16 v[48:51], a[172:175], a[148:151], v[48:51]
buffer_load_dwordx4 a[76:79], v14, s[32:35], s48 offen offset:1024 sc1
v_mfma_f32_16x16x32_bf16 v[52:55], a[168:171], a[152:155], v[52:55]
v_mfma_f32_16x16x32_bf16 v[52:55], a[172:175], a[156:159], v[52:55]
s_waitcnt lgkmcnt(0)
v_mfma_f32_16x16x32_bf16 v[56:59], a[176:179], a[128:131], v[56:59]
ds_read_b64_tr_b16 a[160:161], v13 offset:64
ds_read_b64_tr_b16 a[162:163], v13 offset:4672
v_mfma_f32_16x16x32_bf16 v[56:59], a[180:183], a[132:135], v[56:59]
ds_read_b64_tr_b16 a[164:165], v13 offset:9280
ds_read_b64_tr_b16 a[166:167], v13 offset:13888
v_mfma_f32_16x16x32_bf16 v[60:63], a[176:179], a[136:139], v[60:63]
ds_read_b64_tr_b16 a[168:169], v13 offset:18496
ds_read_b64_tr_b16 a[170:171], v13 offset:23104
v_mfma_f32_16x16x32_bf16 v[60:63], a[180:183], a[140:143], v[60:63]
ds_read_b64_tr_b16 a[172:173], v13 offset:27712
ds_read_b64_tr_b16 a[174:175], v13 offset:32320
v_mfma_f32_16x16x32_bf16 v[64:67], a[176:179], a[144:147], v[64:67]
v_mfma_f32_16x16x32_bf16 v[64:67], a[180:183], a[148:151], v[64:67]
v_mfma_f32_16x16x32_bf16 v[68:71], a[176:179], a[152:155], v[68:71]
s_add_u32 m0, s52, 0x22000
v_mfma_f32_16x16x32_bf16 v[68:71], a[180:183], a[156:159], v[68:71]
buffer_load_dwordx4 v23, s[20:23], s49 offen lds
s_add_u32 s49, s49, 0x20000
v_mfma_f32_16x16x32_bf16 v[72:75], a[184:187], a[128:131], v[72:75]
v_mfma_f32_16x16x32_bf16 v[72:75], a[188:191], a[132:135], v[72:75]
v_mfma_f32_16x16x32_bf16 v[76:79], a[184:187], a[136:139], v[76:79]
buffer_load_dwordx4 a[88:91], v14, s[32:35], s48 offen offset:2048 sc1
v_mfma_f32_16x16x32_bf16 v[76:79], a[188:191], a[140:143], v[76:79]
v_mfma_f32_16x16x32_bf16 v[80:83], a[184:187], a[144:147], v[80:83]
v_mfma_f32_16x16x32_bf16 v[80:83], a[188:191], a[148:151], v[80:83]
buffer_load_dwordx4 a[100:103], v14, s[32:35], s48 offen offset:3072 sc1
v_mfma_f32_16x16x32_bf16 v[84:87], a[184:187], a[152:155], v[84:87]
v_mfma_f32_16x16x32_bf16 v[84:87], a[188:191], a[156:159], v[84:87]
s_waitcnt lgkmcnt(0)
v_mfma_f32_16x16x32_bf16 v[88:91], a[160:163], a[128:131], v[88:91]
ds_read_b64_tr_b16 a[176:177], v13 offset:96
ds_read_b64_tr_b16 a[178:179], v13 offset:4704
v_mfma_f32_16x16x32_bf16 v[88:91], a[164:167], a[132:135], v[88:91]
ds_read_b64_tr_b16 a[180:181], v13 offset:9312
ds_read_b64_tr_b16 a[182:183], v13 offset:13920
v_mfma_f32_16x16x32_bf16 v[92:95], a[160:163], a[136:139], v[92:95]
ds_read_b64_tr_b16 a[184:185], v13 offset:18528
ds_read_b64_tr_b16 a[186:187], v13 offset:23136
v_mfma_f32_16x16x32_bf16 v[92:95], a[164:167], a[140:143], v[92:95]
ds_read_b64_tr_b16 a[188:189], v13 offset:27744
ds_read_b64_tr_b16 a[190:191], v13 offset:32352
v_mfma_f32_16x16x32_bf16 v[96:99], a[160:163], a[144:147], v[96:99]
v_mfma_f32_16x16x32_bf16 v[96:99], a[164:167], a[148:151], v[96:99]
v_mfma_f32_16x16x32_bf16 v[100:103], a[160:163], a[152:155], v[100:103]
s_add_u32 m0, s52, 0x23000
v_mfma_f32_16x16x32_bf16 v[100:103], a[164:167], a[156:159], v[100:103]
buffer_load_dwordx4 v23, s[20:23], s49 offen lds
s_add_u32 s49, s49, 0x20000
v_mfma_f32_16x16x32_bf16 v[104:107], a[168:171], a[128:131], v[104:107]
v_mfma_f32_16x16x32_bf16 v[104:107], a[172:175], a[132:135], v[104:107]
v_mfma_f32_16x16x32_bf16 v[108:111], a[168:171], a[136:139], v[108:111]
buffer_load_dwordx4 a[68:71], v15, s[32:35], s48 offen sc1
v_mfma_f32_16x16x32_bf16 v[108:111], a[172:175], a[140:143], v[108:111]
v_mfma_f32_16x16x32_bf16 v[112:115], a[168:171], a[144:147], v[112:115]
v_mfma_f32_16x16x32_bf16 v[112:115], a[172:175], a[148:151], v[112:115]
buffer_load_dwordx4 a[80:83], v15, s[32:35], s48 offen offset:1024 sc1
v_mfma_f32_16x16x32_bf16 v[116:119], a[168:171], a[152:155], v[116:119]
v_mfma_f32_16x16x32_bf16 v[116:119], a[172:175], a[156:159], v[116:119]
s_waitcnt lgkmcnt(0)
v_mfma_f32_16x16x32_bf16 v[120:123], a[176:179], a[128:131], v[120:123]
ds_read_b64_tr_b16 a[160:161], v13 offset:128
ds_read_b64_tr_b16 a[162:163], v13 offset:4736
v_mfma_f32_16x16x32_bf16 v[120:123], a[180:183], a[132:135], v[120:123]
ds_read_b64_tr_b16 a[164:165], v13 offset:9344
ds_read_b64_tr_b16 a[166:167], v13 offset:13952
v_mfma_f32_16x16x32_bf16 v[124:127], a[176:179], a[136:139], v[124:127]
ds_read_b64_tr_b16 a[168:169], v13 offset:18560
ds_read_b64_tr_b16 a[170:171], v13 offset:23168
v_mfma_f32_16x16x32_bf16 v[124:127], a[180:183], a[140:143], v[124:127]
ds_read_b64_tr_b16 a[172:173], v13 offset:27776
ds_read_b64_tr_b16 a[174:175], v13 offset:32384
v_mfma_f32_16x16x32_bf16 v[128:131], a[176:179], a[144:147], v[128:131]
v_mfma_f32_16x16x32_bf16 v[128:131], a[180:183], a[148:151], v[128:131]
v_mfma_f32_16x16x32_bf16 v[132:135], a[176:179], a[152:155], v[132:135]
s_add_u32 m0, s52, 0x24000
v_mfma_f32_16x16x32_bf16 v[132:135], a[180:183], a[156:159], v[132:135]
buffer_load_dwordx4 v23, s[20:23], s49 offen lds
s_add_u32 s49, s49, 0x20000
v_mfma_f32_16x16x32_bf16 v[136:139], a[184:187], a[128:131], v[136:139]
v_mfma_f32_16x16x32_bf16 v[136:139], a[188:191], a[132:135], v[136:139]
v_mfma_f32_16x16x32_bf16 v[140:143], a[184:187], a[136:139], v[140:143]
buffer_load_dwordx4 a[92:95], v15, s[32:35], s48 offen offset:2048 sc1
v_mfma_f32_16x16x32_bf16 v[140:143], a[188:191], a[140:143], v[140:143]
v_mfma_f32_16x16x32_bf16 v[144:147], a[184:187], a[144:147], v[144:147]
v_mfma_f32_16x16x32_bf16 v[144:147], a[188:191], a[148:151], v[144:147]
buffer_load_dwordx4 a[104:107], v15, s[32:35], s48 offen offset:3072 sc1
v_mfma_f32_16x16x32_bf16 v[148:151], a[184:187], a[152:155], v[148:151]
v_mfma_f32_16x16x32_bf16 v[148:151], a[188:191], a[156:159], v[148:151]
s_waitcnt lgkmcnt(0)
v_mfma_f32_16x16x32_bf16 v[152:155], a[160:163], a[128:131], v[152:155]
ds_read_b64_tr_b16 a[176:177], v13 offset:160
ds_read_b64_tr_b16 a[178:179], v13 offset:4768
v_mfma_f32_16x16x32_bf16 v[152:155], a[164:167], a[132:135], v[152:155]
ds_read_b64_tr_b16 a[180:181], v13 offset:9376
ds_read_b64_tr_b16 a[182:183], v13 offset:13984
v_mfma_f32_16x16x32_bf16 v[156:159], a[160:163], a[136:139], v[156:159]
ds_read_b64_tr_b16 a[184:185], v13 offset:18592
ds_read_b64_tr_b16 a[186:187], v13 offset:23200
v_mfma_f32_16x16x32_bf16 v[156:159], a[164:167], a[140:143], v[156:159]
ds_read_b64_tr_b16 a[188:189], v13 offset:27808
ds_read_b64_tr_b16 a[190:191], v13 offset:32416
v_mfma_f32_16x16x32_bf16 v[160:163], a[160:163], a[144:147], v[160:163]
v_mfma_f32_16x16x32_bf16 v[160:163], a[164:167], a[148:151], v[160:163]
v_mfma_f32_16x16x32_bf16 v[164:167], a[160:163], a[152:155], v[164:167]
s_add_u32 m0, s52, 0x25000
v_mfma_f32_16x16x32_bf16 v[164:167], a[164:167], a[156:159], v[164:167]
buffer_load_dwordx4 v23, s[20:23], s49 offen lds
s_add_u32 s49, s49, 0x20000
v_mfma_f32_16x16x32_bf16 v[168:171], a[168:171], a[128:131], v[168:171]
v_mfma_f32_16x16x32_bf16 v[168:171], a[172:175], a[132:135], v[168:171]
v_mfma_f32_16x16x32_bf16 v[172:175], a[168:171], a[136:139], v[172:175]
buffer_load_dwordx4 a[72:75], v16, s[32:35], s48 offen sc1
v_mfma_f32_16x16x32_bf16 v[172:175], a[172:175], a[140:143], v[172:175]
v_mfma_f32_16x16x32_bf16 v[176:179], a[168:171], a[144:147], v[176:179]
v_mfma_f32_16x16x32_bf16 v[176:179], a[172:175], a[148:151], v[176:179]
buffer_load_dwordx4 a[84:87], v16, s[32:35], s48 offen offset:1024 sc1
v_mfma_f32_16x16x32_bf16 v[180:183], a[168:171], a[152:155], v[180:183]
v_mfma_f32_16x16x32_bf16 v[180:183], a[172:175], a[156:159], v[180:183]
s_waitcnt lgkmcnt(0)
v_mfma_f32_16x16x32_bf16 v[184:187], a[176:179], a[128:131], v[184:187]
ds_read_b64_tr_b16 a[160:161], v13 offset:192
ds_read_b64_tr_b16 a[162:163], v13 offset:4800
v_mfma_f32_16x16x32_bf16 v[184:187], a[180:183], a[132:135], v[184:187]
ds_read_b64_tr_b16 a[164:165], v13 offset:9408
ds_read_b64_tr_b16 a[166:167], v13 offset:14016
v_mfma_f32_16x16x32_bf16 v[188:191], a[176:179], a[136:139], v[188:191]
ds_read_b64_tr_b16 a[168:169], v13 offset:18624
ds_read_b64_tr_b16 a[170:171], v13 offset:23232
v_mfma_f32_16x16x32_bf16 v[188:191], a[180:183], a[140:143], v[188:191]
ds_read_b64_tr_b16 a[172:173], v13 offset:27840
ds_read_b64_tr_b16 a[174:175], v13 offset:32448
v_mfma_f32_16x16x32_bf16 v[192:195], a[176:179], a[144:147], v[192:195]
v_mfma_f32_16x16x32_bf16 v[192:195], a[180:183], a[148:151], v[192:195]
v_mfma_f32_16x16x32_bf16 v[196:199], a[176:179], a[152:155], v[196:199]
s_add_u32 m0, s52, 0x26000
v_mfma_f32_16x16x32_bf16 v[196:199], a[180:183], a[156:159], v[196:199]
buffer_load_dwordx4 v23, s[20:23], s49 offen lds
s_add_u32 s49, s49, 0x20000
v_mfma_f32_16x16x32_bf16 v[200:203], a[184:187], a[128:131], v[200:203]
v_mfma_f32_16x16x32_bf16 v[200:203], a[188:191], a[132:135], v[200:203]
v_mfma_f32_16x16x32_bf16 v[204:207], a[184:187], a[136:139], v[204:207]
buffer_load_dwordx4 a[96:99], v16, s[32:35], s48 offen offset:2048 sc1
v_mfma_f32_16x16x32_bf16 v[204:207], a[188:191], a[140:143], v[204:207]
v_mfma_f32_16x16x32_bf16 v[208:211], a[184:187], a[144:147], v[208:211]
v_mfma_f32_16x16x32_bf16 v[208:211], a[188:191], a[148:151], v[208:211]
buffer_load_dwordx4 a[108:111], v16, s[32:35], s48 offen offset:3072 sc1
s_add_u32 s48, s48, 0x60000
v_mfma_f32_16x16x32_bf16 v[212:215], a[184:187], a[152:155], v[212:215]
v_mfma_f32_16x16x32_bf16 v[212:215], a[188:191], a[156:159], v[212:215]
s_waitcnt lgkmcnt(0)
v_mfma_f32_16x16x32_bf16 v[216:219], a[160:163], a[128:131], v[216:219]
ds_read_b64_tr_b16 a[176:177], v13 offset:224
ds_read_b64_tr_b16 a[178:179], v13 offset:4832
v_mfma_f32_16x16x32_bf16 v[216:219], a[164:167], a[132:135], v[216:219]
ds_read_b64_tr_b16 a[180:181], v13 offset:9440
ds_read_b64_tr_b16 a[182:183], v13 offset:14048
v_mfma_f32_16x16x32_bf16 v[220:223], a[160:163], a[136:139], v[220:223]
ds_read_b64_tr_b16 a[184:185], v13 offset:18656
ds_read_b64_tr_b16 a[186:187], v13 offset:23264
v_mfma_f32_16x16x32_bf16 v[220:223], a[164:167], a[140:143], v[220:223]
ds_read_b64_tr_b16 a[188:189], v13 offset:27872
ds_read_b64_tr_b16 a[190:191], v13 offset:32480
v_mfma_f32_16x16x32_bf16 v[224:227], a[160:163], a[144:147], v[224:227]
v_mfma_f32_16x16x32_bf16 v[224:227], a[164:167], a[148:151], v[224:227]
v_mfma_f32_16x16x32_bf16 v[228:231], a[160:163], a[152:155], v[228:231]
v_mfma_f32_16x16x32_bf16 v[228:231], a[164:167], a[156:159], v[228:231]
v_mfma_f32_16x16x32_bf16 v[232:235], a[168:171], a[128:131], v[232:235]
v_mfma_f32_16x16x32_bf16 v[232:235], a[172:175], a[132:135], v[232:235]
v_mfma_f32_16x16x32_bf16 v[236:239], a[168:171], a[136:139], v[236:239]
v_mfma_f32_16x16x32_bf16 v[236:239], a[172:175], a[140:143], v[236:239]
v_mfma_f32_16x16x32_bf16 v[240:243], a[168:171], a[144:147], v[240:243]
v_mfma_f32_16x16x32_bf16 v[240:243], a[172:175], a[148:151], v[240:243]
v_mfma_f32_16x16x32_bf16 v[244:247], a[168:171], a[152:155], v[244:247]
v_mfma_f32_16x16x32_bf16 v[244:247], a[172:175], a[156:159], v[244:247]
s_waitcnt lgkmcnt(0)
v_mfma_f32_16x16x32_bf16 a[0:3], a[176:179], a[128:131], a[0:3]
ds_read_b64_tr_b16 a[160:161], v13 offset:256
ds_read_b64_tr_b16 a[162:163], v13 offset:4864
v_mfma_f32_16x16x32_bf16 a[0:3], a[180:183], a[132:135], a[0:3]
ds_read_b64_tr_b16 a[164:165], v13 offset:9472
ds_read_b64_tr_b16 a[166:167], v13 offset:14080
v_mfma_f32_16x16x32_bf16 a[4:7], a[176:179], a[136:139], a[4:7]
ds_read_b64_tr_b16 a[168:169], v13 offset:18688
ds_read_b64_tr_b16 a[170:171], v13 offset:23296
v_mfma_f32_16x16x32_bf16 a[4:7], a[180:183], a[140:143], a[4:7]
ds_read_b64_tr_b16 a[172:173], v13 offset:27904
ds_read_b64_tr_b16 a[174:175], v13 offset:32512
v_mfma_f32_16x16x32_bf16 a[8:11], a[176:179], a[144:147], a[8:11]
v_mfma_f32_16x16x32_bf16 a[8:11], a[180:183], a[148:151], a[8:11]
v_mfma_f32_16x16x32_bf16 a[12:15], a[176:179], a[152:155], a[12:15]
v_mfma_f32_16x16x32_bf16 a[12:15], a[180:183], a[156:159], a[12:15]
v_mfma_f32_16x16x32_bf16 a[16:19], a[184:187], a[128:131], a[16:19]
v_mfma_f32_16x16x32_bf16 a[16:19], a[188:191], a[132:135], a[16:19]
v_mfma_f32_16x16x32_bf16 a[20:23], a[184:187], a[136:139], a[20:23]
v_mfma_f32_16x16x32_bf16 a[20:23], a[188:191], a[140:143], a[20:23]
v_mfma_f32_16x16x32_bf16 a[24:27], a[184:187], a[144:147], a[24:27]
v_mfma_f32_16x16x32_bf16 a[24:27], a[188:191], a[148:151], a[24:27]
v_mfma_f32_16x16x32_bf16 a[28:31], a[184:187], a[152:155], a[28:31]
v_mfma_f32_16x16x32_bf16 a[28:31], a[188:191], a[156:159], a[28:31]
s_waitcnt lgkmcnt(0)
v_mfma_f32_16x16x32_bf16 a[32:35], a[160:163], a[128:131], a[32:35]
v_mfma_f32_16x16x32_bf16 a[32:35], a[164:167], a[132:135], a[32:35]
v_mfma_f32_16x16x32_bf16 a[36:39], a[160:163], a[136:139], a[36:39]
v_mfma_f32_16x16x32_bf16 a[36:39], a[164:167], a[140:143], a[36:39]
v_mfma_f32_16x16x32_bf16 a[40:43], a[160:163], a[144:147], a[40:43]
v_mfma_f32_16x16x32_bf16 a[40:43], a[164:167], a[148:151], a[40:43]
v_mfma_f32_16x16x32_bf16 a[44:47], a[160:163], a[152:155], a[44:47]
v_mfma_f32_16x16x32_bf16 a[44:47], a[164:167], a[156:159], a[44:47]
v_mfma_f32_16x16x32_bf16 a[48:51], a[168:171], a[128:131], a[48:51]
v_mfma_f32_16x16x32_bf16 a[48:51], a[172:175], a[132:135], a[48:51]
v_mfma_f32_16x16x32_bf16 a[52:55], a[168:171], a[136:139], a[52:55]
v_mfma_f32_16x16x32_bf16 a[52:55], a[172:175], a[140:143], a[52:55]
v_mfma_f32_16x16x32_bf16 a[56:59], a[168:171], a[144:147], a[56:59]
v_mfma_f32_16x16x32_bf16 a[56:59], a[172:175], a[148:151], a[56:59]
v_mfma_f32_16x16x32_bf16 a[60:63], a[168:171], a[152:155], a[60:63]
v_mfma_f32_16x16x32_bf16 a[60:63], a[172:175], a[156:159], a[60:63]
buffer_load_dwordx4 a[112:115], v14, s[32:35], s48 offen sc1
buffer_load_dwordx4 a[124:127], v14, s[32:35], s48 offen offset:1024 sc1
buffer_load_dwordx4 a[136:139], v14, s[32:35], s48 offen offset:2048 sc1
buffer_load_dwordx4 a[148:151], v14, s[32:35], s48 offen offset:3072 sc1
buffer_load_dwordx4 a[116:119], v15, s[32:35], s48 offen sc1
buffer_load_dwordx4 a[128:131], v15, s[32:35], s48 offen offset:1024 sc1
buffer_load_dwordx4 a[140:143], v15, s[32:35], s48 offen offset:2048 sc1
buffer_load_dwordx4 a[152:155], v15, s[32:35], s48 offen offset:3072 sc1
buffer_load_dwordx4 a[120:123], v16, s[32:35], s48 offen sc1
buffer_load_dwordx4 a[132:135], v16, s[32:35], s48 offen offset:1024 sc1
buffer_load_dwordx4 a[144:147], v16, s[32:35], s48 offen offset:2048 sc1
buffer_load_dwordx4 a[156:159], v16, s[32:35], s48 offen offset:3072 sc1
s_add_u32 s48, s48, 0x60000
s_mul_i32 s56, s45, 9
s_lshr_b32 s56, s56, 1
s_lshl_b32 s56, s56, 17
s_add_u32 s53, s53, s56
s_bitcmp1_b32 s45, 0
s_cbranch_scc1 recurrent_scan__gqa_block_cached__glu_gated_reglu__prompt_kernel_godd9
s_add_u32 s92, s53, 0
s_add_u32 s93, s53, 0x40000
s_add_u32 s94, s53, 0x20000
s_add_u32 s95, s53, 0x60000
s_add_u32 s59, s53, 0x80000
v_max_f32 v152, 0, v152
v_max_f32 v153, 0, v153
v_max_f32 v154, 0, v154
v_max_f32 v155, 0, v155
v_pk_mul_f32 v[152:153], v[152:153], v[168:169]
v_pk_mul_f32 v[154:155], v[154:155], v[170:171]
v_cvt_pk_bf16_f32 v168, v152, v153
v_cvt_pk_bf16_f32 v169, v154, v155
v_max_f32 v156, 0, v156
v_max_f32 v157, 0, v157
v_max_f32 v158, 0, v158
v_max_f32 v159, 0, v159
v_pk_mul_f32 v[156:157], v[156:157], v[172:173]
v_pk_mul_f32 v[158:159], v[158:159], v[174:175]
v_cvt_pk_bf16_f32 v172, v156, v157
v_cvt_pk_bf16_f32 v173, v158, v159
v_max_f32 v160, 0, v160
v_max_f32 v161, 0, v161
v_max_f32 v162, 0, v162
v_max_f32 v163, 0, v163
v_pk_mul_f32 v[160:161], v[160:161], v[176:177]
v_pk_mul_f32 v[162:163], v[162:163], v[178:179]
v_cvt_pk_bf16_f32 v176, v160, v161
v_cvt_pk_bf16_f32 v177, v162, v163
v_max_f32 v164, 0, v164
v_max_f32 v165, 0, v165
v_max_f32 v166, 0, v166
v_max_f32 v167, 0, v167
v_pk_mul_f32 v[164:165], v[164:165], v[180:181]
v_pk_mul_f32 v[166:167], v[166:167], v[182:183]
v_cvt_pk_bf16_f32 v180, v164, v165
v_cvt_pk_bf16_f32 v181, v166, v167
v_max_f32 v184, 0, v184
v_max_f32 v185, 0, v185
v_max_f32 v186, 0, v186
v_max_f32 v187, 0, v187
v_pk_mul_f32 v[184:185], v[184:185], v[200:201]
v_pk_mul_f32 v[186:187], v[186:187], v[202:203]
v_cvt_pk_bf16_f32 v170, v184, v185
v_cvt_pk_bf16_f32 v171, v186, v187
v_max_f32 v188, 0, v188
v_max_f32 v189, 0, v189
v_max_f32 v190, 0, v190
v_max_f32 v191, 0, v191
v_pk_mul_f32 v[188:189], v[188:189], v[204:205]
v_pk_mul_f32 v[190:191], v[190:191], v[206:207]
v_cvt_pk_bf16_f32 v174, v188, v189
v_cvt_pk_bf16_f32 v175, v190, v191
v_max_f32 v192, 0, v192
v_max_f32 v193, 0, v193
v_max_f32 v194, 0, v194
v_max_f32 v195, 0, v195
v_pk_mul_f32 v[192:193], v[192:193], v[208:209]
v_pk_mul_f32 v[194:195], v[194:195], v[210:211]
v_cvt_pk_bf16_f32 v178, v192, v193
v_cvt_pk_bf16_f32 v179, v194, v195
v_max_f32 v196, 0, v196
v_max_f32 v197, 0, v197
v_max_f32 v198, 0, v198
v_max_f32 v199, 0, v199
v_pk_mul_f32 v[196:197], v[196:197], v[212:213]
v_pk_mul_f32 v[198:199], v[198:199], v[214:215]
v_cvt_pk_bf16_f32 v182, v196, v197
v_cvt_pk_bf16_f32 v183, v198, v199
v_max_f32 v24, 0, v24
v_max_f32 v25, 0, v25
v_max_f32 v26, 0, v26
v_max_f32 v27, 0, v27
v_pk_mul_f32 v[24:25], v[24:25], v[40:41]
v_pk_mul_f32 v[26:27], v[26:27], v[42:43]
v_cvt_pk_bf16_f32 v152, v24, v25
v_cvt_pk_bf16_f32 v153, v26, v27
buffer_store_dwordx4 v[168:171], v18, s[36:39], s93 offen sc1
v_max_f32 v28, 0, v28
v_max_f32 v29, 0, v29
v_max_f32 v30, 0, v30
v_max_f32 v31, 0, v31
v_pk_mul_f32 v[28:29], v[28:29], v[44:45]
v_pk_mul_f32 v[30:31], v[30:31], v[46:47]
v_cvt_pk_bf16_f32 v156, v28, v29
v_cvt_pk_bf16_f32 v157, v30, v31
v_max_f32 v32, 0, v32
v_max_f32 v33, 0, v33
v_max_f32 v34, 0, v34
v_max_f32 v35, 0, v35
v_pk_mul_f32 v[32:33], v[32:33], v[48:49]
v_pk_mul_f32 v[34:35], v[34:35], v[50:51]
v_cvt_pk_bf16_f32 v160, v32, v33
v_cvt_pk_bf16_f32 v161, v34, v35
v_max_f32 v36, 0, v36
v_max_f32 v37, 0, v37
v_max_f32 v38, 0, v38
v_max_f32 v39, 0, v39
v_pk_mul_f32 v[36:37], v[36:37], v[52:53]
v_pk_mul_f32 v[38:39], v[38:39], v[54:55]
v_cvt_pk_bf16_f32 v164, v36, v37
v_cvt_pk_bf16_f32 v165, v38, v39
v_max_f32 v56, 0, v56
v_max_f32 v57, 0, v57
v_max_f32 v58, 0, v58
v_max_f32 v59, 0, v59
v_pk_mul_f32 v[56:57], v[56:57], v[72:73]
v_pk_mul_f32 v[58:59], v[58:59], v[74:75]
v_cvt_pk_bf16_f32 v154, v56, v57
v_cvt_pk_bf16_f32 v155, v58, v59
v_max_f32 v60, 0, v60
v_max_f32 v61, 0, v61
v_max_f32 v62, 0, v62
v_max_f32 v63, 0, v63
v_pk_mul_f32 v[60:61], v[60:61], v[76:77]
v_pk_mul_f32 v[62:63], v[62:63], v[78:79]
v_cvt_pk_bf16_f32 v158, v60, v61
v_cvt_pk_bf16_f32 v159, v62, v63
buffer_store_dwordx4 v[172:175], v18, s[36:39], s93 offen offset:1024 sc1
v_max_f32 v64, 0, v64
v_max_f32 v65, 0, v65
v_max_f32 v66, 0, v66
v_max_f32 v67, 0, v67
v_pk_mul_f32 v[64:65], v[64:65], v[80:81]
v_pk_mul_f32 v[66:67], v[66:67], v[82:83]
v_cvt_pk_bf16_f32 v162, v64, v65
v_cvt_pk_bf16_f32 v163, v66, v67
v_max_f32 v68, 0, v68
v_max_f32 v69, 0, v69
v_max_f32 v70, 0, v70
v_max_f32 v71, 0, v71
v_pk_mul_f32 v[68:69], v[68:69], v[84:85]
v_pk_mul_f32 v[70:71], v[70:71], v[86:87]
v_cvt_pk_bf16_f32 v166, v68, v69
v_cvt_pk_bf16_f32 v167, v70, v71
v_max_f32 v88, 0, v88
v_max_f32 v89, 0, v89
v_max_f32 v90, 0, v90
v_max_f32 v91, 0, v91
v_pk_mul_f32 v[88:89], v[88:89], v[104:105]
v_pk_mul_f32 v[90:91], v[90:91], v[106:107]
v_cvt_pk_bf16_f32 v184, v88, v89
v_cvt_pk_bf16_f32 v185, v90, v91
v_max_f32 v92, 0, v92
v_max_f32 v93, 0, v93
v_max_f32 v94, 0, v94
v_max_f32 v95, 0, v95
v_pk_mul_f32 v[92:93], v[92:93], v[108:109]
v_pk_mul_f32 v[94:95], v[94:95], v[110:111]
v_cvt_pk_bf16_f32 v188, v92, v93
v_cvt_pk_bf16_f32 v189, v94, v95
v_max_f32 v96, 0, v96
v_max_f32 v97, 0, v97
v_max_f32 v98, 0, v98
v_max_f32 v99, 0, v99
v_pk_mul_f32 v[96:97], v[96:97], v[112:113]
v_pk_mul_f32 v[98:99], v[98:99], v[114:115]
v_cvt_pk_bf16_f32 v192, v96, v97
v_cvt_pk_bf16_f32 v193, v98, v99
buffer_store_dwordx4 v[176:179], v18, s[36:39], s93 offen offset:2048 sc1
v_max_f32 v100, 0, v100
v_max_f32 v101, 0, v101
v_max_f32 v102, 0, v102
v_max_f32 v103, 0, v103
v_pk_mul_f32 v[100:101], v[100:101], v[116:117]
v_pk_mul_f32 v[102:103], v[102:103], v[118:119]
v_cvt_pk_bf16_f32 v196, v100, v101
v_cvt_pk_bf16_f32 v197, v102, v103
v_max_f32 v120, 0, v120
v_max_f32 v121, 0, v121
v_max_f32 v122, 0, v122
v_max_f32 v123, 0, v123
v_pk_mul_f32 v[120:121], v[120:121], v[136:137]
v_pk_mul_f32 v[122:123], v[122:123], v[138:139]
v_cvt_pk_bf16_f32 v186, v120, v121
v_cvt_pk_bf16_f32 v187, v122, v123
v_max_f32 v124, 0, v124
v_max_f32 v125, 0, v125
v_max_f32 v126, 0, v126
v_max_f32 v127, 0, v127
v_pk_mul_f32 v[124:125], v[124:125], v[140:141]
v_pk_mul_f32 v[126:127], v[126:127], v[142:143]
v_cvt_pk_bf16_f32 v190, v124, v125
v_cvt_pk_bf16_f32 v191, v126, v127
v_max_f32 v128, 0, v128
v_max_f32 v129, 0, v129
v_max_f32 v130, 0, v130
v_max_f32 v131, 0, v131
v_pk_mul_f32 v[128:129], v[128:129], v[144:145]
v_pk_mul_f32 v[130:131], v[130:131], v[146:147]
v_cvt_pk_bf16_f32 v194, v128, v129
v_cvt_pk_bf16_f32 v195, v130, v131
v_max_f32 v132, 0, v132
v_max_f32 v133, 0, v133
v_max_f32 v134, 0, v134
v_max_f32 v135, 0, v135
v_pk_mul_f32 v[132:133], v[132:133], v[148:149]
v_pk_mul_f32 v[134:135], v[134:135], v[150:151]
v_cvt_pk_bf16_f32 v198, v132, v133
v_cvt_pk_bf16_f32 v199, v134, v135
buffer_store_dwordx4 v[180:183], v18, s[36:39], s93 offen offset:3072 sc1
v_max_f32 v216, 0, v216
v_max_f32 v217, 0, v217
v_max_f32 v218, 0, v218
v_max_f32 v219, 0, v219
v_pk_mul_f32 v[216:217], v[216:217], v[232:233]
v_pk_mul_f32 v[218:219], v[218:219], v[234:235]
v_cvt_pk_bf16_f32 v200, v216, v217
v_cvt_pk_bf16_f32 v201, v218, v219
v_max_f32 v220, 0, v220
v_max_f32 v221, 0, v221
v_max_f32 v222, 0, v222
v_max_f32 v223, 0, v223
v_pk_mul_f32 v[220:221], v[220:221], v[236:237]
v_pk_mul_f32 v[222:223], v[222:223], v[238:239]
v_cvt_pk_bf16_f32 v204, v220, v221
v_cvt_pk_bf16_f32 v205, v222, v223
v_max_f32 v224, 0, v224
v_max_f32 v225, 0, v225
v_max_f32 v226, 0, v226
v_max_f32 v227, 0, v227
v_pk_mul_f32 v[224:225], v[224:225], v[240:241]
v_pk_mul_f32 v[226:227], v[226:227], v[242:243]
v_cvt_pk_bf16_f32 v208, v224, v225
v_cvt_pk_bf16_f32 v209, v226, v227
v_max_f32 v228, 0, v228
v_max_f32 v229, 0, v229
v_max_f32 v230, 0, v230
v_max_f32 v231, 0, v231
v_pk_mul_f32 v[228:229], v[228:229], v[244:245]
v_pk_mul_f32 v[230:231], v[230:231], v[246:247]
v_cvt_pk_bf16_f32 v212, v228, v229
v_cvt_pk_bf16_f32 v213, v230, v231
v_accvgpr_read_b32 v248, a0
v_accvgpr_read_b32 v249, a1
v_accvgpr_read_b32 v250, a2
v_accvgpr_read_b32 v251, a3
v_accvgpr_read_b32 v252, a16
v_accvgpr_read_b32 v253, a17
v_accvgpr_read_b32 v254, a18
v_accvgpr_read_b32 v255, a19
v_max_f32 v248, 0, v248
v_max_f32 v249, 0, v249
v_max_f32 v250, 0, v250
v_max_f32 v251, 0, v251
v_pk_mul_f32 v[248:249], v[248:249], v[252:253]
v_pk_mul_f32 v[250:251], v[250:251], v[254:255]
v_cvt_pk_bf16_f32 v202, v248, v249
v_cvt_pk_bf16_f32 v203, v250, v251
buffer_store_dwordx4 v[152:155], v18, s[36:39], s92 offen sc1
v_accvgpr_read_b32 v248, a4
v_accvgpr_read_b32 v249, a5
v_accvgpr_read_b32 v250, a6
v_accvgpr_read_b32 v251, a7
v_accvgpr_read_b32 v252, a20
v_accvgpr_read_b32 v253, a21
v_accvgpr_read_b32 v254, a22
v_accvgpr_read_b32 v255, a23
v_max_f32 v248, 0, v248
v_max_f32 v249, 0, v249
v_max_f32 v250, 0, v250
v_max_f32 v251, 0, v251
v_pk_mul_f32 v[248:249], v[248:249], v[252:253]
v_pk_mul_f32 v[250:251], v[250:251], v[254:255]
v_cvt_pk_bf16_f32 v206, v248, v249
v_cvt_pk_bf16_f32 v207, v250, v251
v_accvgpr_read_b32 v248, a8
v_accvgpr_read_b32 v249, a9
v_accvgpr_read_b32 v250, a10
v_accvgpr_read_b32 v251, a11
v_accvgpr_read_b32 v252, a24
v_accvgpr_read_b32 v253, a25
v_accvgpr_read_b32 v254, a26
v_accvgpr_read_b32 v255, a27
v_max_f32 v248, 0, v248
v_max_f32 v249, 0, v249
v_max_f32 v250, 0, v250
v_max_f32 v251, 0, v251
v_pk_mul_f32 v[248:249], v[248:249], v[252:253]
v_pk_mul_f32 v[250:251], v[250:251], v[254:255]
v_cvt_pk_bf16_f32 v210, v248, v249
v_cvt_pk_bf16_f32 v211, v250, v251
v_accvgpr_read_b32 v248, a12
v_accvgpr_read_b32 v249, a13
v_accvgpr_read_b32 v250, a14
v_accvgpr_read_b32 v251, a15
v_accvgpr_read_b32 v252, a28
v_accvgpr_read_b32 v253, a29
v_accvgpr_read_b32 v254, a30
v_accvgpr_read_b32 v255, a31
v_max_f32 v248, 0, v248
v_max_f32 v249, 0, v249
v_max_f32 v250, 0, v250
v_max_f32 v251, 0, v251
v_pk_mul_f32 v[248:249], v[248:249], v[252:253]
v_pk_mul_f32 v[250:251], v[250:251], v[254:255]
v_cvt_pk_bf16_f32 v214, v248, v249
v_cvt_pk_bf16_f32 v215, v250, v251
v_accvgpr_read_b32 v248, a32
v_accvgpr_read_b32 v249, a33
v_accvgpr_read_b32 v250, a34
v_accvgpr_read_b32 v251, a35
v_accvgpr_read_b32 v252, a48
v_accvgpr_read_b32 v253, a49
v_accvgpr_read_b32 v254, a50
v_accvgpr_read_b32 v255, a51
v_max_f32 v248, 0, v248
v_max_f32 v249, 0, v249
v_max_f32 v250, 0, v250
v_max_f32 v251, 0, v251
v_pk_mul_f32 v[248:249], v[248:249], v[252:253]
v_pk_mul_f32 v[250:251], v[250:251], v[254:255]
v_cvt_pk_bf16_f32 v216, v248, v249
v_cvt_pk_bf16_f32 v217, v250, v251
v_accvgpr_read_b32 v248, a36
v_accvgpr_read_b32 v249, a37
v_accvgpr_read_b32 v250, a38
v_accvgpr_read_b32 v251, a39
v_accvgpr_read_b32 v252, a52
v_accvgpr_read_b32 v253, a53
v_accvgpr_read_b32 v254, a54
v_accvgpr_read_b32 v255, a55
v_max_f32 v248, 0, v248
v_max_f32 v249, 0, v249
v_max_f32 v250, 0, v250
v_max_f32 v251, 0, v251
v_pk_mul_f32 v[248:249], v[248:249], v[252:253]
v_pk_mul_f32 v[250:251], v[250:251], v[254:255]
v_cvt_pk_bf16_f32 v218, v248, v249
v_cvt_pk_bf16_f32 v219, v250, v251
buffer_store_dwordx4 v[156:159], v18, s[36:39], s92 offen offset:1024 sc1
v_accvgpr_read_b32 v248, a40
v_accvgpr_read_b32 v249, a41
v_accvgpr_read_b32 v250, a42
v_accvgpr_read_b32 v251, a43
v_accvgpr_read_b32 v252, a56
v_accvgpr_read_b32 v253, a57
v_accvgpr_read_b32 v254, a58
v_accvgpr_read_b32 v255, a59
v_max_f32 v248, 0, v248
v_max_f32 v249, 0, v249
v_max_f32 v250, 0, v250
v_max_f32 v251, 0, v251
v_pk_mul_f32 v[248:249], v[248:249], v[252:253]
v_pk_mul_f32 v[250:251], v[250:251], v[254:255]
v_cvt_pk_bf16_f32 v220, v248, v249
v_cvt_pk_bf16_f32 v221, v250, v251
v_accvgpr_read_b32 v248, a44
v_accvgpr_read_b32 v249, a45
v_accvgpr_read_b32 v250, a46
v_accvgpr_read_b32 v251, a47
v_accvgpr_read_b32 v252, a60
v_accvgpr_read_b32 v253, a61
v_accvgpr_read_b32 v254, a62
v_accvgpr_read_b32 v255, a63
v_max_f32 v248, 0, v248
v_max_f32 v249, 0, v249
v_max_f32 v250, 0, v250
v_max_f32 v251, 0, v251
v_pk_mul_f32 v[248:249], v[248:249], v[252:253]
v_pk_mul_f32 v[250:251], v[250:251], v[254:255]
v_cvt_pk_bf16_f32 v222, v248, v249
v_cvt_pk_bf16_f32 v223, v250, v251
s_branch recurrent_scan__gqa_block_cached__glu_gated_reglu__prompt_kernel_gjoin10
recurrent_scan__gqa_block_cached__glu_gated_reglu__prompt_kernel_godd9:
s_add_u32 s92, s53, 0x20000
s_add_u32 s93, s53, 0x40000
s_add_u32 s94, s53, 0x80000
s_add_u32 s95, s53, 0x60000
s_add_u32 s59, s53, 8
v_max_f32 v152, 0, v152
v_max_f32 v153, 0, v153
v_max_f32 v154, 0, v154
v_max_f32 v155, 0, v155
v_pk_mul_f32 v[152:153], v[152:153], v[168:169]
v_pk_mul_f32 v[154:155], v[154:155], v[170:171]
v_cvt_pk_bf16_f32 v170, v152, v153
v_cvt_pk_bf16_f32 v171, v154, v155
v_max_f32 v156, 0, v156
v_max_f32 v157, 0, v157
v_max_f32 v158, 0, v158
v_max_f32 v159, 0, v159
v_pk_mul_f32 v[156:157], v[156:157], v[172:173]
v_pk_mul_f32 v[158:159], v[158:159], v[174:175]
v_cvt_pk_bf16_f32 v174, v156, v157
v_cvt_pk_bf16_f32 v175, v158, v159
v_max_f32 v160, 0, v160
v_max_f32 v161, 0, v161
v_max_f32 v162, 0, v162
v_max_f32 v163, 0, v163
v_pk_mul_f32 v[160:161], v[160:161], v[176:177]
v_pk_mul_f32 v[162:163], v[162:163], v[178:179]
v_cvt_pk_bf16_f32 v178, v160, v161
v_cvt_pk_bf16_f32 v179, v162, v163
v_max_f32 v164, 0, v164
v_max_f32 v165, 0, v165
v_max_f32 v166, 0, v166
v_max_f32 v167, 0, v167
v_pk_mul_f32 v[164:165], v[164:165], v[180:181]
v_pk_mul_f32 v[166:167], v[166:167], v[182:183]
v_cvt_pk_bf16_f32 v182, v164, v165
v_cvt_pk_bf16_f32 v183, v166, v167
v_max_f32 v120, 0, v120
v_max_f32 v121, 0, v121
v_max_f32 v122, 0, v122
v_max_f32 v123, 0, v123
v_pk_mul_f32 v[120:121], v[120:121], v[136:137]
v_pk_mul_f32 v[122:123], v[122:123], v[138:139]
v_cvt_pk_bf16_f32 v168, v120, v121
v_cvt_pk_bf16_f32 v169, v122, v123
v_max_f32 v124, 0, v124
v_max_f32 v125, 0, v125
v_max_f32 v126, 0, v126
v_max_f32 v127, 0, v127
v_pk_mul_f32 v[124:125], v[124:125], v[140:141]
v_pk_mul_f32 v[126:127], v[126:127], v[142:143]
v_cvt_pk_bf16_f32 v172, v124, v125
v_cvt_pk_bf16_f32 v173, v126, v127
v_max_f32 v128, 0, v128
v_max_f32 v129, 0, v129
v_max_f32 v130, 0, v130
v_max_f32 v131, 0, v131
v_pk_mul_f32 v[128:129], v[128:129], v[144:145]
v_pk_mul_f32 v[130:131], v[130:131], v[146:147]
v_cvt_pk_bf16_f32 v176, v128, v129
v_cvt_pk_bf16_f32 v177, v130, v131
v_max_f32 v132, 0, v132
v_max_f32 v133, 0, v133
v_max_f32 v134, 0, v134
v_max_f32 v135, 0, v135
v_pk_mul_f32 v[132:133], v[132:133], v[148:149]
v_pk_mul_f32 v[134:135], v[134:135], v[150:151]
v_cvt_pk_bf16_f32 v180, v132, v133
v_cvt_pk_bf16_f32 v181, v134, v135
v_max_f32 v184, 0, v184
v_max_f32 v185, 0, v185
v_max_f32 v186, 0, v186
v_max_f32 v187, 0, v187
v_pk_mul_f32 v[184:185], v[184:185], v[200:201]
v_pk_mul_f32 v[186:187], v[186:187], v[202:203]
v_cvt_pk_bf16_f32 v200, v184, v185
v_cvt_pk_bf16_f32 v201, v186, v187
buffer_store_dwordx4 v[168:171], v18, s[36:39], s93 offen sc1
v_max_f32 v188, 0, v188
v_max_f32 v189, 0, v189
v_max_f32 v190, 0, v190
v_max_f32 v191, 0, v191
v_pk_mul_f32 v[188:189], v[188:189], v[204:205]
v_pk_mul_f32 v[190:191], v[190:191], v[206:207]
v_cvt_pk_bf16_f32 v204, v188, v189
v_cvt_pk_bf16_f32 v205, v190, v191
v_max_f32 v192, 0, v192
v_max_f32 v193, 0, v193
v_max_f32 v194, 0, v194
v_max_f32 v195, 0, v195
v_pk_mul_f32 v[192:193], v[192:193], v[208:209]
v_pk_mul_f32 v[194:195], v[194:195], v[210:211]
v_cvt_pk_bf16_f32 v208, v192, v193
v_cvt_pk_bf16_f32 v209, v194, v195
v_max_f32 v196, 0, v196
v_max_f32 v197, 0, v197
v_max_f32 v198, 0, v198
v_max_f32 v199, 0, v199
v_pk_mul_f32 v[196:197], v[196:197], v[212:213]
v_pk_mul_f32 v[198:199], v[198:199], v[214:215]
v_cvt_pk_bf16_f32 v212, v196, v197
v_cvt_pk_bf16_f32 v213, v198, v199
v_max_f32 v216, 0, v216
v_max_f32 v217, 0, v217
v_max_f32 v218, 0, v218
v_max_f32 v219, 0, v219
v_pk_mul_f32 v[216:217], v[216:217], v[232:233]
v_pk_mul_f32 v[218:219], v[218:219], v[234:235]
v_cvt_pk_bf16_f32 v202, v216, v217
v_cvt_pk_bf16_f32 v203, v218, v219
v_max_f32 v220, 0, v220
v_max_f32 v221, 0, v221
v_max_f32 v222, 0, v222
v_max_f32 v223, 0, v223
v_pk_mul_f32 v[220:221], v[220:221], v[236:237]
v_pk_mul_f32 v[222:223], v[222:223], v[238:239]
v_cvt_pk_bf16_f32 v206, v220, v221
v_cvt_pk_bf16_f32 v207, v222, v223
buffer_store_dwordx4 v[172:175], v18, s[36:39], s93 offen offset:1024 sc1
v_max_f32 v224, 0, v224
v_max_f32 v225, 0, v225
v_max_f32 v226, 0, v226
v_max_f32 v227, 0, v227
v_pk_mul_f32 v[224:225], v[224:225], v[240:241]
v_pk_mul_f32 v[226:227], v[226:227], v[242:243]
v_cvt_pk_bf16_f32 v210, v224, v225
v_cvt_pk_bf16_f32 v211, v226, v227
v_max_f32 v228, 0, v228
v_max_f32 v229, 0, v229
v_max_f32 v230, 0, v230
v_max_f32 v231, 0, v231
v_pk_mul_f32 v[228:229], v[228:229], v[244:245]
v_pk_mul_f32 v[230:231], v[230:231], v[246:247]
v_cvt_pk_bf16_f32 v214, v228, v229
v_cvt_pk_bf16_f32 v215, v230, v231
v_max_f32 v56, 0, v56
v_max_f32 v57, 0, v57
v_max_f32 v58, 0, v58
v_max_f32 v59, 0, v59
v_pk_mul_f32 v[56:57], v[56:57], v[72:73]
v_pk_mul_f32 v[58:59], v[58:59], v[74:75]
v_cvt_pk_bf16_f32 v152, v56, v57
v_cvt_pk_bf16_f32 v153, v58, v59
v_max_f32 v60, 0, v60
v_max_f32 v61, 0, v61
v_max_f32 v62, 0, v62
v_max_f32 v63, 0, v63
v_pk_mul_f32 v[60:61], v[60:61], v[76:77]
v_pk_mul_f32 v[62:63], v[62:63], v[78:79]
v_cvt_pk_bf16_f32 v156, v60, v61
v_cvt_pk_bf16_f32 v157, v62, v63
v_max_f32 v64, 0, v64
v_max_f32 v65, 0, v65
v_max_f32 v66, 0, v66
v_max_f32 v67, 0, v67
v_pk_mul_f32 v[64:65], v[64:65], v[80:81]
v_pk_mul_f32 v[66:67], v[66:67], v[82:83]
v_cvt_pk_bf16_f32 v160, v64, v65
v_cvt_pk_bf16_f32 v161, v66, v67
buffer_store_dwordx4 v[176:179], v18, s[36:39], s93 offen offset:2048 sc1
v_max_f32 v68, 0, v68
v_max_f32 v69, 0, v69
v_max_f32 v70, 0, v70
v_max_f32 v71, 0, v71
v_pk_mul_f32 v[68:69], v[68:69], v[84:85]
v_pk_mul_f32 v[70:71], v[70:71], v[86:87]
v_cvt_pk_bf16_f32 v164, v68, v69
v_cvt_pk_bf16_f32 v165, v70, v71
v_max_f32 v88, 0, v88
v_max_f32 v89, 0, v89
v_max_f32 v90, 0, v90
v_max_f32 v91, 0, v91
v_pk_mul_f32 v[88:89], v[88:89], v[104:105]
v_pk_mul_f32 v[90:91], v[90:91], v[106:107]
v_cvt_pk_bf16_f32 v154, v88, v89
v_cvt_pk_bf16_f32 v155, v90, v91
v_max_f32 v92, 0, v92
v_max_f32 v93, 0, v93
v_max_f32 v94, 0, v94
v_max_f32 v95, 0, v95
v_pk_mul_f32 v[92:93], v[92:93], v[108:109]
v_pk_mul_f32 v[94:95], v[94:95], v[110:111]
v_cvt_pk_bf16_f32 v158, v92, v93
v_cvt_pk_bf16_f32 v159, v94, v95
v_max_f32 v96, 0, v96
v_max_f32 v97, 0, v97
v_max_f32 v98, 0, v98
v_max_f32 v99, 0, v99
v_pk_mul_f32 v[96:97], v[96:97], v[112:113]
v_pk_mul_f32 v[98:99], v[98:99], v[114:115]
v_cvt_pk_bf16_f32 v162, v96, v97
v_cvt_pk_bf16_f32 v163, v98, v99
v_max_f32 v100, 0, v100
v_max_f32 v101, 0, v101
v_max_f32 v102, 0, v102
v_max_f32 v103, 0, v103
v_pk_mul_f32 v[100:101], v[100:101], v[116:117]
v_pk_mul_f32 v[102:103], v[102:103], v[118:119]
v_cvt_pk_bf16_f32 v166, v100, v101
v_cvt_pk_bf16_f32 v167, v102, v103
buffer_store_dwordx4 v[180:183], v18, s[36:39], s93 offen offset:3072 sc1
v_accvgpr_read_b32 v248, a0
v_accvgpr_read_b32 v249, a1
v_accvgpr_read_b32 v250, a2
v_accvgpr_read_b32 v251, a3
v_accvgpr_read_b32 v252, a16
v_accvgpr_read_b32 v253, a17
v_accvgpr_read_b32 v254, a18
v_accvgpr_read_b32 v255, a19
v_max_f32 v248, 0, v248
v_max_f32 v249, 0, v249
v_max_f32 v250, 0, v250
v_max_f32 v251, 0, v251
v_pk_mul_f32 v[248:249], v[248:249], v[252:253]
v_pk_mul_f32 v[250:251], v[250:251], v[254:255]
v_cvt_pk_bf16_f32 v184, v248, v249
v_cvt_pk_bf16_f32 v185, v250, v251
v_accvgpr_read_b32 v248, a4
v_accvgpr_read_b32 v249, a5
v_accvgpr_read_b32 v250, a6
v_accvgpr_read_b32 v251, a7
v_accvgpr_read_b32 v252, a20
v_accvgpr_read_b32 v253, a21
v_accvgpr_read_b32 v254, a22
v_accvgpr_read_b32 v255, a23
v_max_f32 v248, 0, v248
v_max_f32 v249, 0, v249
v_max_f32 v250, 0, v250
v_max_f32 v251, 0, v251
v_pk_mul_f32 v[248:249], v[248:249], v[252:253]
v_pk_mul_f32 v[250:251], v[250:251], v[254:255]
v_cvt_pk_bf16_f32 v188, v248, v249
v_cvt_pk_bf16_f32 v189, v250, v251
v_accvgpr_read_b32 v248, a8
v_accvgpr_read_b32 v249, a9
v_accvgpr_read_b32 v250, a10
v_accvgpr_read_b32 v251, a11
v_accvgpr_read_b32 v252, a24
v_accvgpr_read_b32 v253, a25
v_accvgpr_read_b32 v254, a26
v_accvgpr_read_b32 v255, a27
v_max_f32 v248, 0, v248
v_max_f32 v249, 0, v249
v_max_f32 v250, 0, v250
v_max_f32 v251, 0, v251
v_pk_mul_f32 v[248:249], v[248:249], v[252:253]
v_pk_mul_f32 v[250:251], v[250:251], v[254:255]
v_cvt_pk_bf16_f32 v192, v248, v249
v_cvt_pk_bf16_f32 v193, v250, v251
v_accvgpr_read_b32 v248, a12
v_accvgpr_read_b32 v249, a13
v_accvgpr_read_b32 v250, a14
v_accvgpr_read_b32 v251, a15
v_accvgpr_read_b32 v252, a28
v_accvgpr_read_b32 v253, a29
v_accvgpr_read_b32 v254, a30
v_accvgpr_read_b32 v255, a31
v_max_f32 v248, 0, v248
v_max_f32 v249, 0, v249
v_max_f32 v250, 0, v250
v_max_f32 v251, 0, v251
v_pk_mul_f32 v[248:249], v[248:249], v[252:253]
v_pk_mul_f32 v[250:251], v[250:251], v[254:255]
v_cvt_pk_bf16_f32 v196, v248, v249
v_cvt_pk_bf16_f32 v197, v250, v251
v_accvgpr_read_b32 v248, a32
v_accvgpr_read_b32 v249, a33
v_accvgpr_read_b32 v250, a34
v_accvgpr_read_b32 v251, a35
v_accvgpr_read_b32 v252, a48
v_accvgpr_read_b32 v253, a49
v_accvgpr_read_b32 v254, a50
v_accvgpr_read_b32 v255, a51
v_max_f32 v248, 0, v248
v_max_f32 v249, 0, v249
v_max_f32 v250, 0, v250
v_max_f32 v251, 0, v251
v_pk_mul_f32 v[248:249], v[248:249], v[252:253]
v_pk_mul_f32 v[250:251], v[250:251], v[254:255]
v_cvt_pk_bf16_f32 v186, v248, v249
v_cvt_pk_bf16_f32 v187, v250, v251
buffer_store_dwordx4 v[152:155], v18, s[36:39], s92 offen sc1
v_accvgpr_read_b32 v248, a36
v_accvgpr_read_b32 v249, a37
v_accvgpr_read_b32 v250, a38
v_accvgpr_read_b32 v251, a39
v_accvgpr_read_b32 v252, a52
v_accvgpr_read_b32 v253, a53
v_accvgpr_read_b32 v254, a54
v_accvgpr_read_b32 v255, a55
v_max_f32 v248, 0, v248
v_max_f32 v249, 0, v249
v_max_f32 v250, 0, v250
v_max_f32 v251, 0, v251
v_pk_mul_f32 v[248:249], v[248:249], v[252:253]
v_pk_mul_f32 v[250:251], v[250:251], v[254:255]
v_cvt_pk_bf16_f32 v190, v248, v249
v_cvt_pk_bf16_f32 v191, v250, v251
v_accvgpr_read_b32 v248, a40
v_accvgpr_read_b32 v249, a41
v_accvgpr_read_b32 v250, a42
v_accvgpr_read_b32 v251, a43
v_accvgpr_read_b32 v252, a56
v_accvgpr_read_b32 v253, a57
v_accvgpr_read_b32 v254, a58
v_accvgpr_read_b32 v255, a59
v_max_f32 v248, 0, v248
v_max_f32 v249, 0, v249
v_max_f32 v250, 0, v250
v_max_f32 v251, 0, v251
v_pk_mul_f32 v[248:249], v[248:249], v[252:253]
v_pk_mul_f32 v[250:251], v[250:251], v[254:255]
v_cvt_pk_bf16_f32 v194, v248, v249
v_cvt_pk_bf16_f32 v195, v250, v251
v_accvgpr_read_b32 v248, a44
v_accvgpr_read_b32 v249, a45
v_accvgpr_read_b32 v250, a46
v_accvgpr_read_b32 v251, a47
v_accvgpr_read_b32 v252, a60
v_accvgpr_read_b32 v253, a61
v_accvgpr_read_b32 v254, a62
v_accvgpr_read_b32 v255, a63
v_max_f32 v248, 0, v248
v_max_f32 v249, 0, v249
v_max_f32 v250, 0, v250
v_max_f32 v251, 0, v251
v_pk_mul_f32 v[248:249], v[248:249], v[252:253]
v_pk_mul_f32 v[250:251], v[250:251], v[254:255]
v_cvt_pk_bf16_f32 v198, v248, v249
v_cvt_pk_bf16_f32 v199, v250, v251
v_max_f32 v24, 0, v24
v_max_f32 v25, 0, v25
v_max_f32 v26, 0, v26
v_max_f32 v27, 0, v27
v_pk_mul_f32 v[24:25], v[24:25], v[40:41]
v_pk_mul_f32 v[26:27], v[26:27], v[42:43]
v_cvt_pk_bf16_f32 v216, v24, v25
v_cvt_pk_bf16_f32 v217, v26, v27
v_max_f32 v28, 0, v28
v_max_f32 v29, 0, v29
v_max_f32 v30, 0, v30
v_max_f32 v31, 0, v31
v_pk_mul_f32 v[28:29], v[28:29], v[44:45]
v_pk_mul_f32 v[30:31], v[30:31], v[46:47]
v_cvt_pk_bf16_f32 v218, v28, v29
v_cvt_pk_bf16_f32 v219, v30, v31
buffer_store_dwordx4 v[156:159], v18, s[36:39], s92 offen offset:1024 sc1
v_max_f32 v32, 0, v32
v_max_f32 v33, 0, v33
v_max_f32 v34, 0, v34
v_max_f32 v35, 0, v35
v_pk_mul_f32 v[32:33], v[32:33], v[48:49]
v_pk_mul_f32 v[34:35], v[34:35], v[50:51]
v_cvt_pk_bf16_f32 v220, v32, v33
v_cvt_pk_bf16_f32 v221, v34, v35
v_max_f32 v36, 0, v36
v_max_f32 v37, 0, v37
v_max_f32 v38, 0, v38
v_max_f32 v39, 0, v39
v_pk_mul_f32 v[36:37], v[36:37], v[52:53]
v_pk_mul_f32 v[38:39], v[38:39], v[54:55]
v_cvt_pk_bf16_f32 v222, v36, v37
v_cvt_pk_bf16_f32 v223, v38, v39
recurrent_scan__gqa_block_cached__glu_gated_reglu__prompt_kernel_gjoin10:
v_lshrrev_b32 v19, 2, v1
v_and_b32 v20, 7, v19
v_lshlrev_b32 v19, 8, v19
v_and_b32 v21, 3, v1
v_lshl_add_u32 v19, v21, 3, v19
v_add_u32 v19, 0x1b000, v19
v_xor_b32 v21, 0, v20
v_lshl_add_u32 v232, v21, 5, v19
v_xor_b32 v21, 1, v20
v_lshl_add_u32 v233, v21, 5, v19
v_xor_b32 v21, 2, v20
v_lshl_add_u32 v234, v21, 5, v19
v_xor_b32 v21, 3, v20
v_lshl_add_u32 v235, v21, 5, v19
v_xor_b32 v21, 4, v20
v_lshl_add_u32 v236, v21, 5, v19
v_xor_b32 v21, 5, v20
v_lshl_add_u32 v237, v21, 5, v19
v_xor_b32 v21, 6, v20
v_lshl_add_u32 v238, v21, 5, v19
v_xor_b32 v21, 7, v20
v_lshl_add_u32 v239, v21, 5, v19
s_waitcnt vmcnt(18)
s_barrier
ds_read_b64_tr_b16 a[208:209], v232
ds_read_b64_tr_b16 a[210:211], v232 offset:4096
ds_read_b64_tr_b16 a[212:213], v232 offset:8192
ds_read_b64_tr_b16 a[214:215], v232 offset:12288
ds_read_b64_tr_b16 a[216:217], v232 offset:16384
ds_read_b64_tr_b16 a[218:219], v232 offset:20480
s_waitcnt lgkmcnt(0)
v_mfma_f32_16x16x32_bf16 v[24:27], a[208:211], a[64:67], 0
ds_read_b64_tr_b16 a[220:221], v233
ds_read_b64_tr_b16 a[222:223], v233 offset:4096
v_mfma_f32_16x16x32_bf16 v[24:27], a[212:215], a[68:71], v[24:27]
ds_read_b64_tr_b16 a[224:225], v233 offset:8192
ds_read_b64_tr_b16 a[226:227], v233 offset:12288
v_mfma_f32_16x16x32_bf16 v[24:27], a[216:219], a[72:75], v[24:27]
ds_read_b64_tr_b16 a[228:229], v233 offset:16384
ds_read_b64_tr_b16 a[230:231], v233 offset:20480
v_mfma_f32_16x16x32_bf16 v[28:31], a[208:211], a[76:79], 0
v_subrev_u32 v224, 0x11000, v232
v_subrev_u32 v225, 0x11000, v233
v_mfma_f32_16x16x32_bf16 v[28:31], a[212:215], a[80:83], v[28:31]
s_add_u32 m0, s52, 0xa000
v_mfma_f32_16x16x32_bf16 v[28:31], a[216:219], a[84:87], v[28:31]
buffer_load_dwordx4 v23, s[20:23], s49 offen lds
s_add_u32 s49, s49, 0x20000
v_mfma_f32_16x16x32_bf16 v[32:35], a[208:211], a[88:91], 0
v_subrev_u32 v226, 0x11000, v234
v_subrev_u32 v227, 0x11000, v235
v_mfma_f32_16x16x32_bf16 v[32:35], a[212:215], a[92:95], v[32:35]
buffer_load_dwordx4 a[160:163], v14, s[32:35], s48 offen sc1
v_mfma_f32_16x16x32_bf16 v[32:35], a[216:219], a[96:99], v[32:35]
v_subrev_u32 v228, 0x11000, v236
v_subrev_u32 v229, 0x11000, v237
v_mfma_f32_16x16x32_bf16 v[36:39], a[208:211], a[100:103], 0
buffer_load_dwordx4 a[172:175], v14, s[32:35], s48 offen offset:1024 sc1
v_mfma_f32_16x16x32_bf16 v[36:39], a[212:215], a[104:107], v[36:39]
v_subrev_u32 v230, 0x11000, v238
v_subrev_u32 v231, 0x11000, v239
v_mfma_f32_16x16x32_bf16 v[36:39], a[216:219], a[108:111], v[36:39]
s_waitcnt lgkmcnt(0)
v_mfma_f32_16x16x32_bf16 v[40:43], a[220:223], a[64:67], 0
ds_read_b64_tr_b16 a[208:209], v234
ds_read_b64_tr_b16 a[210:211], v234 offset:4096
v_mfma_f32_16x16x32_bf16 v[40:43], a[224:227], a[68:71], v[40:43]
ds_read_b64_tr_b16 a[212:213], v234 offset:8192
ds_read_b64_tr_b16 a[214:215], v234 offset:12288
v_mfma_f32_16x16x32_bf16 v[40:43], a[228:231], a[72:75], v[40:43]
ds_read_b64_tr_b16 a[216:217], v234 offset:16384
ds_read_b64_tr_b16 a[218:219], v234 offset:20480
v_mfma_f32_16x16x32_bf16 v[44:47], a[220:223], a[76:79], 0
v_lshrrev_b32 v19, 4, v1
s_lshl_b32 s55, s44, 2
v_mfma_f32_16x16x32_bf16 v[44:47], a[224:227], a[80:83], v[44:47]
s_add_u32 m0, s52, 0xb000
v_mfma_f32_16x16x32_bf16 v[44:47], a[228:231], a[84:87], v[44:47]
buffer_load_dwordx4 v23, s[20:23], s49 offen lds
s_add_u32 s49, s49, 0x20000
v_mfma_f32_16x16x32_bf16 v[48:51], a[220:223], a[88:91], 0
v_add_u32 v19, s55, v19
v_and_b32 v21, 15, v1
v_mfma_f32_16x16x32_bf16 v[48:51], a[224:227], a[92:95], v[48:51]
buffer_load_dwordx4 a[184:187], v14, s[32:35], s48 offen offset:2048 sc1
v_mfma_f32_16x16x32_bf16 v[48:51], a[228:231], a[96:99], v[48:51]
v_xor_b32 v20, v19, v21
v_lshlrev_b32 v20, 4, v20
v_mfma_f32_16x16x32_bf16 v[52:55], a[220:223], a[100:103], 0
buffer_load_dwordx4 a[196:199], v14, s[32:35], s48 offen offset:3072 sc1
v_mfma_f32_16x16x32_bf16 v[52:55], a[224:227], a[104:107], v[52:55]
v_lshl_add_u32 v240, v19, 8, v20
v_and_b32 v20, 7, v19
v_mfma_f32_16x16x32_bf16 v[52:55], a[228:231], a[108:111], v[52:55]
s_waitcnt lgkmcnt(0)
v_mfma_f32_16x16x32_bf16 v[56:59], a[208:211], a[64:67], 0
ds_read_b64_tr_b16 a[220:221], v235
ds_read_b64_tr_b16 a[222:223], v235 offset:4096
v_mfma_f32_16x16x32_bf16 v[56:59], a[212:215], a[68:71], v[56:59]
ds_read_b64_tr_b16 a[224:225], v235 offset:8192
ds_read_b64_tr_b16 a[226:227], v235 offset:12288
v_mfma_f32_16x16x32_bf16 v[56:59], a[216:219], a[72:75], v[56:59]
ds_read_b64_tr_b16 a[228:229], v235 offset:16384
ds_read_b64_tr_b16 a[230:231], v235 offset:20480
v_mfma_f32_16x16x32_bf16 v[60:63], a[208:211], a[76:79], 0
v_lshlrev_b32 v20, 1, v20
v_xor_b32 v20, v20, v21
v_mfma_f32_16x16x32_bf16 v[60:63], a[212:215], a[80:83], v[60:63]
s_add_u32 m0, s52, 0xc000
v_mfma_f32_16x16x32_bf16 v[60:63], a[216:219], a[84:87], v[60:63]
buffer_load_dwordx4 v23, s[20:23], s49 offen lds
s_add_u32 s49, s49, 0x20000
v_mfma_f32_16x16x32_bf16 v[64:67], a[208:211], a[88:91], 0
v_lshlrev_b32 v20, 4, v20
v_lshl_add_u32 v241, v19, 8, v20
v_mfma_f32_16x16x32_bf16 v[64:67], a[212:215], a[92:95], v[64:67]
buffer_load_dwordx4 a[164:167], v15, s[32:35], s48 offen sc1
v_mfma_f32_16x16x32_bf16 v[64:67], a[216:219], a[96:99], v[64:67]
s_mov_b32 s50, 0
s_mov_b32 s55, 0xe39
v_mfma_f32_16x16x32_bf16 v[68:71], a[208:211], a[100:103], 0
buffer_load_dwordx4 a[176:179], v15, s[32:35], s48 offen offset:1024 sc1
v_mfma_f32_16x16x32_bf16 v[68:71], a[212:215], a[104:107], v[68:71]
v_add_u32 v19, 0, v1
v_mul_u32_u24 v20, s55, v19
v_mfma_f32_16x16x32_bf16 v[68:71], a[216:219], a[108:111], v[68:71]
s_waitcnt lgkmcnt(0)
v_mfma_f32_16x16x32_bf16 v[72:75], a[220:223], a[64:67], 0
ds_read_b64_tr_b16 a[208:209], v236
ds_read_b64_tr_b16 a[210:211], v236 offset:4096
v_mfma_f32_16x16x32_bf16 v[72:75], a[224:227], a[68:71], v[72:75]
ds_read_b64_tr_b16 a[212:213], v236 offset:8192
ds_read_b64_tr_b16 a[214:215], v236 offset:12288
v_mfma_f32_16x16x32_bf16 v[72:75], a[228:231], a[72:75], v[72:75]
ds_read_b64_tr_b16 a[216:217], v236 offset:16384
ds_read_b64_tr_b16 a[218:219], v236 offset:20480
v_mfma_f32_16x16x32_bf16 v[76:79], a[220:223], a[76:79], 0
v_lshrrev_b32 v20, 16, v20
v_mul_u32_u24 v21, 18, v20
v_mfma_f32_16x16x32_bf16 v[76:79], a[224:227], a[80:83], v[76:79]
s_add_u32 m0, s52, 0xd000
v_mfma_f32_16x16x32_bf16 v[76:79], a[228:231], a[84:87], v[76:79]
buffer_load_dwordx4 v23, s[20:23], s49 offen lds
s_add_u32 s49, s49, 0x20000
v_mfma_f32_16x16x32_bf16 v[80:83], a[220:223], a[88:91], 0
v_sub_u32 v21, v19, v21
v_mul_u32_u24 v20, 0x480, v20
v_mfma_f32_16x16x32_bf16 v[80:83], a[224:227], a[92:95], v[80:83]
buffer_load_dwordx4 a[188:191], v15, s[32:35], s48 offen offset:2048 sc1
v_mfma_f32_16x16x32_bf16 v[80:83], a[228:231], a[96:99], v[80:83]
v_lshl_add_u32 v242, v21, 4, v20
v_add_u32 v19, 64, v1
v_mfma_f32_16x16x32_bf16 v[84:87], a[220:223], a[100:103], 0
buffer_load_dwordx4 a[200:203], v15, s[32:35], s48 offen offset:3072 sc1
v_mfma_f32_16x16x32_bf16 v[84:87], a[224:227], a[104:107], v[84:87]
v_mul_u32_u24 v20, s55, v19
v_lshrrev_b32 v20, 16, v20
v_mfma_f32_16x16x32_bf16 v[84:87], a[228:231], a[108:111], v[84:87]
s_waitcnt lgkmcnt(0)
v_mfma_f32_16x16x32_bf16 v[88:91], a[208:211], a[64:67], 0
ds_read_b64_tr_b16 a[220:221], v237
ds_read_b64_tr_b16 a[222:223], v237 offset:4096
v_mfma_f32_16x16x32_bf16 v[88:91], a[212:215], a[68:71], v[88:91]
ds_read_b64_tr_b16 a[224:225], v237 offset:8192
ds_read_b64_tr_b16 a[226:227], v237 offset:12288
v_mfma_f32_16x16x32_bf16 v[88:91], a[216:219], a[72:75], v[88:91]
ds_read_b64_tr_b16 a[228:229], v237 offset:16384
ds_read_b64_tr_b16 a[230:231], v237 offset:20480
v_mfma_f32_16x16x32_bf16 v[92:95], a[208:211], a[76:79], 0
v_mul_u32_u24 v21, 18, v20
v_sub_u32 v21, v19, v21
v_mfma_f32_16x16x32_bf16 v[92:95], a[212:215], a[80:83], v[92:95]
s_add_u32 m0, s52, 0xe000
v_mfma_f32_16x16x32_bf16 v[92:95], a[216:219], a[84:87], v[92:95]
buffer_load_dwordx4 v23, s[20:23], s49 offen lds
s_add_u32 s49, s49, 0x20000
v_mfma_f32_16x16x32_bf16 v[96:99], a[208:211], a[88:91], 0
v_mul_u32_u24 v20, 0x480, v20
v_lshl_add_u32 v243, v21, 4, v20
v_mfma_f32_16x16x32_bf16 v[96:99], a[212:215], a[92:95], v[96:99]
buffer_load_dwordx4 a[168:171], v16, s[32:35], s48 offen sc1
v_mfma_f32_16x16x32_bf16 v[96:99], a[216:219], a[96:99], v[96:99]
v_add_u32 v19, 0x80, v1
v_mul_u32_u24 v20, s55, v19
v_mfma_f32_16x16x32_bf16 v[100:103], a[208:211], a[100:103], 0
buffer_load_dwordx4 a[180:183], v16, s[32:35], s48 offen offset:1024 sc1
v_mfma_f32_16x16x32_bf16 v[100:103], a[212:215], a[104:107], v[100:103]
v_lshrrev_b32 v20, 16, v20
v_mul_u32_u24 v21, 18, v20
v_mfma_f32_16x16x32_bf16 v[100:103], a[216:219], a[108:111], v[100:103]
s_waitcnt lgkmcnt(0)
v_mfma_f32_16x16x32_bf16 v[104:107], a[220:223], a[64:67], 0
ds_read_b64_tr_b16 a[208:209], v238
ds_read_b64_tr_b16 a[210:211], v238 offset:4096
v_mfma_f32_16x16x32_bf16 v[104:107], a[224:227], a[68:71], v[104:107]
ds_read_b64_tr_b16 a[212:213], v238 offset:8192
ds_read_b64_tr_b16 a[214:215], v238 offset:12288
v_mfma_f32_16x16x32_bf16 v[104:107], a[228:231], a[72:75], v[104:107]
ds_read_b64_tr_b16 a[216:217], v238 offset:16384
ds_read_b64_tr_b16 a[218:219], v238 offset:20480
v_mfma_f32_16x16x32_bf16 v[108:111], a[220:223], a[76:79], 0
v_sub_u32 v21, v19, v21
v_mul_u32_u24 v20, 0x480, v20
v_mfma_f32_16x16x32_bf16 v[108:111], a[224:227], a[80:83], v[108:111]
s_add_u32 m0, s52, 0xf000
v_mfma_f32_16x16x32_bf16 v[108:111], a[228:231], a[84:87], v[108:111]
buffer_load_dwordx4 v23, s[20:23], s49 offen lds
s_add_u32 s49, s49, 0x20000
v_mfma_f32_16x16x32_bf16 v[112:115], a[220:223], a[88:91], 0
v_lshl_add_u32 v244, v21, 4, v20
v_add_u32 v19, 0xc0, v1
v_mfma_f32_16x16x32_bf16 v[112:115], a[224:227], a[92:95], v[112:115]
buffer_load_dwordx4 a[192:195], v16, s[32:35], s48 offen offset:2048 sc1
v_mfma_f32_16x16x32_bf16 v[112:115], a[228:231], a[96:99], v[112:115]
v_mul_u32_u24 v20, s55, v19
v_lshrrev_b32 v20, 16, v20
v_mfma_f32_16x16x32_bf16 v[116:119], a[220:223], a[100:103], 0
buffer_load_dwordx4 a[204:207], v16, s[32:35], s48 offen offset:3072 sc1
s_add_u32 s48, s48, 0x60000
v_mfma_f32_16x16x32_bf16 v[116:119], a[224:227], a[104:107], v[116:119]
v_mul_u32_u24 v21, 18, v20
v_sub_u32 v21, v19, v21
v_mfma_f32_16x16x32_bf16 v[116:119], a[228:231], a[108:111], v[116:119]
s_waitcnt lgkmcnt(0)
v_mfma_f32_16x16x32_bf16 v[120:123], a[208:211], a[64:67], 0
ds_read_b64_tr_b16 a[220:221], v239
ds_read_b64_tr_b16 a[222:223], v239 offset:4096
v_mfma_f32_16x16x32_bf16 v[120:123], a[212:215], a[68:71], v[120:123]
ds_read_b64_tr_b16 a[224:225], v239 offset:8192
ds_read_b64_tr_b16 a[226:227], v239 offset:12288
v_mfma_f32_16x16x32_bf16 v[120:123], a[216:219], a[72:75], v[120:123]
ds_read_b64_tr_b16 a[228:229], v239 offset:16384
ds_read_b64_tr_b16 a[230:231], v239 offset:20480
v_mfma_f32_16x16x32_bf16 v[124:127], a[208:211], a[76:79], 0
v_mul_u32_u24 v20, 0x480, v20
v_lshl_add_u32 v245, v21, 4, v20
v_mfma_f32_16x16x32_bf16 v[124:127], a[212:215], a[80:83], v[124:127]
buffer_store_dwordx4 v[160:163], v18, s[36:39], s92 offen offset:2048 sc1
v_mfma_f32_16x16x32_bf16 v[124:127], a[216:219], a[84:87], v[124:127]
v_mfma_f32_16x16x32_bf16 v[128:131], a[208:211], a[88:91], 0
v_add_u32 v19, 0x100, v1
v_mul_u32_u24 v20, s55, v19
v_mfma_f32_16x16x32_bf16 v[128:131], a[212:215], a[92:95], v[128:131]
v_mfma_f32_16x16x32_bf16 v[128:131], a[216:219], a[96:99], v[128:131]
v_lshrrev_b32 v20, 16, v20
v_mul_u32_u24 v21, 18, v20
v_mfma_f32_16x16x32_bf16 v[132:135], a[208:211], a[100:103], 0
v_mfma_f32_16x16x32_bf16 v[132:135], a[212:215], a[104:107], v[132:135]
v_sub_u32 v21, v19, v21
v_mul_u32_u24 v20, 0x480, v20
v_mfma_f32_16x16x32_bf16 v[132:135], a[216:219], a[108:111], v[132:135]
s_waitcnt lgkmcnt(0)
v_mfma_f32_16x16x32_bf16 v[136:139], a[220:223], a[64:67], 0
s_waitcnt vmcnt(25)
s_barrier
v_mfma_f32_16x16x32_bf16 v[136:139], a[224:227], a[68:71], v[136:139]
ds_read_b64_tr_b16 a[208:209], v232 offset:24576
ds_read_b64_tr_b16 a[210:211], v232 offset:28672
v_mfma_f32_16x16x32_bf16 v[136:139], a[228:231], a[72:75], v[136:139]
ds_read_b64_tr_b16 a[212:213], v232 offset:32768
ds_read_b64_tr_b16 a[214:215], v232 offset:36864
v_mfma_f32_16x16x32_bf16 v[140:143], a[220:223], a[76:79], 0
ds_read_b64_tr_b16 a[216:217], v232 offset:40960
ds_read_b64_tr_b16 a[218:219], v232 offset:45056
v_mfma_f32_16x16x32_bf16 v[140:143], a[224:227], a[80:83], v[140:143]
v_mfma_f32_16x16x32_bf16 v[140:143], a[228:231], a[84:87], v[140:143]
v_mfma_f32_16x16x32_bf16 v[144:147], a[220:223], a[88:91], 0
v_lshl_add_u32 v246, v21, 4, v20
v_add_u32 v19, 0x140, v1
v_mfma_f32_16x16x32_bf16 v[144:147], a[224:227], a[92:95], v[144:147]
v_mfma_f32_16x16x32_bf16 v[144:147], a[228:231], a[96:99], v[144:147]
v_mul_u32_u24 v20, s55, v19
v_lshrrev_b32 v20, 16, v20
v_mfma_f32_16x16x32_bf16 v[148:151], a[220:223], a[100:103], 0
v_mfma_f32_16x16x32_bf16 v[148:151], a[224:227], a[104:107], v[148:151]
v_mul_u32_u24 v21, 18, v20
v_sub_u32 v21, v19, v21
v_mfma_f32_16x16x32_bf16 v[148:151], a[228:231], a[108:111], v[148:151]
s_waitcnt lgkmcnt(0)
v_mfma_f32_16x16x32_bf16 v[24:27], a[208:211], a[112:115], v[24:27]
ds_read_b64_tr_b16 a[220:221], v233 offset:24576
ds_read_b64_tr_b16 a[222:223], v233 offset:28672
v_mfma_f32_16x16x32_bf16 v[24:27], a[212:215], a[116:119], v[24:27]
ds_read_b64_tr_b16 a[224:225], v233 offset:32768
ds_read_b64_tr_b16 a[226:227], v233 offset:36864
v_mfma_f32_16x16x32_bf16 v[24:27], a[216:219], a[120:123], v[24:27]
ds_read_b64_tr_b16 a[228:229], v233 offset:40960
ds_read_b64_tr_b16 a[230:231], v233 offset:45056
v_mfma_f32_16x16x32_bf16 v[28:31], a[208:211], a[124:127], v[28:31]
v_mul_u32_u24 v20, 0x480, v20
v_lshl_add_u32 v247, v21, 4, v20
v_mfma_f32_16x16x32_bf16 v[28:31], a[212:215], a[128:131], v[28:31]
s_add_u32 m0, s52, 0x1b000
v_mfma_f32_16x16x32_bf16 v[28:31], a[216:219], a[132:135], v[28:31]
buffer_load_dwordx4 v23, s[20:23], s49 offen lds
s_add_u32 s49, s49, 0x20000
v_mfma_f32_16x16x32_bf16 v[32:35], a[208:211], a[136:139], v[32:35]
v_add_u32 v19, 0x180, v1
v_mul_u32_u24 v20, s55, v19
v_mfma_f32_16x16x32_bf16 v[32:35], a[212:215], a[140:143], v[32:35]
buffer_load_dwordx4 a[64:67], v14, s[32:35], s48 offen sc1
v_mfma_f32_16x16x32_bf16 v[32:35], a[216:219], a[144:147], v[32:35]
v_lshrrev_b32 v20, 16, v20
v_mul_u32_u24 v21, 18, v20
v_mfma_f32_16x16x32_bf16 v[36:39], a[208:211], a[148:151], v[36:39]
buffer_load_dwordx4 a[76:79], v14, s[32:35], s48 offen offset:1024 sc1
v_mfma_f32_16x16x32_bf16 v[36:39], a[212:215], a[152:155], v[36:39]
v_sub_u32 v21, v19, v21
v_mul_u32_u24 v20, 0x480, v20
v_mfma_f32_16x16x32_bf16 v[36:39], a[216:219], a[156:159], v[36:39]
s_waitcnt lgkmcnt(0)
v_mfma_f32_16x16x32_bf16 v[40:43], a[220:223], a[112:115], v[40:43]
ds_read_b64_tr_b16 a[208:209], v234 offset:24576
ds_read_b64_tr_b16 a[210:211], v234 offset:28672
v_mfma_f32_16x16x32_bf16 v[40:43], a[224:227], a[116:119], v[40:43]
ds_read_b64_tr_b16 a[212:213], v234 offset:32768
ds_read_b64_tr_b16 a[214:215], v234 offset:36864
v_mfma_f32_16x16x32_bf16 v[40:43], a[228:231], a[120:123], v[40:43]
ds_read_b64_tr_b16 a[216:217], v234 offset:40960
ds_read_b64_tr_b16 a[218:219], v234 offset:45056
v_mfma_f32_16x16x32_bf16 v[44:47], a[220:223], a[124:127], v[44:47]
v_lshl_add_u32 v248, v21, 4, v20
v_add_u32 v19, 0x1c0, v1
v_mfma_f32_16x16x32_bf16 v[44:47], a[224:227], a[128:131], v[44:47]
s_add_u32 m0, s52, 0x1c000
v_mfma_f32_16x16x32_bf16 v[44:47], a[228:231], a[132:135], v[44:47]
buffer_load_dwordx4 v23, s[20:23], s49 offen lds
s_add_u32 s49, s49, 0x20000
v_mfma_f32_16x16x32_bf16 v[48:51], a[220:223], a[136:139], v[48:51]
v_mul_u32_u24 v20, s55, v19
v_lshrrev_b32 v20, 16, v20
v_mfma_f32_16x16x32_bf16 v[48:51], a[224:227], a[140:143], v[48:51]
buffer_load_dwordx4 a[88:91], v14, s[32:35], s48 offen offset:2048 sc1
v_mfma_f32_16x16x32_bf16 v[48:51], a[228:231], a[144:147], v[48:51]
v_mul_u32_u24 v21, 18, v20
v_sub_u32 v21, v19, v21
v_mfma_f32_16x16x32_bf16 v[52:55], a[220:223], a[148:151], v[52:55]
buffer_load_dwordx4 a[100:103], v14, s[32:35], s48 offen offset:3072 sc1
v_mfma_f32_16x16x32_bf16 v[52:55], a[224:227], a[152:155], v[52:55]
v_mul_u32_u24 v20, 0x480, v20
v_lshl_add_u32 v249, v21, 4, v20
v_mfma_f32_16x16x32_bf16 v[52:55], a[228:231], a[156:159], v[52:55]
s_waitcnt lgkmcnt(0)
v_mfma_f32_16x16x32_bf16 v[56:59], a[208:211], a[112:115], v[56:59]
ds_read_b64_tr_b16 a[220:221], v235 offset:24576
ds_read_b64_tr_b16 a[222:223], v235 offset:28672
v_mfma_f32_16x16x32_bf16 v[56:59], a[212:215], a[116:119], v[56:59]
ds_read_b64_tr_b16 a[224:225], v235 offset:32768
ds_read_b64_tr_b16 a[226:227], v235 offset:36864
v_mfma_f32_16x16x32_bf16 v[56:59], a[216:219], a[120:123], v[56:59]
ds_read_b64_tr_b16 a[228:229], v235 offset:40960
ds_read_b64_tr_b16 a[230:231], v235 offset:45056
v_mfma_f32_16x16x32_bf16 v[60:63], a[208:211], a[124:127], v[60:63]
v_add_u32 v19, 0x200, v1
v_mul_u32_u24 v20, s55, v19
v_mfma_f32_16x16x32_bf16 v[60:63], a[212:215], a[128:131], v[60:63]
s_add_u32 m0, s52, 0x1d000
v_mfma_f32_16x16x32_bf16 v[60:63], a[216:219], a[132:135], v[60:63]
buffer_load_dwordx4 v23, s[20:23], s49 offen lds
s_add_u32 s49, s49, 0x20000
v_mfma_f32_16x16x32_bf16 v[64:67], a[208:211], a[136:139], v[64:67]
v_lshrrev_b32 v20, 16, v20
v_mul_u32_u24 v21, 18, v20
v_mfma_f32_16x16x32_bf16 v[64:67], a[212:215], a[140:143], v[64:67]
buffer_load_dwordx4 a[68:71], v15, s[32:35], s48 offen sc1
v_mfma_f32_16x16x32_bf16 v[64:67], a[216:219], a[144:147], v[64:67]
v_sub_u32 v21, v19, v21
v_mul_u32_u24 v20, 0x480, v20
v_mfma_f32_16x16x32_bf16 v[68:71], a[208:211], a[148:151], v[68:71]
buffer_load_dwordx4 a[80:83], v15, s[32:35], s48 offen offset:1024 sc1
v_mfma_f32_16x16x32_bf16 v[68:71], a[212:215], a[152:155], v[68:71]
v_lshl_add_u32 v250, v21, 4, v20
v_mfma_f32_16x16x32_bf16 v[68:71], a[216:219], a[156:159], v[68:71]
s_waitcnt lgkmcnt(0)
v_mfma_f32_16x16x32_bf16 v[72:75], a[220:223], a[112:115], v[72:75]
ds_read_b64_tr_b16 a[208:209], v236 offset:24576
ds_read_b64_tr_b16 a[210:211], v236 offset:28672
v_mfma_f32_16x16x32_bf16 v[72:75], a[224:227], a[116:119], v[72:75]
ds_read_b64_tr_b16 a[212:213], v236 offset:32768
ds_read_b64_tr_b16 a[214:215], v236 offset:36864
v_mfma_f32_16x16x32_bf16 v[72:75], a[228:231], a[120:123], v[72:75]
ds_read_b64_tr_b16 a[216:217], v236 offset:40960
ds_read_b64_tr_b16 a[218:219], v236 offset:45056
v_mfma_f32_16x16x32_bf16 v[76:79], a[220:223], a[124:127], v[76:79]
v_mfma_f32_16x16x32_bf16 v[76:79], a[224:227], a[128:131], v[76:79]
s_add_u32 m0, s52, 0x1e000
v_mfma_f32_16x16x32_bf16 v[76:79], a[228:231], a[132:135], v[76:79]
buffer_load_dwordx4 v23, s[20:23], s49 offen lds
s_add_u32 s49, s49, 0x20000
v_mfma_f32_16x16x32_bf16 v[80:83], a[220:223], a[136:139], v[80:83]
v_mfma_f32_16x16x32_bf16 v[80:83], a[224:227], a[140:143], v[80:83]
buffer_load_dwordx4 a[92:95], v15, s[32:35], s48 offen offset:2048 sc1
v_mfma_f32_16x16x32_bf16 v[80:83], a[228:231], a[144:147], v[80:83]
v_mfma_f32_16x16x32_bf16 v[84:87], a[220:223], a[148:151], v[84:87]
buffer_load_dwordx4 a[104:107], v15, s[32:35], s48 offen offset:3072 sc1
v_mfma_f32_16x16x32_bf16 v[84:87], a[224:227], a[152:155], v[84:87]
v_mfma_f32_16x16x32_bf16 v[84:87], a[228:231], a[156:159], v[84:87]
s_waitcnt lgkmcnt(0)
v_mfma_f32_16x16x32_bf16 v[88:91], a[208:211], a[112:115], v[88:91]
ds_read_b64_tr_b16 a[220:221], v237 offset:24576
ds_read_b64_tr_b16 a[222:223], v237 offset:28672
v_mfma_f32_16x16x32_bf16 v[88:91], a[212:215], a[116:119], v[88:91]
ds_read_b64_tr_b16 a[224:225], v237 offset:32768
ds_read_b64_tr_b16 a[226:227], v237 offset:36864
v_mfma_f32_16x16x32_bf16 v[88:91], a[216:219], a[120:123], v[88:91]
ds_read_b64_tr_b16 a[228:229], v237 offset:40960
ds_read_b64_tr_b16 a[230:231], v237 offset:45056
v_mfma_f32_16x16x32_bf16 v[92:95], a[208:211], a[124:127], v[92:95]
v_mfma_f32_16x16x32_bf16 v[92:95], a[212:215], a[128:131], v[92:95]
s_add_u32 m0, s52, 0x1f000
v_mfma_f32_16x16x32_bf16 v[92:95], a[216:219], a[132:135], v[92:95]
buffer_load_dwordx4 v23, s[20:23], s49 offen lds
s_add_u32 s49, s49, 0x20000
v_mfma_f32_16x16x32_bf16 v[96:99], a[208:211], a[136:139], v[96:99]
v_mfma_f32_16x16x32_bf16 v[96:99], a[212:215], a[140:143], v[96:99]
buffer_load_dwordx4 a[72:75], v16, s[32:35], s48 offen sc1
v_mfma_f32_16x16x32_bf16 v[96:99], a[216:219], a[144:147], v[96:99]
v_mfma_f32_16x16x32_bf16 v[100:103], a[208:211], a[148:151], v[100:103]
buffer_load_dwordx4 a[84:87], v16, s[32:35], s48 offen offset:1024 sc1
v_mfma_f32_16x16x32_bf16 v[100:103], a[212:215], a[152:155], v[100:103]
v_mfma_f32_16x16x32_bf16 v[100:103], a[216:219], a[156:159], v[100:103]
s_waitcnt lgkmcnt(0)
v_mfma_f32_16x16x32_bf16 v[104:107], a[220:223], a[112:115], v[104:107]
ds_read_b64_tr_b16 a[208:209], v238 offset:24576
ds_read_b64_tr_b16 a[210:211], v238 offset:28672
v_mfma_f32_16x16x32_bf16 v[104:107], a[224:227], a[116:119], v[104:107]
ds_read_b64_tr_b16 a[212:213], v238 offset:32768
ds_read_b64_tr_b16 a[214:215], v238 offset:36864
v_mfma_f32_16x16x32_bf16 v[104:107], a[228:231], a[120:123], v[104:107]
ds_read_b64_tr_b16 a[216:217], v238 offset:40960
ds_read_b64_tr_b16 a[218:219], v238 offset:45056
v_mfma_f32_16x16x32_bf16 v[108:111], a[220:223], a[124:127], v[108:111]
v_mfma_f32_16x16x32_bf16 v[108:111], a[224:227], a[128:131], v[108:111]
s_add_u32 m0, s52, 0x20000
v_mfma_f32_16x16x32_bf16 v[108:111], a[228:231], a[132:135], v[108:111]
buffer_load_dwordx4 v23, s[20:23], s49 offen lds
s_add_u32 s49, s49, 0x20000
v_mfma_f32_16x16x32_bf16 v[112:115], a[220:223], a[136:139], v[112:115]
v_mfma_f32_16x16x32_bf16 v[112:115], a[224:227], a[140:143], v[112:115]
buffer_load_dwordx4 a[96:99], v16, s[32:35], s48 offen offset:2048 sc1
v_mfma_f32_16x16x32_bf16 v[112:115], a[228:231], a[144:147], v[112:115]
v_mfma_f32_16x16x32_bf16 v[116:119], a[220:223], a[148:151], v[116:119]
buffer_load_dwordx4 a[108:111], v16, s[32:35], s48 offen offset:3072 sc1
s_add_u32 s48, s48, 0x60000
v_mfma_f32_16x16x32_bf16 v[116:119], a[224:227], a[152:155], v[116:119]
v_mfma_f32_16x16x32_bf16 v[116:119], a[228:231], a[156:159], v[116:119]
s_waitcnt lgkmcnt(0)
v_mfma_f32_16x16x32_bf16 v[120:123], a[208:211], a[112:115], v[120:123]
ds_read_b64_tr_b16 a[220:221], v239 offset:24576
ds_read_b64_tr_b16 a[222:223], v239 offset:28672
v_mfma_f32_16x16x32_bf16 v[120:123], a[212:215], a[116:119], v[120:123]
ds_read_b64_tr_b16 a[224:225], v239 offset:32768
ds_read_b64_tr_b16 a[226:227], v239 offset:36864
v_mfma_f32_16x16x32_bf16 v[120:123], a[216:219], a[120:123], v[120:123]
ds_read_b64_tr_b16 a[228:229], v239 offset:40960
ds_read_b64_tr_b16 a[230:231], v239 offset:45056
v_mfma_f32_16x16x32_bf16 v[124:127], a[208:211], a[124:127], v[124:127]
v_mfma_f32_16x16x32_bf16 v[124:127], a[212:215], a[128:131], v[124:127]
buffer_store_dwordx4 v[164:167], v18, s[36:39], s92 offen offset:3072 sc1
v_mfma_f32_16x16x32_bf16 v[124:127], a[216:219], a[132:135], v[124:127]
v_mfma_f32_16x16x32_bf16 v[128:131], a[208:211], a[136:139], v[128:131]
v_mfma_f32_16x16x32_bf16 v[128:131], a[212:215], a[140:143], v[128:131]
v_mfma_f32_16x16x32_bf16 v[128:131], a[216:219], a[144:147], v[128:131]
v_mfma_f32_16x16x32_bf16 v[132:135], a[208:211], a[148:151], v[132:135]
v_mfma_f32_16x16x32_bf16 v[132:135], a[212:215], a[152:155], v[132:135]
v_mfma_f32_16x16x32_bf16 v[132:135], a[216:219], a[156:159], v[132:135]
s_waitcnt lgkmcnt(0)
v_mfma_f32_16x16x32_bf16 v[136:139], a[220:223], a[112:115], v[136:139]
s_waitcnt vmcnt(20)
s_barrier
v_mfma_f32_16x16x32_bf16 v[136:139], a[224:227], a[116:119], v[136:139]
ds_read_b64_tr_b16 a[208:209], v224
ds_read_b64_tr_b16 a[210:211], v224 offset:4096
v_mfma_f32_16x16x32_bf16 v[136:139], a[228:231], a[120:123], v[136:139]
ds_read_b64_tr_b16 a[212:213], v224 offset:8192
ds_read_b64_tr_b16 a[214:215], v224 offset:12288
v_mfma_f32_16x16x32_bf16 v[140:143], a[220:223], a[124:127], v[140:143]
ds_read_b64_tr_b16 a[216:217], v224 offset:16384
ds_read_b64_tr_b16 a[218:219], v224 offset:20480
v_mfma_f32_16x16x32_bf16 v[140:143], a[224:227], a[128:131], v[140:143]
v_mfma_f32_16x16x32_bf16 v[140:143], a[228:231], a[132:135], v[140:143]
v_mfma_f32_16x16x32_bf16 v[144:147], a[220:223], a[136:139], v[144:147]
v_mfma_f32_16x16x32_bf16 v[144:147], a[224:227], a[140:143], v[144:147]
v_mfma_f32_16x16x32_bf16 v[144:147], a[228:231], a[144:147], v[144:147]
v_mfma_f32_16x16x32_bf16 v[148:151], a[220:223], a[148:151], v[148:151]
v_mfma_f32_16x16x32_bf16 v[148:151], a[224:227], a[152:155], v[148:151]
v_mfma_f32_16x16x32_bf16 v[148:151], a[228:231], a[156:159], v[148:151]
s_waitcnt lgkmcnt(0)
v_mfma_f32_16x16x32_bf16 v[24:27], a[208:211], a[160:163], v[24:27]
ds_read_b64_tr_b16 a[220:221], v225
ds_read_b64_tr_b16 a[222:223], v225 offset:4096
v_mfma_f32_16x16x32_bf16 v[24:27], a[212:215], a[164:167], v[24:27]
ds_read_b64_tr_b16 a[224:225], v225 offset:8192
ds_read_b64_tr_b16 a[226:227], v225 offset:12288
v_mfma_f32_16x16x32_bf16 v[24:27], a[216:219], a[168:171], v[24:27]
ds_read_b64_tr_b16 a[228:229], v225 offset:16384
ds_read_b64_tr_b16 a[230:231], v225 offset:20480
v_mfma_f32_16x16x32_bf16 v[28:31], a[208:211], a[172:175], v[28:31]
v_mfma_f32_16x16x32_bf16 v[28:31], a[212:215], a[176:179], v[28:31]
s_add_u32 m0, s52, 0x21000
v_mfma_f32_16x16x32_bf16 v[28:31], a[216:219], a[180:183], v[28:31]
buffer_load_dwordx4 v23, s[20:23], s49 offen lds
s_add_u32 s49, s49, 0x20000
v_mfma_f32_16x16x32_bf16 v[32:35], a[208:211], a[184:187], v[32:35]
v_mfma_f32_16x16x32_bf16 v[32:35], a[212:215], a[188:191], v[32:35]
buffer_load_dwordx4 a[112:115], v14, s[32:35], s48 offen sc1
v_mfma_f32_16x16x32_bf16 v[32:35], a[216:219], a[192:195], v[32:35]
v_mfma_f32_16x16x32_bf16 v[36:39], a[208:211], a[196:199], v[36:39]
buffer_load_dwordx4 a[124:127], v14, s[32:35], s48 offen offset:1024 sc1
v_mfma_f32_16x16x32_bf16 v[36:39], a[212:215], a[200:203], v[36:39]
v_mfma_f32_16x16x32_bf16 v[36:39], a[216:219], a[204:207], v[36:39]
s_waitcnt lgkmcnt(0)
v_mfma_f32_16x16x32_bf16 v[40:43], a[220:223], a[160:163], v[40:43]
ds_read_b64_tr_b16 a[208:209], v226
ds_read_b64_tr_b16 a[210:211], v226 offset:4096
v_mfma_f32_16x16x32_bf16 v[40:43], a[224:227], a[164:167], v[40:43]
ds_read_b64_tr_b16 a[212:213], v226 offset:8192
ds_read_b64_tr_b16 a[214:215], v226 offset:12288
v_mfma_f32_16x16x32_bf16 v[40:43], a[228:231], a[168:171], v[40:43]
ds_read_b64_tr_b16 a[216:217], v226 offset:16384
ds_read_b64_tr_b16 a[218:219], v226 offset:20480
v_mfma_f32_16x16x32_bf16 v[44:47], a[220:223], a[172:175], v[44:47]
v_mfma_f32_16x16x32_bf16 v[44:47], a[224:227], a[176:179], v[44:47]
s_add_u32 m0, s52, 0x22000
v_mfma_f32_16x16x32_bf16 v[44:47], a[228:231], a[180:183], v[44:47]
buffer_load_dwordx4 v23, s[20:23], s49 offen lds
s_add_u32 s49, s49, 0x20000
v_mfma_f32_16x16x32_bf16 v[48:51], a[220:223], a[184:187], v[48:51]
v_mfma_f32_16x16x32_bf16 v[48:51], a[224:227], a[188:191], v[48:51]
buffer_load_dwordx4 a[136:139], v14, s[32:35], s48 offen offset:2048 sc1
v_mfma_f32_16x16x32_bf16 v[48:51], a[228:231], a[192:195], v[48:51]
v_mfma_f32_16x16x32_bf16 v[52:55], a[220:223], a[196:199], v[52:55]
buffer_load_dwordx4 a[148:151], v14, s[32:35], s48 offen offset:3072 sc1
v_mfma_f32_16x16x32_bf16 v[52:55], a[224:227], a[200:203], v[52:55]
v_mfma_f32_16x16x32_bf16 v[52:55], a[228:231], a[204:207], v[52:55]
s_waitcnt lgkmcnt(0)
v_mfma_f32_16x16x32_bf16 v[56:59], a[208:211], a[160:163], v[56:59]
ds_read_b64_tr_b16 a[220:221], v227
ds_read_b64_tr_b16 a[222:223], v227 offset:4096
v_mfma_f32_16x16x32_bf16 v[56:59], a[212:215], a[164:167], v[56:59]
ds_read_b64_tr_b16 a[224:225], v227 offset:8192
ds_read_b64_tr_b16 a[226:227], v227 offset:12288
v_mfma_f32_16x16x32_bf16 v[56:59], a[216:219], a[168:171], v[56:59]
ds_read_b64_tr_b16 a[228:229], v227 offset:16384
ds_read_b64_tr_b16 a[230:231], v227 offset:20480
v_mfma_f32_16x16x32_bf16 v[60:63], a[208:211], a[172:175], v[60:63]
v_mfma_f32_16x16x32_bf16 v[60:63], a[212:215], a[176:179], v[60:63]
s_add_u32 m0, s52, 0x23000
v_mfma_f32_16x16x32_bf16 v[60:63], a[216:219], a[180:183], v[60:63]
buffer_load_dwordx4 v23, s[20:23], s49 offen lds
s_add_u32 s49, s49, 0x20000
v_mfma_f32_16x16x32_bf16 v[64:67], a[208:211], a[184:187], v[64:67]
v_mfma_f32_16x16x32_bf16 v[64:67], a[212:215], a[188:191], v[64:67]
buffer_load_dwordx4 a[116:119], v15, s[32:35], s48 offen sc1
v_mfma_f32_16x16x32_bf16 v[64:67], a[216:219], a[192:195], v[64:67]
v_mfma_f32_16x16x32_bf16 v[68:71], a[208:211], a[196:199], v[68:71]
buffer_load_dwordx4 a[128:131], v15, s[32:35], s48 offen offset:1024 sc1
v_mfma_f32_16x16x32_bf16 v[68:71], a[212:215], a[200:203], v[68:71]
v_mfma_f32_16x16x32_bf16 v[68:71], a[216:219], a[204:207], v[68:71]
s_waitcnt lgkmcnt(0)
v_mfma_f32_16x16x32_bf16 v[72:75], a[220:223], a[160:163], v[72:75]
ds_read_b64_tr_b16 a[208:209], v228
ds_read_b64_tr_b16 a[210:211], v228 offset:4096
v_mfma_f32_16x16x32_bf16 v[72:75], a[224:227], a[164:167], v[72:75]
ds_read_b64_tr_b16 a[212:213], v228 offset:8192
ds_read_b64_tr_b16 a[214:215], v228 offset:12288
v_mfma_f32_16x16x32_bf16 v[72:75], a[228:231], a[168:171], v[72:75]
ds_read_b64_tr_b16 a[216:217], v228 offset:16384
ds_read_b64_tr_b16 a[218:219], v228 offset:20480
v_mfma_f32_16x16x32_bf16 v[76:79], a[220:223], a[172:175], v[76:79]
v_mfma_f32_16x16x32_bf16 v[76:79], a[224:227], a[176:179], v[76:79]
s_add_u32 m0, s52, 0x24000
v_mfma_f32_16x16x32_bf16 v[76:79], a[228:231], a[180:183], v[76:79]
buffer_load_dwordx4 v23, s[20:23], s49 offen lds
s_add_u32 s49, s49, 0x20000
v_mfma_f32_16x16x32_bf16 v[80:83], a[220:223], a[184:187], v[80:83]
v_mfma_f32_16x16x32_bf16 v[80:83], a[224:227], a[188:191], v[80:83]
buffer_load_dwordx4 a[140:143], v15, s[32:35], s48 offen offset:2048 sc1
v_mfma_f32_16x16x32_bf16 v[80:83], a[228:231], a[192:195], v[80:83]
v_mfma_f32_16x16x32_bf16 v[84:87], a[220:223], a[196:199], v[84:87]
buffer_load_dwordx4 a[152:155], v15, s[32:35], s48 offen offset:3072 sc1
v_mfma_f32_16x16x32_bf16 v[84:87], a[224:227], a[200:203], v[84:87]
v_mfma_f32_16x16x32_bf16 v[84:87], a[228:231], a[204:207], v[84:87]
s_waitcnt lgkmcnt(0)
v_mfma_f32_16x16x32_bf16 v[88:91], a[208:211], a[160:163], v[88:91]
ds_read_b64_tr_b16 a[220:221], v229
ds_read_b64_tr_b16 a[222:223], v229 offset:4096
v_mfma_f32_16x16x32_bf16 v[88:91], a[212:215], a[164:167], v[88:91]
ds_read_b64_tr_b16 a[224:225], v229 offset:8192
ds_read_b64_tr_b16 a[226:227], v229 offset:12288
v_mfma_f32_16x16x32_bf16 v[88:91], a[216:219], a[168:171], v[88:91]
ds_read_b64_tr_b16 a[228:229], v229 offset:16384
ds_read_b64_tr_b16 a[230:231], v229 offset:20480
v_mfma_f32_16x16x32_bf16 v[92:95], a[208:211], a[172:175], v[92:95]
v_mfma_f32_16x16x32_bf16 v[92:95], a[212:215], a[176:179], v[92:95]
s_add_u32 m0, s52, 0x25000
v_mfma_f32_16x16x32_bf16 v[92:95], a[216:219], a[180:183], v[92:95]
buffer_load_dwordx4 v23, s[20:23], s49 offen lds
s_add_u32 s49, s49, 0x20000
v_mfma_f32_16x16x32_bf16 v[96:99], a[208:211], a[184:187], v[96:99]
v_mfma_f32_16x16x32_bf16 v[96:99], a[212:215], a[188:191], v[96:99]
buffer_load_dwordx4 a[120:123], v16, s[32:35], s48 offen sc1
v_mfma_f32_16x16x32_bf16 v[96:99], a[216:219], a[192:195], v[96:99]
v_mfma_f32_16x16x32_bf16 v[100:103], a[208:211], a[196:199], v[100:103]
buffer_load_dwordx4 a[132:135], v16, s[32:35], s48 offen offset:1024 sc1
v_mfma_f32_16x16x32_bf16 v[100:103], a[212:215], a[200:203], v[100:103]
v_mfma_f32_16x16x32_bf16 v[100:103], a[216:219], a[204:207], v[100:103]
s_waitcnt lgkmcnt(0)
v_mfma_f32_16x16x32_bf16 v[104:107], a[220:223], a[160:163], v[104:107]
ds_read_b64_tr_b16 a[208:209], v230
ds_read_b64_tr_b16 a[210:211], v230 offset:4096
v_mfma_f32_16x16x32_bf16 v[104:107], a[224:227], a[164:167], v[104:107]
ds_read_b64_tr_b16 a[212:213], v230 offset:8192
ds_read_b64_tr_b16 a[214:215], v230 offset:12288
v_mfma_f32_16x16x32_bf16 v[104:107], a[228:231], a[168:171], v[104:107]
ds_read_b64_tr_b16 a[216:217], v230 offset:16384
ds_read_b64_tr_b16 a[218:219], v230 offset:20480
v_mfma_f32_16x16x32_bf16 v[108:111], a[220:223], a[172:175], v[108:111]
v_mfma_f32_16x16x32_bf16 v[108:111], a[224:227], a[176:179], v[108:111]
s_add_u32 m0, s52, 0x26000
v_mfma_f32_16x16x32_bf16 v[108:111], a[228:231], a[180:183], v[108:111]
buffer_load_dwordx4 v23, s[20:23], s49 offen lds
s_add_u32 s49, s49, 0x20000
v_mfma_f32_16x16x32_bf16 v[112:115], a[220:223], a[184:187], v[112:115]
v_mfma_f32_16x16x32_bf16 v[112:115], a[224:227], a[188:191], v[112:115]
buffer_load_dwordx4 a[144:147], v16, s[32:35], s48 offen offset:2048 sc1
v_mfma_f32_16x16x32_bf16 v[112:115], a[228:231], a[192:195], v[112:115]
v_mfma_f32_16x16x32_bf16 v[116:119], a[220:223], a[196:199], v[116:119]
buffer_load_dwordx4 a[156:159], v16, s[32:35], s48 offen offset:3072 sc1
s_add_u32 s48, s48, 0x60000
v_mfma_f32_16x16x32_bf16 v[116:119], a[224:227], a[200:203], v[116:119]
v_mfma_f32_16x16x32_bf16 v[116:119], a[228:231], a[204:207], v[116:119]
s_waitcnt lgkmcnt(0)
v_mfma_f32_16x16x32_bf16 v[120:123], a[208:211], a[160:163], v[120:123]
ds_read_b64_tr_b16 a[220:221], v231
ds_read_b64_tr_b16 a[222:223], v231 offset:4096
v_mfma_f32_16x16x32_bf16 v[120:123], a[212:215], a[164:167], v[120:123]
ds_read_b64_tr_b16 a[224:225], v231 offset:8192
ds_read_b64_tr_b16 a[226:227], v231 offset:12288
v_mfma_f32_16x16x32_bf16 v[120:123], a[216:219], a[168:171], v[120:123]
ds_read_b64_tr_b16 a[228:229], v231 offset:16384
ds_read_b64_tr_b16 a[230:231], v231 offset:20480
v_mfma_f32_16x16x32_bf16 v[124:127], a[208:211], a[172:175], v[124:127]
v_mfma_f32_16x16x32_bf16 v[124:127], a[212:215], a[176:179], v[124:127]
buffer_store_dwordx4 v[184:187], v18, s[36:39], s94 offen sc1
v_mfma_f32_16x16x32_bf16 v[124:127], a[216:219], a[180:183], v[124:127]
v_mfma_f32_16x16x32_bf16 v[128:131], a[208:211], a[184:187], v[128:131]
v_mfma_f32_16x16x32_bf16 v[128:131], a[212:215], a[188:191], v[128:131]
v_mfma_f32_16x16x32_bf16 v[128:131], a[216:219], a[192:195], v[128:131]
v_mfma_f32_16x16x32_bf16 v[132:135], a[208:211], a[196:199], v[132:135]
v_mfma_f32_16x16x32_bf16 v[132:135], a[212:215], a[200:203], v[132:135]
v_mfma_f32_16x16x32_bf16 v[132:135], a[216:219], a[204:207], v[132:135]
s_waitcnt lgkmcnt(0)
v_mfma_f32_16x16x32_bf16 v[136:139], a[220:223], a[160:163], v[136:139]
s_waitcnt vmcnt(20)
s_barrier
v_mfma_f32_16x16x32_bf16 v[136:139], a[224:227], a[164:167], v[136:139]
ds_read_b64_tr_b16 a[208:209], v232
ds_read_b64_tr_b16 a[210:211], v232 offset:4096
v_mfma_f32_16x16x32_bf16 v[136:139], a[228:231], a[168:171], v[136:139]
ds_read_b64_tr_b16 a[212:213], v232 offset:8192
ds_read_b64_tr_b16 a[214:215], v232 offset:12288
v_mfma_f32_16x16x32_bf16 v[140:143], a[220:223], a[172:175], v[140:143]
ds_read_b64_tr_b16 a[216:217], v232 offset:16384
ds_read_b64_tr_b16 a[218:219], v232 offset:20480
v_mfma_f32_16x16x32_bf16 v[140:143], a[224:227], a[176:179], v[140:143]
v_mfma_f32_16x16x32_bf16 v[140:143], a[228:231], a[180:183], v[140:143]
v_mfma_f32_16x16x32_bf16 v[144:147], a[220:223], a[184:187], v[144:147]
v_mfma_f32_16x16x32_bf16 v[144:147], a[224:227], a[188:191], v[144:147]
v_mfma_f32_16x16x32_bf16 v[144:147], a[228:231], a[192:195], v[144:147]
v_mfma_f32_16x16x32_bf16 v[148:151], a[220:223], a[196:199], v[148:151]
v_mfma_f32_16x16x32_bf16 v[148:151], a[224:227], a[200:203], v[148:151]
v_mfma_f32_16x16x32_bf16 v[148:151], a[228:231], a[204:207], v[148:151]
s_waitcnt lgkmcnt(0)
v_mfma_f32_16x16x32_bf16 v[24:27], a[208:211], a[64:67], v[24:27]
ds_read_b64_tr_b16 a[220:221], v233
ds_read_b64_tr_b16 a[222:223], v233 offset:4096
v_mfma_f32_16x16x32_bf16 v[24:27], a[212:215], a[68:71], v[24:27]
ds_read_b64_tr_b16 a[224:225], v233 offset:8192
ds_read_b64_tr_b16 a[226:227], v233 offset:12288
v_mfma_f32_16x16x32_bf16 v[24:27], a[216:219], a[72:75], v[24:27]
ds_read_b64_tr_b16 a[228:229], v233 offset:16384
ds_read_b64_tr_b16 a[230:231], v233 offset:20480
v_mfma_f32_16x16x32_bf16 v[28:31], a[208:211], a[76:79], v[28:31]
v_mfma_f32_16x16x32_bf16 v[28:31], a[212:215], a[80:83], v[28:31]
s_add_u32 m0, s52, 0xa000
v_mfma_f32_16x16x32_bf16 v[28:31], a[216:219], a[84:87], v[28:31]
buffer_load_dwordx4 v23, s[20:23], s49 offen lds
s_add_u32 s49, s49, 0x20000
v_mfma_f32_16x16x32_bf16 v[32:35], a[208:211], a[88:91], v[32:35]
v_mfma_f32_16x16x32_bf16 v[32:35], a[212:215], a[92:95], v[32:35]
buffer_load_dwordx4 a[160:163], v14, s[32:35], s48 offen sc1
v_mfma_f32_16x16x32_bf16 v[32:35], a[216:219], a[96:99], v[32:35]
v_mfma_f32_16x16x32_bf16 v[36:39], a[208:211], a[100:103], v[36:39]
buffer_load_dwordx4 a[172:175], v14, s[32:35], s48 offen offset:1024 sc1
v_mfma_f32_16x16x32_bf16 v[36:39], a[212:215], a[104:107], v[36:39]
v_mfma_f32_16x16x32_bf16 v[36:39], a[216:219], a[108:111], v[36:39]
s_waitcnt lgkmcnt(0)
v_mfma_f32_16x16x32_bf16 v[40:43], a[220:223], a[64:67], v[40:43]
ds_read_b64_tr_b16 a[208:209], v234
ds_read_b64_tr_b16 a[210:211], v234 offset:4096
v_mfma_f32_16x16x32_bf16 v[40:43], a[224:227], a[68:71], v[40:43]
ds_read_b64_tr_b16 a[212:213], v234 offset:8192
ds_read_b64_tr_b16 a[214:215], v234 offset:12288
v_mfma_f32_16x16x32_bf16 v[40:43], a[228:231], a[72:75], v[40:43]
ds_read_b64_tr_b16 a[216:217], v234 offset:16384
ds_read_b64_tr_b16 a[218:219], v234 offset:20480
v_mfma_f32_16x16x32_bf16 v[44:47], a[220:223], a[76:79], v[44:47]
v_mfma_f32_16x16x32_bf16 v[44:47], a[224:227], a[80:83], v[44:47]
s_add_u32 m0, s52, 0xb000
v_mfma_f32_16x16x32_bf16 v[44:47], a[228:231], a[84:87], v[44:47]
buffer_load_dwordx4 v23, s[20:23], s49 offen lds
s_add_u32 s49, s49, 0x20000
v_mfma_f32_16x16x32_bf16 v[48:51], a[220:223], a[88:91], v[48:51]
v_mfma_f32_16x16x32_bf16 v[48:51], a[224:227], a[92:95], v[48:51]
buffer_load_dwordx4 a[184:187], v14, s[32:35], s48 offen offset:2048 sc1
v_mfma_f32_16x16x32_bf16 v[48:51], a[228:231], a[96:99], v[48:51]
v_mfma_f32_16x16x32_bf16 v[52:55], a[220:223], a[100:103], v[52:55]
buffer_load_dwordx4 a[196:199], v14, s[32:35], s48 offen offset:3072 sc1
v_mfma_f32_16x16x32_bf16 v[52:55], a[224:227], a[104:107], v[52:55]
v_mfma_f32_16x16x32_bf16 v[52:55], a[228:231], a[108:111], v[52:55]
s_waitcnt lgkmcnt(0)
v_mfma_f32_16x16x32_bf16 v[56:59], a[208:211], a[64:67], v[56:59]
ds_read_b64_tr_b16 a[220:221], v235
ds_read_b64_tr_b16 a[222:223], v235 offset:4096
v_mfma_f32_16x16x32_bf16 v[56:59], a[212:215], a[68:71], v[56:59]
ds_read_b64_tr_b16 a[224:225], v235 offset:8192
ds_read_b64_tr_b16 a[226:227], v235 offset:12288
v_mfma_f32_16x16x32_bf16 v[56:59], a[216:219], a[72:75], v[56:59]
ds_read_b64_tr_b16 a[228:229], v235 offset:16384
ds_read_b64_tr_b16 a[230:231], v235 offset:20480
v_mfma_f32_16x16x32_bf16 v[60:63], a[208:211], a[76:79], v[60:63]
v_mfma_f32_16x16x32_bf16 v[60:63], a[212:215], a[80:83], v[60:63]
s_add_u32 m0, s52, 0xc000
v_mfma_f32_16x16x32_bf16 v[60:63], a[216:219], a[84:87], v[60:63]
buffer_load_dwordx4 v23, s[20:23], s49 offen lds
s_add_u32 s49, s49, 0x20000
v_mfma_f32_16x16x32_bf16 v[64:67], a[208:211], a[88:91], v[64:67]
v_mfma_f32_16x16x32_bf16 v[64:67], a[212:215], a[92:95], v[64:67]
buffer_load_dwordx4 a[164:167], v15, s[32:35], s48 offen sc1
v_mfma_f32_16x16x32_bf16 v[64:67], a[216:219], a[96:99], v[64:67]
v_mfma_f32_16x16x32_bf16 v[68:71], a[208:211], a[100:103], v[68:71]
buffer_load_dwordx4 a[176:179], v15, s[32:35], s48 offen offset:1024 sc1
v_mfma_f32_16x16x32_bf16 v[68:71], a[212:215], a[104:107], v[68:71]
v_mfma_f32_16x16x32_bf16 v[68:71], a[216:219], a[108:111], v[68:71]
s_waitcnt lgkmcnt(0)
v_mfma_f32_16x16x32_bf16 v[72:75], a[220:223], a[64:67], v[72:75]
ds_read_b64_tr_b16 a[208:209], v236
ds_read_b64_tr_b16 a[210:211], v236 offset:4096
v_mfma_f32_16x16x32_bf16 v[72:75], a[224:227], a[68:71], v[72:75]
ds_read_b64_tr_b16 a[212:213], v236 offset:8192
ds_read_b64_tr_b16 a[214:215], v236 offset:12288
v_mfma_f32_16x16x32_bf16 v[72:75], a[228:231], a[72:75], v[72:75]
ds_read_b64_tr_b16 a[216:217], v236 offset:16384
ds_read_b64_tr_b16 a[218:219], v236 offset:20480
v_mfma_f32_16x16x32_bf16 v[76:79], a[220:223], a[76:79], v[76:79]
v_mfma_f32_16x16x32_bf16 v[76:79], a[224:227], a[80:83], v[76:79]
s_add_u32 m0, s52, 0xd000
v_mfma_f32_16x16x32_bf16 v[76:79], a[228:231], a[84:87], v[76:79]
buffer_load_dwordx4 v23, s[20:23], s49 offen lds
s_add_u32 s49, s49, 0x20000
v_mfma_f32_16x16x32_bf16 v[80:83], a[220:223], a[88:91], v[80:83]
v_mfma_f32_16x16x32_bf16 v[80:83], a[224:227], a[92:95], v[80:83]
buffer_load_dwordx4 a[188:191], v15, s[32:35], s48 offen offset:2048 sc1
v_mfma_f32_16x16x32_bf16 v[80:83], a[228:231], a[96:99], v[80:83]
v_mfma_f32_16x16x32_bf16 v[84:87], a[220:223], a[100:103], v[84:87]
buffer_load_dwordx4 a[200:203], v15, s[32:35], s48 offen offset:3072 sc1
v_mfma_f32_16x16x32_bf16 v[84:87], a[224:227], a[104:107], v[84:87]
v_mfma_f32_16x16x32_bf16 v[84:87], a[228:231], a[108:111], v[84:87]
s_waitcnt lgkmcnt(0)
v_mfma_f32_16x16x32_bf16 v[88:91], a[208:211], a[64:67], v[88:91]
ds_read_b64_tr_b16 a[220:221], v237
ds_read_b64_tr_b16 a[222:223], v237 offset:4096
v_mfma_f32_16x16x32_bf16 v[88:91], a[212:215], a[68:71], v[88:91]
ds_read_b64_tr_b16 a[224:225], v237 offset:8192
ds_read_b64_tr_b16 a[226:227], v237 offset:12288
v_mfma_f32_16x16x32_bf16 v[88:91], a[216:219], a[72:75], v[88:91]
ds_read_b64_tr_b16 a[228:229], v237 offset:16384
ds_read_b64_tr_b16 a[230:231], v237 offset:20480
v_mfma_f32_16x16x32_bf16 v[92:95], a[208:211], a[76:79], v[92:95]
v_mfma_f32_16x16x32_bf16 v[92:95], a[212:215], a[80:83], v[92:95]
s_add_u32 m0, s52, 0xe000
v_mfma_f32_16x16x32_bf16 v[92:95], a[216:219], a[84:87], v[92:95]
buffer_load_dwordx4 v23, s[20:23], s49 offen lds
s_add_u32 s49, s49, 0x20000
v_mfma_f32_16x16x32_bf16 v[96:99], a[208:211], a[88:91], v[96:99]
v_mfma_f32_16x16x32_bf16 v[96:99], a[212:215], a[92:95], v[96:99]
buffer_load_dwordx4 a[168:171], v16, s[32:35], s48 offen sc1
v_mfma_f32_16x16x32_bf16 v[96:99], a[216:219], a[96:99], v[96:99]
v_mfma_f32_16x16x32_bf16 v[100:103], a[208:211], a[100:103], v[100:103]
buffer_load_dwordx4 a[180:183], v16, s[32:35], s48 offen offset:1024 sc1
v_mfma_f32_16x16x32_bf16 v[100:103], a[212:215], a[104:107], v[100:103]
v_mfma_f32_16x16x32_bf16 v[100:103], a[216:219], a[108:111], v[100:103]
s_waitcnt lgkmcnt(0)
v_mfma_f32_16x16x32_bf16 v[104:107], a[220:223], a[64:67], v[104:107]
ds_read_b64_tr_b16 a[208:209], v238
ds_read_b64_tr_b16 a[210:211], v238 offset:4096
v_mfma_f32_16x16x32_bf16 v[104:107], a[224:227], a[68:71], v[104:107]
ds_read_b64_tr_b16 a[212:213], v238 offset:8192
ds_read_b64_tr_b16 a[214:215], v238 offset:12288
v_mfma_f32_16x16x32_bf16 v[104:107], a[228:231], a[72:75], v[104:107]
ds_read_b64_tr_b16 a[216:217], v238 offset:16384
ds_read_b64_tr_b16 a[218:219], v238 offset:20480
v_mfma_f32_16x16x32_bf16 v[108:111], a[220:223], a[76:79], v[108:111]
v_mfma_f32_16x16x32_bf16 v[108:111], a[224:227], a[80:83], v[108:111]
s_add_u32 m0, s52, 0xf000
v_mfma_f32_16x16x32_bf16 v[108:111], a[228:231], a[84:87], v[108:111]
buffer_load_dwordx4 v23, s[20:23], s49 offen lds
s_add_u32 s49, s49, 0x20000
v_mfma_f32_16x16x32_bf16 v[112:115], a[220:223], a[88:91], v[112:115]
v_mfma_f32_16x16x32_bf16 v[112:115], a[224:227], a[92:95], v[112:115]
buffer_load_dwordx4 a[192:195], v16, s[32:35], s48 offen offset:2048 sc1
v_mfma_f32_16x16x32_bf16 v[112:115], a[228:231], a[96:99], v[112:115]
v_mfma_f32_16x16x32_bf16 v[116:119], a[220:223], a[100:103], v[116:119]
buffer_load_dwordx4 a[204:207], v16, s[32:35], s48 offen offset:3072 sc1
s_add_u32 s48, s48, 0x60000
v_mfma_f32_16x16x32_bf16 v[116:119], a[224:227], a[104:107], v[116:119]
v_mfma_f32_16x16x32_bf16 v[116:119], a[228:231], a[108:111], v[116:119]
s_waitcnt lgkmcnt(0)
v_mfma_f32_16x16x32_bf16 v[120:123], a[208:211], a[64:67], v[120:123]
ds_read_b64_tr_b16 a[220:221], v239
ds_read_b64_tr_b16 a[222:223], v239 offset:4096
v_mfma_f32_16x16x32_bf16 v[120:123], a[212:215], a[68:71], v[120:123]
ds_read_b64_tr_b16 a[224:225], v239 offset:8192
ds_read_b64_tr_b16 a[226:227], v239 offset:12288
v_mfma_f32_16x16x32_bf16 v[120:123], a[216:219], a[72:75], v[120:123]
ds_read_b64_tr_b16 a[228:229], v239 offset:16384
ds_read_b64_tr_b16 a[230:231], v239 offset:20480
v_mfma_f32_16x16x32_bf16 v[124:127], a[208:211], a[76:79], v[124:127]
v_mfma_f32_16x16x32_bf16 v[124:127], a[212:215], a[80:83], v[124:127]
buffer_store_dwordx4 v[188:191], v18, s[36:39], s94 offen offset:1024 sc1
v_mfma_f32_16x16x32_bf16 v[124:127], a[216:219], a[84:87], v[124:127]
v_mfma_f32_16x16x32_bf16 v[128:131], a[208:211], a[88:91], v[128:131]
v_mfma_f32_16x16x32_bf16 v[128:131], a[212:215], a[92:95], v[128:131]
v_mfma_f32_16x16x32_bf16 v[128:131], a[216:219], a[96:99], v[128:131]
v_mfma_f32_16x16x32_bf16 v[132:135], a[208:211], a[100:103], v[132:135]
v_mfma_f32_16x16x32_bf16 v[132:135], a[212:215], a[104:107], v[132:135]
v_mfma_f32_16x16x32_bf16 v[132:135], a[216:219], a[108:111], v[132:135]
s_waitcnt lgkmcnt(0)
v_mfma_f32_16x16x32_bf16 v[136:139], a[220:223], a[64:67], v[136:139]
s_waitcnt vmcnt(20)
s_barrier
v_mfma_f32_16x16x32_bf16 v[136:139], a[224:227], a[68:71], v[136:139]
ds_read_b64_tr_b16 a[208:209], v232 offset:24576
ds_read_b64_tr_b16 a[210:211], v232 offset:28672
v_mfma_f32_16x16x32_bf16 v[136:139], a[228:231], a[72:75], v[136:139]
ds_read_b64_tr_b16 a[212:213], v232 offset:32768
ds_read_b64_tr_b16 a[214:215], v232 offset:36864
v_mfma_f32_16x16x32_bf16 v[140:143], a[220:223], a[76:79], v[140:143]
ds_read_b64_tr_b16 a[216:217], v232 offset:40960
ds_read_b64_tr_b16 a[218:219], v232 offset:45056
v_mfma_f32_16x16x32_bf16 v[140:143], a[224:227], a[80:83], v[140:143]
v_mfma_f32_16x16x32_bf16 v[140:143], a[228:231], a[84:87], v[140:143]
v_mfma_f32_16x16x32_bf16 v[144:147], a[220:223], a[88:91], v[144:147]
v_mfma_f32_16x16x32_bf16 v[144:147], a[224:227], a[92:95], v[144:147]
v_mfma_f32_16x16x32_bf16 v[144:147], a[228:231], a[96:99], v[144:147]
v_mfma_f32_16x16x32_bf16 v[148:151], a[220:223], a[100:103], v[148:151]
v_mfma_f32_16x16x32_bf16 v[148:151], a[224:227], a[104:107], v[148:151]
v_mfma_f32_16x16x32_bf16 v[148:151], a[228:231], a[108:111], v[148:151]
s_waitcnt lgkmcnt(0)
v_mfma_f32_16x16x32_bf16 v[24:27], a[208:211], a[112:115], v[24:27]
ds_read_b64_tr_b16 a[220:221], v233 offset:24576
ds_read_b64_tr_b16 a[222:223], v233 offset:28672
v_mfma_f32_16x16x32_bf16 v[24:27], a[212:215], a[116:119], v[24:27]
ds_read_b64_tr_b16 a[224:225], v233 offset:32768
ds_read_b64_tr_b16 a[226:227], v233 offset:36864
v_mfma_f32_16x16x32_bf16 v[24:27], a[216:219], a[120:123], v[24:27]
ds_read_b64_tr_b16 a[228:229], v233 offset:40960
ds_read_b64_tr_b16 a[230:231], v233 offset:45056
v_mfma_f32_16x16x32_bf16 v[28:31], a[208:211], a[124:127], v[28:31]
v_and_b32 v19, 15, v1
v_lshrrev_b32 v20, 4, v1
v_mfma_f32_16x16x32_bf16 v[28:31], a[212:215], a[128:131], v[28:31]
s_add_u32 m0, s52, 0
v_mfma_f32_16x16x32_bf16 v[28:31], a[216:219], a[132:135], v[28:31]
buffer_load_dwordx4 v240, s[24:27], s50 offen lds
v_mfma_f32_16x16x32_bf16 v[32:35], a[208:211], a[136:139], v[32:35]
v_add_u32 v21, 0, v20
v_xor_b32 v21, v21, v19
v_mfma_f32_16x16x32_bf16 v[32:35], a[212:215], a[140:143], v[32:35]
v_mfma_f32_16x16x32_bf16 v[32:35], a[216:219], a[144:147], v[32:35]
s_add_u32 m0, s52, 0x10000
v_mfma_f32_16x16x32_bf16 v[36:39], a[208:211], a[148:151], v[36:39]
buffer_load_dwordx4 v241, s[28:31], s50 offen lds
s_add_u32 s50, s50, 0x1000
v_mfma_f32_16x16x32_bf16 v[36:39], a[212:215], a[152:155], v[36:39]
v_lshlrev_b32 v21, 4, v21
v_lshl_add_u32 v14, v19, 8, v21
v_mfma_f32_16x16x32_bf16 v[36:39], a[216:219], a[156:159], v[36:39]
s_waitcnt lgkmcnt(0)
v_mfma_f32_16x16x32_bf16 v[40:43], a[220:223], a[112:115], v[40:43]
ds_read_b64_tr_b16 a[208:209], v234 offset:24576
ds_read_b64_tr_b16 a[210:211], v234 offset:28672
v_mfma_f32_16x16x32_bf16 v[40:43], a[224:227], a[116:119], v[40:43]
ds_read_b64_tr_b16 a[212:213], v234 offset:32768
ds_read_b64_tr_b16 a[214:215], v234 offset:36864
v_mfma_f32_16x16x32_bf16 v[40:43], a[228:231], a[120:123], v[40:43]
ds_read_b64_tr_b16 a[216:217], v234 offset:40960
ds_read_b64_tr_b16 a[218:219], v234 offset:45056
v_mfma_f32_16x16x32_bf16 v[44:47], a[220:223], a[124:127], v[44:47]
v_add_u32 v21, 4, v20
v_xor_b32 v21, v21, v19
v_mfma_f32_16x16x32_bf16 v[44:47], a[224:227], a[128:131], v[44:47]
s_add_u32 m0, s52, 0x1000
v_mfma_f32_16x16x32_bf16 v[44:47], a[228:231], a[132:135], v[44:47]
buffer_load_dwordx4 v240, s[24:27], s50 offen lds
v_mfma_f32_16x16x32_bf16 v[48:51], a[220:223], a[136:139], v[48:51]
v_lshlrev_b32 v21, 4, v21
v_lshl_add_u32 v15, v19, 8, v21
v_mfma_f32_16x16x32_bf16 v[48:51], a[224:227], a[140:143], v[48:51]
v_mfma_f32_16x16x32_bf16 v[48:51], a[228:231], a[144:147], v[48:51]
s_add_u32 m0, s52, 0x11000
v_mfma_f32_16x16x32_bf16 v[52:55], a[220:223], a[148:151], v[52:55]
buffer_load_dwordx4 v241, s[28:31], s50 offen lds
s_add_u32 s50, s50, 0x1000
v_mfma_f32_16x16x32_bf16 v[52:55], a[224:227], a[152:155], v[52:55]
v_add_u32 v21, 8, v20
v_xor_b32 v21, v21, v19
v_mfma_f32_16x16x32_bf16 v[52:55], a[228:231], a[156:159], v[52:55]
s_waitcnt lgkmcnt(0)
v_mfma_f32_16x16x32_bf16 v[56:59], a[208:211], a[112:115], v[56:59]
ds_read_b64_tr_b16 a[220:221], v235 offset:24576
ds_read_b64_tr_b16 a[222:223], v235 offset:28672
v_mfma_f32_16x16x32_bf16 v[56:59], a[212:215], a[116:119], v[56:59]
ds_read_b64_tr_b16 a[224:225], v235 offset:32768
ds_read_b64_tr_b16 a[226:227], v235 offset:36864
v_mfma_f32_16x16x32_bf16 v[56:59], a[216:219], a[120:123], v[56:59]
ds_read_b64_tr_b16 a[228:229], v235 offset:40960
ds_read_b64_tr_b16 a[230:231], v235 offset:45056
v_mfma_f32_16x16x32_bf16 v[60:63], a[208:211], a[124:127], v[60:63]
v_lshlrev_b32 v21, 4, v21
v_lshl_add_u32 v16, v19, 8, v21
v_mfma_f32_16x16x32_bf16 v[60:63], a[212:215], a[128:131], v[60:63]
s_add_u32 m0, s52, 0x2000
v_mfma_f32_16x16x32_bf16 v[60:63], a[216:219], a[132:135], v[60:63]
buffer_load_dwordx4 v240, s[24:27], s50 offen lds
v_mfma_f32_16x16x32_bf16 v[64:67], a[208:211], a[136:139], v[64:67]
v_add_u32 v21, 12, v20
v_xor_b32 v21, v21, v19
v_mfma_f32_16x16x32_bf16 v[64:67], a[212:215], a[140:143], v[64:67]
v_mfma_f32_16x16x32_bf16 v[64:67], a[216:219], a[144:147], v[64:67]
s_add_u32 m0, s52, 0x12000
v_mfma_f32_16x16x32_bf16 v[68:71], a[208:211], a[148:151], v[68:71]
buffer_load_dwordx4 v241, s[28:31], s50 offen lds
s_add_u32 s50, s50, 0x1000
v_mfma_f32_16x16x32_bf16 v[68:71], a[212:215], a[152:155], v[68:71]
v_lshlrev_b32 v21, 4, v21
v_lshl_add_u32 v17, v19, 8, v21
v_mfma_f32_16x16x32_bf16 v[68:71], a[216:219], a[156:159], v[68:71]
s_waitcnt lgkmcnt(0)
v_mfma_f32_16x16x32_bf16 v[72:75], a[220:223], a[112:115], v[72:75]
ds_read_b64_tr_b16 a[208:209], v236 offset:24576
ds_read_b64_tr_b16 a[210:211], v236 offset:28672
v_mfma_f32_16x16x32_bf16 v[72:75], a[224:227], a[116:119], v[72:75]
ds_read_b64_tr_b16 a[212:213], v236 offset:32768
ds_read_b64_tr_b16 a[214:215], v236 offset:36864
v_mfma_f32_16x16x32_bf16 v[72:75], a[228:231], a[120:123], v[72:75]
ds_read_b64_tr_b16 a[216:217], v236 offset:40960
ds_read_b64_tr_b16 a[218:219], v236 offset:45056
v_mfma_f32_16x16x32_bf16 v[76:79], a[220:223], a[124:127], v[76:79]
v_mfma_f32_16x16x32_bf16 v[76:79], a[224:227], a[128:131], v[76:79]
s_add_u32 m0, s52, 0x3000
v_mfma_f32_16x16x32_bf16 v[76:79], a[228:231], a[132:135], v[76:79]
buffer_load_dwordx4 v240, s[24:27], s50 offen lds
v_mfma_f32_16x16x32_bf16 v[80:83], a[220:223], a[136:139], v[80:83]
v_mfma_f32_16x16x32_bf16 v[80:83], a[224:227], a[140:143], v[80:83]
v_mfma_f32_16x16x32_bf16 v[80:83], a[228:231], a[144:147], v[80:83]
s_add_u32 m0, s52, 0x13000
v_mfma_f32_16x16x32_bf16 v[84:87], a[220:223], a[148:151], v[84:87]
buffer_load_dwordx4 v241, s[28:31], s50 offen lds
s_add_u32 s50, s50, 0x1000
v_mfma_f32_16x16x32_bf16 v[84:87], a[224:227], a[152:155], v[84:87]
v_mfma_f32_16x16x32_bf16 v[84:87], a[228:231], a[156:159], v[84:87]
s_waitcnt lgkmcnt(0)
v_mfma_f32_16x16x32_bf16 v[88:91], a[208:211], a[112:115], v[88:91]
ds_read_b64_tr_b16 a[220:221], v237 offset:24576
ds_read_b64_tr_b16 a[222:223], v237 offset:28672
v_mfma_f32_16x16x32_bf16 v[88:91], a[212:215], a[116:119], v[88:91]
ds_read_b64_tr_b16 a[224:225], v237 offset:32768
ds_read_b64_tr_b16 a[226:227], v237 offset:36864
v_mfma_f32_16x16x32_bf16 v[88:91], a[216:219], a[120:123], v[88:91]
ds_read_b64_tr_b16 a[228:229], v237 offset:40960
ds_read_b64_tr_b16 a[230:231], v237 offset:45056
v_mfma_f32_16x16x32_bf16 v[92:95], a[208:211], a[124:127], v[92:95]
v_mfma_f32_16x16x32_bf16 v[92:95], a[212:215], a[128:131], v[92:95]
buffer_store_dwordx4 v[192:195], v18, s[36:39], s94 offen offset:2048 sc1
v_mfma_f32_16x16x32_bf16 v[92:95], a[216:219], a[132:135], v[92:95]
v_mfma_f32_16x16x32_bf16 v[96:99], a[208:211], a[136:139], v[96:99]
v_mfma_f32_16x16x32_bf16 v[96:99], a[212:215], a[140:143], v[96:99]
v_mfma_f32_16x16x32_bf16 v[96:99], a[216:219], a[144:147], v[96:99]
v_mfma_f32_16x16x32_bf16 v[100:103], a[208:211], a[148:151], v[100:103]
v_mfma_f32_16x16x32_bf16 v[100:103], a[212:215], a[152:155], v[100:103]
v_mfma_f32_16x16x32_bf16 v[100:103], a[216:219], a[156:159], v[100:103]
s_waitcnt lgkmcnt(0)
v_mfma_f32_16x16x32_bf16 v[104:107], a[220:223], a[112:115], v[104:107]
ds_read_b64_tr_b16 a[208:209], v238 offset:24576
ds_read_b64_tr_b16 a[210:211], v238 offset:28672
v_mfma_f32_16x16x32_bf16 v[104:107], a[224:227], a[116:119], v[104:107]
ds_read_b64_tr_b16 a[212:213], v238 offset:32768
ds_read_b64_tr_b16 a[214:215], v238 offset:36864
v_mfma_f32_16x16x32_bf16 v[104:107], a[228:231], a[120:123], v[104:107]
ds_read_b64_tr_b16 a[216:217], v238 offset:40960
ds_read_b64_tr_b16 a[218:219], v238 offset:45056
v_mfma_f32_16x16x32_bf16 v[108:111], a[220:223], a[124:127], v[108:111]
v_mfma_f32_16x16x32_bf16 v[108:111], a[224:227], a[128:131], v[108:111]
v_mfma_f32_16x16x32_bf16 v[108:111], a[228:231], a[132:135], v[108:111]
v_mfma_f32_16x16x32_bf16 v[112:115], a[220:223], a[136:139], v[112:115]
v_mfma_f32_16x16x32_bf16 v[112:115], a[224:227], a[140:143], v[112:115]
v_mfma_f32_16x16x32_bf16 v[112:115], a[228:231], a[144:147], v[112:115]
v_mfma_f32_16x16x32_bf16 v[116:119], a[220:223], a[148:151], v[116:119]
v_mfma_f32_16x16x32_bf16 v[116:119], a[224:227], a[152:155], v[116:119]
v_mfma_f32_16x16x32_bf16 v[116:119], a[228:231], a[156:159], v[116:119]
s_waitcnt lgkmcnt(0)
v_mfma_f32_16x16x32_bf16 v[120:123], a[208:211], a[112:115], v[120:123]
ds_read_b64_tr_b16 a[220:221], v239 offset:24576
ds_read_b64_tr_b16 a[222:223], v239 offset:28672
v_mfma_f32_16x16x32_bf16 v[120:123], a[212:215], a[116:119], v[120:123]
ds_read_b64_tr_b16 a[224:225], v239 offset:32768
ds_read_b64_tr_b16 a[226:227], v239 offset:36864
v_mfma_f32_16x16x32_bf16 v[120:123], a[216:219], a[120:123], v[120:123]
ds_read_b64_tr_b16 a[228:229], v239 offset:40960
ds_read_b64_tr_b16 a[230:231], v239 offset:45056
v_mfma_f32_16x16x32_bf16 v[124:127], a[208:211], a[124:127], v[124:127]
v_mfma_f32_16x16x32_bf16 v[124:127], a[212:215], a[128:131], v[124:127]
buffer_store_dwordx4 v[196:199], v18, s[36:39], s94 offen offset:3072 sc1
v_mfma_f32_16x16x32_bf16 v[124:127], a[216:219], a[132:135], v[124:127]
v_mfma_f32_16x16x32_bf16 v[128:131], a[208:211], a[136:139], v[128:131]
v_mfma_f32_16x16x32_bf16 v[128:131], a[212:215], a[140:143], v[128:131]
v_mfma_f32_16x16x32_bf16 v[128:131], a[216:219], a[144:147], v[128:131]
v_mfma_f32_16x16x32_bf16 v[132:135], a[208:211], a[148:151], v[132:135]
v_mfma_f32_16x16x32_bf16 v[132:135], a[212:215], a[152:155], v[132:135]
v_mfma_f32_16x16x32_bf16 v[132:135], a[216:219], a[156:159], v[132:135]
s_waitcnt lgkmcnt(0)
v_mfma_f32_16x16x32_bf16 v[136:139], a[220:223], a[112:115], v[136:139]
s_waitcnt vmcnt(11)
s_barrier
v_mfma_f32_16x16x32_bf16 v[136:139], a[224:227], a[116:119], v[136:139]
ds_read_b64_tr_b16 a[208:209], v224
ds_read_b64_tr_b16 a[210:211], v224 offset:4096
v_mfma_f32_16x16x32_bf16 v[136:139], a[228:231], a[120:123], v[136:139]
ds_read_b64_tr_b16 a[212:213], v224 offset:8192
ds_read_b64_tr_b16 a[214:215], v224 offset:12288
v_mfma_f32_16x16x32_bf16 v[140:143], a[220:223], a[124:127], v[140:143]
ds_read_b64_tr_b16 a[216:217], v224 offset:16384
ds_read_b64_tr_b16 a[218:219], v224 offset:20480
v_mfma_f32_16x16x32_bf16 v[140:143], a[224:227], a[128:131], v[140:143]
v_mfma_f32_16x16x32_bf16 v[140:143], a[228:231], a[132:135], v[140:143]
v_mfma_f32_16x16x32_bf16 v[144:147], a[220:223], a[136:139], v[144:147]
v_mfma_f32_16x16x32_bf16 v[144:147], a[224:227], a[140:143], v[144:147]
v_mfma_f32_16x16x32_bf16 v[144:147], a[228:231], a[144:147], v[144:147]
v_mfma_f32_16x16x32_bf16 v[148:151], a[220:223], a[148:151], v[148:151]
v_mfma_f32_16x16x32_bf16 v[148:151], a[224:227], a[152:155], v[148:151]
v_mfma_f32_16x16x32_bf16 v[148:151], a[228:231], a[156:159], v[148:151]
s_waitcnt lgkmcnt(0)
v_mfma_f32_16x16x32_bf16 v[24:27], a[208:211], a[160:163], v[24:27]
ds_read_b64_tr_b16 a[220:221], v225
ds_read_b64_tr_b16 a[222:223], v225 offset:4096
v_mfma_f32_16x16x32_bf16 v[24:27], a[212:215], a[164:167], v[24:27]
ds_read_b64_tr_b16 a[224:225], v225 offset:8192
ds_read_b64_tr_b16 a[226:227], v225 offset:12288
v_mfma_f32_16x16x32_bf16 v[24:27], a[216:219], a[168:171], v[24:27]
ds_read_b64_tr_b16 a[228:229], v225 offset:16384
ds_read_b64_tr_b16 a[230:231], v225 offset:20480
v_mfma_f32_16x16x32_bf16 v[28:31], a[208:211], a[172:175], v[28:31]
s_and_b32 s55, s84, 3
s_mov_b32 s56, 0x144000
s_cmp_lt_u32 s84, 4
s_cselect_b32 s56, 0x120000, s56
s_mul_i32 s55, s55, s56
s_cselect_b32 s16, s64, s66
s_cselect_b32 s17, s65, s67
s_add_u32 s16, s16, s55
s_addc_u32 s17, s17, 0
s_mov_b32 s18, s56
s_mov_b32 s19, 0x20000
s_lshr_b32 s55, s2, 3
s_lshl_b32 s55, s55, 2
s_add_u32 s55, s55, s44
s_mul_i32 s91, s55, 0x600
v_min_u32 v251, 11, v1
v_lshlrev_b32 v251, 7, v251
v_mfma_f32_16x16x32_bf16 v[28:31], a[212:215], a[176:179], v[28:31]
s_add_u32 m0, s52, 0x4000
v_mfma_f32_16x16x32_bf16 v[28:31], a[216:219], a[180:183], v[28:31]
buffer_load_dwordx4 v240, s[24:27], s50 offen lds
v_mfma_f32_16x16x32_bf16 v[32:35], a[208:211], a[184:187], v[32:35]
v_mfma_f32_16x16x32_bf16 v[32:35], a[212:215], a[188:191], v[32:35]
v_mfma_f32_16x16x32_bf16 v[32:35], a[216:219], a[192:195], v[32:35]
s_add_u32 m0, s52, 0x14000
v_mfma_f32_16x16x32_bf16 v[36:39], a[208:211], a[196:199], v[36:39]
buffer_load_dwordx4 v241, s[28:31], s50 offen lds
s_add_u32 s50, s50, 0x1000
v_mfma_f32_16x16x32_bf16 v[36:39], a[212:215], a[200:203], v[36:39]
v_mfma_f32_16x16x32_bf16 v[36:39], a[216:219], a[204:207], v[36:39]
s_waitcnt lgkmcnt(0)
v_mfma_f32_16x16x32_bf16 v[40:43], a[220:223], a[160:163], v[40:43]
ds_read_b64_tr_b16 a[208:209], v226
ds_read_b64_tr_b16 a[210:211], v226 offset:4096
v_mfma_f32_16x16x32_bf16 v[40:43], a[224:227], a[164:167], v[40:43]
ds_read_b64_tr_b16 a[212:213], v226 offset:8192
ds_read_b64_tr_b16 a[214:215], v226 offset:12288
v_mfma_f32_16x16x32_bf16 v[40:43], a[228:231], a[168:171], v[40:43]
ds_read_b64_tr_b16 a[216:217], v226 offset:16384
ds_read_b64_tr_b16 a[218:219], v226 offset:20480
v_mfma_f32_16x16x32_bf16 v[44:47], a[220:223], a[172:175], v[44:47]
v_mfma_f32_16x16x32_bf16 v[44:47], a[224:227], a[176:179], v[44:47]
s_add_u32 m0, s52, 0x5000
v_mfma_f32_16x16x32_bf16 v[44:47], a[228:231], a[180:183], v[44:47]
buffer_load_dwordx4 v240, s[24:27], s50 offen lds
v_mfma_f32_16x16x32_bf16 v[48:51], a[220:223], a[184:187], v[48:51]
v_mfma_f32_16x16x32_bf16 v[48:51], a[224:227], a[188:191], v[48:51]
v_mfma_f32_16x16x32_bf16 v[48:51], a[228:231], a[192:195], v[48:51]
s_add_u32 m0, s52, 0x15000
v_mfma_f32_16x16x32_bf16 v[52:55], a[220:223], a[196:199], v[52:55]
buffer_load_dwordx4 v241, s[28:31], s50 offen lds
s_add_u32 s50, s50, 0x1000
v_mfma_f32_16x16x32_bf16 v[52:55], a[224:227], a[200:203], v[52:55]
v_mfma_f32_16x16x32_bf16 v[52:55], a[228:231], a[204:207], v[52:55]
s_waitcnt lgkmcnt(0)
v_mfma_f32_16x16x32_bf16 v[56:59], a[208:211], a[160:163], v[56:59]
ds_read_b64_tr_b16 a[220:221], v227
ds_read_b64_tr_b16 a[222:223], v227 offset:4096
v_mfma_f32_16x16x32_bf16 v[56:59], a[212:215], a[164:167], v[56:59]
ds_read_b64_tr_b16 a[224:225], v227 offset:8192
ds_read_b64_tr_b16 a[226:227], v227 offset:12288
v_mfma_f32_16x16x32_bf16 v[56:59], a[216:219], a[168:171], v[56:59]
ds_read_b64_tr_b16 a[228:229], v227 offset:16384
ds_read_b64_tr_b16 a[230:231], v227 offset:20480
v_mfma_f32_16x16x32_bf16 v[60:63], a[208:211], a[172:175], v[60:63]
v_mfma_f32_16x16x32_bf16 v[60:63], a[212:215], a[176:179], v[60:63]
s_add_u32 m0, s52, 0x6000
v_mfma_f32_16x16x32_bf16 v[60:63], a[216:219], a[180:183], v[60:63]
buffer_load_dwordx4 v240, s[24:27], s50 offen lds
v_mfma_f32_16x16x32_bf16 v[64:67], a[208:211], a[184:187], v[64:67]
v_mfma_f32_16x16x32_bf16 v[64:67], a[212:215], a[188:191], v[64:67]
v_mfma_f32_16x16x32_bf16 v[64:67], a[216:219], a[192:195], v[64:67]
s_add_u32 m0, s52, 0x16000
v_mfma_f32_16x16x32_bf16 v[68:71], a[208:211], a[196:199], v[68:71]
buffer_load_dwordx4 v241, s[28:31], s50 offen lds
s_add_u32 s50, s50, 0x1000
v_mfma_f32_16x16x32_bf16 v[68:71], a[212:215], a[200:203], v[68:71]
v_mfma_f32_16x16x32_bf16 v[68:71], a[216:219], a[204:207], v[68:71]
s_waitcnt lgkmcnt(0)
v_mfma_f32_16x16x32_bf16 v[72:75], a[220:223], a[160:163], v[72:75]
ds_read_b64_tr_b16 a[208:209], v228
ds_read_b64_tr_b16 a[210:211], v228 offset:4096
v_mfma_f32_16x16x32_bf16 v[72:75], a[224:227], a[164:167], v[72:75]
ds_read_b64_tr_b16 a[212:213], v228 offset:8192
ds_read_b64_tr_b16 a[214:215], v228 offset:12288
v_mfma_f32_16x16x32_bf16 v[72:75], a[228:231], a[168:171], v[72:75]
ds_read_b64_tr_b16 a[216:217], v228 offset:16384
ds_read_b64_tr_b16 a[218:219], v228 offset:20480
v_mfma_f32_16x16x32_bf16 v[76:79], a[220:223], a[172:175], v[76:79]
v_mfma_f32_16x16x32_bf16 v[76:79], a[224:227], a[176:179], v[76:79]
s_add_u32 m0, s52, 0x7000
v_mfma_f32_16x16x32_bf16 v[76:79], a[228:231], a[180:183], v[76:79]
buffer_load_dwordx4 v240, s[24:27], s50 offen lds
v_mfma_f32_16x16x32_bf16 v[80:83], a[220:223], a[184:187], v[80:83]
v_mfma_f32_16x16x32_bf16 v[80:83], a[224:227], a[188:191], v[80:83]
v_mfma_f32_16x16x32_bf16 v[80:83], a[228:231], a[192:195], v[80:83]
s_add_u32 m0, s52, 0x17000
v_mfma_f32_16x16x32_bf16 v[84:87], a[220:223], a[196:199], v[84:87]
buffer_load_dwordx4 v241, s[28:31], s50 offen lds
s_add_u32 s50, s50, 0x1000
v_mfma_f32_16x16x32_bf16 v[84:87], a[224:227], a[200:203], v[84:87]
v_mfma_f32_16x16x32_bf16 v[84:87], a[228:231], a[204:207], v[84:87]
s_waitcnt lgkmcnt(0)
v_mfma_f32_16x16x32_bf16 v[88:91], a[208:211], a[160:163], v[88:91]
ds_read_b64_tr_b16 a[220:221], v229
ds_read_b64_tr_b16 a[222:223], v229 offset:4096
v_mfma_f32_16x16x32_bf16 v[88:91], a[212:215], a[164:167], v[88:91]
ds_read_b64_tr_b16 a[224:225], v229 offset:8192
ds_read_b64_tr_b16 a[226:227], v229 offset:12288
v_mfma_f32_16x16x32_bf16 v[88:91], a[216:219], a[168:171], v[88:91]
ds_read_b64_tr_b16 a[228:229], v229 offset:16384
ds_read_b64_tr_b16 a[230:231], v229 offset:20480
v_mfma_f32_16x16x32_bf16 v[92:95], a[208:211], a[172:175], v[92:95]
v_mfma_f32_16x16x32_bf16 v[92:95], a[212:215], a[176:179], v[92:95]
buffer_store_dwordx4 v[200:203], v18, s[36:39], s95 offen sc1
v_mfma_f32_16x16x32_bf16 v[92:95], a[216:219], a[180:183], v[92:95]
v_mfma_f32_16x16x32_bf16 v[96:99], a[208:211], a[184:187], v[96:99]
v_mfma_f32_16x16x32_bf16 v[96:99], a[212:215], a[188:191], v[96:99]
v_mfma_f32_16x16x32_bf16 v[96:99], a[216:219], a[192:195], v[96:99]
v_mfma_f32_16x16x32_bf16 v[100:103], a[208:211], a[196:199], v[100:103]
v_mfma_f32_16x16x32_bf16 v[100:103], a[212:215], a[200:203], v[100:103]
v_mfma_f32_16x16x32_bf16 v[100:103], a[216:219], a[204:207], v[100:103]
s_waitcnt lgkmcnt(0)
v_mfma_f32_16x16x32_bf16 v[104:107], a[220:223], a[160:163], v[104:107]
ds_read_b64_tr_b16 a[208:209], v230
ds_read_b64_tr_b16 a[210:211], v230 offset:4096
v_mfma_f32_16x16x32_bf16 v[104:107], a[224:227], a[164:167], v[104:107]
ds_read_b64_tr_b16 a[212:213], v230 offset:8192
ds_read_b64_tr_b16 a[214:215], v230 offset:12288
v_mfma_f32_16x16x32_bf16 v[104:107], a[228:231], a[168:171], v[104:107]
ds_read_b64_tr_b16 a[216:217], v230 offset:16384
ds_read_b64_tr_b16 a[218:219], v230 offset:20480
v_mfma_f32_16x16x32_bf16 v[108:111], a[220:223], a[172:175], v[108:111]
v_mfma_f32_16x16x32_bf16 v[108:111], a[224:227], a[176:179], v[108:111]
v_mfma_f32_16x16x32_bf16 v[108:111], a[228:231], a[180:183], v[108:111]
v_mfma_f32_16x16x32_bf16 v[112:115], a[220:223], a[184:187], v[112:115]
v_mfma_f32_16x16x32_bf16 v[112:115], a[224:227], a[188:191], v[112:115]
v_mfma_f32_16x16x32_bf16 v[112:115], a[228:231], a[192:195], v[112:115]
v_mfma_f32_16x16x32_bf16 v[116:119], a[220:223], a[196:199], v[116:119]
v_mfma_f32_16x16x32_bf16 v[116:119], a[224:227], a[200:203], v[116:119]
v_mfma_f32_16x16x32_bf16 v[116:119], a[228:231], a[204:207], v[116:119]
s_waitcnt lgkmcnt(0)
v_mfma_f32_16x16x32_bf16 v[120:123], a[208:211], a[160:163], v[120:123]
ds_read_b64_tr_b16 a[220:221], v231
ds_read_b64_tr_b16 a[222:223], v231 offset:4096
v_mfma_f32_16x16x32_bf16 v[120:123], a[212:215], a[164:167], v[120:123]
ds_read_b64_tr_b16 a[224:225], v231 offset:8192
ds_read_b64_tr_b16 a[226:227], v231 offset:12288
v_mfma_f32_16x16x32_bf16 v[120:123], a[216:219], a[168:171], v[120:123]
ds_read_b64_tr_b16 a[228:229], v231 offset:16384
ds_read_b64_tr_b16 a[230:231], v231 offset:20480
v_mfma_f32_16x16x32_bf16 v[124:127], a[208:211], a[172:175], v[124:127]
v_mfma_f32_16x16x32_bf16 v[124:127], a[212:215], a[176:179], v[124:127]
buffer_store_dwordx4 v[204:207], v18, s[36:39], s95 offen offset:1024 sc1
v_mfma_f32_16x16x32_bf16 v[124:127], a[216:219], a[180:183], v[124:127]
v_mfma_f32_16x16x32_bf16 v[128:131], a[208:211], a[184:187], v[128:131]
v_mfma_f32_16x16x32_bf16 v[128:131], a[212:215], a[188:191], v[128:131]
v_mfma_f32_16x16x32_bf16 v[128:131], a[216:219], a[192:195], v[128:131]
v_mfma_f32_16x16x32_bf16 v[132:135], a[208:211], a[196:199], v[132:135]
v_mfma_f32_16x16x32_bf16 v[132:135], a[212:215], a[200:203], v[132:135]
v_mfma_f32_16x16x32_bf16 v[132:135], a[216:219], a[204:207], v[132:135]
s_waitcnt lgkmcnt(0)
v_mfma_f32_16x16x32_bf16 v[136:139], a[220:223], a[160:163], v[136:139]
v_mfma_f32_16x16x32_bf16 v[136:139], a[224:227], a[164:167], v[136:139]
v_mfma_f32_16x16x32_bf16 v[136:139], a[228:231], a[168:171], v[136:139]
v_mfma_f32_16x16x32_bf16 v[140:143], a[220:223], a[172:175], v[140:143]
v_mfma_f32_16x16x32_bf16 v[140:143], a[224:227], a[176:179], v[140:143]
v_mfma_f32_16x16x32_bf16 v[140:143], a[228:231], a[180:183], v[140:143]
v_mfma_f32_16x16x32_bf16 v[144:147], a[220:223], a[184:187], v[144:147]
v_mfma_f32_16x16x32_bf16 v[144:147], a[224:227], a[188:191], v[144:147]
v_mfma_f32_16x16x32_bf16 v[144:147], a[228:231], a[192:195], v[144:147]
v_mfma_f32_16x16x32_bf16 v[148:151], a[220:223], a[196:199], v[148:151]
v_mfma_f32_16x16x32_bf16 v[148:151], a[224:227], a[200:203], v[148:151]
v_mfma_f32_16x16x32_bf16 v[148:151], a[228:231], a[204:207], v[148:151]
v_mov_b32 v20, 0x3e0293ee
v_mov_b32 v21, 0x3e0293ee
s_nop 5
v_pk_mul_f32 v[24:25], v[24:25], v[20:21]
v_pk_mul_f32 v[26:27], v[26:27], v[20:21]
v_pk_mul_f32 v[40:41], v[40:41], v[20:21]
v_pk_mul_f32 v[42:43], v[42:43], v[20:21]
v_pk_mul_f32 v[56:57], v[56:57], v[20:21]
v_pk_mul_f32 v[58:59], v[58:59], v[20:21]
v_pk_mul_f32 v[72:73], v[72:73], v[20:21]
v_pk_mul_f32 v[74:75], v[74:75], v[20:21]
v_cvt_pk_bf16_f32 v24, v24, v25
v_cvt_pk_bf16_f32 v25, v26, v27
v_cvt_pk_bf16_f32 v26, v40, v41
v_cvt_pk_bf16_f32 v27, v42, v43
v_cvt_pk_bf16_f32 v56, v56, v57
v_cvt_pk_bf16_f32 v57, v58, v59
v_cvt_pk_bf16_f32 v58, v72, v73
v_cvt_pk_bf16_f32 v59, v74, v75
s_nop 0
v_permlane32_swap_b32 v24, v26
v_permlane32_swap_b32 v25, v27
v_permlane32_swap_b32 v56, v58
v_permlane32_swap_b32 v57, v59
v_permlane16_swap_b32 v24, v26
v_permlane16_swap_b32 v25, v27
v_permlane16_swap_b32 v56, v58
v_permlane16_swap_b32 v57, v59
buffer_store_dwordx4 v[208:211], v18, s[36:39], s95 offen offset:2048 sc1
v_pk_mul_f32 v[88:89], v[88:89], v[20:21]
v_pk_mul_f32 v[90:91], v[90:91], v[20:21]
v_pk_mul_f32 v[104:105], v[104:105], v[20:21]
v_pk_mul_f32 v[106:107], v[106:107], v[20:21]
v_pk_mul_f32 v[120:121], v[120:121], v[20:21]
v_pk_mul_f32 v[122:123], v[122:123], v[20:21]
v_pk_mul_f32 v[136:137], v[136:137], v[20:21]
v_pk_mul_f32 v[138:139], v[138:139], v[20:21]
v_cvt_pk_bf16_f32 v88, v88, v89
v_cvt_pk_bf16_f32 v89, v90, v91
v_cvt_pk_bf16_f32 v90, v104, v105
v_cvt_pk_bf16_f32 v91, v106, v107
v_cvt_pk_bf16_f32 v120, v120, v121
v_cvt_pk_bf16_f32 v121, v122, v123
v_cvt_pk_bf16_f32 v122, v136, v137
v_cvt_pk_bf16_f32 v123, v138, v139
s_nop 0
v_permlane32_swap_b32 v88, v90
v_permlane32_swap_b32 v89, v91
v_permlane32_swap_b32 v120, v122
v_permlane32_swap_b32 v121, v123
v_permlane16_swap_b32 v88, v90
v_permlane16_swap_b32 v89, v91
v_permlane16_swap_b32 v120, v122
v_permlane16_swap_b32 v121, v123
v_pk_mul_f32 v[28:29], v[28:29], v[20:21]
v_pk_mul_f32 v[30:31], v[30:31], v[20:21]
v_pk_mul_f32 v[44:45], v[44:45], v[20:21]
v_pk_mul_f32 v[46:47], v[46:47], v[20:21]
v_pk_mul_f32 v[60:61], v[60:61], v[20:21]
v_pk_mul_f32 v[62:63], v[62:63], v[20:21]
v_pk_mul_f32 v[76:77], v[76:77], v[20:21]
v_pk_mul_f32 v[78:79], v[78:79], v[20:21]
v_cvt_pk_bf16_f32 v28, v28, v29
v_cvt_pk_bf16_f32 v29, v30, v31
v_cvt_pk_bf16_f32 v30, v44, v45
v_cvt_pk_bf16_f32 v31, v46, v47
v_cvt_pk_bf16_f32 v60, v60, v61
v_cvt_pk_bf16_f32 v61, v62, v63
v_cvt_pk_bf16_f32 v62, v76, v77
v_cvt_pk_bf16_f32 v63, v78, v79
s_nop 0
v_permlane32_swap_b32 v28, v30
v_permlane32_swap_b32 v29, v31
v_permlane32_swap_b32 v60, v62
v_permlane32_swap_b32 v61, v63
v_permlane16_swap_b32 v28, v30
v_permlane16_swap_b32 v29, v31
v_permlane16_swap_b32 v60, v62
v_permlane16_swap_b32 v61, v63
buffer_store_dwordx4 v[212:215], v18, s[36:39], s95 offen offset:3072 sc1
v_pk_mul_f32 v[92:93], v[92:93], v[20:21]
v_pk_mul_f32 v[94:95], v[94:95], v[20:21]
v_pk_mul_f32 v[108:109], v[108:109], v[20:21]
v_pk_mul_f32 v[110:111], v[110:111], v[20:21]
v_pk_mul_f32 v[124:125], v[124:125], v[20:21]
v_pk_mul_f32 v[126:127], v[126:127], v[20:21]
v_pk_mul_f32 v[140:141], v[140:141], v[20:21]
v_pk_mul_f32 v[142:143], v[142:143], v[20:21]
v_cvt_pk_bf16_f32 v92, v92, v93
v_cvt_pk_bf16_f32 v93, v94, v95
v_cvt_pk_bf16_f32 v94, v108, v109
v_cvt_pk_bf16_f32 v95, v110, v111
v_cvt_pk_bf16_f32 v124, v124, v125
v_cvt_pk_bf16_f32 v125, v126, v127
v_cvt_pk_bf16_f32 v126, v140, v141
v_cvt_pk_bf16_f32 v127, v142, v143
s_nop 0
v_permlane32_swap_b32 v92, v94
v_permlane32_swap_b32 v93, v95
v_permlane32_swap_b32 v124, v126
v_permlane32_swap_b32 v125, v127
v_permlane16_swap_b32 v92, v94
v_permlane16_swap_b32 v93, v95
v_permlane16_swap_b32 v124, v126
v_permlane16_swap_b32 v125, v127
v_pk_mul_f32 v[32:33], v[32:33], v[20:21]
v_pk_mul_f32 v[34:35], v[34:35], v[20:21]
v_pk_mul_f32 v[48:49], v[48:49], v[20:21]
v_pk_mul_f32 v[50:51], v[50:51], v[20:21]
v_pk_mul_f32 v[64:65], v[64:65], v[20:21]
v_pk_mul_f32 v[66:67], v[66:67], v[20:21]
v_pk_mul_f32 v[80:81], v[80:81], v[20:21]
v_pk_mul_f32 v[82:83], v[82:83], v[20:21]
v_cvt_pk_bf16_f32 v32, v32, v33
v_cvt_pk_bf16_f32 v33, v34, v35
v_cvt_pk_bf16_f32 v34, v48, v49
v_cvt_pk_bf16_f32 v35, v50, v51
v_cvt_pk_bf16_f32 v64, v64, v65
v_cvt_pk_bf16_f32 v65, v66, v67
v_cvt_pk_bf16_f32 v66, v80, v81
v_cvt_pk_bf16_f32 v67, v82, v83
s_nop 0
v_permlane32_swap_b32 v32, v34
v_permlane32_swap_b32 v33, v35
v_permlane32_swap_b32 v64, v66
v_permlane32_swap_b32 v65, v67
v_permlane16_swap_b32 v32, v34
v_permlane16_swap_b32 v33, v35
v_permlane16_swap_b32 v64, v66
v_permlane16_swap_b32 v65, v67
buffer_store_dwordx2 v[216:217], v18, s[36:39], s59 offen sc1
v_pk_mul_f32 v[96:97], v[96:97], v[20:21]
v_pk_mul_f32 v[98:99], v[98:99], v[20:21]
v_pk_mul_f32 v[112:113], v[112:113], v[20:21]
v_pk_mul_f32 v[114:115], v[114:115], v[20:21]
v_pk_mul_f32 v[128:129], v[128:129], v[20:21]
v_pk_mul_f32 v[130:131], v[130:131], v[20:21]
v_pk_mul_f32 v[144:145], v[144:145], v[20:21]
v_pk_mul_f32 v[146:147], v[146:147], v[20:21]
v_cvt_pk_bf16_f32 v96, v96, v97
v_cvt_pk_bf16_f32 v97, v98, v99
v_cvt_pk_bf16_f32 v98, v112, v113
v_cvt_pk_bf16_f32 v99, v114, v115
v_cvt_pk_bf16_f32 v128, v128, v129
v_cvt_pk_bf16_f32 v129, v130, v131
v_cvt_pk_bf16_f32 v130, v144, v145
v_cvt_pk_bf16_f32 v131, v146, v147
s_nop 0
v_permlane32_swap_b32 v96, v98
v_permlane32_swap_b32 v97, v99
v_permlane32_swap_b32 v128, v130
v_permlane32_swap_b32 v129, v131
v_permlane16_swap_b32 v96, v98
v_permlane16_swap_b32 v97, v99
v_permlane16_swap_b32 v128, v130
v_permlane16_swap_b32 v129, v131
v_pk_mul_f32 v[36:37], v[36:37], v[20:21]
v_pk_mul_f32 v[38:39], v[38:39], v[20:21]
v_pk_mul_f32 v[52:53], v[52:53], v[20:21]
v_pk_mul_f32 v[54:55], v[54:55], v[20:21]
v_pk_mul_f32 v[68:69], v[68:69], v[20:21]
v_pk_mul_f32 v[70:71], v[70:71], v[20:21]
v_pk_mul_f32 v[84:85], v[84:85], v[20:21]
v_pk_mul_f32 v[86:87], v[86:87], v[20:21]
v_cvt_pk_bf16_f32 v36, v36, v37
v_cvt_pk_bf16_f32 v37, v38, v39
v_cvt_pk_bf16_f32 v38, v52, v53
v_cvt_pk_bf16_f32 v39, v54, v55
v_cvt_pk_bf16_f32 v68, v68, v69
v_cvt_pk_bf16_f32 v69, v70, v71
v_cvt_pk_bf16_f32 v70, v84, v85
v_cvt_pk_bf16_f32 v71, v86, v87
s_nop 0
v_permlane32_swap_b32 v36, v38
v_permlane32_swap_b32 v37, v39
v_permlane32_swap_b32 v68, v70
v_permlane32_swap_b32 v69, v71
v_permlane16_swap_b32 v36, v38
v_permlane16_swap_b32 v37, v39
v_permlane16_swap_b32 v68, v70
v_permlane16_swap_b32 v69, v71
buffer_store_dwordx2 v[218:219], v18, s[36:39], s59 offen offset:1024 sc1
v_pk_mul_f32 v[100:101], v[100:101], v[20:21]
v_pk_mul_f32 v[102:103], v[102:103], v[20:21]
v_pk_mul_f32 v[116:117], v[116:117], v[20:21]
v_pk_mul_f32 v[118:119], v[118:119], v[20:21]
v_pk_mul_f32 v[132:133], v[132:133], v[20:21]
v_pk_mul_f32 v[134:135], v[134:135], v[20:21]
v_pk_mul_f32 v[148:149], v[148:149], v[20:21]
v_pk_mul_f32 v[150:151], v[150:151], v[20:21]
v_cvt_pk_bf16_f32 v100, v100, v101
v_cvt_pk_bf16_f32 v101, v102, v103
v_cvt_pk_bf16_f32 v102, v116, v117
v_cvt_pk_bf16_f32 v103, v118, v119
v_cvt_pk_bf16_f32 v132, v132, v133
v_cvt_pk_bf16_f32 v133, v134, v135
v_cvt_pk_bf16_f32 v134, v148, v149
v_cvt_pk_bf16_f32 v135, v150, v151
s_nop 0
v_permlane32_swap_b32 v100, v102
v_permlane32_swap_b32 v101, v103
v_permlane32_swap_b32 v132, v134
v_permlane32_swap_b32 v133, v135
v_permlane16_swap_b32 v100, v102
v_permlane16_swap_b32 v101, v103
v_permlane16_swap_b32 v132, v134
v_permlane16_swap_b32 v133, v135
v_add_u32 v2, 0x6000, v224
v_add_u32 v3, 0x6000, v225
v_add_u32 v4, 0x6000, v226
v_add_u32 v5, 0x6000, v227
v_add_u32 v6, 0x6000, v228
v_add_u32 v7, 0x6000, v229
v_add_u32 v8, 0x6000, v230
v_add_u32 v9, 0x6000, v231
v_mov_b32 v144, 0x3f803f80
v_mov_b32 v145, 0x3f803f80
v_mov_b32 v146, 0x3f803f80
v_mov_b32 v147, 0x3f803f80
s_mov_b32 s58, 0
s_mov_b32 s60, 1
v_mov_b32 v10, 0x27000
v_mov_b32 v11, 0
ds_write_b32 v10, v11
s_waitcnt lgkmcnt(0)
s_waitcnt vmcnt(16)
s_barrier
s_lshr_b32 s56, s2, 3
s_lshl_b32 s56, s56, 2
s_add_u32 s56, s56, s44
s_getpc_b64 s[96:97]
recurrent_scan__gqa_block_cached__glu_gated_reglu__prompt_kernel_pc11:
s_add_u32 s96, s96, recurrent_scan__gqa_block_cached__glu_gated_reglu__prompt_kernel_adone-recurrent_scan__gqa_block_cached__glu_gated_reglu__prompt_kernel_pc11
s_addc_u32 s97, s97, 0
s_mul_i32 s55, s56, (((recurrent_scan__gqa_block_cached__glu_gated_reglu__prompt_kernel_afall-recurrent_scan__gqa_block_cached__glu_gated_reglu__prompt_kernel_adone)+127)/128+127)/128
v_min_u32 v254, (((recurrent_scan__gqa_block_cached__glu_gated_reglu__prompt_kernel_afall-recurrent_scan__gqa_block_cached__glu_gated_reglu__prompt_kernel_adone)+127)/128+127)/128-1, v1
v_add_u32 v254, s55, v254
v_lshlrev_b32 v254, 7, v254
v_min_u32 v254, recurrent_scan__gqa_block_cached__glu_gated_reglu__prompt_kernel_afall-recurrent_scan__gqa_block_cached__glu_gated_reglu__prompt_kernel_adone-4, v254
v_mov_b32 v255, s97
v_add_co_u32 v254, vcc, s96, v254
s_nop 1
v_addc_co_u32 v255, vcc, 0, v255, vcc
global_load_dword v253, v[254:255], off
ds_read_b128 a[128:131], v14
ds_read_b128 a[132:135], v15
ds_read_b128 a[136:139], v16
ds_read_b128 a[140:143], v17
ds_read_b128 a[144:147], v14 offset:4096
ds_read_b128 a[148:151], v15 offset:4096
ds_read_b128 a[152:155], v16 offset:4096
ds_read_b128 a[156:159], v17 offset:4096
s_waitcnt lgkmcnt(0)
buffer_store_dwordx2 v[220:221], v18, s[36:39], s59 offen offset:2048 sc1
v_mfma_f32_16x16x32_bf16 v[40:43], a[128:131], v[24:27], 0
v_mfma_f32_16x16x32_bf16 v[40:43], a[132:135], v[56:59], v[40:43]
v_mfma_f32_16x16x32_bf16 v[40:43], a[136:139], v[88:91], v[40:43]
v_mfma_f32_16x16x32_bf16 v[40:43], a[140:143], v[120:123], v[40:43]
v_mfma_f32_16x16x32_bf16 v[44:47], a[144:147], v[24:27], 0
v_mfma_f32_16x16x32_bf16 v[44:47], a[148:151], v[56:59], v[44:47]
v_mfma_f32_16x16x32_bf16 v[44:47], a[152:155], v[88:91], v[44:47]
v_mfma_f32_16x16x32_bf16 v[44:47], a[156:159], v[120:123], v[44:47]
v_mfma_f32_16x16x32_bf16 v[48:51], a[128:131], v[28:31], 0
v_mfma_f32_16x16x32_bf16 v[48:51], a[132:135], v[60:63], v[48:51]
v_mfma_f32_16x16x32_bf16 v[48:51], a[136:139], v[92:95], v[48:51]
v_mfma_f32_16x16x32_bf16 v[48:51], a[140:143], v[124:127], v[48:51]
v_mfma_f32_16x16x32_bf16 v[52:55], a[144:147], v[28:31], 0
v_mfma_f32_16x16x32_bf16 v[52:55], a[148:151], v[60:63], v[52:55]
v_mfma_f32_16x16x32_bf16 v[52:55], a[152:155], v[92:95], v[52:55]
v_mfma_f32_16x16x32_bf16 v[52:55], a[156:159], v[124:127], v[52:55]
v_mfma_f32_16x16x32_bf16 v[104:107], a[128:131], v[32:35], 0
v_mfma_f32_16x16x32_bf16 v[104:107], a[132:135], v[64:67], v[104:107]
v_mfma_f32_16x16x32_bf16 v[104:107], a[136:139], v[96:99], v[104:107]
v_mfma_f32_16x16x32_bf16 v[104:107], a[140:143], v[128:131], v[104:107]
v_mfma_f32_16x16x32_bf16 v[108:111], a[144:147], v[32:35], 0
v_mfma_f32_16x16x32_bf16 v[108:111], a[148:151], v[64:67], v[108:111]
v_mfma_f32_16x16x32_bf16 v[108:111], a[152:155], v[96:99], v[108:111]
v_mfma_f32_16x16x32_bf16 v[108:111], a[156:159], v[128:131], v[108:111]
v_mfma_f32_16x16x32_bf16 v[112:115], a[128:131], v[36:39], 0
v_mfma_f32_16x16x32_bf16 v[112:115], a[132:135], v[68:71], v[112:115]
v_mfma_f32_16x16x32_bf16 v[112:115], a[136:139], v[100:103], v[112:115]
v_mfma_f32_16x16x32_bf16 v[112:115], a[140:143], v[132:135], v[112:115]
v_mfma_f32_16x16x32_bf16 v[116:119], a[144:147], v[36:39], 0
v_mfma_f32_16x16x32_bf16 v[116:119], a[148:151], v[68:71], v[116:119]
v_mfma_f32_16x16x32_bf16 v[116:119], a[152:155], v[100:103], v[116:119]
v_mfma_f32_16x16x32_bf16 v[116:119], a[156:159], v[132:135], v[116:119]
v_max3_f32 v40, v40, v41, v42
v_max3_f32 v43, v43, v44, v45
v_max3_f32 v40, v40, v46, v47
v_max_f32 v72, v40, v43
v_max3_f32 v48, v48, v49, v50
v_max3_f32 v51, v51, v52, v53
v_max3_f32 v48, v48, v54, v55
v_max_f32 v76, v48, v51
v_max3_f32 v104, v104, v105, v106
v_max3_f32 v107, v107, v108, v109
v_max3_f32 v104, v104, v110, v111
v_max_f32 v80, v104, v107
s_nop 0
v_max3_f32 v112, v112, v113, v114
v_max3_f32 v115, v115, v116, v117
v_max3_f32 v112, v112, v118, v119
v_max_f32 v84, v112, v115
buffer_store_dwordx2 v[222:223], v18, s[36:39], s59 offen offset:3072 sc1
v_mov_b32 v73, v72
v_mov_b32 v77, v76
v_mov_b32 v81, v80
v_mov_b32 v85, v84
v_permlane32_swap_b32 v72, v73
v_permlane32_swap_b32 v76, v77
v_permlane32_swap_b32 v80, v81
v_permlane32_swap_b32 v84, v85
v_max_f32 v72, v72, v73
v_max_f32 v76, v76, v77
v_max_f32 v80, v80, v81
v_max_f32 v84, v84, v85
v_mov_b32 v73, v72
v_mov_b32 v77, v76
v_mov_b32 v81, v80
v_mov_b32 v85, v84
v_permlane16_swap_b32 v72, v73
v_permlane16_swap_b32 v76, v77
v_permlane16_swap_b32 v80, v81
v_permlane16_swap_b32 v84, v85
v_max_f32 v72, v72, v73
v_max_f32 v76, v76, v77
v_max_f32 v80, v80, v81
v_max_f32 v84, v84, v85
v_sub_f32 v72, 0, v72
v_sub_f32 v76, 0, v76
v_sub_f32 v80, 0, v80
v_sub_f32 v84, 0, v84
v_mov_b32 v73, v72
v_mov_b32 v74, v72
v_mov_b32 v75, v72
v_mov_b32 v77, v76
v_mov_b32 v78, v76
v_mov_b32 v79, v76
v_mov_b32 v81, v80
v_mov_b32 v82, v80
v_mov_b32 v83, v80
v_mov_b32 v85, v84
v_mov_b32 v86, v84
v_mov_b32 v87, v84
recurrent_scan__gqa_block_cached__glu_gated_reglu__prompt_kernel_amain:
ds_read_b128 a[160:163], v14 offset:8192
ds_read_b128 a[164:167], v15 offset:8192
ds_read_b64_tr_b16 a[192:193], v2
ds_read_b64_tr_b16 a[194:195], v2 offset:4096
ds_read_b64_tr_b16 a[196:197], v3
ds_read_b64_tr_b16 a[198:199], v3 offset:4096
ds_read_b64_tr_b16 a[200:201], v4
ds_read_b64_tr_b16 a[202:203], v4 offset:4096
ds_read_b64_tr_b16 a[204:205], v5
ds_read_b64_tr_b16 a[206:207], v5 offset:4096
s_add_u32 m0, s52, 0x8000
s_nop 0
buffer_load_dwordx4 v240, s[24:27], s50 offen lds
v_mfma_f32_16x16x32_bf16 v[40:43], a[128:131], v[24:27], v[72:75]
v_mfma_f32_16x16x32_bf16 v[40:43], a[132:135], v[56:59], v[40:43]
v_mfma_f32_16x16x32_bf16 v[40:43], a[136:139], v[88:91], v[40:43]
v_mfma_f32_16x16x32_bf16 v[40:43], a[140:143], v[120:123], v[40:43]
v_mfma_f32_16x16x32_bf16 v[44:47], a[144:147], v[24:27], v[72:75]
v_mfma_f32_16x16x32_bf16 v[44:47], a[148:151], v[56:59], v[44:47]
v_mfma_f32_16x16x32_bf16 v[44:47], a[152:155], v[88:91], v[44:47]
v_mfma_f32_16x16x32_bf16 v[44:47], a[156:159], v[120:123], v[44:47]
s_add_u32 m0, s52, 0x18000
s_nop 0
buffer_load_dwordx4 v241, s[28:31], s50 offen lds
s_add_u32 s50, s50, 0x1000
s_nop 3
ds_read_b128 a[168:171], v16 offset:8192
ds_read_b128 a[172:175], v17 offset:8192
ds_read_b64_tr_b16 a[208:209], v6
ds_read_b64_tr_b16 a[210:211], v6 offset:4096
ds_read_b64_tr_b16 a[212:213], v7
ds_read_b64_tr_b16 a[214:215], v7 offset:4096
ds_read_b64_tr_b16 a[216:217], v8
ds_read_b64_tr_b16 a[218:219], v8 offset:4096
ds_read_b64_tr_b16 a[220:221], v9
ds_read_b64_tr_b16 a[222:223], v9 offset:4096
s_add_u32 m0, s52, 0x9000
s_nop 0
buffer_load_dwordx4 v240, s[24:27], s50 offen lds
v_exp_f32 v40, v40
v_exp_f32 v41, v41
v_exp_f32 v42, v42
v_exp_f32 v43, v43
v_exp_f32 v44, v44
v_exp_f32 v45, v45
v_exp_f32 v46, v46
v_exp_f32 v47, v47
s_nop 0
v_cvt_pk_bf16_f32 v136, v40, v41
v_cvt_pk_bf16_f32 v137, v42, v43
v_cvt_pk_bf16_f32 v138, v44, v45
v_cvt_pk_bf16_f32 v139, v46, v47
s_nop 1
v_mfma_f32_16x16x32_bf16 v[48:51], a[128:131], v[28:31], v[76:79]
v_mfma_f32_16x16x32_bf16 v[48:51], a[132:135], v[60:63], v[48:51]
v_mfma_f32_16x16x32_bf16 v[48:51], a[136:139], v[92:95], v[48:51]
v_mfma_f32_16x16x32_bf16 v[48:51], a[140:143], v[124:127], v[48:51]
v_mfma_f32_16x16x32_bf16 v[52:55], a[144:147], v[28:31], v[76:79]
v_mfma_f32_16x16x32_bf16 v[52:55], a[148:151], v[60:63], v[52:55]
v_mfma_f32_16x16x32_bf16 v[52:55], a[152:155], v[92:95], v[52:55]
v_mfma_f32_16x16x32_bf16 v[52:55], a[156:159], v[124:127], v[52:55]
s_waitcnt lgkmcnt(0)
s_add_u32 m0, s52, 0x19000
s_nop 0
buffer_load_dwordx4 v241, s[28:31], s50 offen lds
s_add_u32 s50, s50, 0x1000
s_add_u32 m0, s52, 0xa000
s_nop 0
buffer_load_dwordx4 v240, s[24:27], s50 offen lds
v_mfma_f32_16x16x32_bf16 v[40:43], a[128:131], v[32:35], v[80:83]
v_exp_f32 v48, v48
v_mfma_f32_16x16x32_bf16 v[40:43], a[132:135], v[64:67], v[40:43]
ds_read_b128 a[176:179], v14 offset:12288
ds_read_b128 a[180:183], v15 offset:12288
v_mfma_f32_16x16x32_bf16 v[40:43], a[136:139], v[96:99], v[40:43]
v_exp_f32 v49, v49
v_mfma_f32_16x16x32_bf16 v[40:43], a[140:143], v[128:131], v[40:43]
ds_read_b64_tr_b16 a[224:225], v2 offset:8192
ds_read_b64_tr_b16 a[226:227], v2 offset:12288
v_mfma_f32_16x16x32_bf16 v[44:47], a[144:147], v[32:35], v[80:83]
v_exp_f32 v50, v50
v_mfma_f32_16x16x32_bf16 v[44:47], a[148:151], v[64:67], v[44:47]
ds_read_b64_tr_b16 a[228:229], v3 offset:8192
ds_read_b64_tr_b16 a[230:231], v3 offset:12288
v_mfma_f32_16x16x32_bf16 v[44:47], a[152:155], v[96:99], v[44:47]
v_exp_f32 v51, v51
v_mfma_f32_16x16x32_bf16 v[44:47], a[156:159], v[128:131], v[44:47]
v_cvt_pk_bf16_f32 v140, v48, v49
v_cvt_pk_bf16_f32 v141, v50, v51
v_mfma_f32_16x16x32_bf16 a[0:3], a[192:195], v[136:139], 0
v_exp_f32 v52, v52
v_mfma_f32_16x16x32_bf16 a[4:7], a[196:199], v[136:139], 0
v_exp_f32 v53, v53
v_mfma_f32_16x16x32_bf16 a[8:11], a[200:203], v[136:139], 0
v_exp_f32 v54, v54
v_mfma_f32_16x16x32_bf16 a[12:15], a[204:207], v[136:139], 0
v_exp_f32 v55, v55
v_mfma_f32_16x16x32_bf16 a[16:19], a[208:211], v[136:139], 0
v_cvt_pk_bf16_f32 v142, v52, v53
v_cvt_pk_bf16_f32 v143, v54, v55
v_mfma_f32_16x16x32_bf16 a[20:23], a[212:215], v[136:139], 0
s_add_u32 m0, s52, 0x1a000
v_mfma_f32_16x16x32_bf16 a[24:27], a[216:219], v[136:139], 0
buffer_load_dwordx4 v241, s[28:31], s50 offen lds
s_add_u32 s50, s50, 0x1000
v_mfma_f32_16x16x32_bf16 a[28:31], a[220:223], v[136:139], 0
v_mfma_f32_16x16x32_bf16 v[104:107], v[144:147], v[136:139], 0
s_add_u32 m0, s52, 0xb000
s_nop 0
buffer_load_dwordx4 v240, s[24:27], s50 offen lds
v_mfma_f32_16x16x32_bf16 v[48:51], a[128:131], v[36:39], v[84:87]
v_exp_f32 v40, v40
v_mfma_f32_16x16x32_bf16 v[48:51], a[132:135], v[68:71], v[48:51]
ds_read_b128 a[184:187], v16 offset:12288
ds_read_b128 a[188:191], v17 offset:12288
v_mfma_f32_16x16x32_bf16 v[48:51], a[136:139], v[100:103], v[48:51]
v_exp_f32 v41, v41
v_mfma_f32_16x16x32_bf16 v[48:51], a[140:143], v[132:135], v[48:51]
ds_read_b64_tr_b16 a[232:233], v4 offset:8192
ds_read_b64_tr_b16 a[234:235], v4 offset:12288
v_mfma_f32_16x16x32_bf16 v[52:55], a[144:147], v[36:39], v[84:87]
v_exp_f32 v42, v42
v_mfma_f32_16x16x32_bf16 v[52:55], a[148:151], v[68:71], v[52:55]
ds_read_b64_tr_b16 a[236:237], v5 offset:8192
ds_read_b64_tr_b16 a[238:239], v5 offset:12288
v_mfma_f32_16x16x32_bf16 v[52:55], a[152:155], v[100:103], v[52:55]
v_exp_f32 v43, v43
v_mfma_f32_16x16x32_bf16 v[52:55], a[156:159], v[132:135], v[52:55]
v_cvt_pk_bf16_f32 v136, v40, v41
v_cvt_pk_bf16_f32 v137, v42, v43
v_mfma_f32_16x16x32_bf16 a[32:35], a[192:195], v[140:143], 0
v_exp_f32 v44, v44
v_mfma_f32_16x16x32_bf16 a[36:39], a[196:199], v[140:143], 0
v_exp_f32 v45, v45
v_mfma_f32_16x16x32_bf16 a[40:43], a[200:203], v[140:143], 0
v_exp_f32 v46, v46
v_mfma_f32_16x16x32_bf16 a[44:47], a[204:207], v[140:143], 0
v_exp_f32 v47, v47
v_mfma_f32_16x16x32_bf16 a[48:51], a[208:211], v[140:143], 0
v_cvt_pk_bf16_f32 v138, v44, v45
v_cvt_pk_bf16_f32 v139, v46, v47
v_mfma_f32_16x16x32_bf16 a[52:55], a[212:215], v[140:143], 0
s_add_u32 m0, s52, 0x1b000
v_mfma_f32_16x16x32_bf16 a[56:59], a[216:219], v[140:143], 0
buffer_load_dwordx4 v241, s[28:31], s50 offen lds
s_add_u32 s50, s50, 0x1000
v_mfma_f32_16x16x32_bf16 a[60:63], a[220:223], v[140:143], 0
v_mfma_f32_16x16x32_bf16 v[108:111], v[144:147], v[140:143], 0
s_waitcnt lgkmcnt(0)
s_waitcnt vmcnt(8)
s_barrier
v_mfma_f32_16x16x32_bf16 v[40:43], a[160:163], v[24:27], v[72:75]
v_exp_f32 v48, v48
v_mfma_f32_16x16x32_bf16 v[40:43], a[164:167], v[56:59], v[40:43]
ds_read_b128 a[128:131], v14 offset:16384
ds_read_b128 a[132:135], v15 offset:16384
v_mfma_f32_16x16x32_bf16 v[40:43], a[168:171], v[88:91], v[40:43]
v_exp_f32 v49, v49
v_mfma_f32_16x16x32_bf16 v[40:43], a[172:175], v[120:123], v[40:43]
ds_read_b64_tr_b16 a[240:241], v6 offset:8192
ds_read_b64_tr_b16 a[242:243], v6 offset:12288
v_mfma_f32_16x16x32_bf16 v[44:47], a[176:179], v[24:27], v[72:75]
v_exp_f32 v50, v50
v_mfma_f32_16x16x32_bf16 v[44:47], a[180:183], v[56:59], v[44:47]
ds_read_b64_tr_b16 a[244:245], v7 offset:8192
ds_read_b64_tr_b16 a[246:247], v7 offset:12288
v_mfma_f32_16x16x32_bf16 v[44:47], a[184:187], v[88:91], v[44:47]
v_exp_f32 v51, v51
v_mfma_f32_16x16x32_bf16 v[44:47], a[188:191], v[120:123], v[44:47]
v_cvt_pk_bf16_f32 v140, v48, v49
v_cvt_pk_bf16_f32 v141, v50, v51
v_mfma_f32_16x16x32_bf16 a[64:67], a[192:195], v[136:139], 0
v_exp_f32 v52, v52
v_mfma_f32_16x16x32_bf16 a[68:71], a[196:199], v[136:139], 0
v_exp_f32 v53, v53
v_mfma_f32_16x16x32_bf16 a[72:75], a[200:203], v[136:139], 0
v_exp_f32 v54, v54
v_mfma_f32_16x16x32_bf16 a[76:79], a[204:207], v[136:139], 0
v_exp_f32 v55, v55
v_mfma_f32_16x16x32_bf16 a[80:83], a[208:211], v[136:139], 0
v_cvt_pk_bf16_f32 v142, v52, v53
v_cvt_pk_bf16_f32 v143, v54, v55
v_mfma_f32_16x16x32_bf16 a[84:87], a[212:215], v[136:139], 0
s_add_u32 m0, s52, 0xc000
v_mfma_f32_16x16x32_bf16 a[88:91], a[216:219], v[136:139], 0
buffer_load_dwordx4 v240, s[24:27], s50 offen lds
v_mfma_f32_16x16x32_bf16 a[92:95], a[220:223], v[136:139], 0
v_mfma_f32_16x16x32_bf16 v[112:115], v[144:147], v[136:139], 0
v_mfma_f32_16x16x32_bf16 v[48:51], a[160:163], v[28:31], v[76:79]
v_exp_f32 v40, v40
v_mfma_f32_16x16x32_bf16 v[48:51], a[164:167], v[60:63], v[48:51]
ds_read_b128 a[136:139], v16 offset:16384
ds_read_b128 a[140:143], v17 offset:16384
v_mfma_f32_16x16x32_bf16 v[48:51], a[168:171], v[92:95], v[48:51]
v_exp_f32 v41, v41
v_mfma_f32_16x16x32_bf16 v[48:51], a[172:175], v[124:127], v[48:51]
ds_read_b64_tr_b16 a[248:249], v8 offset:8192
ds_read_b64_tr_b16 a[250:251], v8 offset:12288
v_mfma_f32_16x16x32_bf16 v[52:55], a[176:179], v[28:31], v[76:79]
v_exp_f32 v42, v42
v_mfma_f32_16x16x32_bf16 v[52:55], a[180:183], v[60:63], v[52:55]
ds_read_b64_tr_b16 a[252:253], v9 offset:8192
ds_read_b64_tr_b16 a[254:255], v9 offset:12288
v_mfma_f32_16x16x32_bf16 v[52:55], a[184:187], v[92:95], v[52:55]
v_exp_f32 v43, v43
v_mfma_f32_16x16x32_bf16 v[52:55], a[188:191], v[124:127], v[52:55]
v_cvt_pk_bf16_f32 v136, v40, v41
v_cvt_pk_bf16_f32 v137, v42, v43
v_mfma_f32_16x16x32_bf16 a[96:99], a[192:195], v[140:143], 0
v_exp_f32 v44, v44
v_mfma_f32_16x16x32_bf16 a[100:103], a[196:199], v[140:143], 0
v_exp_f32 v45, v45
v_mfma_f32_16x16x32_bf16 a[104:107], a[200:203], v[140:143], 0
v_exp_f32 v46, v46
v_mfma_f32_16x16x32_bf16 a[108:111], a[204:207], v[140:143], 0
v_exp_f32 v47, v47
v_mfma_f32_16x16x32_bf16 a[112:115], a[208:211], v[140:143], 0
v_cvt_pk_bf16_f32 v138, v44, v45
v_cvt_pk_bf16_f32 v139, v46, v47
v_mfma_f32_16x16x32_bf16 a[116:119], a[212:215], v[140:143], 0
s_add_u32 m0, s52, 0x1c000
v_mfma_f32_16x16x32_bf16 a[120:123], a[216:219], v[140:143], 0
buffer_load_dwordx4 v241, s[28:31], s50 offen lds
s_add_u32 s50, s50, 0x1000
v_mfma_f32_16x16x32_bf16 a[124:127], a[220:223], v[140:143], 0
v_mfma_f32_16x16x32_bf16 v[116:119], v[144:147], v[140:143], 0
s_waitcnt lgkmcnt(0)
s_mov_b32 s57, 0
recurrent_scan__gqa_block_cached__glu_gated_reglu__prompt_kernel_aloop:
v_mfma_f32_16x16x32_bf16 v[40:43], a[160:163], v[32:35], v[80:83]
v_exp_f32 v48, v48
v_mfma_f32_16x16x32_bf16 v[40:43], a[164:167], v[64:67], v[40:43]
ds_read_b128 a[144:147], v14 offset:20480
ds_read_b128 a[148:151], v15 offset:20480
v_mfma_f32_16x16x32_bf16 v[40:43], a[168:171], v[96:99], v[40:43]
v_exp_f32 v49, v49
v_mfma_f32_16x16x32_bf16 v[40:43], a[172:175], v[128:131], v[40:43]
ds_read_b64_tr_b16 a[192:193], v2 offset:16384
ds_read_b64_tr_b16 a[194:195], v2 offset:20480
v_mfma_f32_16x16x32_bf16 v[44:47], a[176:179], v[32:35], v[80:83]
v_exp_f32 v50, v50
v_mfma_f32_16x16x32_bf16 v[44:47], a[180:183], v[64:67], v[44:47]
ds_read_b64_tr_b16 a[196:197], v3 offset:16384
ds_read_b64_tr_b16 a[198:199], v3 offset:20480
v_mfma_f32_16x16x32_bf16 v[44:47], a[184:187], v[96:99], v[44:47]
v_exp_f32 v51, v51
v_mfma_f32_16x16x32_bf16 v[44:47], a[188:191], v[128:131], v[44:47]
v_cvt_pk_bf16_f32 v140, v48, v49
v_cvt_pk_bf16_f32 v141, v50, v51
v_mfma_f32_16x16x32_bf16 a[0:3], a[224:227], v[136:139], a[0:3]
v_exp_f32 v52, v52
v_mfma_f32_16x16x32_bf16 a[4:7], a[228:231], v[136:139], a[4:7]
v_exp_f32 v53, v53
v_mfma_f32_16x16x32_bf16 a[8:11], a[232:235], v[136:139], a[8:11]
v_exp_f32 v54, v54
v_mfma_f32_16x16x32_bf16 a[12:15], a[236:239], v[136:139], a[12:15]
v_exp_f32 v55, v55
v_mfma_f32_16x16x32_bf16 a[16:19], a[240:243], v[136:139], a[16:19]
v_cvt_pk_bf16_f32 v142, v52, v53
v_cvt_pk_bf16_f32 v143, v54, v55
v_mfma_f32_16x16x32_bf16 a[20:23], a[244:247], v[136:139], a[20:23]
s_add_u32 m0, s52, 0xd000
v_mfma_f32_16x16x32_bf16 a[24:27], a[248:251], v[136:139], a[24:27]
buffer_load_dwordx4 v240, s[24:27], s50 offen lds
v_mfma_f32_16x16x32_bf16 a[28:31], a[252:255], v[136:139], a[28:31]
v_mfma_f32_16x16x32_bf16 v[104:107], v[144:147], v[136:139], v[104:107]
v_mfma_f32_16x16x32_bf16 v[48:51], a[160:163], v[36:39], v[84:87]
v_exp_f32 v40, v40
v_mfma_f32_16x16x32_bf16 v[48:51], a[164:167], v[68:71], v[48:51]
ds_read_b128 a[152:155], v16 offset:20480
ds_read_b128 a[156:159], v17 offset:20480
v_mfma_f32_16x16x32_bf16 v[48:51], a[168:171], v[100:103], v[48:51]
v_exp_f32 v41, v41
v_mfma_f32_16x16x32_bf16 v[48:51], a[172:175], v[132:135], v[48:51]
ds_read_b64_tr_b16 a[200:201], v4 offset:16384
ds_read_b64_tr_b16 a[202:203], v4 offset:20480
v_mfma_f32_16x16x32_bf16 v[52:55], a[176:179], v[36:39], v[84:87]
v_exp_f32 v42, v42
v_mfma_f32_16x16x32_bf16 v[52:55], a[180:183], v[68:71], v[52:55]
ds_read_b64_tr_b16 a[204:205], v5 offset:16384
ds_read_b64_tr_b16 a[206:207], v5 offset:20480
v_mfma_f32_16x16x32_bf16 v[52:55], a[184:187], v[100:103], v[52:55]
v_exp_f32 v43, v43
v_mfma_f32_16x16x32_bf16 v[52:55], a[188:191], v[132:135], v[52:55]
v_cvt_pk_bf16_f32 v136, v40, v41
v_cvt_pk_bf16_f32 v137, v42, v43
v_mfma_f32_16x16x32_bf16 a[32:35], a[224:227], v[140:143], a[32:35]
v_exp_f32 v44, v44
v_mfma_f32_16x16x32_bf16 a[36:39], a[228:231], v[140:143], a[36:39]
v_exp_f32 v45, v45
v_mfma_f32_16x16x32_bf16 a[40:43], a[232:235], v[140:143], a[40:43]
v_exp_f32 v46, v46
v_mfma_f32_16x16x32_bf16 a[44:47], a[236:239], v[140:143], a[44:47]
v_exp_f32 v47, v47
v_mfma_f32_16x16x32_bf16 a[48:51], a[240:243], v[140:143], a[48:51]
v_cvt_pk_bf16_f32 v138, v44, v45
v_cvt_pk_bf16_f32 v139, v46, v47
v_mfma_f32_16x16x32_bf16 a[52:55], a[244:247], v[140:143], a[52:55]
s_add_u32 m0, s52, 0x1d000
v_mfma_f32_16x16x32_bf16 a[56:59], a[248:251], v[140:143], a[56:59]
buffer_load_dwordx4 v241, s[28:31], s50 offen lds
s_add_u32 s50, s50, 0x1000
v_mfma_f32_16x16x32_bf16 a[60:63], a[252:255], v[140:143], a[60:63]
v_mfma_f32_16x16x32_bf16 v[108:111], v[144:147], v[140:143], v[108:111]
s_waitcnt lgkmcnt(0)
v_mfma_f32_16x16x32_bf16 v[40:43], a[128:131], v[24:27], v[72:75]
v_exp_f32 v48, v48
v_mfma_f32_16x16x32_bf16 v[40:43], a[132:135], v[56:59], v[40:43]
ds_read_b128 a[160:163], v14 offset:24576
ds_read_b128 a[164:167], v15 offset:24576
v_mfma_f32_16x16x32_bf16 v[40:43], a[136:139], v[88:91], v[40:43]
v_exp_f32 v49, v49
v_mfma_f32_16x16x32_bf16 v[40:43], a[140:143], v[120:123], v[40:43]
ds_read_b64_tr_b16 a[208:209], v6 offset:16384
ds_read_b64_tr_b16 a[210:211], v6 offset:20480
v_mfma_f32_16x16x32_bf16 v[44:47], a[144:147], v[24:27], v[72:75]
v_exp_f32 v50, v50
v_mfma_f32_16x16x32_bf16 v[44:47], a[148:151], v[56:59], v[44:47]
ds_read_b64_tr_b16 a[212:213], v7 offset:16384
ds_read_b64_tr_b16 a[214:215], v7 offset:20480
v_mfma_f32_16x16x32_bf16 v[44:47], a[152:155], v[88:91], v[44:47]
v_exp_f32 v51, v51
v_mfma_f32_16x16x32_bf16 v[44:47], a[156:159], v[120:123], v[44:47]
v_cvt_pk_bf16_f32 v140, v48, v49
v_cvt_pk_bf16_f32 v141, v50, v51
v_mfma_f32_16x16x32_bf16 a[64:67], a[224:227], v[136:139], a[64:67]
v_exp_f32 v52, v52
v_mfma_f32_16x16x32_bf16 a[68:71], a[228:231], v[136:139], a[68:71]
v_exp_f32 v53, v53
v_mfma_f32_16x16x32_bf16 a[72:75], a[232:235], v[136:139], a[72:75]
v_exp_f32 v54, v54
v_mfma_f32_16x16x32_bf16 a[76:79], a[236:239], v[136:139], a[76:79]
v_exp_f32 v55, v55
v_mfma_f32_16x16x32_bf16 a[80:83], a[240:243], v[136:139], a[80:83]
v_cvt_pk_bf16_f32 v142, v52, v53
v_cvt_pk_bf16_f32 v143, v54, v55
v_mfma_f32_16x16x32_bf16 a[84:87], a[244:247], v[136:139], a[84:87]
s_add_u32 m0, s52, 0xe000
v_mfma_f32_16x16x32_bf16 a[88:91], a[248:251], v[136:139], a[88:91]
buffer_load_dwordx4 v240, s[24:27], s50 offen lds
v_mfma_f32_16x16x32_bf16 a[92:95], a[252:255], v[136:139], a[92:95]
v_mfma_f32_16x16x32_bf16 v[112:115], v[144:147], v[136:139], v[112:115]
v_mfma_f32_16x16x32_bf16 v[48:51], a[128:131], v[28:31], v[76:79]
v_exp_f32 v40, v40
v_mfma_f32_16x16x32_bf16 v[48:51], a[132:135], v[60:63], v[48:51]
ds_read_b128 a[168:171], v16 offset:24576
ds_read_b128 a[172:175], v17 offset:24576
v_mfma_f32_16x16x32_bf16 v[48:51], a[136:139], v[92:95], v[48:51]
v_exp_f32 v41, v41
v_mfma_f32_16x16x32_bf16 v[48:51], a[140:143], v[124:127], v[48:51]
ds_read_b64_tr_b16 a[216:217], v8 offset:16384
ds_read_b64_tr_b16 a[218:219], v8 offset:20480
v_mfma_f32_16x16x32_bf16 v[52:55], a[144:147], v[28:31], v[76:79]
v_exp_f32 v42, v42
v_mfma_f32_16x16x32_bf16 v[52:55], a[148:151], v[60:63], v[52:55]
ds_read_b64_tr_b16 a[220:221], v9 offset:16384
ds_read_b64_tr_b16 a[222:223], v9 offset:20480
v_mfma_f32_16x16x32_bf16 v[52:55], a[152:155], v[92:95], v[52:55]
v_exp_f32 v43, v43
v_mfma_f32_16x16x32_bf16 v[52:55], a[156:159], v[124:127], v[52:55]
v_cvt_pk_bf16_f32 v136, v40, v41
v_cvt_pk_bf16_f32 v137, v42, v43
v_mfma_f32_16x16x32_bf16 a[96:99], a[224:227], v[140:143], a[96:99]
v_exp_f32 v44, v44
v_mfma_f32_16x16x32_bf16 a[100:103], a[228:231], v[140:143], a[100:103]
v_exp_f32 v45, v45
v_mfma_f32_16x16x32_bf16 a[104:107], a[232:235], v[140:143], a[104:107]
v_exp_f32 v46, v46
v_mfma_f32_16x16x32_bf16 a[108:111], a[236:239], v[140:143], a[108:111]
v_exp_f32 v47, v47
v_mfma_f32_16x16x32_bf16 a[112:115], a[240:243], v[140:143], a[112:115]
v_cvt_pk_bf16_f32 v138, v44, v45
v_cvt_pk_bf16_f32 v139, v46, v47
v_mfma_f32_16x16x32_bf16 a[116:119], a[244:247], v[140:143], a[116:119]
s_add_u32 m0, s52, 0x1e000
v_mfma_f32_16x16x32_bf16 a[120:123], a[248:251], v[140:143], a[120:123]
buffer_load_dwordx4 v241, s[28:31], s50 offen lds
s_add_u32 s50, s50, 0x1000
v_mfma_f32_16x16x32_bf16 a[124:127], a[252:255], v[140:143], a[124:127]
v_mfma_f32_16x16x32_bf16 v[116:119], v[144:147], v[140:143], v[116:119]
s_waitcnt lgkmcnt(0)
v_mfma_f32_16x16x32_bf16 v[40:43], a[128:131], v[32:35], v[80:83]
v_exp_f32 v48, v48
v_mfma_f32_16x16x32_bf16 v[40:43], a[132:135], v[64:67], v[40:43]
ds_read_b128 a[176:179], v14 offset:28672
ds_read_b128 a[180:183], v15 offset:28672
v_mfma_f32_16x16x32_bf16 v[40:43], a[136:139], v[96:99], v[40:43]
v_exp_f32 v49, v49
v_mfma_f32_16x16x32_bf16 v[40:43], a[140:143], v[128:131], v[40:43]
ds_read_b64_tr_b16 a[224:225], v2 offset:24576
ds_read_b64_tr_b16 a[226:227], v2 offset:28672
v_mfma_f32_16x16x32_bf16 v[44:47], a[144:147], v[32:35], v[80:83]
v_exp_f32 v50, v50
v_mfma_f32_16x16x32_bf16 v[44:47], a[148:151], v[64:67], v[44:47]
ds_read_b64_tr_b16 a[228:229], v3 offset:24576
ds_read_b64_tr_b16 a[230:231], v3 offset:28672
v_mfma_f32_16x16x32_bf16 v[44:47], a[152:155], v[96:99], v[44:47]
v_exp_f32 v51, v51
v_mfma_f32_16x16x32_bf16 v[44:47], a[156:159], v[128:131], v[44:47]
v_cvt_pk_bf16_f32 v140, v48, v49
v_cvt_pk_bf16_f32 v141, v50, v51
v_mfma_f32_16x16x32_bf16 a[0:3], a[192:195], v[136:139], a[0:3]
v_exp_f32 v52, v52
v_mfma_f32_16x16x32_bf16 a[4:7], a[196:199], v[136:139], a[4:7]
v_exp_f32 v53, v53
v_mfma_f32_16x16x32_bf16 a[8:11], a[200:203], v[136:139], a[8:11]
v_exp_f32 v54, v54
v_mfma_f32_16x16x32_bf16 a[12:15], a[204:207], v[136:139], a[12:15]
v_exp_f32 v55, v55
v_mfma_f32_16x16x32_bf16 a[16:19], a[208:211], v[136:139], a[16:19]
v_cvt_pk_bf16_f32 v142, v52, v53
v_cvt_pk_bf16_f32 v143, v54, v55
v_mfma_f32_16x16x32_bf16 a[20:23], a[212:215], v[136:139], a[20:23]
s_add_u32 m0, s52, 0xf000
v_mfma_f32_16x16x32_bf16 a[24:27], a[216:219], v[136:139], a[24:27]
buffer_load_dwordx4 v240, s[24:27], s50 offen lds
v_mfma_f32_16x16x32_bf16 a[28:31], a[220:223], v[136:139], a[28:31]
v_mfma_f32_16x16x32_bf16 v[104:107], v[144:147], v[136:139], v[104:107]
v_mfma_f32_16x16x32_bf16 v[48:51], a[128:131], v[36:39], v[84:87]
v_exp_f32 v40, v40
v_mfma_f32_16x16x32_bf16 v[48:51], a[132:135], v[68:71], v[48:51]
ds_read_b128 a[184:187], v16 offset:28672
ds_read_b128 a[188:191], v17 offset:28672
v_mfma_f32_16x16x32_bf16 v[48:51], a[136:139], v[100:103], v[48:51]
v_exp_f32 v41, v41
v_mfma_f32_16x16x32_bf16 v[48:51], a[140:143], v[132:135], v[48:51]
ds_read_b64_tr_b16 a[232:233], v4 offset:24576
ds_read_b64_tr_b16 a[234:235], v4 offset:28672
v_mfma_f32_16x16x32_bf16 v[52:55], a[144:147], v[36:39], v[84:87]
v_exp_f32 v42, v42
v_mfma_f32_16x16x32_bf16 v[52:55], a[148:151], v[68:71], v[52:55]
ds_read_b64_tr_b16 a[236:237], v5 offset:24576
ds_read_b64_tr_b16 a[238:239], v5 offset:28672
v_mfma_f32_16x16x32_bf16 v[52:55], a[152:155], v[100:103], v[52:55]
v_exp_f32 v43, v43
v_mfma_f32_16x16x32_bf16 v[52:55], a[156:159], v[132:135], v[52:55]
v_cvt_pk_bf16_f32 v136, v40, v41
v_cvt_pk_bf16_f32 v137, v42, v43
v_mfma_f32_16x16x32_bf16 a[32:35], a[192:195], v[140:143], a[32:35]
v_exp_f32 v44, v44
v_mfma_f32_16x16x32_bf16 a[36:39], a[196:199], v[140:143], a[36:39]
v_exp_f32 v45, v45
v_mfma_f32_16x16x32_bf16 a[40:43], a[200:203], v[140:143], a[40:43]
v_exp_f32 v46, v46
v_mfma_f32_16x16x32_bf16 a[44:47], a[204:207], v[140:143], a[44:47]
v_exp_f32 v47, v47
v_mfma_f32_16x16x32_bf16 a[48:51], a[208:211], v[140:143], a[48:51]
v_cvt_pk_bf16_f32 v138, v44, v45
v_cvt_pk_bf16_f32 v139, v46, v47
v_mfma_f32_16x16x32_bf16 a[52:55], a[212:215], v[140:143], a[52:55]
s_add_u32 m0, s52, 0x1f000
v_mfma_f32_16x16x32_bf16 a[56:59], a[216:219], v[140:143], a[56:59]
buffer_load_dwordx4 v241, s[28:31], s50 offen lds
s_add_u32 s50, s50, 0x1000
v_mfma_f32_16x16x32_bf16 a[60:63], a[220:223], v[140:143], a[60:63]
v_mfma_f32_16x16x32_bf16 v[108:111], v[144:147], v[140:143], v[108:111]
s_waitcnt lgkmcnt(0)
s_waitcnt vmcnt(8)
s_barrier
v_mfma_f32_16x16x32_bf16 v[40:43], a[160:163], v[24:27], v[72:75]
v_exp_f32 v48, v48
v_mfma_f32_16x16x32_bf16 v[40:43], a[164:167], v[56:59], v[40:43]
ds_read_b128 a[128:131], v14 offset:32768
ds_read_b128 a[132:135], v15 offset:32768
v_mfma_f32_16x16x32_bf16 v[40:43], a[168:171], v[88:91], v[40:43]
v_exp_f32 v49, v49
v_mfma_f32_16x16x32_bf16 v[40:43], a[172:175], v[120:123], v[40:43]
ds_read_b64_tr_b16 a[240:241], v6 offset:24576
ds_read_b64_tr_b16 a[242:243], v6 offset:28672
v_mfma_f32_16x16x32_bf16 v[44:47], a[176:179], v[24:27], v[72:75]
v_exp_f32 v50, v50
v_mfma_f32_16x16x32_bf16 v[44:47], a[180:183], v[56:59], v[44:47]
ds_read_b64_tr_b16 a[244:245], v7 offset:24576
ds_read_b64_tr_b16 a[246:247], v7 offset:28672
v_mfma_f32_16x16x32_bf16 v[44:47], a[184:187], v[88:91], v[44:47]
v_exp_f32 v51, v51
v_mfma_f32_16x16x32_bf16 v[44:47], a[188:191], v[120:123], v[44:47]
v_cvt_pk_bf16_f32 v140, v48, v49
v_cvt_pk_bf16_f32 v141, v50, v51
v_mfma_f32_16x16x32_bf16 a[64:67], a[192:195], v[136:139], a[64:67]
v_exp_f32 v52, v52
v_mfma_f32_16x16x32_bf16 a[68:71], a[196:199], v[136:139], a[68:71]
v_exp_f32 v53, v53
v_mfma_f32_16x16x32_bf16 a[72:75], a[200:203], v[136:139], a[72:75]
v_exp_f32 v54, v54
v_mfma_f32_16x16x32_bf16 a[76:79], a[204:207], v[136:139], a[76:79]
v_exp_f32 v55, v55
v_mfma_f32_16x16x32_bf16 a[80:83], a[208:211], v[136:139], a[80:83]
v_cvt_pk_bf16_f32 v142, v52, v53
v_cvt_pk_bf16_f32 v143, v54, v55
v_mfma_f32_16x16x32_bf16 a[84:87], a[212:215], v[136:139], a[84:87]
s_add_u32 m0, s52, 0
v_mfma_f32_16x16x32_bf16 a[88:91], a[216:219], v[136:139], a[88:91]
buffer_load_dwordx4 v240, s[24:27], s50 offen lds
v_mfma_f32_16x16x32_bf16 a[92:95], a[220:223], v[136:139], a[92:95]
v_mfma_f32_16x16x32_bf16 v[112:115], v[144:147], v[136:139], v[112:115]
v_mfma_f32_16x16x32_bf16 v[48:51], a[160:163], v[28:31], v[76:79]
v_exp_f32 v40, v40
v_mfma_f32_16x16x32_bf16 v[48:51], a[164:167], v[60:63], v[48:51]
ds_read_b128 a[136:139], v16 offset:32768
ds_read_b128 a[140:143], v17 offset:32768
v_mfma_f32_16x16x32_bf16 v[48:51], a[168:171], v[92:95], v[48:51]
v_exp_f32 v41, v41
v_mfma_f32_16x16x32_bf16 v[48:51], a[172:175], v[124:127], v[48:51]
ds_read_b64_tr_b16 a[248:249], v8 offset:24576
ds_read_b64_tr_b16 a[250:251], v8 offset:28672
v_mfma_f32_16x16x32_bf16 v[52:55], a[176:179], v[28:31], v[76:79]
v_exp_f32 v42, v42
v_mfma_f32_16x16x32_bf16 v[52:55], a[180:183], v[60:63], v[52:55]
ds_read_b64_tr_b16 a[252:253], v9 offset:24576
ds_read_b64_tr_b16 a[254:255], v9 offset:28672
v_mfma_f32_16x16x32_bf16 v[52:55], a[184:187], v[92:95], v[52:55]
v_exp_f32 v43, v43
v_mfma_f32_16x16x32_bf16 v[52:55], a[188:191], v[124:127], v[52:55]
v_cvt_pk_bf16_f32 v136, v40, v41
v_cvt_pk_bf16_f32 v137, v42, v43
v_mfma_f32_16x16x32_bf16 a[96:99], a[192:195], v[140:143], a[96:99]
v_exp_f32 v44, v44
v_mfma_f32_16x16x32_bf16 a[100:103], a[196:199], v[140:143], a[100:103]
v_exp_f32 v45, v45
v_mfma_f32_16x16x32_bf16 a[104:107], a[200:203], v[140:143], a[104:107]
v_exp_f32 v46, v46
v_mfma_f32_16x16x32_bf16 a[108:111], a[204:207], v[140:143], a[108:111]
v_exp_f32 v47, v47
v_mfma_f32_16x16x32_bf16 a[112:115], a[208:211], v[140:143], a[112:115]
v_cvt_pk_bf16_f32 v138, v44, v45
v_cvt_pk_bf16_f32 v139, v46, v47
v_mfma_f32_16x16x32_bf16 a[116:119], a[212:215], v[140:143], a[116:119]
s_add_u32 m0, s52, 0x10000
v_mfma_f32_16x16x32_bf16 a[120:123], a[216:219], v[140:143], a[120:123]
buffer_load_dwordx4 v241, s[28:31], s50 offen lds
s_add_u32 s50, s50, 0x1000
v_mfma_f32_16x16x32_bf16 a[124:127], a[220:223], v[140:143], a[124:127]
v_mfma_f32_16x16x32_bf16 v[116:119], v[144:147], v[140:143], v[116:119]
s_waitcnt lgkmcnt(0)
v_mfma_f32_16x16x32_bf16 v[40:43], a[160:163], v[32:35], v[80:83]
v_exp_f32 v48, v48
v_mfma_f32_16x16x32_bf16 v[40:43], a[164:167], v[64:67], v[40:43]
ds_read_b128 a[144:147], v14 offset:36864
ds_read_b128 a[148:151], v15 offset:36864
v_mfma_f32_16x16x32_bf16 v[40:43], a[168:171], v[96:99], v[40:43]
v_exp_f32 v49, v49
v_mfma_f32_16x16x32_bf16 v[40:43], a[172:175], v[128:131], v[40:43]
ds_read_b64_tr_b16 a[192:193], v2 offset:32768
ds_read_b64_tr_b16 a[194:195], v2 offset:36864
v_mfma_f32_16x16x32_bf16 v[44:47], a[176:179], v[32:35], v[80:83]
v_exp_f32 v50, v50
v_mfma_f32_16x16x32_bf16 v[44:47], a[180:183], v[64:67], v[44:47]
ds_read_b64_tr_b16 a[196:197], v3 offset:32768
ds_read_b64_tr_b16 a[198:199], v3 offset:36864
v_mfma_f32_16x16x32_bf16 v[44:47], a[184:187], v[96:99], v[44:47]
v_exp_f32 v51, v51
v_mfma_f32_16x16x32_bf16 v[44:47], a[188:191], v[128:131], v[44:47]
v_cvt_pk_bf16_f32 v140, v48, v49
v_cvt_pk_bf16_f32 v141, v50, v51
v_mfma_f32_16x16x32_bf16 a[0:3], a[224:227], v[136:139], a[0:3]
v_exp_f32 v52, v52
v_mfma_f32_16x16x32_bf16 a[4:7], a[228:231], v[136:139], a[4:7]
v_exp_f32 v53, v53
v_mfma_f32_16x16x32_bf16 a[8:11], a[232:235], v[136:139], a[8:11]
v_exp_f32 v54, v54
v_mfma_f32_16x16x32_bf16 a[12:15], a[236:239], v[136:139], a[12:15]
v_exp_f32 v55, v55
v_mfma_f32_16x16x32_bf16 a[16:19], a[240:243], v[136:139], a[16:19]
v_cvt_pk_bf16_f32 v142, v52, v53
v_cvt_pk_bf16_f32 v143, v54, v55
v_mfma_f32_16x16x32_bf16 a[20:23], a[244:247], v[136:139], a[20:23]
s_add_u32 m0, s52, 0x1000
v_mfma_f32_16x16x32_bf16 a[24:27], a[248:251], v[136:139], a[24:27]
buffer_load_dwordx4 v240, s[24:27], s50 offen lds
v_mfma_f32_16x16x32_bf16 a[28:31], a[252:255], v[136:139], a[28:31]
v_mfma_f32_16x16x32_bf16 v[104:107], v[144:147], v[136:139], v[104:107]
v_mfma_f32_16x16x32_bf16 v[48:51], a[160:163], v[36:39], v[84:87]
v_exp_f32 v40, v40
v_mfma_f32_16x16x32_bf16 v[48:51], a[164:167], v[68:71], v[48:51]
ds_read_b128 a[152:155], v16 offset:36864
ds_read_b128 a[156:159], v17 offset:36864
v_mfma_f32_16x16x32_bf16 v[48:51], a[168:171], v[100:103], v[48:51]
v_exp_f32 v41, v41
v_mfma_f32_16x16x32_bf16 v[48:51], a[172:175], v[132:135], v[48:51]
ds_read_b64_tr_b16 a[200:201], v4 offset:32768
ds_read_b64_tr_b16 a[202:203], v4 offset:36864
v_mfma_f32_16x16x32_bf16 v[52:55], a[176:179], v[36:39], v[84:87]
v_exp_f32 v42, v42
v_mfma_f32_16x16x32_bf16 v[52:55], a[180:183], v[68:71], v[52:55]
ds_read_b64_tr_b16 a[204:205], v5 offset:32768
ds_read_b64_tr_b16 a[206:207], v5 offset:36864
v_mfma_f32_16x16x32_bf16 v[52:55], a[184:187], v[100:103], v[52:55]
v_exp_f32 v43, v43
v_mfma_f32_16x16x32_bf16 v[52:55], a[188:191], v[132:135], v[52:55]
v_cvt_pk_bf16_f32 v136, v40, v41
v_cvt_pk_bf16_f32 v137, v42, v43
v_mfma_f32_16x16x32_bf16 a[32:35], a[224:227], v[140:143], a[32:35]
v_exp_f32 v44, v44
v_mfma_f32_16x16x32_bf16 a[36:39], a[228:231], v[140:143], a[36:39]
v_exp_f32 v45, v45
v_mfma_f32_16x16x32_bf16 a[40:43], a[232:235], v[140:143], a[40:43]
v_exp_f32 v46, v46
v_mfma_f32_16x16x32_bf16 a[44:47], a[236:239], v[140:143], a[44:47]
v_exp_f32 v47, v47
v_mfma_f32_16x16x32_bf16 a[48:51], a[240:243], v[140:143], a[48:51]
v_cvt_pk_bf16_f32 v138, v44, v45
v_cvt_pk_bf16_f32 v139, v46, v47
v_mfma_f32_16x16x32_bf16 a[52:55], a[244:247], v[140:143], a[52:55]
s_add_u32 m0, s52, 0x11000
v_mfma_f32_16x16x32_bf16 a[56:59], a[248:251], v[140:143], a[56:59]
buffer_load_dwordx4 v241, s[28:31], s50 offen lds
s_add_u32 s50, s50, 0x1000
v_mfma_f32_16x16x32_bf16 a[60:63], a[252:255], v[140:143], a[60:63]
v_mfma_f32_16x16x32_bf16 v[108:111], v[144:147], v[140:143], v[108:111]
s_waitcnt lgkmcnt(0)
v_mfma_f32_16x16x32_bf16 v[40:43], a[128:131], v[24:27], v[72:75]
v_exp_f32 v48, v48
v_mfma_f32_16x16x32_bf16 v[40:43], a[132:135], v[56:59], v[40:43]
ds_read_b128 a[160:163], v14 offset:40960
ds_read_b128 a[164:167], v15 offset:40960
v_mfma_f32_16x16x32_bf16 v[40:43], a[136:139], v[88:91], v[40:43]
v_exp_f32 v49, v49
v_mfma_f32_16x16x32_bf16 v[40:43], a[140:143], v[120:123], v[40:43]
ds_read_b64_tr_b16 a[208:209], v6 offset:32768
ds_read_b64_tr_b16 a[210:211], v6 offset:36864
v_mfma_f32_16x16x32_bf16 v[44:47], a[144:147], v[24:27], v[72:75]
v_exp_f32 v50, v50
v_mfma_f32_16x16x32_bf16 v[44:47], a[148:151], v[56:59], v[44:47]
ds_read_b64_tr_b16 a[212:213], v7 offset:32768
ds_read_b64_tr_b16 a[214:215], v7 offset:36864
v_mfma_f32_16x16x32_bf16 v[44:47], a[152:155], v[88:91], v[44:47]
v_exp_f32 v51, v51
v_mfma_f32_16x16x32_bf16 v[44:47], a[156:159], v[120:123], v[44:47]
v_cvt_pk_bf16_f32 v140, v48, v49
v_cvt_pk_bf16_f32 v141, v50, v51
v_mfma_f32_16x16x32_bf16 a[64:67], a[224:227], v[136:139], a[64:67]
v_exp_f32 v52, v52
v_mfma_f32_16x16x32_bf16 a[68:71], a[228:231], v[136:139], a[68:71]
v_exp_f32 v53, v53
v_mfma_f32_16x16x32_bf16 a[72:75], a[232:235], v[136:139], a[72:75]
v_exp_f32 v54, v54
v_mfma_f32_16x16x32_bf16 a[76:79], a[236:239], v[136:139], a[76:79]
v_exp_f32 v55, v55
v_mfma_f32_16x16x32_bf16 a[80:83], a[240:243], v[136:139], a[80:83]
v_cvt_pk_bf16_f32 v142, v52, v53
v_cvt_pk_bf16_f32 v143, v54, v55
v_mfma_f32_16x16x32_bf16 a[84:87], a[244:247], v[136:139], a[84:87]
s_add_u32 m0, s52, 0x2000
v_mfma_f32_16x16x32_bf16 a[88:91], a[248:251], v[136:139], a[88:91]
buffer_load_dwordx4 v240, s[24:27], s50 offen lds
v_mfma_f32_16x16x32_bf16 a[92:95], a[252:255], v[136:139], a[92:95]
v_mfma_f32_16x16x32_bf16 v[112:115], v[144:147], v[136:139], v[112:115]
v_mfma_f32_16x16x32_bf16 v[48:51], a[128:131], v[28:31], v[76:79]
v_exp_f32 v40, v40
v_mfma_f32_16x16x32_bf16 v[48:51], a[132:135], v[60:63], v[48:51]
ds_read_b128 a[168:171], v16 offset:40960
ds_read_b128 a[172:175], v17 offset:40960
v_mfma_f32_16x16x32_bf16 v[48:51], a[136:139], v[92:95], v[48:51]
v_exp_f32 v41, v41
v_mfma_f32_16x16x32_bf16 v[48:51], a[140:143], v[124:127], v[48:51]
ds_read_b64_tr_b16 a[216:217], v8 offset:32768
ds_read_b64_tr_b16 a[218:219], v8 offset:36864
v_mfma_f32_16x16x32_bf16 v[52:55], a[144:147], v[28:31], v[76:79]
v_exp_f32 v42, v42
v_mfma_f32_16x16x32_bf16 v[52:55], a[148:151], v[60:63], v[52:55]
ds_read_b64_tr_b16 a[220:221], v9 offset:32768
ds_read_b64_tr_b16 a[222:223], v9 offset:36864
v_mfma_f32_16x16x32_bf16 v[52:55], a[152:155], v[92:95], v[52:55]
v_exp_f32 v43, v43
v_mfma_f32_16x16x32_bf16 v[52:55], a[156:159], v[124:127], v[52:55]
v_cvt_pk_bf16_f32 v136, v40, v41
v_cvt_pk_bf16_f32 v137, v42, v43
v_mfma_f32_16x16x32_bf16 a[96:99], a[224:227], v[140:143], a[96:99]
v_exp_f32 v44, v44
v_mfma_f32_16x16x32_bf16 a[100:103], a[228:231], v[140:143], a[100:103]
v_exp_f32 v45, v45
v_mfma_f32_16x16x32_bf16 a[104:107], a[232:235], v[140:143], a[104:107]
v_exp_f32 v46, v46
v_mfma_f32_16x16x32_bf16 a[108:111], a[236:239], v[140:143], a[108:111]
v_exp_f32 v47, v47
v_mfma_f32_16x16x32_bf16 a[112:115], a[240:243], v[140:143], a[112:115]
v_cvt_pk_bf16_f32 v138, v44, v45
v_cvt_pk_bf16_f32 v139, v46, v47
v_mfma_f32_16x16x32_bf16 a[116:119], a[244:247], v[140:143], a[116:119]
s_add_u32 m0, s52, 0x12000
v_mfma_f32_16x16x32_bf16 a[120:123], a[248:251], v[140:143], a[120:123]
buffer_load_dwordx4 v241, s[28:31], s50 offen lds
s_add_u32 s50, s50, 0x1000
v_mfma_f32_16x16x32_bf16 a[124:127], a[252:255], v[140:143], a[124:127]
v_mfma_f32_16x16x32_bf16 v[116:119], v[144:147], v[140:143], v[116:119]
s_waitcnt lgkmcnt(0)
v_mfma_f32_16x16x32_bf16 v[40:43], a[128:131], v[32:35], v[80:83]
v_exp_f32 v48, v48
v_mfma_f32_16x16x32_bf16 v[40:43], a[132:135], v[64:67], v[40:43]
ds_read_b128 a[176:179], v14 offset:45056
ds_read_b128 a[180:183], v15 offset:45056
v_mfma_f32_16x16x32_bf16 v[40:43], a[136:139], v[96:99], v[40:43]
v_exp_f32 v49, v49
v_mfma_f32_16x16x32_bf16 v[40:43], a[140:143], v[128:131], v[40:43]
ds_read_b64_tr_b16 a[224:225], v2 offset:40960
ds_read_b64_tr_b16 a[226:227], v2 offset:45056
v_mfma_f32_16x16x32_bf16 v[44:47], a[144:147], v[32:35], v[80:83]
v_exp_f32 v50, v50
v_mfma_f32_16x16x32_bf16 v[44:47], a[148:151], v[64:67], v[44:47]
ds_read_b64_tr_b16 a[228:229], v3 offset:40960
ds_read_b64_tr_b16 a[230:231], v3 offset:45056
v_mfma_f32_16x16x32_bf16 v[44:47], a[152:155], v[96:99], v[44:47]
v_exp_f32 v51, v51
v_mfma_f32_16x16x32_bf16 v[44:47], a[156:159], v[128:131], v[44:47]
v_cvt_pk_bf16_f32 v140, v48, v49
v_cvt_pk_bf16_f32 v141, v50, v51
v_mfma_f32_16x16x32_bf16 a[0:3], a[192:195], v[136:139], a[0:3]
v_exp_f32 v52, v52
v_mfma_f32_16x16x32_bf16 a[4:7], a[196:199], v[136:139], a[4:7]
v_exp_f32 v53, v53
v_mfma_f32_16x16x32_bf16 a[8:11], a[200:203], v[136:139], a[8:11]
v_exp_f32 v54, v54
v_mfma_f32_16x16x32_bf16 a[12:15], a[204:207], v[136:139], a[12:15]
v_exp_f32 v55, v55
v_mfma_f32_16x16x32_bf16 a[16:19], a[208:211], v[136:139], a[16:19]
v_cvt_pk_bf16_f32 v142, v52, v53
v_cvt_pk_bf16_f32 v143, v54, v55
v_mfma_f32_16x16x32_bf16 a[20:23], a[212:215], v[136:139], a[20:23]
s_add_u32 m0, s52, 0x3000
v_mfma_f32_16x16x32_bf16 a[24:27], a[216:219], v[136:139], a[24:27]
buffer_load_dwordx4 v240, s[24:27], s50 offen lds
v_mfma_f32_16x16x32_bf16 a[28:31], a[220:223], v[136:139], a[28:31]
v_mfma_f32_16x16x32_bf16 v[104:107], v[144:147], v[136:139], v[104:107]
v_mfma_f32_16x16x32_bf16 v[48:51], a[128:131], v[36:39], v[84:87]
v_exp_f32 v40, v40
v_mfma_f32_16x16x32_bf16 v[48:51], a[132:135], v[68:71], v[48:51]
ds_read_b128 a[184:187], v16 offset:45056
ds_read_b128 a[188:191], v17 offset:45056
v_mfma_f32_16x16x32_bf16 v[48:51], a[136:139], v[100:103], v[48:51]
v_exp_f32 v41, v41
v_mfma_f32_16x16x32_bf16 v[48:51], a[140:143], v[132:135], v[48:51]
ds_read_b64_tr_b16 a[232:233], v4 offset:40960
ds_read_b64_tr_b16 a[234:235], v4 offset:45056
v_mfma_f32_16x16x32_bf16 v[52:55], a[144:147], v[36:39], v[84:87]
v_exp_f32 v42, v42
v_mfma_f32_16x16x32_bf16 v[52:55], a[148:151], v[68:71], v[52:55]
ds_read_b64_tr_b16 a[236:237], v5 offset:40960
ds_read_b64_tr_b16 a[238:239], v5 offset:45056
v_mfma_f32_16x16x32_bf16 v[52:55], a[152:155], v[100:103], v[52:55]
v_exp_f32 v43, v43
v_mfma_f32_16x16x32_bf16 v[52:55], a[156:159], v[132:135], v[52:55]
v_cvt_pk_bf16_f32 v136, v40, v41
v_cvt_pk_bf16_f32 v137, v42, v43
v_mfma_f32_16x16x32_bf16 a[32:35], a[192:195], v[140:143], a[32:35]
v_exp_f32 v44, v44
v_mfma_f32_16x16x32_bf16 a[36:39], a[196:199], v[140:143], a[36:39]
v_exp_f32 v45, v45
v_mfma_f32_16x16x32_bf16 a[40:43], a[200:203], v[140:143], a[40:43]
v_exp_f32 v46, v46
v_mfma_f32_16x16x32_bf16 a[44:47], a[204:207], v[140:143], a[44:47]
v_exp_f32 v47, v47
v_mfma_f32_16x16x32_bf16 a[48:51], a[208:211], v[140:143], a[48:51]
v_cvt_pk_bf16_f32 v138, v44, v45
v_cvt_pk_bf16_f32 v139, v46, v47
v_mfma_f32_16x16x32_bf16 a[52:55], a[212:215], v[140:143], a[52:55]
s_add_u32 m0, s52, 0x13000
v_mfma_f32_16x16x32_bf16 a[56:59], a[216:219], v[140:143], a[56:59]
buffer_load_dwordx4 v241, s[28:31], s50 offen lds
s_add_u32 s50, s50, 0x1000
buffer_load_dword v252, v251, s[16:19], s91 offen
s_add_u32 s91, s91, 0x30000
v_mfma_f32_16x16x32_bf16 a[60:63], a[220:223], v[140:143], a[60:63]
v_mfma_f32_16x16x32_bf16 v[108:111], v[144:147], v[140:143], v[108:111]
s_waitcnt lgkmcnt(0)
s_waitcnt vmcnt(9)
s_barrier
s_sub_u32 s60, s60, 1
s_cmp_lg_u32 s60, 0
s_cbranch_scc1 recurrent_scan__gqa_block_cached__glu_gated_reglu__prompt_kernel_hsig12
s_cmp_lg_u32 s44, 0
s_cbranch_scc1 recurrent_scan__gqa_block_cached__glu_gated_reglu__prompt_kernel_sig13
s_lshl_b32 s90, s46, 3
s_add_u32 s90, s90, 1
s_lshl_b32 s90, s90, 2
v_mov_b32 v12, s90
v_mov_b32 v13, 1
s_mov_b64 exec, 1
buffer_atomic_add v13, v12, s[72:75], 0 offen sc1
s_mov_b64 exec, -1
recurrent_scan__gqa_block_cached__glu_gated_reglu__prompt_kernel_sig13:
recurrent_scan__gqa_block_cached__glu_gated_reglu__prompt_kernel_hsig12:
v_mfma_f32_16x16x32_bf16 v[40:43], a[160:163], v[24:27], v[72:75]
v_exp_f32 v48, v48
v_mfma_f32_16x16x32_bf16 v[40:43], a[164:167], v[56:59], v[40:43]
ds_read_b128 a[128:131], v14 offset:49152
ds_read_b128 a[132:135], v15 offset:49152
v_mfma_f32_16x16x32_bf16 v[40:43], a[168:171], v[88:91], v[40:43]
v_exp_f32 v49, v49
v_mfma_f32_16x16x32_bf16 v[40:43], a[172:175], v[120:123], v[40:43]
ds_read_b64_tr_b16 a[240:241], v6 offset:40960
ds_read_b64_tr_b16 a[242:243], v6 offset:45056
v_mfma_f32_16x16x32_bf16 v[44:47], a[176:179], v[24:27], v[72:75]
v_exp_f32 v50, v50
v_mfma_f32_16x16x32_bf16 v[44:47], a[180:183], v[56:59], v[44:47]
ds_read_b64_tr_b16 a[244:245], v7 offset:40960
ds_read_b64_tr_b16 a[246:247], v7 offset:45056
v_mfma_f32_16x16x32_bf16 v[44:47], a[184:187], v[88:91], v[44:47]
v_exp_f32 v51, v51
v_mfma_f32_16x16x32_bf16 v[44:47], a[188:191], v[120:123], v[44:47]
v_cvt_pk_bf16_f32 v140, v48, v49
v_cvt_pk_bf16_f32 v141, v50, v51
v_mfma_f32_16x16x32_bf16 a[64:67], a[192:195], v[136:139], a[64:67]
v_exp_f32 v52, v52
v_mfma_f32_16x16x32_bf16 a[68:71], a[196:199], v[136:139], a[68:71]
v_exp_f32 v53, v53
v_mfma_f32_16x16x32_bf16 a[72:75], a[200:203], v[136:139], a[72:75]
v_exp_f32 v54, v54
v_mfma_f32_16x16x32_bf16 a[76:79], a[204:207], v[136:139], a[76:79]
v_exp_f32 v55, v55
v_mfma_f32_16x16x32_bf16 a[80:83], a[208:211], v[136:139], a[80:83]
v_cvt_pk_bf16_f32 v142, v52, v53
v_cvt_pk_bf16_f32 v143, v54, v55
v_mfma_f32_16x16x32_bf16 a[84:87], a[212:215], v[136:139], a[84:87]
s_add_u32 m0, s52, 0x4000
v_mfma_f32_16x16x32_bf16 a[88:91], a[216:219], v[136:139], a[88:91]
buffer_load_dwordx4 v240, s[24:27], s50 offen lds
v_mfma_f32_16x16x32_bf16 a[92:95], a[220:223], v[136:139], a[92:95]
v_mfma_f32_16x16x32_bf16 v[112:115], v[144:147], v[136:139], v[112:115]
v_mfma_f32_16x16x32_bf16 v[48:51], a[160:163], v[28:31], v[76:79]
v_exp_f32 v40, v40
v_mfma_f32_16x16x32_bf16 v[48:51], a[164:167], v[60:63], v[48:51]
ds_read_b128 a[136:139], v16 offset:49152
ds_read_b128 a[140:143], v17 offset:49152
v_mfma_f32_16x16x32_bf16 v[48:51], a[168:171], v[92:95], v[48:51]
v_exp_f32 v41, v41
v_mfma_f32_16x16x32_bf16 v[48:51], a[172:175], v[124:127], v[48:51]
ds_read_b64_tr_b16 a[248:249], v8 offset:40960
ds_read_b64_tr_b16 a[250:251], v8 offset:45056
v_mfma_f32_16x16x32_bf16 v[52:55], a[176:179], v[28:31], v[76:79]
v_exp_f32 v42, v42
v_mfma_f32_16x16x32_bf16 v[52:55], a[180:183], v[60:63], v[52:55]
ds_read_b64_tr_b16 a[252:253], v9 offset:40960
ds_read_b64_tr_b16 a[254:255], v9 offset:45056
v_mfma_f32_16x16x32_bf16 v[52:55], a[184:187], v[92:95], v[52:55]
v_exp_f32 v43, v43
v_mfma_f32_16x16x32_bf16 v[52:55], a[188:191], v[124:127], v[52:55]
v_cvt_pk_bf16_f32 v136, v40, v41
v_cvt_pk_bf16_f32 v137, v42, v43
v_mfma_f32_16x16x32_bf16 a[96:99], a[192:195], v[140:143], a[96:99]
v_exp_f32 v44, v44
v_mfma_f32_16x16x32_bf16 a[100:103], a[196:199], v[140:143], a[100:103]
v_exp_f32 v45, v45
v_mfma_f32_16x16x32_bf16 a[104:107], a[200:203], v[140:143], a[104:107]
v_exp_f32 v46, v46
v_mfma_f32_16x16x32_bf16 a[108:111], a[204:207], v[140:143], a[108:111]
v_exp_f32 v47, v47
v_mfma_f32_16x16x32_bf16 a[112:115], a[208:211], v[140:143], a[112:115]
v_cvt_pk_bf16_f32 v138, v44, v45
v_cvt_pk_bf16_f32 v139, v46, v47
v_mfma_f32_16x16x32_bf16 a[116:119], a[212:215], v[140:143], a[116:119]
s_add_u32 m0, s52, 0x14000
v_mfma_f32_16x16x32_bf16 a[120:123], a[216:219], v[140:143], a[120:123]
buffer_load_dwordx4 v241, s[28:31], s50 offen lds
s_add_u32 s50, s50, 0x1000
v_mfma_f32_16x16x32_bf16 a[124:127], a[220:223], v[140:143], a[124:127]
v_mfma_f32_16x16x32_bf16 v[116:119], v[144:147], v[140:143], v[116:119]
s_waitcnt lgkmcnt(0)
v_mfma_f32_16x16x32_bf16 v[40:43], a[160:163], v[32:35], v[80:83]
v_exp_f32 v48, v48
v_mfma_f32_16x16x32_bf16 v[40:43], a[164:167], v[64:67], v[40:43]
ds_read_b128 a[144:147], v14 offset:53248
ds_read_b128 a[148:151], v15 offset:53248
v_mfma_f32_16x16x32_bf16 v[40:43], a[168:171], v[96:99], v[40:43]
v_exp_f32 v49, v49
v_mfma_f32_16x16x32_bf16 v[40:43], a[172:175], v[128:131], v[40:43]
ds_read_b64_tr_b16 a[192:193], v2 offset:49152
ds_read_b64_tr_b16 a[194:195], v2 offset:53248
v_mfma_f32_16x16x32_bf16 v[44:47], a[176:179], v[32:35], v[80:83]
v_exp_f32 v50, v50
v_mfma_f32_16x16x32_bf16 v[44:47], a[180:183], v[64:67], v[44:47]
ds_read_b64_tr_b16 a[196:197], v3 offset:49152
ds_read_b64_tr_b16 a[198:199], v3 offset:53248
v_mfma_f32_16x16x32_bf16 v[44:47], a[184:187], v[96:99], v[44:47]
v_exp_f32 v51, v51
v_mfma_f32_16x16x32_bf16 v[44:47], a[188:191], v[128:131], v[44:47]
v_cvt_pk_bf16_f32 v140, v48, v49
v_cvt_pk_bf16_f32 v141, v50, v51
v_mfma_f32_16x16x32_bf16 a[0:3], a[224:227], v[136:139], a[0:3]
v_exp_f32 v52, v52
v_mfma_f32_16x16x32_bf16 a[4:7], a[228:231], v[136:139], a[4:7]
v_exp_f32 v53, v53
v_mfma_f32_16x16x32_bf16 a[8:11], a[232:235], v[136:139], a[8:11]
v_exp_f32 v54, v54
v_mfma_f32_16x16x32_bf16 a[12:15], a[236:239], v[136:139], a[12:15]
v_exp_f32 v55, v55
v_mfma_f32_16x16x32_bf16 a[16:19], a[240:243], v[136:139], a[16:19]
v_cvt_pk_bf16_f32 v142, v52, v53
v_cvt_pk_bf16_f32 v143, v54, v55
v_mfma_f32_16x16x32_bf16 a[20:23], a[244:247], v[136:139], a[20:23]
s_add_u32 m0, s52, 0x5000
v_mfma_f32_16x16x32_bf16 a[24:27], a[248:251], v[136:139], a[24:27]
buffer_load_dwordx4 v240, s[24:27], s50 offen lds
v_mfma_f32_16x16x32_bf16 a[28:31], a[252:255], v[136:139], a[28:31]
v_mfma_f32_16x16x32_bf16 v[104:107], v[144:147], v[136:139], v[104:107]
v_mfma_f32_16x16x32_bf16 v[48:51], a[160:163], v[36:39], v[84:87]
v_exp_f32 v40, v40
v_mfma_f32_16x16x32_bf16 v[48:51], a[164:167], v[68:71], v[48:51]
ds_read_b128 a[152:155], v16 offset:53248
ds_read_b128 a[156:159], v17 offset:53248
v_mfma_f32_16x16x32_bf16 v[48:51], a[168:171], v[100:103], v[48:51]
v_exp_f32 v41, v41
v_mfma_f32_16x16x32_bf16 v[48:51], a[172:175], v[132:135], v[48:51]
ds_read_b64_tr_b16 a[200:201], v4 offset:49152
ds_read_b64_tr_b16 a[202:203], v4 offset:53248
v_mfma_f32_16x16x32_bf16 v[52:55], a[176:179], v[36:39], v[84:87]
v_exp_f32 v42, v42
v_mfma_f32_16x16x32_bf16 v[52:55], a[180:183], v[68:71], v[52:55]
ds_read_b64_tr_b16 a[204:205], v5 offset:49152
ds_read_b64_tr_b16 a[206:207], v5 offset:53248
v_mfma_f32_16x16x32_bf16 v[52:55], a[184:187], v[100:103], v[52:55]
v_exp_f32 v43, v43
v_mfma_f32_16x16x32_bf16 v[52:55], a[188:191], v[132:135], v[52:55]
v_cvt_pk_bf16_f32 v136, v40, v41
v_cvt_pk_bf16_f32 v137, v42, v43
v_mfma_f32_16x16x32_bf16 a[32:35], a[224:227], v[140:143], a[32:35]
v_exp_f32 v44, v44
v_mfma_f32_16x16x32_bf16 a[36:39], a[228:231], v[140:143], a[36:39]
v_exp_f32 v45, v45
v_mfma_f32_16x16x32_bf16 a[40:43], a[232:235], v[140:143], a[40:43]
v_exp_f32 v46, v46
v_mfma_f32_16x16x32_bf16 a[44:47], a[236:239], v[140:143], a[44:47]
v_exp_f32 v47, v47
v_mfma_f32_16x16x32_bf16 a[48:51], a[240:243], v[140:143], a[48:51]
v_cvt_pk_bf16_f32 v138, v44, v45
v_cvt_pk_bf16_f32 v139, v46, v47
v_mfma_f32_16x16x32_bf16 a[52:55], a[244:247], v[140:143], a[52:55]
s_add_u32 m0, s52, 0x15000
v_mfma_f32_16x16x32_bf16 a[56:59], a[248:251], v[140:143], a[56:59]
buffer_load_dwordx4 v241, s[28:31], s50 offen lds
s_add_u32 s50, s50, 0x1000
v_mfma_f32_16x16x32_bf16 a[60:63], a[252:255], v[140:143], a[60:63]
v_mfma_f32_16x16x32_bf16 v[108:111], v[144:147], v[140:143], v[108:111]
s_waitcnt lgkmcnt(0)
v_mfma_f32_16x16x32_bf16 v[40:43], a[128:131], v[24:27], v[72:75]
v_exp_f32 v48, v48
v_mfma_f32_16x16x32_bf16 v[40:43], a[132:135], v[56:59], v[40:43]
ds_read_b128 a[160:163], v14 offset:57344
ds_read_b128 a[164:167], v15 offset:57344
v_mfma_f32_16x16x32_bf16 v[40:43], a[136:139], v[88:91], v[40:43]
v_exp_f32 v49, v49
v_mfma_f32_16x16x32_bf16 v[40:43], a[140:143], v[120:123], v[40:43]
ds_read_b64_tr_b16 a[208:209], v6 offset:49152
ds_read_b64_tr_b16 a[210:211], v6 offset:53248
v_mfma_f32_16x16x32_bf16 v[44:47], a[144:147], v[24:27], v[72:75]
v_exp_f32 v50, v50
v_mfma_f32_16x16x32_bf16 v[44:47], a[148:151], v[56:59], v[44:47]
ds_read_b64_tr_b16 a[212:213], v7 offset:49152
ds_read_b64_tr_b16 a[214:215], v7 offset:53248
v_mfma_f32_16x16x32_bf16 v[44:47], a[152:155], v[88:91], v[44:47]
v_exp_f32 v51, v51
v_mfma_f32_16x16x32_bf16 v[44:47], a[156:159], v[120:123], v[44:47]
v_cvt_pk_bf16_f32 v140, v48, v49
v_cvt_pk_bf16_f32 v141, v50, v51
v_mfma_f32_16x16x32_bf16 a[64:67], a[224:227], v[136:139], a[64:67]
v_exp_f32 v52, v52
v_mfma_f32_16x16x32_bf16 a[68:71], a[228:231], v[136:139], a[68:71]
v_exp_f32 v53, v53
v_mfma_f32_16x16x32_bf16 a[72:75], a[232:235], v[136:139], a[72:75]
v_exp_f32 v54, v54
v_mfma_f32_16x16x32_bf16 a[76:79], a[236:239], v[136:139], a[76:79]
v_exp_f32 v55, v55
v_mfma_f32_16x16x32_bf16 a[80:83], a[240:243], v[136:139], a[80:83]
v_cvt_pk_bf16_f32 v142, v52, v53
v_cvt_pk_bf16_f32 v143, v54, v55
v_mfma_f32_16x16x32_bf16 a[84:87], a[244:247], v[136:139], a[84:87]
s_add_u32 m0, s52, 0x6000
v_mfma_f32_16x16x32_bf16 a[88:91], a[248:251], v[136:139], a[88:91]
buffer_load_dwordx4 v240, s[24:27], s50 offen lds
v_mfma_f32_16x16x32_bf16 a[92:95], a[252:255], v[136:139], a[92:95]
v_mfma_f32_16x16x32_bf16 v[112:115], v[144:147], v[136:139], v[112:115]
v_mfma_f32_16x16x32_bf16 v[48:51], a[128:131], v[28:31], v[76:79]
v_exp_f32 v40, v40
v_mfma_f32_16x16x32_bf16 v[48:51], a[132:135], v[60:63], v[48:51]
ds_read_b128 a[168:171], v16 offset:57344
ds_read_b128 a[172:175], v17 offset:57344
v_mfma_f32_16x16x32_bf16 v[48:51], a[136:139], v[92:95], v[48:51]
v_exp_f32 v41, v41
v_mfma_f32_16x16x32_bf16 v[48:51], a[140:143], v[124:127], v[48:51]
ds_read_b64_tr_b16 a[216:217], v8 offset:49152
ds_read_b64_tr_b16 a[218:219], v8 offset:53248
v_mfma_f32_16x16x32_bf16 v[52:55], a[144:147], v[28:31], v[76:79]
v_exp_f32 v42, v42
v_mfma_f32_16x16x32_bf16 v[52:55], a[148:151], v[60:63], v[52:55]
ds_read_b64_tr_b16 a[220:221], v9 offset:49152
ds_read_b64_tr_b16 a[222:223], v9 offset:53248
v_mfma_f32_16x16x32_bf16 v[52:55], a[152:155], v[92:95], v[52:55]
v_exp_f32 v43, v43
v_mfma_f32_16x16x32_bf16 v[52:55], a[156:159], v[124:127], v[52:55]
v_cvt_pk_bf16_f32 v136, v40, v41
v_cvt_pk_bf16_f32 v137, v42, v43
v_mfma_f32_16x16x32_bf16 a[96:99], a[224:227], v[140:143], a[96:99]
v_exp_f32 v44, v44
v_mfma_f32_16x16x32_bf16 a[100:103], a[228:231], v[140:143], a[100:103]
v_exp_f32 v45, v45
v_mfma_f32_16x16x32_bf16 a[104:107], a[232:235], v[140:143], a[104:107]
v_exp_f32 v46, v46
v_mfma_f32_16x16x32_bf16 a[108:111], a[236:239], v[140:143], a[108:111]
v_exp_f32 v47, v47
v_mfma_f32_16x16x32_bf16 a[112:115], a[240:243], v[140:143], a[112:115]
v_cvt_pk_bf16_f32 v138, v44, v45
v_cvt_pk_bf16_f32 v139, v46, v47
v_mfma_f32_16x16x32_bf16 a[116:119], a[244:247], v[140:143], a[116:119]
s_add_u32 m0, s52, 0x16000
v_mfma_f32_16x16x32_bf16 a[120:123], a[248:251], v[140:143], a[120:123]
buffer_load_dwordx4 v241, s[28:31], s50 offen lds
s_add_u32 s50, s50, 0x1000
v_mfma_f32_16x16x32_bf16 a[124:127], a[252:255], v[140:143], a[124:127]
v_mfma_f32_16x16x32_bf16 v[116:119], v[144:147], v[140:143], v[116:119]
s_waitcnt lgkmcnt(0)
v_mfma_f32_16x16x32_bf16 v[40:43], a[128:131], v[32:35], v[80:83]
v_exp_f32 v48, v48
v_mfma_f32_16x16x32_bf16 v[40:43], a[132:135], v[64:67], v[40:43]
ds_read_b128 a[176:179], v14 offset:61440
ds_read_b128 a[180:183], v15 offset:61440
v_mfma_f32_16x16x32_bf16 v[40:43], a[136:139], v[96:99], v[40:43]
v_exp_f32 v49, v49
v_mfma_f32_16x16x32_bf16 v[40:43], a[140:143], v[128:131], v[40:43]
ds_read_b64_tr_b16 a[224:225], v2 offset:57344
ds_read_b64_tr_b16 a[226:227], v2 offset:61440
v_mfma_f32_16x16x32_bf16 v[44:47], a[144:147], v[32:35], v[80:83]
v_exp_f32 v50, v50
v_mfma_f32_16x16x32_bf16 v[44:47], a[148:151], v[64:67], v[44:47]
ds_read_b64_tr_b16 a[228:229], v3 offset:57344
ds_read_b64_tr_b16 a[230:231], v3 offset:61440
v_mfma_f32_16x16x32_bf16 v[44:47], a[152:155], v[96:99], v[44:47]
v_exp_f32 v51, v51
v_mfma_f32_16x16x32_bf16 v[44:47], a[156:159], v[128:131], v[44:47]
v_cvt_pk_bf16_f32 v140, v48, v49
v_cvt_pk_bf16_f32 v141, v50, v51
v_mfma_f32_16x16x32_bf16 a[0:3], a[192:195], v[136:139], a[0:3]
v_exp_f32 v52, v52
v_mfma_f32_16x16x32_bf16 a[4:7], a[196:199], v[136:139], a[4:7]
v_exp_f32 v53, v53
v_mfma_f32_16x16x32_bf16 a[8:11], a[200:203], v[136:139], a[8:11]
v_exp_f32 v54, v54
v_mfma_f32_16x16x32_bf16 a[12:15], a[204:207], v[136:139], a[12:15]
v_exp_f32 v55, v55
v_mfma_f32_16x16x32_bf16 a[16:19], a[208:211], v[136:139], a[16:19]
v_cvt_pk_bf16_f32 v142, v52, v53
v_cvt_pk_bf16_f32 v143, v54, v55
v_mfma_f32_16x16x32_bf16 a[20:23], a[212:215], v[136:139], a[20:23]
s_add_u32 m0, s52, 0x7000
v_mfma_f32_16x16x32_bf16 a[24:27], a[216:219], v[136:139], a[24:27]
buffer_load_dwordx4 v240, s[24:27], s50 offen lds
v_mfma_f32_16x16x32_bf16 a[28:31], a[220:223], v[136:139], a[28:31]
v_mfma_f32_16x16x32_bf16 v[104:107], v[144:147], v[136:139], v[104:107]
v_mfma_f32_16x16x32_bf16 v[48:51], a[128:131], v[36:39], v[84:87]
v_exp_f32 v40, v40
v_mfma_f32_16x16x32_bf16 v[48:51], a[132:135], v[68:71], v[48:51]
ds_read_b128 a[184:187], v16 offset:61440
ds_read_b128 a[188:191], v17 offset:61440
v_mfma_f32_16x16x32_bf16 v[48:51], a[136:139], v[100:103], v[48:51]
v_exp_f32 v41, v41
v_mfma_f32_16x16x32_bf16 v[48:51], a[140:143], v[132:135], v[48:51]
ds_read_b64_tr_b16 a[232:233], v4 offset:57344
ds_read_b64_tr_b16 a[234:235], v4 offset:61440
v_mfma_f32_16x16x32_bf16 v[52:55], a[144:147], v[36:39], v[84:87]
v_exp_f32 v42, v42
v_mfma_f32_16x16x32_bf16 v[52:55], a[148:151], v[68:71], v[52:55]
ds_read_b64_tr_b16 a[236:237], v5 offset:57344
ds_read_b64_tr_b16 a[238:239], v5 offset:61440
v_mfma_f32_16x16x32_bf16 v[52:55], a[152:155], v[100:103], v[52:55]
v_exp_f32 v43, v43
v_mfma_f32_16x16x32_bf16 v[52:55], a[156:159], v[132:135], v[52:55]
v_cvt_pk_bf16_f32 v136, v40, v41
v_cvt_pk_bf16_f32 v137, v42, v43
v_mfma_f32_16x16x32_bf16 a[32:35], a[192:195], v[140:143], a[32:35]
v_exp_f32 v44, v44
v_mfma_f32_16x16x32_bf16 a[36:39], a[196:199], v[140:143], a[36:39]
v_exp_f32 v45, v45
v_mfma_f32_16x16x32_bf16 a[40:43], a[200:203], v[140:143], a[40:43]
v_exp_f32 v46, v46
v_mfma_f32_16x16x32_bf16 a[44:47], a[204:207], v[140:143], a[44:47]
v_exp_f32 v47, v47
v_mfma_f32_16x16x32_bf16 a[48:51], a[208:211], v[140:143], a[48:51]
v_cvt_pk_bf16_f32 v138, v44, v45
v_cvt_pk_bf16_f32 v139, v46, v47
v_mfma_f32_16x16x32_bf16 a[52:55], a[212:215], v[140:143], a[52:55]
s_add_u32 m0, s52, 0x17000
v_mfma_f32_16x16x32_bf16 a[56:59], a[216:219], v[140:143], a[56:59]
buffer_load_dwordx4 v241, s[28:31], s50 offen lds
s_add_u32 s50, s50, 0x1000
v_mfma_f32_16x16x32_bf16 a[60:63], a[220:223], v[140:143], a[60:63]
v_mfma_f32_16x16x32_bf16 v[108:111], v[144:147], v[140:143], v[108:111]
s_waitcnt lgkmcnt(0)
s_waitcnt vmcnt(9)
s_barrier
v_mfma_f32_16x16x32_bf16 v[40:43], a[160:163], v[24:27], v[72:75]
v_exp_f32 v48, v48
v_mfma_f32_16x16x32_bf16 v[40:43], a[164:167], v[56:59], v[40:43]
ds_read_b128 a[128:131], v14
ds_read_b128 a[132:135], v15
v_mfma_f32_16x16x32_bf16 v[40:43], a[168:171], v[88:91], v[40:43]
v_exp_f32 v49, v49
v_mfma_f32_16x16x32_bf16 v[40:43], a[172:175], v[120:123], v[40:43]
ds_read_b64_tr_b16 a[240:241], v6 offset:57344
ds_read_b64_tr_b16 a[242:243], v6 offset:61440
v_mfma_f32_16x16x32_bf16 v[44:47], a[176:179], v[24:27], v[72:75]
v_exp_f32 v50, v50
v_mfma_f32_16x16x32_bf16 v[44:47], a[180:183], v[56:59], v[44:47]
ds_read_b64_tr_b16 a[244:245], v7 offset:57344
ds_read_b64_tr_b16 a[246:247], v7 offset:61440
v_mfma_f32_16x16x32_bf16 v[44:47], a[184:187], v[88:91], v[44:47]
v_exp_f32 v51, v51
v_mfma_f32_16x16x32_bf16 v[44:47], a[188:191], v[120:123], v[44:47]
v_cvt_pk_bf16_f32 v140, v48, v49
v_cvt_pk_bf16_f32 v141, v50, v51
v_mfma_f32_16x16x32_bf16 a[64:67], a[192:195], v[136:139], a[64:67]
v_exp_f32 v52, v52
v_mfma_f32_16x16x32_bf16 a[68:71], a[196:199], v[136:139], a[68:71]
v_exp_f32 v53, v53
v_mfma_f32_16x16x32_bf16 a[72:75], a[200:203], v[136:139], a[72:75]
v_exp_f32 v54, v54
v_mfma_f32_16x16x32_bf16 a[76:79], a[204:207], v[136:139], a[76:79]
v_exp_f32 v55, v55
v_mfma_f32_16x16x32_bf16 a[80:83], a[208:211], v[136:139], a[80:83]
v_cvt_pk_bf16_f32 v142, v52, v53
v_cvt_pk_bf16_f32 v143, v54, v55
v_mfma_f32_16x16x32_bf16 a[84:87], a[212:215], v[136:139], a[84:87]
s_add_u32 m0, s52, 0x8000
v_mfma_f32_16x16x32_bf16 a[88:91], a[216:219], v[136:139], a[88:91]
buffer_load_dwordx4 v240, s[24:27], s50 offen lds
v_mfma_f32_16x16x32_bf16 a[92:95], a[220:223], v[136:139], a[92:95]
v_mfma_f32_16x16x32_bf16 v[112:115], v[144:147], v[136:139], v[112:115]
v_mfma_f32_16x16x32_bf16 v[48:51], a[160:163], v[28:31], v[76:79]
v_exp_f32 v40, v40
v_mfma_f32_16x16x32_bf16 v[48:51], a[164:167], v[60:63], v[48:51]
ds_read_b128 a[136:139], v16
ds_read_b128 a[140:143], v17
v_mfma_f32_16x16x32_bf16 v[48:51], a[168:171], v[92:95], v[48:51]
v_exp_f32 v41, v41
v_mfma_f32_16x16x32_bf16 v[48:51], a[172:175], v[124:127], v[48:51]
ds_read_b64_tr_b16 a[248:249], v8 offset:57344
ds_read_b64_tr_b16 a[250:251], v8 offset:61440
v_mfma_f32_16x16x32_bf16 v[52:55], a[176:179], v[28:31], v[76:79]
v_exp_f32 v42, v42
v_mfma_f32_16x16x32_bf16 v[52:55], a[180:183], v[60:63], v[52:55]
ds_read_b64_tr_b16 a[252:253], v9 offset:57344
ds_read_b64_tr_b16 a[254:255], v9 offset:61440
v_mfma_f32_16x16x32_bf16 v[52:55], a[184:187], v[92:95], v[52:55]
v_exp_f32 v43, v43
v_mfma_f32_16x16x32_bf16 v[52:55], a[188:191], v[124:127], v[52:55]
v_cvt_pk_bf16_f32 v136, v40, v41
v_cvt_pk_bf16_f32 v137, v42, v43
v_mfma_f32_16x16x32_bf16 a[96:99], a[192:195], v[140:143], a[96:99]
v_exp_f32 v44, v44
v_mfma_f32_16x16x32_bf16 a[100:103], a[196:199], v[140:143], a[100:103]
v_exp_f32 v45, v45
v_mfma_f32_16x16x32_bf16 a[104:107], a[200:203], v[140:143], a[104:107]
v_exp_f32 v46, v46
v_mfma_f32_16x16x32_bf16 a[108:111], a[204:207], v[140:143], a[108:111]
v_exp_f32 v47, v47
v_mfma_f32_16x16x32_bf16 a[112:115], a[208:211], v[140:143], a[112:115]
v_cvt_pk_bf16_f32 v138, v44, v45
v_cvt_pk_bf16_f32 v139, v46, v47
v_mfma_f32_16x16x32_bf16 a[116:119], a[212:215], v[140:143], a[116:119]
s_add_u32 m0, s52, 0x18000
v_mfma_f32_16x16x32_bf16 a[120:123], a[216:219], v[140:143], a[120:123]
buffer_load_dwordx4 v241, s[28:31], s50 offen lds
s_add_u32 s50, s50, 0x1000
v_mfma_f32_16x16x32_bf16 a[124:127], a[220:223], v[140:143], a[124:127]
v_mfma_f32_16x16x32_bf16 v[116:119], v[144:147], v[140:143], v[116:119]
s_waitcnt lgkmcnt(0)
v_mfma_f32_16x16x32_bf16 v[40:43], a[160:163], v[32:35], v[80:83]
v_exp_f32 v48, v48
v_mfma_f32_16x16x32_bf16 v[40:43], a[164:167], v[64:67], v[40:43]
ds_read_b128 a[144:147], v14 offset:4096
ds_read_b128 a[148:151], v15 offset:4096
v_mfma_f32_16x16x32_bf16 v[40:43], a[168:171], v[96:99], v[40:43]
v_exp_f32 v49, v49
v_mfma_f32_16x16x32_bf16 v[40:43], a[172:175], v[128:131], v[40:43]
ds_read_b64_tr_b16 a[192:193], v2
ds_read_b64_tr_b16 a[194:195], v2 offset:4096
v_mfma_f32_16x16x32_bf16 v[44:47], a[176:179], v[32:35], v[80:83]
v_exp_f32 v50, v50
v_mfma_f32_16x16x32_bf16 v[44:47], a[180:183], v[64:67], v[44:47]
ds_read_b64_tr_b16 a[196:197], v3
ds_read_b64_tr_b16 a[198:199], v3 offset:4096
v_mfma_f32_16x16x32_bf16 v[44:47], a[184:187], v[96:99], v[44:47]
v_exp_f32 v51, v51
v_mfma_f32_16x16x32_bf16 v[44:47], a[188:191], v[128:131], v[44:47]
v_cvt_pk_bf16_f32 v140, v48, v49
v_cvt_pk_bf16_f32 v141, v50, v51
v_mfma_f32_16x16x32_bf16 a[0:3], a[224:227], v[136:139], a[0:3]
v_exp_f32 v52, v52
v_mfma_f32_16x16x32_bf16 a[4:7], a[228:231], v[136:139], a[4:7]
v_exp_f32 v53, v53
v_mfma_f32_16x16x32_bf16 a[8:11], a[232:235], v[136:139], a[8:11]
v_exp_f32 v54, v54
v_mfma_f32_16x16x32_bf16 a[12:15], a[236:239], v[136:139], a[12:15]
v_exp_f32 v55, v55
v_mfma_f32_16x16x32_bf16 a[16:19], a[240:243], v[136:139], a[16:19]
v_cvt_pk_bf16_f32 v142, v52, v53
v_cvt_pk_bf16_f32 v143, v54, v55
v_mfma_f32_16x16x32_bf16 a[20:23], a[244:247], v[136:139], a[20:23]
s_add_u32 m0, s52, 0x9000
v_mfma_f32_16x16x32_bf16 a[24:27], a[248:251], v[136:139], a[24:27]
buffer_load_dwordx4 v240, s[24:27], s50 offen lds
v_mfma_f32_16x16x32_bf16 a[28:31], a[252:255], v[136:139], a[28:31]
v_mfma_f32_16x16x32_bf16 v[104:107], v[144:147], v[136:139], v[104:107]
v_mfma_f32_16x16x32_bf16 v[48:51], a[160:163], v[36:39], v[84:87]
v_exp_f32 v40, v40
v_mfma_f32_16x16x32_bf16 v[48:51], a[164:167], v[68:71], v[48:51]
ds_read_b128 a[152:155], v16 offset:4096
ds_read_b128 a[156:159], v17 offset:4096
v_mfma_f32_16x16x32_bf16 v[48:51], a[168:171], v[100:103], v[48:51]
v_exp_f32 v41, v41
v_mfma_f32_16x16x32_bf16 v[48:51], a[172:175], v[132:135], v[48:51]
ds_read_b64_tr_b16 a[200:201], v4
ds_read_b64_tr_b16 a[202:203], v4 offset:4096
v_mfma_f32_16x16x32_bf16 v[52:55], a[176:179], v[36:39], v[84:87]
v_exp_f32 v42, v42
v_mfma_f32_16x16x32_bf16 v[52:55], a[180:183], v[68:71], v[52:55]
ds_read_b64_tr_b16 a[204:205], v5
ds_read_b64_tr_b16 a[206:207], v5 offset:4096
v_mfma_f32_16x16x32_bf16 v[52:55], a[184:187], v[100:103], v[52:55]
v_exp_f32 v43, v43
v_mfma_f32_16x16x32_bf16 v[52:55], a[188:191], v[132:135], v[52:55]
v_cvt_pk_bf16_f32 v136, v40, v41
v_cvt_pk_bf16_f32 v137, v42, v43
v_mfma_f32_16x16x32_bf16 a[32:35], a[224:227], v[140:143], a[32:35]
v_exp_f32 v44, v44
v_mfma_f32_16x16x32_bf16 a[36:39], a[228:231], v[140:143], a[36:39]
v_exp_f32 v45, v45
v_mfma_f32_16x16x32_bf16 a[40:43], a[232:235], v[140:143], a[40:43]
v_exp_f32 v46, v46
v_mfma_f32_16x16x32_bf16 a[44:47], a[236:239], v[140:143], a[44:47]
v_exp_f32 v47, v47
v_mfma_f32_16x16x32_bf16 a[48:51], a[240:243], v[140:143], a[48:51]
v_cvt_pk_bf16_f32 v138, v44, v45
v_cvt_pk_bf16_f32 v139, v46, v47
v_mfma_f32_16x16x32_bf16 a[52:55], a[244:247], v[140:143], a[52:55]
s_add_u32 m0, s52, 0x19000
v_mfma_f32_16x16x32_bf16 a[56:59], a[248:251], v[140:143], a[56:59]
buffer_load_dwordx4 v241, s[28:31], s50 offen lds
s_add_u32 s50, s50, 0x1000
v_mfma_f32_16x16x32_bf16 a[60:63], a[252:255], v[140:143], a[60:63]
v_mfma_f32_16x16x32_bf16 v[108:111], v[144:147], v[140:143], v[108:111]
s_waitcnt lgkmcnt(0)
v_mfma_f32_16x16x32_bf16 v[40:43], a[128:131], v[24:27], v[72:75]
v_exp_f32 v48, v48
v_mfma_f32_16x16x32_bf16 v[40:43], a[132:135], v[56:59], v[40:43]
ds_read_b128 a[160:163], v14 offset:8192
ds_read_b128 a[164:167], v15 offset:8192
v_mfma_f32_16x16x32_bf16 v[40:43], a[136:139], v[88:91], v[40:43]
v_exp_f32 v49, v49
v_mfma_f32_16x16x32_bf16 v[40:43], a[140:143], v[120:123], v[40:43]
ds_read_b64_tr_b16 a[208:209], v6
ds_read_b64_tr_b16 a[210:211], v6 offset:4096
v_mfma_f32_16x16x32_bf16 v[44:47], a[144:147], v[24:27], v[72:75]
v_exp_f32 v50, v50
v_mfma_f32_16x16x32_bf16 v[44:47], a[148:151], v[56:59], v[44:47]
ds_read_b64_tr_b16 a[212:213], v7
ds_read_b64_tr_b16 a[214:215], v7 offset:4096
v_mfma_f32_16x16x32_bf16 v[44:47], a[152:155], v[88:91], v[44:47]
v_exp_f32 v51, v51
v_mfma_f32_16x16x32_bf16 v[44:47], a[156:159], v[120:123], v[44:47]
v_cvt_pk_bf16_f32 v140, v48, v49
v_cvt_pk_bf16_f32 v141, v50, v51
v_mfma_f32_16x16x32_bf16 a[64:67], a[224:227], v[136:139], a[64:67]
v_exp_f32 v52, v52
v_mfma_f32_16x16x32_bf16 a[68:71], a[228:231], v[136:139], a[68:71]
v_exp_f32 v53, v53
v_mfma_f32_16x16x32_bf16 a[72:75], a[232:235], v[136:139], a[72:75]
v_exp_f32 v54, v54
v_mfma_f32_16x16x32_bf16 a[76:79], a[236:239], v[136:139], a[76:79]
v_exp_f32 v55, v55
v_mfma_f32_16x16x32_bf16 a[80:83], a[240:243], v[136:139], a[80:83]
v_cvt_pk_bf16_f32 v142, v52, v53
v_cvt_pk_bf16_f32 v143, v54, v55
v_mfma_f32_16x16x32_bf16 a[84:87], a[244:247], v[136:139], a[84:87]
s_add_u32 m0, s52, 0xa000
v_mfma_f32_16x16x32_bf16 a[88:91], a[248:251], v[136:139], a[88:91]
buffer_load_dwordx4 v240, s[24:27], s50 offen lds
v_mfma_f32_16x16x32_bf16 a[92:95], a[252:255], v[136:139], a[92:95]
v_mfma_f32_16x16x32_bf16 v[112:115], v[144:147], v[136:139], v[112:115]
v_mfma_f32_16x16x32_bf16 v[48:51], a[128:131], v[28:31], v[76:79]
v_exp_f32 v40, v40
v_mfma_f32_16x16x32_bf16 v[48:51], a[132:135], v[60:63], v[48:51]
ds_read_b128 a[168:171], v16 offset:8192
ds_read_b128 a[172:175], v17 offset:8192
v_mfma_f32_16x16x32_bf16 v[48:51], a[136:139], v[92:95], v[48:51]
v_exp_f32 v41, v41
v_mfma_f32_16x16x32_bf16 v[48:51], a[140:143], v[124:127], v[48:51]
ds_read_b64_tr_b16 a[216:217], v8
ds_read_b64_tr_b16 a[218:219], v8 offset:4096
v_mfma_f32_16x16x32_bf16 v[52:55], a[144:147], v[28:31], v[76:79]
v_exp_f32 v42, v42
v_mfma_f32_16x16x32_bf16 v[52:55], a[148:151], v[60:63], v[52:55]
ds_read_b64_tr_b16 a[220:221], v9
ds_read_b64_tr_b16 a[222:223], v9 offset:4096
v_mfma_f32_16x16x32_bf16 v[52:55], a[152:155], v[92:95], v[52:55]
v_exp_f32 v43, v43
v_mfma_f32_16x16x32_bf16 v[52:55], a[156:159], v[124:127], v[52:55]
v_cvt_pk_bf16_f32 v136, v40, v41
v_cvt_pk_bf16_f32 v137, v42, v43
v_mfma_f32_16x16x32_bf16 a[96:99], a[224:227], v[140:143], a[96:99]
v_exp_f32 v44, v44
v_mfma_f32_16x16x32_bf16 a[100:103], a[228:231], v[140:143], a[100:103]
v_exp_f32 v45, v45
v_mfma_f32_16x16x32_bf16 a[104:107], a[232:235], v[140:143], a[104:107]
v_exp_f32 v46, v46
v_mfma_f32_16x16x32_bf16 a[108:111], a[236:239], v[140:143], a[108:111]
v_exp_f32 v47, v47
v_mfma_f32_16x16x32_bf16 a[112:115], a[240:243], v[140:143], a[112:115]
v_cvt_pk_bf16_f32 v138, v44, v45
v_cvt_pk_bf16_f32 v139, v46, v47
v_mfma_f32_16x16x32_bf16 a[116:119], a[244:247], v[140:143], a[116:119]
s_add_u32 m0, s52, 0x1a000
v_mfma_f32_16x16x32_bf16 a[120:123], a[248:251], v[140:143], a[120:123]
buffer_load_dwordx4 v241, s[28:31], s50 offen lds
s_add_u32 s50, s50, 0x1000
v_mfma_f32_16x16x32_bf16 a[124:127], a[252:255], v[140:143], a[124:127]
v_mfma_f32_16x16x32_bf16 v[116:119], v[144:147], v[140:143], v[116:119]
s_waitcnt lgkmcnt(0)
s_cmp_eq_u32 s57, 7
s_cbranch_scc1 recurrent_scan__gqa_block_cached__glu_gated_reglu__prompt_kernel_adone
v_mfma_f32_16x16x32_bf16 v[40:43], a[128:131], v[32:35], v[80:83]
v_exp_f32 v48, v48
v_mfma_f32_16x16x32_bf16 v[40:43], a[132:135], v[64:67], v[40:43]
ds_read_b128 a[176:179], v14 offset:12288
ds_read_b128 a[180:183], v15 offset:12288
v_mfma_f32_16x16x32_bf16 v[40:43], a[136:139], v[96:99], v[40:43]
v_exp_f32 v49, v49
v_mfma_f32_16x16x32_bf16 v[40:43], a[140:143], v[128:131], v[40:43]
ds_read_b64_tr_b16 a[224:225], v2 offset:8192
ds_read_b64_tr_b16 a[226:227], v2 offset:12288
v_mfma_f32_16x16x32_bf16 v[44:47], a[144:147], v[32:35], v[80:83]
v_exp_f32 v50, v50
v_mfma_f32_16x16x32_bf16 v[44:47], a[148:151], v[64:67], v[44:47]
ds_read_b64_tr_b16 a[228:229], v3 offset:8192
ds_read_b64_tr_b16 a[230:231], v3 offset:12288
v_mfma_f32_16x16x32_bf16 v[44:47], a[152:155], v[96:99], v[44:47]
v_exp_f32 v51, v51
v_mfma_f32_16x16x32_bf16 v[44:47], a[156:159], v[128:131], v[44:47]
v_cvt_pk_bf16_f32 v140, v48, v49
v_cvt_pk_bf16_f32 v141, v50, v51
v_mfma_f32_16x16x32_bf16 a[0:3], a[192:195], v[136:139], a[0:3]
v_exp_f32 v52, v52
v_mfma_f32_16x16x32_bf16 a[4:7], a[196:199], v[136:139], a[4:7]
v_exp_f32 v53, v53
v_mfma_f32_16x16x32_bf16 a[8:11], a[200:203], v[136:139], a[8:11]
v_exp_f32 v54, v54
v_mfma_f32_16x16x32_bf16 a[12:15], a[204:207], v[136:139], a[12:15]
v_exp_f32 v55, v55
v_mfma_f32_16x16x32_bf16 a[16:19], a[208:211], v[136:139], a[16:19]
v_cvt_pk_bf16_f32 v142, v52, v53
v_cvt_pk_bf16_f32 v143, v54, v55
v_mfma_f32_16x16x32_bf16 a[20:23], a[212:215], v[136:139], a[20:23]
s_add_u32 m0, s52, 0xb000
v_mfma_f32_16x16x32_bf16 a[24:27], a[216:219], v[136:139], a[24:27]
buffer_load_dwordx4 v240, s[24:27], s50 offen lds
v_mfma_f32_16x16x32_bf16 a[28:31], a[220:223], v[136:139], a[28:31]
v_mfma_f32_16x16x32_bf16 v[104:107], v[144:147], v[136:139], v[104:107]
v_mfma_f32_16x16x32_bf16 v[48:51], a[128:131], v[36:39], v[84:87]
v_exp_f32 v40, v40
v_mfma_f32_16x16x32_bf16 v[48:51], a[132:135], v[68:71], v[48:51]
ds_read_b128 a[184:187], v16 offset:12288
ds_read_b128 a[188:191], v17 offset:12288
v_mfma_f32_16x16x32_bf16 v[48:51], a[136:139], v[100:103], v[48:51]
v_exp_f32 v41, v41
v_mfma_f32_16x16x32_bf16 v[48:51], a[140:143], v[132:135], v[48:51]
ds_read_b64_tr_b16 a[232:233], v4 offset:8192
ds_read_b64_tr_b16 a[234:235], v4 offset:12288
v_mfma_f32_16x16x32_bf16 v[52:55], a[144:147], v[36:39], v[84:87]
v_exp_f32 v42, v42
v_mfma_f32_16x16x32_bf16 v[52:55], a[148:151], v[68:71], v[52:55]
ds_read_b64_tr_b16 a[236:237], v5 offset:8192
ds_read_b64_tr_b16 a[238:239], v5 offset:12288
v_mfma_f32_16x16x32_bf16 v[52:55], a[152:155], v[100:103], v[52:55]
v_exp_f32 v43, v43
v_mfma_f32_16x16x32_bf16 v[52:55], a[156:159], v[132:135], v[52:55]
v_cvt_pk_bf16_f32 v136, v40, v41
v_cvt_pk_bf16_f32 v137, v42, v43
v_mfma_f32_16x16x32_bf16 a[32:35], a[192:195], v[140:143], a[32:35]
v_exp_f32 v44, v44
v_mfma_f32_16x16x32_bf16 a[36:39], a[196:199], v[140:143], a[36:39]
v_exp_f32 v45, v45
v_mfma_f32_16x16x32_bf16 a[40:43], a[200:203], v[140:143], a[40:43]
v_exp_f32 v46, v46
v_mfma_f32_16x16x32_bf16 a[44:47], a[204:207], v[140:143], a[44:47]
v_exp_f32 v47, v47
v_mfma_f32_16x16x32_bf16 a[48:51], a[208:211], v[140:143], a[48:51]
v_cvt_pk_bf16_f32 v138, v44, v45
v_cvt_pk_bf16_f32 v139, v46, v47
v_mfma_f32_16x16x32_bf16 a[52:55], a[212:215], v[140:143], a[52:55]
s_add_u32 m0, s52, 0x1b000
v_mfma_f32_16x16x32_bf16 a[56:59], a[216:219], v[140:143], a[56:59]
buffer_load_dwordx4 v241, s[28:31], s50 offen lds
s_add_u32 s50, s50, 0x1000
v_mfma_f32_16x16x32_bf16 a[60:63], a[220:223], v[140:143], a[60:63]
v_mfma_f32_16x16x32_bf16 v[108:111], v[144:147], v[140:143], v[108:111]
s_waitcnt lgkmcnt(0)
s_waitcnt vmcnt(8)
s_barrier
v_mfma_f32_16x16x32_bf16 v[40:43], a[160:163], v[24:27], v[72:75]
v_exp_f32 v48, v48
v_mfma_f32_16x16x32_bf16 v[40:43], a[164:167], v[56:59], v[40:43]
ds_read_b128 a[128:131], v14 offset:16384
ds_read_b128 a[132:135], v15 offset:16384
v_mfma_f32_16x16x32_bf16 v[40:43], a[168:171], v[88:91], v[40:43]
v_exp_f32 v49, v49
v_mfma_f32_16x16x32_bf16 v[40:43], a[172:175], v[120:123], v[40:43]
ds_read_b64_tr_b16 a[240:241], v6 offset:8192
ds_read_b64_tr_b16 a[242:243], v6 offset:12288
v_mfma_f32_16x16x32_bf16 v[44:47], a[176:179], v[24:27], v[72:75]
v_exp_f32 v50, v50
v_mfma_f32_16x16x32_bf16 v[44:47], a[180:183], v[56:59], v[44:47]
ds_read_b64_tr_b16 a[244:245], v7 offset:8192
ds_read_b64_tr_b16 a[246:247], v7 offset:12288
v_mfma_f32_16x16x32_bf16 v[44:47], a[184:187], v[88:91], v[44:47]
v_exp_f32 v51, v51
v_mfma_f32_16x16x32_bf16 v[44:47], a[188:191], v[120:123], v[44:47]
v_cvt_pk_bf16_f32 v140, v48, v49
v_cvt_pk_bf16_f32 v141, v50, v51
v_mfma_f32_16x16x32_bf16 a[64:67], a[192:195], v[136:139], a[64:67]
v_exp_f32 v52, v52
v_mfma_f32_16x16x32_bf16 a[68:71], a[196:199], v[136:139], a[68:71]
v_exp_f32 v53, v53
v_mfma_f32_16x16x32_bf16 a[72:75], a[200:203], v[136:139], a[72:75]
v_exp_f32 v54, v54
v_mfma_f32_16x16x32_bf16 a[76:79], a[204:207], v[136:139], a[76:79]
v_exp_f32 v55, v55
v_mfma_f32_16x16x32_bf16 a[80:83], a[208:211], v[136:139], a[80:83]
v_cvt_pk_bf16_f32 v142, v52, v53
v_cvt_pk_bf16_f32 v143, v54, v55
v_mfma_f32_16x16x32_bf16 a[84:87], a[212:215], v[136:139], a[84:87]
s_add_u32 m0, s52, 0xc000
v_mfma_f32_16x16x32_bf16 a[88:91], a[216:219], v[136:139], a[88:91]
buffer_load_dwordx4 v240, s[24:27], s50 offen lds
v_mfma_f32_16x16x32_bf16 a[92:95], a[220:223], v[136:139], a[92:95]
v_mfma_f32_16x16x32_bf16 v[112:115], v[144:147], v[136:139], v[112:115]
v_mfma_f32_16x16x32_bf16 v[48:51], a[160:163], v[28:31], v[76:79]
v_exp_f32 v40, v40
v_mfma_f32_16x16x32_bf16 v[48:51], a[164:167], v[60:63], v[48:51]
ds_read_b128 a[136:139], v16 offset:16384
ds_read_b128 a[140:143], v17 offset:16384
v_mfma_f32_16x16x32_bf16 v[48:51], a[168:171], v[92:95], v[48:51]
v_exp_f32 v41, v41
v_mfma_f32_16x16x32_bf16 v[48:51], a[172:175], v[124:127], v[48:51]
ds_read_b64_tr_b16 a[248:249], v8 offset:8192
ds_read_b64_tr_b16 a[250:251], v8 offset:12288
v_mfma_f32_16x16x32_bf16 v[52:55], a[176:179], v[28:31], v[76:79]
v_exp_f32 v42, v42
v_mfma_f32_16x16x32_bf16 v[52:55], a[180:183], v[60:63], v[52:55]
ds_read_b64_tr_b16 a[252:253], v9 offset:8192
ds_read_b64_tr_b16 a[254:255], v9 offset:12288
v_mfma_f32_16x16x32_bf16 v[52:55], a[184:187], v[92:95], v[52:55]
v_exp_f32 v43, v43
v_mfma_f32_16x16x32_bf16 v[52:55], a[188:191], v[124:127], v[52:55]
v_cvt_pk_bf16_f32 v136, v40, v41
v_cvt_pk_bf16_f32 v137, v42, v43
v_mfma_f32_16x16x32_bf16 a[96:99], a[192:195], v[140:143], a[96:99]
v_exp_f32 v44, v44
v_mfma_f32_16x16x32_bf16 a[100:103], a[196:199], v[140:143], a[100:103]
v_exp_f32 v45, v45
v_mfma_f32_16x16x32_bf16 a[104:107], a[200:203], v[140:143], a[104:107]
v_exp_f32 v46, v46
v_mfma_f32_16x16x32_bf16 a[108:111], a[204:207], v[140:143], a[108:111]
v_exp_f32 v47, v47
v_mfma_f32_16x16x32_bf16 a[112:115], a[208:211], v[140:143], a[112:115]
v_cvt_pk_bf16_f32 v138, v44, v45
v_cvt_pk_bf16_f32 v139, v46, v47
v_mfma_f32_16x16x32_bf16 a[116:119], a[212:215], v[140:143], a[116:119]
s_add_u32 m0, s52, 0x1c000
v_mfma_f32_16x16x32_bf16 a[120:123], a[216:219], v[140:143], a[120:123]
buffer_load_dwordx4 v241, s[28:31], s50 offen lds
s_add_u32 s50, s50, 0x1000
v_mfma_f32_16x16x32_bf16 a[124:127], a[220:223], v[140:143], a[124:127]
v_mfma_f32_16x16x32_bf16 v[116:119], v[144:147], v[140:143], v[116:119]
s_waitcnt lgkmcnt(0)
s_add_u32 s57, s57, 1
s_branch recurrent_scan__gqa_block_cached__glu_gated_reglu__prompt_kernel_aloop
recurrent_scan__gqa_block_cached__glu_gated_reglu__prompt_kernel_adone:
s_lshl_b32 s90, s85, 5
s_add_u32 s90, s90, 4
v_mov_b32 v12, s90
buffer_load_dword v13, v12, s[72:75], 0 offen sc1
s_waitcnt lgkmcnt(0)
s_nop 7
v_rcp_f32 v216, v104
v_rcp_f32 v217, v108
v_rcp_f32 v218, v112
v_rcp_f32 v219, v116
v_add_u32 v220, 0, v18
v_add_u32 v221, 0x20000, v18
v_add_u32 v222, 0x40000, v18
v_add_u32 v223, 0x60000, v18
v_mov_b32 v22, v216
v_mov_b32 v23, v216
v_accvgpr_read_b32 v152, a0
v_accvgpr_read_b32 v153, a1
v_accvgpr_read_b32 v154, a2
v_accvgpr_read_b32 v155, a3
v_accvgpr_read_b32 v156, a4
v_accvgpr_read_b32 v157, a5
v_accvgpr_read_b32 v158, a6
v_accvgpr_read_b32 v159, a7
v_pk_mul_f32 v[152:153], v[152:153], v[22:23]
v_pk_mul_f32 v[154:155], v[154:155], v[22:23]
v_pk_mul_f32 v[156:157], v[156:157], v[22:23]
v_pk_mul_f32 v[158:159], v[158:159], v[22:23]
v_cvt_pk_bf16_f32 v160, v152, v153
v_cvt_pk_bf16_f32 v161, v154, v155
v_cvt_pk_bf16_f32 v162, v156, v157
v_cvt_pk_bf16_f32 v163, v158, v159
buffer_store_dwordx4 v[160:163], v220, s[40:43], s54 offen sc1
v_accvgpr_read_b32 v168, a8
v_accvgpr_read_b32 v169, a9
v_accvgpr_read_b32 v170, a10
v_accvgpr_read_b32 v171, a11
v_accvgpr_read_b32 v172, a12
v_accvgpr_read_b32 v173, a13
v_accvgpr_read_b32 v174, a14
v_accvgpr_read_b32 v175, a15
v_pk_mul_f32 v[168:169], v[168:169], v[22:23]
v_pk_mul_f32 v[170:171], v[170:171], v[22:23]
v_pk_mul_f32 v[172:173], v[172:173], v[22:23]
v_pk_mul_f32 v[174:175], v[174:175], v[22:23]
v_cvt_pk_bf16_f32 v176, v168, v169
v_cvt_pk_bf16_f32 v177, v170, v171
v_cvt_pk_bf16_f32 v178, v172, v173
v_cvt_pk_bf16_f32 v179, v174, v175
buffer_store_dwordx4 v[176:179], v221, s[40:43], s54 offen sc1
v_accvgpr_read_b32 v184, a16
v_accvgpr_read_b32 v185, a17
v_accvgpr_read_b32 v186, a18
v_accvgpr_read_b32 v187, a19
v_accvgpr_read_b32 v188, a20
v_accvgpr_read_b32 v189, a21
v_accvgpr_read_b32 v190, a22
v_accvgpr_read_b32 v191, a23
v_pk_mul_f32 v[184:185], v[184:185], v[22:23]
v_pk_mul_f32 v[186:187], v[186:187], v[22:23]
v_pk_mul_f32 v[188:189], v[188:189], v[22:23]
v_pk_mul_f32 v[190:191], v[190:191], v[22:23]
v_cvt_pk_bf16_f32 v192, v184, v185
v_cvt_pk_bf16_f32 v193, v186, v187
v_cvt_pk_bf16_f32 v194, v188, v189
v_cvt_pk_bf16_f32 v195, v190, v191
buffer_store_dwordx4 v[192:195], v222, s[40:43], s54 offen sc1
v_accvgpr_read_b32 v200, a24
v_accvgpr_read_b32 v201, a25
v_accvgpr_read_b32 v202, a26
v_accvgpr_read_b32 v203, a27
v_accvgpr_read_b32 v204, a28
v_accvgpr_read_b32 v205, a29
v_accvgpr_read_b32 v206, a30
v_accvgpr_read_b32 v207, a31
v_pk_mul_f32 v[200:201], v[200:201], v[22:23]
v_pk_mul_f32 v[202:203], v[202:203], v[22:23]
v_pk_mul_f32 v[204:205], v[204:205], v[22:23]
v_pk_mul_f32 v[206:207], v[206:207], v[22:23]
v_cvt_pk_bf16_f32 v208, v200, v201
v_cvt_pk_bf16_f32 v209, v202, v203
v_cvt_pk_bf16_f32 v210, v204, v205
v_cvt_pk_bf16_f32 v211, v206, v207
buffer_store_dwordx4 v[208:211], v223, s[40:43], s54 offen sc1
v_mov_b32 v22, v217
v_mov_b32 v23, v217
v_accvgpr_read_b32 v152, a32
v_accvgpr_read_b32 v153, a33
v_accvgpr_read_b32 v154, a34
v_accvgpr_read_b32 v155, a35
v_accvgpr_read_b32 v156, a36
v_accvgpr_read_b32 v157, a37
v_accvgpr_read_b32 v158, a38
v_accvgpr_read_b32 v159, a39
v_pk_mul_f32 v[152:153], v[152:153], v[22:23]
v_pk_mul_f32 v[154:155], v[154:155], v[22:23]
v_pk_mul_f32 v[156:157], v[156:157], v[22:23]
v_pk_mul_f32 v[158:159], v[158:159], v[22:23]
v_cvt_pk_bf16_f32 v160, v152, v153
v_cvt_pk_bf16_f32 v161, v154, v155
v_cvt_pk_bf16_f32 v162, v156, v157
v_cvt_pk_bf16_f32 v163, v158, v159
buffer_store_dwordx4 v[160:163], v220, s[40:43], s54 offen offset:1024 sc1
v_accvgpr_read_b32 v168, a40
v_accvgpr_read_b32 v169, a41
v_accvgpr_read_b32 v170, a42
v_accvgpr_read_b32 v171, a43
v_accvgpr_read_b32 v172, a44
v_accvgpr_read_b32 v173, a45
v_accvgpr_read_b32 v174, a46
v_accvgpr_read_b32 v175, a47
v_pk_mul_f32 v[168:169], v[168:169], v[22:23]
v_pk_mul_f32 v[170:171], v[170:171], v[22:23]
v_pk_mul_f32 v[172:173], v[172:173], v[22:23]
v_pk_mul_f32 v[174:175], v[174:175], v[22:23]
v_cvt_pk_bf16_f32 v176, v168, v169
v_cvt_pk_bf16_f32 v177, v170, v171
v_cvt_pk_bf16_f32 v178, v172, v173
v_cvt_pk_bf16_f32 v179, v174, v175
buffer_store_dwordx4 v[176:179], v221, s[40:43], s54 offen offset:1024 sc1
v_accvgpr_read_b32 v184, a48
v_accvgpr_read_b32 v185, a49
v_accvgpr_read_b32 v186, a50
v_accvgpr_read_b32 v187, a51
v_accvgpr_read_b32 v188, a52
v_accvgpr_read_b32 v189, a53
v_accvgpr_read_b32 v190, a54
v_accvgpr_read_b32 v191, a55
v_pk_mul_f32 v[184:185], v[184:185], v[22:23]
v_pk_mul_f32 v[186:187], v[186:187], v[22:23]
v_pk_mul_f32 v[188:189], v[188:189], v[22:23]
v_pk_mul_f32 v[190:191], v[190:191], v[22:23]
v_cvt_pk_bf16_f32 v192, v184, v185
v_cvt_pk_bf16_f32 v193, v186, v187
v_cvt_pk_bf16_f32 v194, v188, v189
v_cvt_pk_bf16_f32 v195, v190, v191
buffer_store_dwordx4 v[192:195], v222, s[40:43], s54 offen offset:1024 sc1
v_accvgpr_read_b32 v200, a56
v_accvgpr_read_b32 v201, a57
v_accvgpr_read_b32 v202, a58
v_accvgpr_read_b32 v203, a59
v_accvgpr_read_b32 v204, a60
v_accvgpr_read_b32 v205, a61
v_accvgpr_read_b32 v206, a62
v_accvgpr_read_b32 v207, a63
v_pk_mul_f32 v[200:201], v[200:201], v[22:23]
v_pk_mul_f32 v[202:203], v[202:203], v[22:23]
v_pk_mul_f32 v[204:205], v[204:205], v[22:23]
v_pk_mul_f32 v[206:207], v[206:207], v[22:23]
v_cvt_pk_bf16_f32 v208, v200, v201
v_cvt_pk_bf16_f32 v209, v202, v203
v_cvt_pk_bf16_f32 v210, v204, v205
v_cvt_pk_bf16_f32 v211, v206, v207
buffer_store_dwordx4 v[208:211], v223, s[40:43], s54 offen offset:1024 sc1
v_mov_b32 v22, v218
v_mov_b32 v23, v218
v_accvgpr_read_b32 v152, a64
v_accvgpr_read_b32 v153, a65
v_accvgpr_read_b32 v154, a66
v_accvgpr_read_b32 v155, a67
v_accvgpr_read_b32 v156, a68
v_accvgpr_read_b32 v157, a69
v_accvgpr_read_b32 v158, a70
v_accvgpr_read_b32 v159, a71
v_pk_mul_f32 v[152:153], v[152:153], v[22:23]
v_pk_mul_f32 v[154:155], v[154:155], v[22:23]
v_pk_mul_f32 v[156:157], v[156:157], v[22:23]
v_pk_mul_f32 v[158:159], v[158:159], v[22:23]
v_cvt_pk_bf16_f32 v160, v152, v153
v_cvt_pk_bf16_f32 v161, v154, v155
v_cvt_pk_bf16_f32 v162, v156, v157
v_cvt_pk_bf16_f32 v163, v158, v159
buffer_store_dwordx4 v[160:163], v220, s[40:43], s54 offen offset:2048 sc1
v_accvgpr_read_b32 v168, a72
v_accvgpr_read_b32 v169, a73
v_accvgpr_read_b32 v170, a74
v_accvgpr_read_b32 v171, a75
v_accvgpr_read_b32 v172, a76
v_accvgpr_read_b32 v173, a77
v_accvgpr_read_b32 v174, a78
v_accvgpr_read_b32 v175, a79
v_pk_mul_f32 v[168:169], v[168:169], v[22:23]
v_pk_mul_f32 v[170:171], v[170:171], v[22:23]
v_pk_mul_f32 v[172:173], v[172:173], v[22:23]
v_pk_mul_f32 v[174:175], v[174:175], v[22:23]
v_cvt_pk_bf16_f32 v176, v168, v169
v_cvt_pk_bf16_f32 v177, v170, v171
v_cvt_pk_bf16_f32 v178, v172, v173
v_cvt_pk_bf16_f32 v179, v174, v175
buffer_store_dwordx4 v[176:179], v221, s[40:43], s54 offen offset:2048 sc1
v_accvgpr_read_b32 v184, a80
v_accvgpr_read_b32 v185, a81
v_accvgpr_read_b32 v186, a82
v_accvgpr_read_b32 v187, a83
v_accvgpr_read_b32 v188, a84
v_accvgpr_read_b32 v189, a85
v_accvgpr_read_b32 v190, a86
v_accvgpr_read_b32 v191, a87
v_pk_mul_f32 v[184:185], v[184:185], v[22:23]
v_pk_mul_f32 v[186:187], v[186:187], v[22:23]
v_pk_mul_f32 v[188:189], v[188:189], v[22:23]
v_pk_mul_f32 v[190:191], v[190:191], v[22:23]
v_cvt_pk_bf16_f32 v192, v184, v185
v_cvt_pk_bf16_f32 v193, v186, v187
v_cvt_pk_bf16_f32 v194, v188, v189
v_cvt_pk_bf16_f32 v195, v190, v191
buffer_store_dwordx4 v[192:195], v222, s[40:43], s54 offen offset:2048 sc1
v_accvgpr_read_b32 v200, a88
v_accvgpr_read_b32 v201, a89
v_accvgpr_read_b32 v202, a90
v_accvgpr_read_b32 v203, a91
v_accvgpr_read_b32 v204, a92
v_accvgpr_read_b32 v205, a93
v_accvgpr_read_b32 v206, a94
v_accvgpr_read_b32 v207, a95
v_pk_mul_f32 v[200:201], v[200:201], v[22:23]
v_pk_mul_f32 v[202:203], v[202:203], v[22:23]
v_pk_mul_f32 v[204:205], v[204:205], v[22:23]
v_pk_mul_f32 v[206:207], v[206:207], v[22:23]
v_cvt_pk_bf16_f32 v208, v200, v201
v_cvt_pk_bf16_f32 v209, v202, v203
v_cvt_pk_bf16_f32 v210, v204, v205
v_cvt_pk_bf16_f32 v211, v206, v207
buffer_store_dwordx4 v[208:211], v223, s[40:43], s54 offen offset:2048 sc1
v_mov_b32 v22, v219
v_mov_b32 v23, v219
v_accvgpr_read_b32 v152, a96
v_accvgpr_read_b32 v153, a97
v_accvgpr_read_b32 v154, a98
v_accvgpr_read_b32 v155, a99
v_accvgpr_read_b32 v156, a100
v_accvgpr_read_b32 v157, a101
v_accvgpr_read_b32 v158, a102
v_accvgpr_read_b32 v159, a103
v_pk_mul_f32 v[152:153], v[152:153], v[22:23]
v_pk_mul_f32 v[154:155], v[154:155], v[22:23]
v_pk_mul_f32 v[156:157], v[156:157], v[22:23]
v_pk_mul_f32 v[158:159], v[158:159], v[22:23]
v_cvt_pk_bf16_f32 v160, v152, v153
v_cvt_pk_bf16_f32 v161, v154, v155
v_cvt_pk_bf16_f32 v162, v156, v157
v_cvt_pk_bf16_f32 v163, v158, v159
buffer_store_dwordx4 v[160:163], v220, s[40:43], s54 offen offset:3072 sc1
v_accvgpr_read_b32 v168, a104
v_accvgpr_read_b32 v169, a105
v_accvgpr_read_b32 v170, a106
v_accvgpr_read_b32 v171, a107
v_accvgpr_read_b32 v172, a108
v_accvgpr_read_b32 v173, a109
v_accvgpr_read_b32 v174, a110
v_accvgpr_read_b32 v175, a111
v_pk_mul_f32 v[168:169], v[168:169], v[22:23]
v_pk_mul_f32 v[170:171], v[170:171], v[22:23]
v_pk_mul_f32 v[172:173], v[172:173], v[22:23]
v_pk_mul_f32 v[174:175], v[174:175], v[22:23]
v_cvt_pk_bf16_f32 v176, v168, v169
v_cvt_pk_bf16_f32 v177, v170, v171
v_cvt_pk_bf16_f32 v178, v172, v173
v_cvt_pk_bf16_f32 v179, v174, v175
buffer_store_dwordx4 v[176:179], v221, s[40:43], s54 offen offset:3072 sc1
v_accvgpr_read_b32 v184, a112
v_accvgpr_read_b32 v185, a113
v_accvgpr_read_b32 v186, a114
v_accvgpr_read_b32 v187, a115
v_accvgpr_read_b32 v188, a116
v_accvgpr_read_b32 v189, a117
v_accvgpr_read_b32 v190, a118
v_accvgpr_read_b32 v191, a119
v_pk_mul_f32 v[184:185], v[184:185], v[22:23]
v_pk_mul_f32 v[186:187], v[186:187], v[22:23]
v_pk_mul_f32 v[188:189], v[188:189], v[22:23]
v_pk_mul_f32 v[190:191], v[190:191], v[22:23]
v_cvt_pk_bf16_f32 v192, v184, v185
v_cvt_pk_bf16_f32 v193, v186, v187
v_cvt_pk_bf16_f32 v194, v188, v189
v_cvt_pk_bf16_f32 v195, v190, v191
buffer_store_dwordx4 v[192:195], v222, s[40:43], s54 offen offset:3072 sc1
v_accvgpr_read_b32 v200, a120
v_accvgpr_read_b32 v201, a121
v_accvgpr_read_b32 v202, a122
v_accvgpr_read_b32 v203, a123
v_accvgpr_read_b32 v204, a124
v_accvgpr_read_b32 v205, a125
v_accvgpr_read_b32 v206, a126
v_accvgpr_read_b32 v207, a127
v_pk_mul_f32 v[200:201], v[200:201], v[22:23]
v_pk_mul_f32 v[202:203], v[202:203], v[22:23]
v_pk_mul_f32 v[204:205], v[204:205], v[22:23]
v_pk_mul_f32 v[206:207], v[206:207], v[22:23]
v_cvt_pk_bf16_f32 v208, v200, v201
v_cvt_pk_bf16_f32 v209, v202, v203
v_cvt_pk_bf16_f32 v210, v204, v205
v_cvt_pk_bf16_f32 v211, v206, v207
buffer_store_dwordx4 v[208:211], v223, s[40:43], s54 offen offset:3072 sc1
s_mov_b32 s55, 0x4f800000
v_mov_b32 v11, 0
v_cmp_nlt_f32 vcc, v104, s55
s_nop 1
v_cndmask_b32_e64 v11, v11, 1, vcc
v_cmp_nlt_f32 vcc, v108, s55
s_nop 1
v_cndmask_b32_e64 v11, v11, 1, vcc
v_cmp_nlt_f32 vcc, v112, s55
s_nop 1
v_cndmask_b32_e64 v11, v11, 1, vcc
v_cmp_nlt_f32 vcc, v116, s55
s_nop 1
v_cndmask_b32_e64 v11, v11, 1, vcc
ds_or_b32 v10, v11
s_waitcnt vmcnt(17) lgkmcnt(0)
s_barrier
ds_read_b32 v11, v10
s_waitcnt lgkmcnt(0)
v_readfirstlane_b32 s55, v11
s_nop 3
s_xor_b32 s56, s58, 1
s_and_b32 s55, s55, s56
s_cmp_lg_u32 s55, 0
s_cbranch_scc1 recurrent_scan__gqa_block_cached__glu_gated_reglu__prompt_kernel_afall
s_cmp_ge_u32 s84, 4
s_cbranch_scc1 recurrent_scan__gqa_block_cached__glu_gated_reglu__prompt_kernel_g2g
s_add_u32 s20, s14, 0x1440000
s_addc_u32 s21, s15, 0
s_mov_b32 s22, 0x1000000
s_mov_b32 s23, 0x20000
s_mul_i32 s88, s84, 0x400000
s_mov_b32 s47, s88
s_mul_i32 s87, s44, 0x9000
s_mul_i32 s55, s86, 0x120
s_add_u32 s87, s87, s55
s_lshl_b32 s55, s85, 4
s_lshl_b32 s56, s44, 2
s_add_u32 s55, s55, s56
s_lshl_b32 s55, s55, 10
s_add_u32 s88, s88, s55
v_add_u32 v212, 0, v18
v_add_u32 v213, 0x20000, v18
v_add_u32 v214, 0x40000, v18
v_add_u32 v215, 0x60000, v18
s_add_u32 s32, s14, 0x2440000
s_addc_u32 s33, s15, 0
s_mov_b32 s34, 0x1200000
s_mov_b32 s35, 0x20000
s_lshl_b32 s55, s84, 5
s_lshl_b32 s56, s85, 2
s_add_u32 s55, s55, s56
s_add_u32 s55, s55, s44
s_lshl_b32 s55, s55, 2
s_add_u32 s55, s55, s86
s_mul_i32 s89, s55, 0x4800
v_lshrrev_b32 v19, 2, v1
v_mul_u32_u24 v208, 0x120, v19
v_and_b32 v20, 3, v1
v_lshl_add_u32 v208, v20, 3, v208
v_add_u32 v209, 0x9000, v208
v_add_u32 v210, 0x12000, v208
v_add_u32 v211, 0x1b000, v208
s_waitcnt vmcnt(0)
s_barrier
s_lshr_b32 s55, s45, 3
s_lshl_b32 s55, s55, 3
s_lshl_b32 s56, 1, s55
s_cmp_lg_u32 s44, 0
s_cbranch_scc1 recurrent_scan__gqa_block_cached__glu_gated_reglu__prompt_kernel_sig14
s_lshl_b32 s90, s46, 3
s_add_u32 s90, s90, 2
s_lshl_b32 s90, s90, 2
v_mov_b32 v12, s90
v_mov_b32 v13, s56
s_mov_b64 exec, 1
buffer_atomic_add v13, v12, s[72:75], 0 offen sc1
s_mov_b64 exec, -1
recurrent_scan__gqa_block_cached__glu_gated_reglu__prompt_kernel_sig14:
s_add_u32 m0, s51, 0
s_nop 0
buffer_load_dwordx4 v242, s[16:19], s87 offen lds
s_add_u32 m0, s51, 0x400
s_nop 0
buffer_load_dwordx4 v243, s[16:19], s87 offen lds
s_add_u32 m0, s51, 0x800
s_nop 0
buffer_load_dwordx4 v244, s[16:19], s87 offen lds
s_add_u32 m0, s51, 0xc00
s_nop 0
buffer_load_dwordx4 v245, s[16:19], s87 offen lds
s_add_u32 m0, s51, 0x1000
s_nop 0
buffer_load_dwordx4 v246, s[16:19], s87 offen lds
s_add_u32 m0, s51, 0x1400
s_nop 0
buffer_load_dwordx4 v247, s[16:19], s87 offen lds
s_add_u32 m0, s51, 0x1800
s_nop 0
buffer_load_dwordx4 v248, s[16:19], s87 offen lds
s_add_u32 m0, s51, 0x1c00
s_nop 0
buffer_load_dwordx4 v249, s[16:19], s87 offen lds
s_add_u32 m0, s51, 0x2000
s_nop 0
buffer_load_dwordx4 v250, s[16:19], s87 offen lds
s_add_u32 s87, s87, 0x24000
s_add_u32 m0, s51, 0x9000
s_nop 0
buffer_load_dwordx4 v242, s[16:19], s87 offen lds
s_add_u32 m0, s51, 0x9400
s_nop 0
buffer_load_dwordx4 v243, s[16:19], s87 offen lds
s_add_u32 m0, s51, 0x9800
s_nop 0
buffer_load_dwordx4 v244, s[16:19], s87 offen lds
s_add_u32 m0, s51, 0x9c00
s_nop 0
buffer_load_dwordx4 v245, s[16:19], s87 offen lds
s_add_u32 m0, s51, 0xa000
s_nop 0
buffer_load_dwordx4 v246, s[16:19], s87 offen lds
s_add_u32 m0, s51, 0xa400
s_nop 0
buffer_load_dwordx4 v247, s[16:19], s87 offen lds
s_add_u32 m0, s51, 0xa800
s_nop 0
buffer_load_dwordx4 v248, s[16:19], s87 offen lds
s_add_u32 m0, s51, 0xac00
s_nop 0
buffer_load_dwordx4 v249, s[16:19], s87 offen lds
s_add_u32 m0, s51, 0xb000
s_nop 0
buffer_load_dwordx4 v250, s[16:19], s87 offen lds
s_add_u32 s87, s87, 0x24000
s_lshl_b32 s56, s84, 3
s_cmp_lg_u32 s44, 0
s_cbranch_scc1 recurrent_scan__gqa_block_cached__glu_gated_reglu__prompt_kernel_got17
s_lshl_b32 s90, s85, 3
s_add_u32 s90, s90, 2
s_lshl_b32 s90, s90, 2
v_mov_b32 v12, s90
s_mov_b32 s90, 262144
recurrent_scan__gqa_block_cached__glu_gated_reglu__prompt_kernel_poll15:
buffer_load_dword v13, v12, s[72:75], 0 offen sc1
s_waitcnt vmcnt(0)
recurrent_scan__gqa_block_cached__glu_gated_reglu__prompt_kernel_pchk16:
v_readfirstlane_b32 s55, v13
s_nop 3
s_lshr_b32 s55, s55, s56
s_and_b32 s55, s55, 0xff
s_cmp_ge_u32 s55, 8
s_cbranch_scc1 recurrent_scan__gqa_block_cached__glu_gated_reglu__prompt_kernel_got17
s_sleep 1
s_sub_u32 s90, s90, 1
s_cmp_lg_u32 s90, 0
s_cbranch_scc1 recurrent_scan__gqa_block_cached__glu_gated_reglu__prompt_kernel_poll15
recurrent_scan__gqa_block_cached__glu_gated_reglu__prompt_kernel_got17:
s_barrier
buffer_load_dwordx4 a[128:131], v212, s[20:23], s88 offen sc1
buffer_load_dwordx4 a[144:147], v212, s[20:23], s88 offen offset:1024 sc1
buffer_load_dwordx4 a[160:163], v212, s[20:23], s88 offen offset:2048 sc1
buffer_load_dwordx4 a[176:179], v212, s[20:23], s88 offen offset:3072 sc1
buffer_load_dwordx4 a[132:135], v213, s[20:23], s88 offen sc1
buffer_load_dwordx4 a[148:151], v213, s[20:23], s88 offen offset:1024 sc1
buffer_load_dwordx4 a[164:167], v213, s[20:23], s88 offen offset:2048 sc1
buffer_load_dwordx4 a[180:183], v213, s[20:23], s88 offen offset:3072 sc1
buffer_load_dwordx4 a[136:139], v214, s[20:23], s88 offen sc1
buffer_load_dwordx4 a[152:155], v214, s[20:23], s88 offen offset:1024 sc1
buffer_load_dwordx4 a[168:171], v214, s[20:23], s88 offen offset:2048 sc1
buffer_load_dwordx4 a[184:187], v214, s[20:23], s88 offen offset:3072 sc1
buffer_load_dwordx4 a[140:143], v215, s[20:23], s88 offen sc1
buffer_load_dwordx4 a[156:159], v215, s[20:23], s88 offen offset:1024 sc1
buffer_load_dwordx4 a[172:175], v215, s[20:23], s88 offen offset:2048 sc1
buffer_load_dwordx4 a[188:191], v215, s[20:23], s88 offen offset:3072 sc1
s_add_u32 s88, s88, 0x80000
buffer_load_dwordx4 a[192:195], v212, s[20:23], s88 offen sc1
buffer_load_dwordx4 a[208:211], v212, s[20:23], s88 offen offset:1024 sc1
buffer_load_dwordx4 a[224:227], v212, s[20:23], s88 offen offset:2048 sc1
buffer_load_dwordx4 a[240:243], v212, s[20:23], s88 offen offset:3072 sc1
buffer_load_dwordx4 a[196:199], v213, s[20:23], s88 offen sc1
buffer_load_dwordx4 a[212:215], v213, s[20:23], s88 offen offset:1024 sc1
buffer_load_dwordx4 a[228:231], v213, s[20:23], s88 offen offset:2048 sc1
buffer_load_dwordx4 a[244:247], v213, s[20:23], s88 offen offset:3072 sc1
buffer_load_dwordx4 a[200:203], v214, s[20:23], s88 offen sc1
buffer_load_dwordx4 a[216:219], v214, s[20:23], s88 offen offset:1024 sc1
buffer_load_dwordx4 a[232:235], v214, s[20:23], s88 offen offset:2048 sc1
buffer_load_dwordx4 a[248:251], v214, s[20:23], s88 offen offset:3072 sc1
buffer_load_dwordx4 a[204:207], v215, s[20:23], s88 offen sc1
buffer_load_dwordx4 a[220:223], v215, s[20:23], s88 offen offset:1024 sc1
buffer_load_dwordx4 a[236:239], v215, s[20:23], s88 offen offset:2048 sc1
buffer_load_dwordx4 a[252:255], v215, s[20:23], s88 offen offset:3072 sc1
s_add_u32 s88, s88, 0x80000
s_waitcnt vmcnt(16)
s_barrier
ds_read_b64_tr_b16 v[176:177], v208
ds_read_b64_tr_b16 v[178:179], v208 offset:4608
ds_read_b64_tr_b16 v[180:181], v208 offset:9216
ds_read_b64_tr_b16 v[182:183], v208 offset:13824
ds_read_b64_tr_b16 v[184:185], v208 offset:18432
ds_read_b64_tr_b16 v[186:187], v208 offset:23040
ds_read_b64_tr_b16 v[188:189], v208 offset:27648
ds_read_b64_tr_b16 v[190:191], v208 offset:32256
s_waitcnt lgkmcnt(0)
v_mfma_f32_16x16x32_bf16 v[32:35], v[176:179], a[128:131], 0
ds_read_b64_tr_b16 v[192:193], v208 offset:32
ds_read_b64_tr_b16 v[194:195], v208 offset:4640
v_mfma_f32_16x16x32_bf16 v[32:35], v[180:183], a[132:135], v[32:35]
ds_read_b64_tr_b16 v[196:197], v208 offset:9248
ds_read_b64_tr_b16 v[198:199], v208 offset:13856
v_mfma_f32_16x16x32_bf16 v[32:35], v[184:187], a[136:139], v[32:35]
ds_read_b64_tr_b16 v[200:201], v208 offset:18464
ds_read_b64_tr_b16 v[202:203], v208 offset:23072
v_mfma_f32_16x16x32_bf16 v[32:35], v[188:191], a[140:143], v[32:35]
ds_read_b64_tr_b16 v[204:205], v208 offset:27680
ds_read_b64_tr_b16 v[206:207], v208 offset:32288
v_mfma_f32_16x16x32_bf16 v[36:39], v[176:179], a[144:147], 0
s_waitcnt vmcnt(40)
s_add_u32 m0, s51, 0x12000
v_mfma_f32_16x16x32_bf16 v[36:39], v[180:183], a[148:151], v[36:39]
buffer_load_dwordx4 v242, s[16:19], s87 offen lds
v_mfma_f32_16x16x32_bf16 v[36:39], v[184:187], a[152:155], v[36:39]
v_mfma_f32_16x16x32_bf16 v[36:39], v[188:191], a[156:159], v[36:39]
s_add_u32 m0, s51, 0x12400
v_mfma_f32_16x16x32_bf16 v[40:43], v[176:179], a[160:163], 0
buffer_load_dwordx4 v243, s[16:19], s87 offen lds
v_mfma_f32_16x16x32_bf16 v[40:43], v[180:183], a[164:167], v[40:43]
v_mfma_f32_16x16x32_bf16 v[40:43], v[184:187], a[168:171], v[40:43]
s_add_u32 m0, s51, 0x12800
v_mfma_f32_16x16x32_bf16 v[40:43], v[188:191], a[172:175], v[40:43]
buffer_load_dwordx4 v244, s[16:19], s87 offen lds
v_mfma_f32_16x16x32_bf16 v[44:47], v[176:179], a[176:179], 0
v_mfma_f32_16x16x32_bf16 v[44:47], v[180:183], a[180:183], v[44:47]
s_add_u32 m0, s51, 0x12c00
v_mfma_f32_16x16x32_bf16 v[44:47], v[184:187], a[184:187], v[44:47]
buffer_load_dwordx4 v245, s[16:19], s87 offen lds
v_mfma_f32_16x16x32_bf16 v[44:47], v[188:191], a[188:191], v[44:47]
s_waitcnt lgkmcnt(0)
v_mfma_f32_16x16x32_bf16 v[48:51], v[192:195], a[128:131], 0
ds_read_b64_tr_b16 v[176:177], v208 offset:64
ds_read_b64_tr_b16 v[178:179], v208 offset:4672
v_mfma_f32_16x16x32_bf16 v[48:51], v[196:199], a[132:135], v[48:51]
ds_read_b64_tr_b16 v[180:181], v208 offset:9280
ds_read_b64_tr_b16 v[182:183], v208 offset:13888
v_mfma_f32_16x16x32_bf16 v[48:51], v[200:203], a[136:139], v[48:51]
ds_read_b64_tr_b16 v[184:185], v208 offset:18496
ds_read_b64_tr_b16 v[186:187], v208 offset:23104
v_mfma_f32_16x16x32_bf16 v[48:51], v[204:207], a[140:143], v[48:51]
ds_read_b64_tr_b16 v[188:189], v208 offset:27712
ds_read_b64_tr_b16 v[190:191], v208 offset:32320
v_mfma_f32_16x16x32_bf16 v[52:55], v[192:195], a[144:147], 0
s_add_u32 m0, s51, 0x13000
v_mfma_f32_16x16x32_bf16 v[52:55], v[196:199], a[148:151], v[52:55]
buffer_load_dwordx4 v246, s[16:19], s87 offen lds
v_mfma_f32_16x16x32_bf16 v[52:55], v[200:203], a[152:155], v[52:55]
v_mfma_f32_16x16x32_bf16 v[52:55], v[204:207], a[156:159], v[52:55]
s_add_u32 m0, s51, 0x13400
v_mfma_f32_16x16x32_bf16 v[56:59], v[192:195], a[160:163], 0
buffer_load_dwordx4 v247, s[16:19], s87 offen lds
v_mfma_f32_16x16x32_bf16 v[56:59], v[196:199], a[164:167], v[56:59]
v_mfma_f32_16x16x32_bf16 v[56:59], v[200:203], a[168:171], v[56:59]
s_add_u32 m0, s51, 0x13800
v_mfma_f32_16x16x32_bf16 v[56:59], v[204:207], a[172:175], v[56:59]
buffer_load_dwordx4 v248, s[16:19], s87 offen lds
v_mfma_f32_16x16x32_bf16 v[60:63], v[192:195], a[176:179], 0
v_mfma_f32_16x16x32_bf16 v[60:63], v[196:199], a[180:183], v[60:63]
s_add_u32 m0, s51, 0x13c00
v_mfma_f32_16x16x32_bf16 v[60:63], v[200:203], a[184:187], v[60:63]
buffer_load_dwordx4 v249, s[16:19], s87 offen lds
v_mfma_f32_16x16x32_bf16 v[60:63], v[204:207], a[188:191], v[60:63]
s_waitcnt lgkmcnt(0)
v_mfma_f32_16x16x32_bf16 v[64:67], v[176:179], a[128:131], 0
ds_read_b64_tr_b16 v[192:193], v208 offset:96
ds_read_b64_tr_b16 v[194:195], v208 offset:4704
v_mfma_f32_16x16x32_bf16 v[64:67], v[180:183], a[132:135], v[64:67]
ds_read_b64_tr_b16 v[196:197], v208 offset:9312
ds_read_b64_tr_b16 v[198:199], v208 offset:13920
v_mfma_f32_16x16x32_bf16 v[64:67], v[184:187], a[136:139], v[64:67]
ds_read_b64_tr_b16 v[200:201], v208 offset:18528
ds_read_b64_tr_b16 v[202:203], v208 offset:23136
v_mfma_f32_16x16x32_bf16 v[64:67], v[188:191], a[140:143], v[64:67]
ds_read_b64_tr_b16 v[204:205], v208 offset:27744
ds_read_b64_tr_b16 v[206:207], v208 offset:32352
v_mfma_f32_16x16x32_bf16 v[68:71], v[176:179], a[144:147], 0
s_add_u32 m0, s51, 0x14000
v_mfma_f32_16x16x32_bf16 v[68:71], v[180:183], a[148:151], v[68:71]
buffer_load_dwordx4 v250, s[16:19], s87 offen lds
s_add_u32 s87, s87, 0x24000
v_mfma_f32_16x16x32_bf16 v[68:71], v[184:187], a[152:155], v[68:71]
v_mfma_f32_16x16x32_bf16 v[68:71], v[188:191], a[156:159], v[68:71]
v_mfma_f32_16x16x32_bf16 v[72:75], v[176:179], a[160:163], 0
buffer_load_dwordx4 a[0:3], v212, s[20:23], s88 offen sc1
v_mfma_f32_16x16x32_bf16 v[72:75], v[180:183], a[164:167], v[72:75]
v_mfma_f32_16x16x32_bf16 v[72:75], v[184:187], a[168:171], v[72:75]
v_mfma_f32_16x16x32_bf16 v[72:75], v[188:191], a[172:175], v[72:75]
buffer_load_dwordx4 a[16:19], v212, s[20:23], s88 offen offset:1024 sc1
v_mfma_f32_16x16x32_bf16 v[76:79], v[176:179], a[176:179], 0
v_mfma_f32_16x16x32_bf16 v[76:79], v[180:183], a[180:183], v[76:79]
v_mfma_f32_16x16x32_bf16 v[76:79], v[184:187], a[184:187], v[76:79]
buffer_load_dwordx4 a[32:35], v212, s[20:23], s88 offen offset:2048 sc1
v_mfma_f32_16x16x32_bf16 v[76:79], v[188:191], a[188:191], v[76:79]
s_waitcnt lgkmcnt(0)
v_mfma_f32_16x16x32_bf16 v[80:83], v[192:195], a[128:131], 0
ds_read_b64_tr_b16 v[176:177], v208 offset:128
ds_read_b64_tr_b16 v[178:179], v208 offset:4736
v_mfma_f32_16x16x32_bf16 v[80:83], v[196:199], a[132:135], v[80:83]
ds_read_b64_tr_b16 v[180:181], v208 offset:9344
ds_read_b64_tr_b16 v[182:183], v208 offset:13952
v_mfma_f32_16x16x32_bf16 v[80:83], v[200:203], a[136:139], v[80:83]
ds_read_b64_tr_b16 v[184:185], v208 offset:18560
ds_read_b64_tr_b16 v[186:187], v208 offset:23168
v_mfma_f32_16x16x32_bf16 v[80:83], v[204:207], a[140:143], v[80:83]
ds_read_b64_tr_b16 v[188:189], v208 offset:27776
ds_read_b64_tr_b16 v[190:191], v208 offset:32384
v_mfma_f32_16x16x32_bf16 v[84:87], v[192:195], a[144:147], 0
v_mfma_f32_16x16x32_bf16 v[84:87], v[196:199], a[148:151], v[84:87]
buffer_load_dwordx4 a[48:51], v212, s[20:23], s88 offen offset:3072 sc1
v_mfma_f32_16x16x32_bf16 v[84:87], v[200:203], a[152:155], v[84:87]
v_mfma_f32_16x16x32_bf16 v[84:87], v[204:207], a[156:159], v[84:87]
v_mfma_f32_16x16x32_bf16 v[88:91], v[192:195], a[160:163], 0
buffer_load_dwordx4 a[4:7], v213, s[20:23], s88 offen sc1
v_mfma_f32_16x16x32_bf16 v[88:91], v[196:199], a[164:167], v[88:91]
v_mfma_f32_16x16x32_bf16 v[88:91], v[200:203], a[168:171], v[88:91]
v_mfma_f32_16x16x32_bf16 v[88:91], v[204:207], a[172:175], v[88:91]
buffer_load_dwordx4 a[20:23], v213, s[20:23], s88 offen offset:1024 sc1
v_mfma_f32_16x16x32_bf16 v[92:95], v[192:195], a[176:179], 0
v_mfma_f32_16x16x32_bf16 v[92:95], v[196:199], a[180:183], v[92:95]
v_mfma_f32_16x16x32_bf16 v[92:95], v[200:203], a[184:187], v[92:95]
buffer_load_dwordx4 a[36:39], v213, s[20:23], s88 offen offset:2048 sc1
v_mfma_f32_16x16x32_bf16 v[92:95], v[204:207], a[188:191], v[92:95]
s_waitcnt lgkmcnt(0)
v_mfma_f32_16x16x32_bf16 v[96:99], v[176:179], a[128:131], 0
ds_read_b64_tr_b16 v[192:193], v208 offset:160
ds_read_b64_tr_b16 v[194:195], v208 offset:4768
v_mfma_f32_16x16x32_bf16 v[96:99], v[180:183], a[132:135], v[96:99]
ds_read_b64_tr_b16 v[196:197], v208 offset:9376
ds_read_b64_tr_b16 v[198:199], v208 offset:13984
v_mfma_f32_16x16x32_bf16 v[96:99], v[184:187], a[136:139], v[96:99]
ds_read_b64_tr_b16 v[200:201], v208 offset:18592
ds_read_b64_tr_b16 v[202:203], v208 offset:23200
v_mfma_f32_16x16x32_bf16 v[96:99], v[188:191], a[140:143], v[96:99]
ds_read_b64_tr_b16 v[204:205], v208 offset:27808
ds_read_b64_tr_b16 v[206:207], v208 offset:32416
v_mfma_f32_16x16x32_bf16 v[100:103], v[176:179], a[144:147], 0
s_waitcnt vmcnt(40)
v_mfma_f32_16x16x32_bf16 v[100:103], v[180:183], a[148:151], v[100:103]
buffer_load_dwordx4 a[52:55], v213, s[20:23], s88 offen offset:3072 sc1
v_mfma_f32_16x16x32_bf16 v[100:103], v[184:187], a[152:155], v[100:103]
v_mfma_f32_16x16x32_bf16 v[100:103], v[188:191], a[156:159], v[100:103]
v_mfma_f32_16x16x32_bf16 v[104:107], v[176:179], a[160:163], 0
buffer_load_dwordx4 a[8:11], v214, s[20:23], s88 offen sc1
v_mfma_f32_16x16x32_bf16 v[104:107], v[180:183], a[164:167], v[104:107]
v_mfma_f32_16x16x32_bf16 v[104:107], v[184:187], a[168:171], v[104:107]
v_mfma_f32_16x16x32_bf16 v[104:107], v[188:191], a[172:175], v[104:107]
buffer_load_dwordx4 a[24:27], v214, s[20:23], s88 offen offset:1024 sc1
v_mfma_f32_16x16x32_bf16 v[108:111], v[176:179], a[176:179], 0
v_mfma_f32_16x16x32_bf16 v[108:111], v[180:183], a[180:183], v[108:111]
v_mfma_f32_16x16x32_bf16 v[108:111], v[184:187], a[184:187], v[108:111]
buffer_load_dwordx4 a[40:43], v214, s[20:23], s88 offen offset:2048 sc1
v_mfma_f32_16x16x32_bf16 v[108:111], v[188:191], a[188:191], v[108:111]
s_waitcnt lgkmcnt(0)
v_mfma_f32_16x16x32_bf16 v[112:115], v[192:195], a[128:131], 0
ds_read_b64_tr_b16 v[176:177], v208 offset:192
ds_read_b64_tr_b16 v[178:179], v208 offset:4800
v_mfma_f32_16x16x32_bf16 v[112:115], v[196:199], a[132:135], v[112:115]
ds_read_b64_tr_b16 v[180:181], v208 offset:9408
ds_read_b64_tr_b16 v[182:183], v208 offset:14016
v_mfma_f32_16x16x32_bf16 v[112:115], v[200:203], a[136:139], v[112:115]
ds_read_b64_tr_b16 v[184:185], v208 offset:18624
ds_read_b64_tr_b16 v[186:187], v208 offset:23232
v_mfma_f32_16x16x32_bf16 v[112:115], v[204:207], a[140:143], v[112:115]
ds_read_b64_tr_b16 v[188:189], v208 offset:27840
ds_read_b64_tr_b16 v[190:191], v208 offset:32448
v_mfma_f32_16x16x32_bf16 v[116:119], v[192:195], a[144:147], 0
v_mfma_f32_16x16x32_bf16 v[116:119], v[196:199], a[148:151], v[116:119]
buffer_load_dwordx4 a[56:59], v214, s[20:23], s88 offen offset:3072 sc1
v_mfma_f32_16x16x32_bf16 v[116:119], v[200:203], a[152:155], v[116:119]
v_mfma_f32_16x16x32_bf16 v[116:119], v[204:207], a[156:159], v[116:119]
v_mfma_f32_16x16x32_bf16 v[120:123], v[192:195], a[160:163], 0
buffer_load_dwordx4 a[12:15], v215, s[20:23], s88 offen sc1
v_mfma_f32_16x16x32_bf16 v[120:123], v[196:199], a[164:167], v[120:123]
v_mfma_f32_16x16x32_bf16 v[120:123], v[200:203], a[168:171], v[120:123]
v_mfma_f32_16x16x32_bf16 v[120:123], v[204:207], a[172:175], v[120:123]
buffer_load_dwordx4 a[28:31], v215, s[20:23], s88 offen offset:1024 sc1
v_mfma_f32_16x16x32_bf16 v[124:127], v[192:195], a[176:179], 0
v_mfma_f32_16x16x32_bf16 v[124:127], v[196:199], a[180:183], v[124:127]
v_mfma_f32_16x16x32_bf16 v[124:127], v[200:203], a[184:187], v[124:127]
buffer_load_dwordx4 a[44:47], v215, s[20:23], s88 offen offset:2048 sc1
v_mfma_f32_16x16x32_bf16 v[124:127], v[204:207], a[188:191], v[124:127]
s_waitcnt lgkmcnt(0)
v_mfma_f32_16x16x32_bf16 v[128:131], v[176:179], a[128:131], 0
ds_read_b64_tr_b16 v[192:193], v208 offset:224
ds_read_b64_tr_b16 v[194:195], v208 offset:4832
v_mfma_f32_16x16x32_bf16 v[128:131], v[180:183], a[132:135], v[128:131]
ds_read_b64_tr_b16 v[196:197], v208 offset:9440
ds_read_b64_tr_b16 v[198:199], v208 offset:14048
v_mfma_f32_16x16x32_bf16 v[128:131], v[184:187], a[136:139], v[128:131]
ds_read_b64_tr_b16 v[200:201], v208 offset:18656
ds_read_b64_tr_b16 v[202:203], v208 offset:23264
v_mfma_f32_16x16x32_bf16 v[128:131], v[188:191], a[140:143], v[128:131]
ds_read_b64_tr_b16 v[204:205], v208 offset:27872
ds_read_b64_tr_b16 v[206:207], v208 offset:32480
v_mfma_f32_16x16x32_bf16 v[132:135], v[176:179], a[144:147], 0
v_mfma_f32_16x16x32_bf16 v[132:135], v[180:183], a[148:151], v[132:135]
buffer_load_dwordx4 a[60:63], v215, s[20:23], s88 offen offset:3072 sc1
s_add_u32 s88, s88, 0x80000
v_mfma_f32_16x16x32_bf16 v[132:135], v[184:187], a[152:155], v[132:135]
v_mfma_f32_16x16x32_bf16 v[132:135], v[188:191], a[156:159], v[132:135]
s_add_u32 m0, s51, 0x1b000
v_mfma_f32_16x16x32_bf16 v[136:139], v[176:179], a[160:163], 0
buffer_load_dwordx4 v242, s[16:19], s87 offen lds
v_mfma_f32_16x16x32_bf16 v[136:139], v[180:183], a[164:167], v[136:139]
v_mfma_f32_16x16x32_bf16 v[136:139], v[184:187], a[168:171], v[136:139]
s_add_u32 m0, s51, 0x1b400
v_mfma_f32_16x16x32_bf16 v[136:139], v[188:191], a[172:175], v[136:139]
buffer_load_dwordx4 v243, s[16:19], s87 offen lds
v_mfma_f32_16x16x32_bf16 v[140:143], v[176:179], a[176:179], 0
v_mfma_f32_16x16x32_bf16 v[140:143], v[180:183], a[180:183], v[140:143]
s_add_u32 m0, s51, 0x1b800
v_mfma_f32_16x16x32_bf16 v[140:143], v[184:187], a[184:187], v[140:143]
buffer_load_dwordx4 v244, s[16:19], s87 offen lds
v_mfma_f32_16x16x32_bf16 v[140:143], v[188:191], a[188:191], v[140:143]
s_waitcnt lgkmcnt(0)
v_mfma_f32_16x16x32_bf16 v[144:147], v[192:195], a[128:131], 0
ds_read_b64_tr_b16 v[176:177], v208 offset:256
ds_read_b64_tr_b16 v[178:179], v208 offset:4864
v_mfma_f32_16x16x32_bf16 v[144:147], v[196:199], a[132:135], v[144:147]
ds_read_b64_tr_b16 v[180:181], v208 offset:9472
ds_read_b64_tr_b16 v[182:183], v208 offset:14080
v_mfma_f32_16x16x32_bf16 v[144:147], v[200:203], a[136:139], v[144:147]
ds_read_b64_tr_b16 v[184:185], v208 offset:18688
ds_read_b64_tr_b16 v[186:187], v208 offset:23296
v_mfma_f32_16x16x32_bf16 v[144:147], v[204:207], a[140:143], v[144:147]
ds_read_b64_tr_b16 v[188:189], v208 offset:27904
ds_read_b64_tr_b16 v[190:191], v208 offset:32512
v_mfma_f32_16x16x32_bf16 v[148:151], v[192:195], a[144:147], 0
v_mfma_f32_16x16x32_bf16 v[148:151], v[196:199], a[148:151], v[148:151]
v_mfma_f32_16x16x32_bf16 v[148:151], v[200:203], a[152:155], v[148:151]
s_add_u32 m0, s51, 0x1bc00
v_mfma_f32_16x16x32_bf16 v[148:151], v[204:207], a[156:159], v[148:151]
buffer_load_dwordx4 v245, s[16:19], s87 offen lds
v_mfma_f32_16x16x32_bf16 v[152:155], v[192:195], a[160:163], 0
v_mfma_f32_16x16x32_bf16 v[152:155], v[196:199], a[164:167], v[152:155]
v_mfma_f32_16x16x32_bf16 v[152:155], v[200:203], a[168:171], v[152:155]
s_add_u32 m0, s51, 0x1c000
v_mfma_f32_16x16x32_bf16 v[152:155], v[204:207], a[172:175], v[152:155]
buffer_load_dwordx4 v246, s[16:19], s87 offen lds
v_mfma_f32_16x16x32_bf16 v[156:159], v[192:195], a[176:179], 0
v_mfma_f32_16x16x32_bf16 v[156:159], v[196:199], a[180:183], v[156:159]
v_mfma_f32_16x16x32_bf16 v[156:159], v[200:203], a[184:187], v[156:159]
v_mfma_f32_16x16x32_bf16 v[156:159], v[204:207], a[188:191], v[156:159]
s_waitcnt lgkmcnt(0)
v_mfma_f32_16x16x32_bf16 v[160:163], v[176:179], a[128:131], 0
s_waitcnt vmcnt(30)
s_barrier
v_mfma_f32_16x16x32_bf16 v[160:163], v[180:183], a[132:135], v[160:163]
ds_read_b64_tr_b16 v[192:193], v209
ds_read_b64_tr_b16 v[194:195], v209 offset:4608
v_mfma_f32_16x16x32_bf16 v[160:163], v[184:187], a[136:139], v[160:163]
ds_read_b64_tr_b16 v[196:197], v209 offset:9216
ds_read_b64_tr_b16 v[198:199], v209 offset:13824
v_mfma_f32_16x16x32_bf16 v[160:163], v[188:191], a[140:143], v[160:163]
ds_read_b64_tr_b16 v[200:201], v209 offset:18432
ds_read_b64_tr_b16 v[202:203], v209 offset:23040
v_mfma_f32_16x16x32_bf16 v[164:167], v[176:179], a[144:147], 0
ds_read_b64_tr_b16 v[204:205], v209 offset:27648
ds_read_b64_tr_b16 v[206:207], v209 offset:32256
v_mfma_f32_16x16x32_bf16 v[164:167], v[180:183], a[148:151], v[164:167]
v_mfma_f32_16x16x32_bf16 v[164:167], v[184:187], a[152:155], v[164:167]
v_mfma_f32_16x16x32_bf16 v[164:167], v[188:191], a[156:159], v[164:167]
v_mfma_f32_16x16x32_bf16 v[168:171], v[176:179], a[160:163], 0
v_mfma_f32_16x16x32_bf16 v[168:171], v[180:183], a[164:167], v[168:171]
v_mfma_f32_16x16x32_bf16 v[168:171], v[184:187], a[168:171], v[168:171]
v_mfma_f32_16x16x32_bf16 v[168:171], v[188:191], a[172:175], v[168:171]
v_mfma_f32_16x16x32_bf16 v[172:175], v[176:179], a[176:179], 0
v_mfma_f32_16x16x32_bf16 v[172:175], v[180:183], a[180:183], v[172:175]
v_mfma_f32_16x16x32_bf16 v[172:175], v[184:187], a[184:187], v[172:175]
v_mfma_f32_16x16x32_bf16 v[172:175], v[188:191], a[188:191], v[172:175]
s_waitcnt lgkmcnt(0)
v_mfma_f32_16x16x32_bf16 v[32:35], v[192:195], a[192:195], v[32:35]
ds_read_b64_tr_b16 v[176:177], v209 offset:32
ds_read_b64_tr_b16 v[178:179], v209 offset:4640
v_mfma_f32_16x16x32_bf16 v[32:35], v[196:199], a[196:199], v[32:35]
ds_read_b64_tr_b16 v[180:181], v209 offset:9248
ds_read_b64_tr_b16 v[182:183], v209 offset:13856
v_mfma_f32_16x16x32_bf16 v[32:35], v[200:203], a[200:203], v[32:35]
ds_read_b64_tr_b16 v[184:185], v209 offset:18464
ds_read_b64_tr_b16 v[186:187], v209 offset:23072
v_mfma_f32_16x16x32_bf16 v[32:35], v[204:207], a[204:207], v[32:35]
ds_read_b64_tr_b16 v[188:189], v209 offset:27680
ds_read_b64_tr_b16 v[190:191], v209 offset:32288
v_mfma_f32_16x16x32_bf16 v[36:39], v[192:195], a[208:211], v[36:39]
s_waitcnt vmcnt(40)
s_add_u32 m0, s51, 0x1c400
v_mfma_f32_16x16x32_bf16 v[36:39], v[196:199], a[212:215], v[36:39]
buffer_load_dwordx4 v247, s[16:19], s87 offen lds
v_mfma_f32_16x16x32_bf16 v[36:39], v[200:203], a[216:219], v[36:39]
v_mfma_f32_16x16x32_bf16 v[36:39], v[204:207], a[220:223], v[36:39]
s_add_u32 m0, s51, 0x1c800
v_mfma_f32_16x16x32_bf16 v[40:43], v[192:195], a[224:227], v[40:43]
buffer_load_dwordx4 v248, s[16:19], s87 offen lds
v_mfma_f32_16x16x32_bf16 v[40:43], v[196:199], a[228:231], v[40:43]
v_mfma_f32_16x16x32_bf16 v[40:43], v[200:203], a[232:235], v[40:43]
s_add_u32 m0, s51, 0x1cc00
v_mfma_f32_16x16x32_bf16 v[40:43], v[204:207], a[236:239], v[40:43]
buffer_load_dwordx4 v249, s[16:19], s87 offen lds
v_mfma_f32_16x16x32_bf16 v[44:47], v[192:195], a[240:243], v[44:47]
v_mfma_f32_16x16x32_bf16 v[44:47], v[196:199], a[244:247], v[44:47]
s_add_u32 m0, s51, 0x1d000
v_mfma_f32_16x16x32_bf16 v[44:47], v[200:203], a[248:251], v[44:47]
buffer_load_dwordx4 v250, s[16:19], s87 offen lds
s_add_u32 s87, s87, 0x24000
v_mfma_f32_16x16x32_bf16 v[44:47], v[204:207], a[252:255], v[44:47]
s_waitcnt lgkmcnt(0)
v_mfma_f32_16x16x32_bf16 v[48:51], v[176:179], a[192:195], v[48:51]
ds_read_b64_tr_b16 v[192:193], v209 offset:64
ds_read_b64_tr_b16 v[194:195], v209 offset:4672
v_mfma_f32_16x16x32_bf16 v[48:51], v[180:183], a[196:199], v[48:51]
ds_read_b64_tr_b16 v[196:197], v209 offset:9280
ds_read_b64_tr_b16 v[198:199], v209 offset:13888
v_mfma_f32_16x16x32_bf16 v[48:51], v[184:187], a[200:203], v[48:51]
ds_read_b64_tr_b16 v[200:201], v209 offset:18496
ds_read_b64_tr_b16 v[202:203], v209 offset:23104
v_mfma_f32_16x16x32_bf16 v[48:51], v[188:191], a[204:207], v[48:51]
ds_read_b64_tr_b16 v[204:205], v209 offset:27712
ds_read_b64_tr_b16 v[206:207], v209 offset:32320
v_mfma_f32_16x16x32_bf16 v[52:55], v[176:179], a[208:211], v[52:55]
v_mfma_f32_16x16x32_bf16 v[52:55], v[180:183], a[212:215], v[52:55]
buffer_load_dwordx4 a[64:67], v212, s[20:23], s88 offen sc1
v_mfma_f32_16x16x32_bf16 v[52:55], v[184:187], a[216:219], v[52:55]
v_mfma_f32_16x16x32_bf16 v[52:55], v[188:191], a[220:223], v[52:55]
v_mfma_f32_16x16x32_bf16 v[56:59], v[176:179], a[224:227], v[56:59]
buffer_load_dwordx4 a[80:83], v212, s[20:23], s88 offen offset:1024 sc1
v_mfma_f32_16x16x32_bf16 v[56:59], v[180:183], a[228:231], v[56:59]
v_mfma_f32_16x16x32_bf16 v[56:59], v[184:187], a[232:235], v[56:59]
v_mfma_f32_16x16x32_bf16 v[56:59], v[188:191], a[236:239], v[56:59]
buffer_load_dwordx4 a[96:99], v212, s[20:23], s88 offen offset:2048 sc1
v_mfma_f32_16x16x32_bf16 v[60:63], v[176:179], a[240:243], v[60:63]
v_mfma_f32_16x16x32_bf16 v[60:63], v[180:183], a[244:247], v[60:63]
v_mfma_f32_16x16x32_bf16 v[60:63], v[184:187], a[248:251], v[60:63]
buffer_load_dwordx4 a[112:115], v212, s[20:23], s88 offen offset:3072 sc1
v_mfma_f32_16x16x32_bf16 v[60:63], v[188:191], a[252:255], v[60:63]
s_waitcnt lgkmcnt(0)
v_mfma_f32_16x16x32_bf16 v[64:67], v[192:195], a[192:195], v[64:67]
ds_read_b64_tr_b16 v[176:177], v209 offset:96
ds_read_b64_tr_b16 v[178:179], v209 offset:4704
v_mfma_f32_16x16x32_bf16 v[64:67], v[196:199], a[196:199], v[64:67]
ds_read_b64_tr_b16 v[180:181], v209 offset:9312
ds_read_b64_tr_b16 v[182:183], v209 offset:13920
v_mfma_f32_16x16x32_bf16 v[64:67], v[200:203], a[200:203], v[64:67]
ds_read_b64_tr_b16 v[184:185], v209 offset:18528
ds_read_b64_tr_b16 v[186:187], v209 offset:23136
v_mfma_f32_16x16x32_bf16 v[64:67], v[204:207], a[204:207], v[64:67]
ds_read_b64_tr_b16 v[188:189], v209 offset:27744
ds_read_b64_tr_b16 v[190:191], v209 offset:32352
v_mfma_f32_16x16x32_bf16 v[68:71], v[192:195], a[208:211], v[68:71]
v_mfma_f32_16x16x32_bf16 v[68:71], v[196:199], a[212:215], v[68:71]
buffer_load_dwordx4 a[68:71], v213, s[20:23], s88 offen sc1
v_mfma_f32_16x16x32_bf16 v[68:71], v[200:203], a[216:219], v[68:71]
v_mfma_f32_16x16x32_bf16 v[68:71], v[204:207], a[220:223], v[68:71]
v_mfma_f32_16x16x32_bf16 v[72:75], v[192:195], a[224:227], v[72:75]
buffer_load_dwordx4 a[84:87], v213, s[20:23], s88 offen offset:1024 sc1
v_mfma_f32_16x16x32_bf16 v[72:75], v[196:199], a[228:231], v[72:75]
v_mfma_f32_16x16x32_bf16 v[72:75], v[200:203], a[232:235], v[72:75]
v_mfma_f32_16x16x32_bf16 v[72:75], v[204:207], a[236:239], v[72:75]
buffer_load_dwordx4 a[100:103], v213, s[20:23], s88 offen offset:2048 sc1
v_mfma_f32_16x16x32_bf16 v[76:79], v[192:195], a[240:243], v[76:79]
v_mfma_f32_16x16x32_bf16 v[76:79], v[196:199], a[244:247], v[76:79]
v_mfma_f32_16x16x32_bf16 v[76:79], v[200:203], a[248:251], v[76:79]
buffer_load_dwordx4 a[116:119], v213, s[20:23], s88 offen offset:3072 sc1
v_mfma_f32_16x16x32_bf16 v[76:79], v[204:207], a[252:255], v[76:79]
s_waitcnt lgkmcnt(0)
v_mfma_f32_16x16x32_bf16 v[80:83], v[176:179], a[192:195], v[80:83]
ds_read_b64_tr_b16 v[192:193], v209 offset:128
ds_read_b64_tr_b16 v[194:195], v209 offset:4736
v_mfma_f32_16x16x32_bf16 v[80:83], v[180:183], a[196:199], v[80:83]
ds_read_b64_tr_b16 v[196:197], v209 offset:9344
ds_read_b64_tr_b16 v[198:199], v209 offset:13952
v_mfma_f32_16x16x32_bf16 v[80:83], v[184:187], a[200:203], v[80:83]
ds_read_b64_tr_b16 v[200:201], v209 offset:18560
ds_read_b64_tr_b16 v[202:203], v209 offset:23168
v_mfma_f32_16x16x32_bf16 v[80:83], v[188:191], a[204:207], v[80:83]
ds_read_b64_tr_b16 v[204:205], v209 offset:27776
ds_read_b64_tr_b16 v[206:207], v209 offset:32384
v_mfma_f32_16x16x32_bf16 v[84:87], v[176:179], a[208:211], v[84:87]
v_mfma_f32_16x16x32_bf16 v[84:87], v[180:183], a[212:215], v[84:87]
buffer_load_dwordx4 a[72:75], v214, s[20:23], s88 offen sc1
v_mfma_f32_16x16x32_bf16 v[84:87], v[184:187], a[216:219], v[84:87]
v_mfma_f32_16x16x32_bf16 v[84:87], v[188:191], a[220:223], v[84:87]
v_mfma_f32_16x16x32_bf16 v[88:91], v[176:179], a[224:227], v[88:91]
buffer_load_dwordx4 a[88:91], v214, s[20:23], s88 offen offset:1024 sc1
v_mfma_f32_16x16x32_bf16 v[88:91], v[180:183], a[228:231], v[88:91]
v_mfma_f32_16x16x32_bf16 v[88:91], v[184:187], a[232:235], v[88:91]
v_mfma_f32_16x16x32_bf16 v[88:91], v[188:191], a[236:239], v[88:91]
buffer_load_dwordx4 a[104:107], v214, s[20:23], s88 offen offset:2048 sc1
v_mfma_f32_16x16x32_bf16 v[92:95], v[176:179], a[240:243], v[92:95]
v_mfma_f32_16x16x32_bf16 v[92:95], v[180:183], a[244:247], v[92:95]
v_mfma_f32_16x16x32_bf16 v[92:95], v[184:187], a[248:251], v[92:95]
buffer_load_dwordx4 a[120:123], v214, s[20:23], s88 offen offset:3072 sc1
v_mfma_f32_16x16x32_bf16 v[92:95], v[188:191], a[252:255], v[92:95]
s_waitcnt lgkmcnt(0)
v_mfma_f32_16x16x32_bf16 v[96:99], v[192:195], a[192:195], v[96:99]
ds_read_b64_tr_b16 v[176:177], v209 offset:160
ds_read_b64_tr_b16 v[178:179], v209 offset:4768
v_mfma_f32_16x16x32_bf16 v[96:99], v[196:199], a[196:199], v[96:99]
ds_read_b64_tr_b16 v[180:181], v209 offset:9376
ds_read_b64_tr_b16 v[182:183], v209 offset:13984
v_mfma_f32_16x16x32_bf16 v[96:99], v[200:203], a[200:203], v[96:99]
ds_read_b64_tr_b16 v[184:185], v209 offset:18592
ds_read_b64_tr_b16 v[186:187], v209 offset:23200
v_mfma_f32_16x16x32_bf16 v[96:99], v[204:207], a[204:207], v[96:99]
ds_read_b64_tr_b16 v[188:189], v209 offset:27808
ds_read_b64_tr_b16 v[190:191], v209 offset:32416
v_mfma_f32_16x16x32_bf16 v[100:103], v[192:195], a[208:211], v[100:103]
s_waitcnt vmcnt(40)
v_mfma_f32_16x16x32_bf16 v[100:103], v[196:199], a[212:215], v[100:103]
buffer_load_dwordx4 a[76:79], v215, s[20:23], s88 offen sc1
v_mfma_f32_16x16x32_bf16 v[100:103], v[200:203], a[216:219], v[100:103]
v_mfma_f32_16x16x32_bf16 v[100:103], v[204:207], a[220:223], v[100:103]
v_mfma_f32_16x16x32_bf16 v[104:107], v[192:195], a[224:227], v[104:107]
buffer_load_dwordx4 a[92:95], v215, s[20:23], s88 offen offset:1024 sc1
v_mfma_f32_16x16x32_bf16 v[104:107], v[196:199], a[228:231], v[104:107]
v_mfma_f32_16x16x32_bf16 v[104:107], v[200:203], a[232:235], v[104:107]
v_mfma_f32_16x16x32_bf16 v[104:107], v[204:207], a[236:239], v[104:107]
buffer_load_dwordx4 a[108:111], v215, s[20:23], s88 offen offset:2048 sc1
v_mfma_f32_16x16x32_bf16 v[108:111], v[192:195], a[240:243], v[108:111]
v_mfma_f32_16x16x32_bf16 v[108:111], v[196:199], a[244:247], v[108:111]
v_mfma_f32_16x16x32_bf16 v[108:111], v[200:203], a[248:251], v[108:111]
buffer_load_dwordx4 a[124:127], v215, s[20:23], s88 offen offset:3072 sc1
s_add_u32 s88, s88, 0x80000
v_mfma_f32_16x16x32_bf16 v[108:111], v[204:207], a[252:255], v[108:111]
s_waitcnt lgkmcnt(0)
v_mfma_f32_16x16x32_bf16 v[112:115], v[176:179], a[192:195], v[112:115]
ds_read_b64_tr_b16 v[192:193], v209 offset:192
ds_read_b64_tr_b16 v[194:195], v209 offset:4800
v_mfma_f32_16x16x32_bf16 v[112:115], v[180:183], a[196:199], v[112:115]
ds_read_b64_tr_b16 v[196:197], v209 offset:9408
ds_read_b64_tr_b16 v[198:199], v209 offset:14016
v_mfma_f32_16x16x32_bf16 v[112:115], v[184:187], a[200:203], v[112:115]
ds_read_b64_tr_b16 v[200:201], v209 offset:18624
ds_read_b64_tr_b16 v[202:203], v209 offset:23232
v_mfma_f32_16x16x32_bf16 v[112:115], v[188:191], a[204:207], v[112:115]
ds_read_b64_tr_b16 v[204:205], v209 offset:27840
ds_read_b64_tr_b16 v[206:207], v209 offset:32448
v_mfma_f32_16x16x32_bf16 v[116:119], v[176:179], a[208:211], v[116:119]
s_add_u32 m0, s51, 0
v_mfma_f32_16x16x32_bf16 v[116:119], v[180:183], a[212:215], v[116:119]
buffer_load_dwordx4 v242, s[16:19], s87 offen lds
v_mfma_f32_16x16x32_bf16 v[116:119], v[184:187], a[216:219], v[116:119]
v_mfma_f32_16x16x32_bf16 v[116:119], v[188:191], a[220:223], v[116:119]
s_add_u32 m0, s51, 0x400
v_mfma_f32_16x16x32_bf16 v[120:123], v[176:179], a[224:227], v[120:123]
buffer_load_dwordx4 v243, s[16:19], s87 offen lds
v_mfma_f32_16x16x32_bf16 v[120:123], v[180:183], a[228:231], v[120:123]
v_mfma_f32_16x16x32_bf16 v[120:123], v[184:187], a[232:235], v[120:123]
s_add_u32 m0, s51, 0x800
v_mfma_f32_16x16x32_bf16 v[120:123], v[188:191], a[236:239], v[120:123]
buffer_load_dwordx4 v244, s[16:19], s87 offen lds
v_mfma_f32_16x16x32_bf16 v[124:127], v[176:179], a[240:243], v[124:127]
v_mfma_f32_16x16x32_bf16 v[124:127], v[180:183], a[244:247], v[124:127]
s_add_u32 m0, s51, 0xc00
v_mfma_f32_16x16x32_bf16 v[124:127], v[184:187], a[248:251], v[124:127]
buffer_load_dwordx4 v245, s[16:19], s87 offen lds
v_mfma_f32_16x16x32_bf16 v[124:127], v[188:191], a[252:255], v[124:127]
s_waitcnt lgkmcnt(0)
v_mfma_f32_16x16x32_bf16 v[128:131], v[192:195], a[192:195], v[128:131]
ds_read_b64_tr_b16 v[176:177], v209 offset:224
ds_read_b64_tr_b16 v[178:179], v209 offset:4832
v_mfma_f32_16x16x32_bf16 v[128:131], v[196:199], a[196:199], v[128:131]
ds_read_b64_tr_b16 v[180:181], v209 offset:9440
ds_read_b64_tr_b16 v[182:183], v209 offset:14048
v_mfma_f32_16x16x32_bf16 v[128:131], v[200:203], a[200:203], v[128:131]
ds_read_b64_tr_b16 v[184:185], v209 offset:18656
ds_read_b64_tr_b16 v[186:187], v209 offset:23264
v_mfma_f32_16x16x32_bf16 v[128:131], v[204:207], a[204:207], v[128:131]
ds_read_b64_tr_b16 v[188:189], v209 offset:27872
ds_read_b64_tr_b16 v[190:191], v209 offset:32480
v_mfma_f32_16x16x32_bf16 v[132:135], v[192:195], a[208:211], v[132:135]
s_add_u32 m0, s51, 0x1000
v_mfma_f32_16x16x32_bf16 v[132:135], v[196:199], a[212:215], v[132:135]
buffer_load_dwordx4 v246, s[16:19], s87 offen lds
v_mfma_f32_16x16x32_bf16 v[132:135], v[200:203], a[216:219], v[132:135]
v_mfma_f32_16x16x32_bf16 v[132:135], v[204:207], a[220:223], v[132:135]
s_add_u32 m0, s51, 0x1400
v_mfma_f32_16x16x32_bf16 v[136:139], v[192:195], a[224:227], v[136:139]
buffer_load_dwordx4 v247, s[16:19], s87 offen lds
v_mfma_f32_16x16x32_bf16 v[136:139], v[196:199], a[228:231], v[136:139]
v_mfma_f32_16x16x32_bf16 v[136:139], v[200:203], a[232:235], v[136:139]
s_add_u32 m0, s51, 0x1800
v_mfma_f32_16x16x32_bf16 v[136:139], v[204:207], a[236:239], v[136:139]
buffer_load_dwordx4 v248, s[16:19], s87 offen lds
v_mfma_f32_16x16x32_bf16 v[140:143], v[192:195], a[240:243], v[140:143]
v_mfma_f32_16x16x32_bf16 v[140:143], v[196:199], a[244:247], v[140:143]
s_add_u32 m0, s51, 0x1c00
v_mfma_f32_16x16x32_bf16 v[140:143], v[200:203], a[248:251], v[140:143]
buffer_load_dwordx4 v249, s[16:19], s87 offen lds
v_mfma_f32_16x16x32_bf16 v[140:143], v[204:207], a[252:255], v[140:143]
s_waitcnt lgkmcnt(0)
v_mfma_f32_16x16x32_bf16 v[144:147], v[176:179], a[192:195], v[144:147]
ds_read_b64_tr_b16 v[192:193], v209 offset:256
ds_read_b64_tr_b16 v[194:195], v209 offset:4864
v_mfma_f32_16x16x32_bf16 v[144:147], v[180:183], a[196:199], v[144:147]
ds_read_b64_tr_b16 v[196:197], v209 offset:9472
ds_read_b64_tr_b16 v[198:199], v209 offset:14080
v_mfma_f32_16x16x32_bf16 v[144:147], v[184:187], a[200:203], v[144:147]
ds_read_b64_tr_b16 v[200:201], v209 offset:18688
ds_read_b64_tr_b16 v[202:203], v209 offset:23296
v_mfma_f32_16x16x32_bf16 v[144:147], v[188:191], a[204:207], v[144:147]
ds_read_b64_tr_b16 v[204:205], v209 offset:27904
ds_read_b64_tr_b16 v[206:207], v209 offset:32512
v_mfma_f32_16x16x32_bf16 v[148:151], v[176:179], a[208:211], v[148:151]
v_mfma_f32_16x16x32_bf16 v[148:151], v[180:183], a[212:215], v[148:151]
v_mfma_f32_16x16x32_bf16 v[148:151], v[184:187], a[216:219], v[148:151]
s_add_u32 m0, s51, 0x2000
v_mfma_f32_16x16x32_bf16 v[148:151], v[188:191], a[220:223], v[148:151]
buffer_load_dwordx4 v250, s[16:19], s87 offen lds
s_add_u32 s87, s87, 0x24000
v_mfma_f32_16x16x32_bf16 v[152:155], v[176:179], a[224:227], v[152:155]
v_mfma_f32_16x16x32_bf16 v[152:155], v[180:183], a[228:231], v[152:155]
v_mfma_f32_16x16x32_bf16 v[152:155], v[184:187], a[232:235], v[152:155]
v_mfma_f32_16x16x32_bf16 v[152:155], v[188:191], a[236:239], v[152:155]
buffer_load_dwordx4 a[128:131], v212, s[20:23], s88 offen sc1
v_mfma_f32_16x16x32_bf16 v[156:159], v[176:179], a[240:243], v[156:159]
v_mfma_f32_16x16x32_bf16 v[156:159], v[180:183], a[244:247], v[156:159]
v_mfma_f32_16x16x32_bf16 v[156:159], v[184:187], a[248:251], v[156:159]
v_mfma_f32_16x16x32_bf16 v[156:159], v[188:191], a[252:255], v[156:159]
s_waitcnt lgkmcnt(0)
v_mfma_f32_16x16x32_bf16 v[160:163], v[192:195], a[192:195], v[160:163]
s_waitcnt vmcnt(35)
s_barrier
v_mfma_f32_16x16x32_bf16 v[160:163], v[196:199], a[196:199], v[160:163]
ds_read_b64_tr_b16 v[176:177], v210
ds_read_b64_tr_b16 v[178:179], v210 offset:4608
v_mfma_f32_16x16x32_bf16 v[160:163], v[200:203], a[200:203], v[160:163]
ds_read_b64_tr_b16 v[180:181], v210 offset:9216
ds_read_b64_tr_b16 v[182:183], v210 offset:13824
v_mfma_f32_16x16x32_bf16 v[160:163], v[204:207], a[204:207], v[160:163]
ds_read_b64_tr_b16 v[184:185], v210 offset:18432
ds_read_b64_tr_b16 v[186:187], v210 offset:23040
v_mfma_f32_16x16x32_bf16 v[164:167], v[192:195], a[208:211], v[164:167]
ds_read_b64_tr_b16 v[188:189], v210 offset:27648
ds_read_b64_tr_b16 v[190:191], v210 offset:32256
v_mfma_f32_16x16x32_bf16 v[164:167], v[196:199], a[212:215], v[164:167]
v_mfma_f32_16x16x32_bf16 v[164:167], v[200:203], a[216:219], v[164:167]
v_mfma_f32_16x16x32_bf16 v[164:167], v[204:207], a[220:223], v[164:167]
v_mfma_f32_16x16x32_bf16 v[168:171], v[192:195], a[224:227], v[168:171]
v_mfma_f32_16x16x32_bf16 v[168:171], v[196:199], a[228:231], v[168:171]
v_mfma_f32_16x16x32_bf16 v[168:171], v[200:203], a[232:235], v[168:171]
v_mfma_f32_16x16x32_bf16 v[168:171], v[204:207], a[236:239], v[168:171]
v_mfma_f32_16x16x32_bf16 v[172:175], v[192:195], a[240:243], v[172:175]
v_mfma_f32_16x16x32_bf16 v[172:175], v[196:199], a[244:247], v[172:175]
v_mfma_f32_16x16x32_bf16 v[172:175], v[200:203], a[248:251], v[172:175]
v_mfma_f32_16x16x32_bf16 v[172:175], v[204:207], a[252:255], v[172:175]
s_waitcnt lgkmcnt(0)
v_mfma_f32_16x16x32_bf16 v[32:35], v[176:179], a[0:3], v[32:35]
ds_read_b64_tr_b16 v[192:193], v210 offset:32
ds_read_b64_tr_b16 v[194:195], v210 offset:4640
v_mfma_f32_16x16x32_bf16 v[32:35], v[180:183], a[4:7], v[32:35]
ds_read_b64_tr_b16 v[196:197], v210 offset:9248
ds_read_b64_tr_b16 v[198:199], v210 offset:13856
v_mfma_f32_16x16x32_bf16 v[32:35], v[184:187], a[8:11], v[32:35]
ds_read_b64_tr_b16 v[200:201], v210 offset:18464
ds_read_b64_tr_b16 v[202:203], v210 offset:23072
v_mfma_f32_16x16x32_bf16 v[32:35], v[188:191], a[12:15], v[32:35]
ds_read_b64_tr_b16 v[204:205], v210 offset:27680
ds_read_b64_tr_b16 v[206:207], v210 offset:32288
v_mfma_f32_16x16x32_bf16 v[36:39], v[176:179], a[16:19], v[36:39]
s_waitcnt vmcnt(40)
v_mfma_f32_16x16x32_bf16 v[36:39], v[180:183], a[20:23], v[36:39]
buffer_load_dwordx4 a[144:147], v212, s[20:23], s88 offen offset:1024 sc1
v_mfma_f32_16x16x32_bf16 v[36:39], v[184:187], a[24:27], v[36:39]
v_mfma_f32_16x16x32_bf16 v[36:39], v[188:191], a[28:31], v[36:39]
v_mfma_f32_16x16x32_bf16 v[40:43], v[176:179], a[32:35], v[40:43]
buffer_load_dwordx4 a[160:163], v212, s[20:23], s88 offen offset:2048 sc1
v_mfma_f32_16x16x32_bf16 v[40:43], v[180:183], a[36:39], v[40:43]
v_mfma_f32_16x16x32_bf16 v[40:43], v[184:187], a[40:43], v[40:43]
v_mfma_f32_16x16x32_bf16 v[40:43], v[188:191], a[44:47], v[40:43]
buffer_load_dwordx4 a[176:179], v212, s[20:23], s88 offen offset:3072 sc1
v_mfma_f32_16x16x32_bf16 v[44:47], v[176:179], a[48:51], v[44:47]
v_mfma_f32_16x16x32_bf16 v[44:47], v[180:183], a[52:55], v[44:47]
v_mfma_f32_16x16x32_bf16 v[44:47], v[184:187], a[56:59], v[44:47]
buffer_load_dwordx4 a[132:135], v213, s[20:23], s88 offen sc1
v_mfma_f32_16x16x32_bf16 v[44:47], v[188:191], a[60:63], v[44:47]
s_waitcnt lgkmcnt(0)
v_mfma_f32_16x16x32_bf16 v[48:51], v[192:195], a[0:3], v[48:51]
ds_read_b64_tr_b16 v[176:177], v210 offset:64
ds_read_b64_tr_b16 v[178:179], v210 offset:4672
v_mfma_f32_16x16x32_bf16 v[48:51], v[196:199], a[4:7], v[48:51]
ds_read_b64_tr_b16 v[180:181], v210 offset:9280
ds_read_b64_tr_b16 v[182:183], v210 offset:13888
v_mfma_f32_16x16x32_bf16 v[48:51], v[200:203], a[8:11], v[48:51]
ds_read_b64_tr_b16 v[184:185], v210 offset:18496
ds_read_b64_tr_b16 v[186:187], v210 offset:23104
v_mfma_f32_16x16x32_bf16 v[48:51], v[204:207], a[12:15], v[48:51]
ds_read_b64_tr_b16 v[188:189], v210 offset:27712
ds_read_b64_tr_b16 v[190:191], v210 offset:32320
v_mfma_f32_16x16x32_bf16 v[52:55], v[192:195], a[16:19], v[52:55]
v_mfma_f32_16x16x32_bf16 v[52:55], v[196:199], a[20:23], v[52:55]
buffer_load_dwordx4 a[148:151], v213, s[20:23], s88 offen offset:1024 sc1
v_mfma_f32_16x16x32_bf16 v[52:55], v[200:203], a[24:27], v[52:55]
v_mfma_f32_16x16x32_bf16 v[52:55], v[204:207], a[28:31], v[52:55]
v_mfma_f32_16x16x32_bf16 v[56:59], v[192:195], a[32:35], v[56:59]
buffer_load_dwordx4 a[164:167], v213, s[20:23], s88 offen offset:2048 sc1
v_mfma_f32_16x16x32_bf16 v[56:59], v[196:199], a[36:39], v[56:59]
v_mfma_f32_16x16x32_bf16 v[56:59], v[200:203], a[40:43], v[56:59]
v_mfma_f32_16x16x32_bf16 v[56:59], v[204:207], a[44:47], v[56:59]
buffer_load_dwordx4 a[180:183], v213, s[20:23], s88 offen offset:3072 sc1
v_mfma_f32_16x16x32_bf16 v[60:63], v[192:195], a[48:51], v[60:63]
v_mfma_f32_16x16x32_bf16 v[60:63], v[196:199], a[52:55], v[60:63]
v_mfma_f32_16x16x32_bf16 v[60:63], v[200:203], a[56:59], v[60:63]
buffer_load_dwordx4 a[136:139], v214, s[20:23], s88 offen sc1
v_mfma_f32_16x16x32_bf16 v[60:63], v[204:207], a[60:63], v[60:63]
s_waitcnt lgkmcnt(0)
v_mfma_f32_16x16x32_bf16 v[64:67], v[176:179], a[0:3], v[64:67]
ds_read_b64_tr_b16 v[192:193], v210 offset:96
ds_read_b64_tr_b16 v[194:195], v210 offset:4704
v_mfma_f32_16x16x32_bf16 v[64:67], v[180:183], a[4:7], v[64:67]
ds_read_b64_tr_b16 v[196:197], v210 offset:9312
ds_read_b64_tr_b16 v[198:199], v210 offset:13920
v_mfma_f32_16x16x32_bf16 v[64:67], v[184:187], a[8:11], v[64:67]
ds_read_b64_tr_b16 v[200:201], v210 offset:18528
ds_read_b64_tr_b16 v[202:203], v210 offset:23136
v_mfma_f32_16x16x32_bf16 v[64:67], v[188:191], a[12:15], v[64:67]
ds_read_b64_tr_b16 v[204:205], v210 offset:27744
ds_read_b64_tr_b16 v[206:207], v210 offset:32352
v_mfma_f32_16x16x32_bf16 v[68:71], v[176:179], a[16:19], v[68:71]
v_mfma_f32_16x16x32_bf16 v[68:71], v[180:183], a[20:23], v[68:71]
buffer_load_dwordx4 a[152:155], v214, s[20:23], s88 offen offset:1024 sc1
v_mfma_f32_16x16x32_bf16 v[68:71], v[184:187], a[24:27], v[68:71]
v_mfma_f32_16x16x32_bf16 v[68:71], v[188:191], a[28:31], v[68:71]
v_mfma_f32_16x16x32_bf16 v[72:75], v[176:179], a[32:35], v[72:75]
buffer_load_dwordx4 a[168:171], v214, s[20:23], s88 offen offset:2048 sc1
v_mfma_f32_16x16x32_bf16 v[72:75], v[180:183], a[36:39], v[72:75]
v_mfma_f32_16x16x32_bf16 v[72:75], v[184:187], a[40:43], v[72:75]
v_mfma_f32_16x16x32_bf16 v[72:75], v[188:191], a[44:47], v[72:75]
buffer_load_dwordx4 a[184:187], v214, s[20:23], s88 offen offset:3072 sc1
v_mfma_f32_16x16x32_bf16 v[76:79], v[176:179], a[48:51], v[76:79]
v_mfma_f32_16x16x32_bf16 v[76:79], v[180:183], a[52:55], v[76:79]
v_mfma_f32_16x16x32_bf16 v[76:79], v[184:187], a[56:59], v[76:79]
buffer_load_dwordx4 a[140:143], v215, s[20:23], s88 offen sc1
v_mfma_f32_16x16x32_bf16 v[76:79], v[188:191], a[60:63], v[76:79]
s_waitcnt lgkmcnt(0)
v_mfma_f32_16x16x32_bf16 v[80:83], v[192:195], a[0:3], v[80:83]
ds_read_b64_tr_b16 v[176:177], v210 offset:128
ds_read_b64_tr_b16 v[178:179], v210 offset:4736
v_mfma_f32_16x16x32_bf16 v[80:83], v[196:199], a[4:7], v[80:83]
ds_read_b64_tr_b16 v[180:181], v210 offset:9344
ds_read_b64_tr_b16 v[182:183], v210 offset:13952
v_mfma_f32_16x16x32_bf16 v[80:83], v[200:203], a[8:11], v[80:83]
ds_read_b64_tr_b16 v[184:185], v210 offset:18560
ds_read_b64_tr_b16 v[186:187], v210 offset:23168
v_mfma_f32_16x16x32_bf16 v[80:83], v[204:207], a[12:15], v[80:83]
ds_read_b64_tr_b16 v[188:189], v210 offset:27776
ds_read_b64_tr_b16 v[190:191], v210 offset:32384
v_mfma_f32_16x16x32_bf16 v[84:87], v[192:195], a[16:19], v[84:87]
v_mfma_f32_16x16x32_bf16 v[84:87], v[196:199], a[20:23], v[84:87]
buffer_load_dwordx4 a[156:159], v215, s[20:23], s88 offen offset:1024 sc1
v_mfma_f32_16x16x32_bf16 v[84:87], v[200:203], a[24:27], v[84:87]
v_mfma_f32_16x16x32_bf16 v[84:87], v[204:207], a[28:31], v[84:87]
v_mfma_f32_16x16x32_bf16 v[88:91], v[192:195], a[32:35], v[88:91]
buffer_load_dwordx4 a[172:175], v215, s[20:23], s88 offen offset:2048 sc1
v_mfma_f32_16x16x32_bf16 v[88:91], v[196:199], a[36:39], v[88:91]
v_mfma_f32_16x16x32_bf16 v[88:91], v[200:203], a[40:43], v[88:91]
v_mfma_f32_16x16x32_bf16 v[88:91], v[204:207], a[44:47], v[88:91]
buffer_load_dwordx4 a[188:191], v215, s[20:23], s88 offen offset:3072 sc1
s_add_u32 s88, s88, 0x80000
v_mfma_f32_16x16x32_bf16 v[92:95], v[192:195], a[48:51], v[92:95]
v_mfma_f32_16x16x32_bf16 v[92:95], v[196:199], a[52:55], v[92:95]
s_add_u32 m0, s51, 0x9000
v_mfma_f32_16x16x32_bf16 v[92:95], v[200:203], a[56:59], v[92:95]
buffer_load_dwordx4 v242, s[16:19], s87 offen lds
v_mfma_f32_16x16x32_bf16 v[92:95], v[204:207], a[60:63], v[92:95]
s_waitcnt lgkmcnt(0)
v_mfma_f32_16x16x32_bf16 v[96:99], v[176:179], a[0:3], v[96:99]
ds_read_b64_tr_b16 v[192:193], v210 offset:160
ds_read_b64_tr_b16 v[194:195], v210 offset:4768
v_mfma_f32_16x16x32_bf16 v[96:99], v[180:183], a[4:7], v[96:99]
ds_read_b64_tr_b16 v[196:197], v210 offset:9376
ds_read_b64_tr_b16 v[198:199], v210 offset:13984
v_mfma_f32_16x16x32_bf16 v[96:99], v[184:187], a[8:11], v[96:99]
ds_read_b64_tr_b16 v[200:201], v210 offset:18592
ds_read_b64_tr_b16 v[202:203], v210 offset:23200
v_mfma_f32_16x16x32_bf16 v[96:99], v[188:191], a[12:15], v[96:99]
ds_read_b64_tr_b16 v[204:205], v210 offset:27808
ds_read_b64_tr_b16 v[206:207], v210 offset:32416
v_mfma_f32_16x16x32_bf16 v[100:103], v[176:179], a[16:19], v[100:103]
s_waitcnt vmcnt(40)
s_add_u32 m0, s51, 0x9400
v_mfma_f32_16x16x32_bf16 v[100:103], v[180:183], a[20:23], v[100:103]
buffer_load_dwordx4 v243, s[16:19], s87 offen lds
v_mfma_f32_16x16x32_bf16 v[100:103], v[184:187], a[24:27], v[100:103]
v_mfma_f32_16x16x32_bf16 v[100:103], v[188:191], a[28:31], v[100:103]
s_add_u32 m0, s51, 0x9800
v_mfma_f32_16x16x32_bf16 v[104:107], v[176:179], a[32:35], v[104:107]
buffer_load_dwordx4 v244, s[16:19], s87 offen lds
v_mfma_f32_16x16x32_bf16 v[104:107], v[180:183], a[36:39], v[104:107]
v_mfma_f32_16x16x32_bf16 v[104:107], v[184:187], a[40:43], v[104:107]
s_add_u32 m0, s51, 0x9c00
v_mfma_f32_16x16x32_bf16 v[104:107], v[188:191], a[44:47], v[104:107]
buffer_load_dwordx4 v245, s[16:19], s87 offen lds
v_mfma_f32_16x16x32_bf16 v[108:111], v[176:179], a[48:51], v[108:111]
v_mfma_f32_16x16x32_bf16 v[108:111], v[180:183], a[52:55], v[108:111]
s_add_u32 m0, s51, 0xa000
v_mfma_f32_16x16x32_bf16 v[108:111], v[184:187], a[56:59], v[108:111]
buffer_load_dwordx4 v246, s[16:19], s87 offen lds
v_mfma_f32_16x16x32_bf16 v[108:111], v[188:191], a[60:63], v[108:111]
s_waitcnt lgkmcnt(0)
v_mfma_f32_16x16x32_bf16 v[112:115], v[192:195], a[0:3], v[112:115]
ds_read_b64_tr_b16 v[176:177], v210 offset:192
ds_read_b64_tr_b16 v[178:179], v210 offset:4800
v_mfma_f32_16x16x32_bf16 v[112:115], v[196:199], a[4:7], v[112:115]
ds_read_b64_tr_b16 v[180:181], v210 offset:9408
ds_read_b64_tr_b16 v[182:183], v210 offset:14016
v_mfma_f32_16x16x32_bf16 v[112:115], v[200:203], a[8:11], v[112:115]
ds_read_b64_tr_b16 v[184:185], v210 offset:18624
ds_read_b64_tr_b16 v[186:187], v210 offset:23232
v_mfma_f32_16x16x32_bf16 v[112:115], v[204:207], a[12:15], v[112:115]
ds_read_b64_tr_b16 v[188:189], v210 offset:27840
ds_read_b64_tr_b16 v[190:191], v210 offset:32448
v_mfma_f32_16x16x32_bf16 v[116:119], v[192:195], a[16:19], v[116:119]
s_add_u32 m0, s51, 0xa400
v_mfma_f32_16x16x32_bf16 v[116:119], v[196:199], a[20:23], v[116:119]
buffer_load_dwordx4 v247, s[16:19], s87 offen lds
v_mfma_f32_16x16x32_bf16 v[116:119], v[200:203], a[24:27], v[116:119]
v_mfma_f32_16x16x32_bf16 v[116:119], v[204:207], a[28:31], v[116:119]
s_add_u32 m0, s51, 0xa800
v_mfma_f32_16x16x32_bf16 v[120:123], v[192:195], a[32:35], v[120:123]
buffer_load_dwordx4 v248, s[16:19], s87 offen lds
v_mfma_f32_16x16x32_bf16 v[120:123], v[196:199], a[36:39], v[120:123]
v_mfma_f32_16x16x32_bf16 v[120:123], v[200:203], a[40:43], v[120:123]
s_add_u32 m0, s51, 0xac00
v_mfma_f32_16x16x32_bf16 v[120:123], v[204:207], a[44:47], v[120:123]
buffer_load_dwordx4 v249, s[16:19], s87 offen lds
v_mfma_f32_16x16x32_bf16 v[124:127], v[192:195], a[48:51], v[124:127]
v_mfma_f32_16x16x32_bf16 v[124:127], v[196:199], a[52:55], v[124:127]
s_add_u32 m0, s51, 0xb000
v_mfma_f32_16x16x32_bf16 v[124:127], v[200:203], a[56:59], v[124:127]
buffer_load_dwordx4 v250, s[16:19], s87 offen lds
s_add_u32 s87, s87, 0x24000
v_mfma_f32_16x16x32_bf16 v[124:127], v[204:207], a[60:63], v[124:127]
s_waitcnt lgkmcnt(0)
v_mfma_f32_16x16x32_bf16 v[128:131], v[176:179], a[0:3], v[128:131]
ds_read_b64_tr_b16 v[192:193], v210 offset:224
ds_read_b64_tr_b16 v[194:195], v210 offset:4832
v_mfma_f32_16x16x32_bf16 v[128:131], v[180:183], a[4:7], v[128:131]
ds_read_b64_tr_b16 v[196:197], v210 offset:9440
ds_read_b64_tr_b16 v[198:199], v210 offset:14048
v_mfma_f32_16x16x32_bf16 v[128:131], v[184:187], a[8:11], v[128:131]
ds_read_b64_tr_b16 v[200:201], v210 offset:18656
ds_read_b64_tr_b16 v[202:203], v210 offset:23264
v_mfma_f32_16x16x32_bf16 v[128:131], v[188:191], a[12:15], v[128:131]
ds_read_b64_tr_b16 v[204:205], v210 offset:27872
ds_read_b64_tr_b16 v[206:207], v210 offset:32480
v_mfma_f32_16x16x32_bf16 v[132:135], v[176:179], a[16:19], v[132:135]
v_mfma_f32_16x16x32_bf16 v[132:135], v[180:183], a[20:23], v[132:135]
buffer_load_dwordx4 a[192:195], v212, s[20:23], s88 offen sc1
v_mfma_f32_16x16x32_bf16 v[132:135], v[184:187], a[24:27], v[132:135]
v_mfma_f32_16x16x32_bf16 v[132:135], v[188:191], a[28:31], v[132:135]
v_mfma_f32_16x16x32_bf16 v[136:139], v[176:179], a[32:35], v[136:139]
buffer_load_dwordx4 a[208:211], v212, s[20:23], s88 offen offset:1024 sc1
v_mfma_f32_16x16x32_bf16 v[136:139], v[180:183], a[36:39], v[136:139]
v_mfma_f32_16x16x32_bf16 v[136:139], v[184:187], a[40:43], v[136:139]
v_mfma_f32_16x16x32_bf16 v[136:139], v[188:191], a[44:47], v[136:139]
buffer_load_dwordx4 a[224:227], v212, s[20:23], s88 offen offset:2048 sc1
v_mfma_f32_16x16x32_bf16 v[140:143], v[176:179], a[48:51], v[140:143]
v_mfma_f32_16x16x32_bf16 v[140:143], v[180:183], a[52:55], v[140:143]
v_mfma_f32_16x16x32_bf16 v[140:143], v[184:187], a[56:59], v[140:143]
buffer_load_dwordx4 a[240:243], v212, s[20:23], s88 offen offset:3072 sc1
v_mfma_f32_16x16x32_bf16 v[140:143], v[188:191], a[60:63], v[140:143]
s_waitcnt lgkmcnt(0)
v_mfma_f32_16x16x32_bf16 v[144:147], v[192:195], a[0:3], v[144:147]
ds_read_b64_tr_b16 v[176:177], v210 offset:256
ds_read_b64_tr_b16 v[178:179], v210 offset:4864
v_mfma_f32_16x16x32_bf16 v[144:147], v[196:199], a[4:7], v[144:147]
ds_read_b64_tr_b16 v[180:181], v210 offset:9472
ds_read_b64_tr_b16 v[182:183], v210 offset:14080
v_mfma_f32_16x16x32_bf16 v[144:147], v[200:203], a[8:11], v[144:147]
ds_read_b64_tr_b16 v[184:185], v210 offset:18688
ds_read_b64_tr_b16 v[186:187], v210 offset:23296
v_mfma_f32_16x16x32_bf16 v[144:147], v[204:207], a[12:15], v[144:147]
ds_read_b64_tr_b16 v[188:189], v210 offset:27904
ds_read_b64_tr_b16 v[190:191], v210 offset:32512
v_mfma_f32_16x16x32_bf16 v[148:151], v[192:195], a[16:19], v[148:151]
v_mfma_f32_16x16x32_bf16 v[148:151], v[196:199], a[20:23], v[148:151]
v_mfma_f32_16x16x32_bf16 v[148:151], v[200:203], a[24:27], v[148:151]
v_mfma_f32_16x16x32_bf16 v[148:151], v[204:207], a[28:31], v[148:151]
buffer_load_dwordx4 a[196:199], v213, s[20:23], s88 offen sc1
v_mfma_f32_16x16x32_bf16 v[152:155], v[192:195], a[32:35], v[152:155]
v_mfma_f32_16x16x32_bf16 v[152:155], v[196:199], a[36:39], v[152:155]
v_mfma_f32_16x16x32_bf16 v[152:155], v[200:203], a[40:43], v[152:155]
v_mfma_f32_16x16x32_bf16 v[152:155], v[204:207], a[44:47], v[152:155]
buffer_load_dwordx4 a[212:215], v213, s[20:23], s88 offen offset:1024 sc1
v_mfma_f32_16x16x32_bf16 v[156:159], v[192:195], a[48:51], v[156:159]
v_mfma_f32_16x16x32_bf16 v[156:159], v[196:199], a[52:55], v[156:159]
v_mfma_f32_16x16x32_bf16 v[156:159], v[200:203], a[56:59], v[156:159]
v_mfma_f32_16x16x32_bf16 v[156:159], v[204:207], a[60:63], v[156:159]
s_waitcnt lgkmcnt(0)
v_mfma_f32_16x16x32_bf16 v[160:163], v[176:179], a[0:3], v[160:163]
s_waitcnt vmcnt(40)
s_barrier
v_mfma_f32_16x16x32_bf16 v[160:163], v[180:183], a[4:7], v[160:163]
ds_read_b64_tr_b16 v[192:193], v211
ds_read_b64_tr_b16 v[194:195], v211 offset:4608
v_mfma_f32_16x16x32_bf16 v[160:163], v[184:187], a[8:11], v[160:163]
ds_read_b64_tr_b16 v[196:197], v211 offset:9216
ds_read_b64_tr_b16 v[198:199], v211 offset:13824
v_mfma_f32_16x16x32_bf16 v[160:163], v[188:191], a[12:15], v[160:163]
ds_read_b64_tr_b16 v[200:201], v211 offset:18432
ds_read_b64_tr_b16 v[202:203], v211 offset:23040
v_mfma_f32_16x16x32_bf16 v[164:167], v[176:179], a[16:19], v[164:167]
ds_read_b64_tr_b16 v[204:205], v211 offset:27648
ds_read_b64_tr_b16 v[206:207], v211 offset:32256
v_mfma_f32_16x16x32_bf16 v[164:167], v[180:183], a[20:23], v[164:167]
v_mfma_f32_16x16x32_bf16 v[164:167], v[184:187], a[24:27], v[164:167]
v_mfma_f32_16x16x32_bf16 v[164:167], v[188:191], a[28:31], v[164:167]
v_mfma_f32_16x16x32_bf16 v[168:171], v[176:179], a[32:35], v[168:171]
v_mfma_f32_16x16x32_bf16 v[168:171], v[180:183], a[36:39], v[168:171]
v_mfma_f32_16x16x32_bf16 v[168:171], v[184:187], a[40:43], v[168:171]
v_mfma_f32_16x16x32_bf16 v[168:171], v[188:191], a[44:47], v[168:171]
v_mfma_f32_16x16x32_bf16 v[172:175], v[176:179], a[48:51], v[172:175]
v_mfma_f32_16x16x32_bf16 v[172:175], v[180:183], a[52:55], v[172:175]
v_mfma_f32_16x16x32_bf16 v[172:175], v[184:187], a[56:59], v[172:175]
v_mfma_f32_16x16x32_bf16 v[172:175], v[188:191], a[60:63], v[172:175]
s_waitcnt lgkmcnt(0)
v_mfma_f32_16x16x32_bf16 v[32:35], v[192:195], a[64:67], v[32:35]
ds_read_b64_tr_b16 v[176:177], v211 offset:32
ds_read_b64_tr_b16 v[178:179], v211 offset:4640
v_mfma_f32_16x16x32_bf16 v[32:35], v[196:199], a[68:71], v[32:35]
ds_read_b64_tr_b16 v[180:181], v211 offset:9248
ds_read_b64_tr_b16 v[182:183], v211 offset:13856
v_mfma_f32_16x16x32_bf16 v[32:35], v[200:203], a[72:75], v[32:35]
ds_read_b64_tr_b16 v[184:185], v211 offset:18464
ds_read_b64_tr_b16 v[186:187], v211 offset:23072
v_mfma_f32_16x16x32_bf16 v[32:35], v[204:207], a[76:79], v[32:35]
ds_read_b64_tr_b16 v[188:189], v211 offset:27680
ds_read_b64_tr_b16 v[190:191], v211 offset:32288
v_mfma_f32_16x16x32_bf16 v[36:39], v[192:195], a[80:83], v[36:39]
s_waitcnt vmcnt(40)
v_mfma_f32_16x16x32_bf16 v[36:39], v[196:199], a[84:87], v[36:39]
buffer_load_dwordx4 a[228:231], v213, s[20:23], s88 offen offset:2048 sc1
v_mfma_f32_16x16x32_bf16 v[36:39], v[200:203], a[88:91], v[36:39]
v_mfma_f32_16x16x32_bf16 v[36:39], v[204:207], a[92:95], v[36:39]
v_mfma_f32_16x16x32_bf16 v[40:43], v[192:195], a[96:99], v[40:43]
buffer_load_dwordx4 a[244:247], v213, s[20:23], s88 offen offset:3072 sc1
v_mfma_f32_16x16x32_bf16 v[40:43], v[196:199], a[100:103], v[40:43]
v_mfma_f32_16x16x32_bf16 v[40:43], v[200:203], a[104:107], v[40:43]
v_mfma_f32_16x16x32_bf16 v[40:43], v[204:207], a[108:111], v[40:43]
buffer_load_dwordx4 a[200:203], v214, s[20:23], s88 offen sc1
v_mfma_f32_16x16x32_bf16 v[44:47], v[192:195], a[112:115], v[44:47]
v_mfma_f32_16x16x32_bf16 v[44:47], v[196:199], a[116:119], v[44:47]
v_mfma_f32_16x16x32_bf16 v[44:47], v[200:203], a[120:123], v[44:47]
buffer_load_dwordx4 a[216:219], v214, s[20:23], s88 offen offset:1024 sc1
v_mfma_f32_16x16x32_bf16 v[44:47], v[204:207], a[124:127], v[44:47]
s_waitcnt lgkmcnt(0)
v_mfma_f32_16x16x32_bf16 v[48:51], v[176:179], a[64:67], v[48:51]
ds_read_b64_tr_b16 v[192:193], v211 offset:64
ds_read_b64_tr_b16 v[194:195], v211 offset:4672
v_mfma_f32_16x16x32_bf16 v[48:51], v[180:183], a[68:71], v[48:51]
ds_read_b64_tr_b16 v[196:197], v211 offset:9280
ds_read_b64_tr_b16 v[198:199], v211 offset:13888
v_mfma_f32_16x16x32_bf16 v[48:51], v[184:187], a[72:75], v[48:51]
ds_read_b64_tr_b16 v[200:201], v211 offset:18496
ds_read_b64_tr_b16 v[202:203], v211 offset:23104
v_mfma_f32_16x16x32_bf16 v[48:51], v[188:191], a[76:79], v[48:51]
ds_read_b64_tr_b16 v[204:205], v211 offset:27712
ds_read_b64_tr_b16 v[206:207], v211 offset:32320
v_mfma_f32_16x16x32_bf16 v[52:55], v[176:179], a[80:83], v[52:55]
v_mfma_f32_16x16x32_bf16 v[52:55], v[180:183], a[84:87], v[52:55]
buffer_load_dwordx4 a[232:235], v214, s[20:23], s88 offen offset:2048 sc1
v_mfma_f32_16x16x32_bf16 v[52:55], v[184:187], a[88:91], v[52:55]
v_mfma_f32_16x16x32_bf16 v[52:55], v[188:191], a[92:95], v[52:55]
v_mfma_f32_16x16x32_bf16 v[56:59], v[176:179], a[96:99], v[56:59]
buffer_load_dwordx4 a[248:251], v214, s[20:23], s88 offen offset:3072 sc1
v_mfma_f32_16x16x32_bf16 v[56:59], v[180:183], a[100:103], v[56:59]
v_mfma_f32_16x16x32_bf16 v[56:59], v[184:187], a[104:107], v[56:59]
v_mfma_f32_16x16x32_bf16 v[56:59], v[188:191], a[108:111], v[56:59]
buffer_load_dwordx4 a[204:207], v215, s[20:23], s88 offen sc1
v_mfma_f32_16x16x32_bf16 v[60:63], v[176:179], a[112:115], v[60:63]
v_mfma_f32_16x16x32_bf16 v[60:63], v[180:183], a[116:119], v[60:63]
v_mfma_f32_16x16x32_bf16 v[60:63], v[184:187], a[120:123], v[60:63]
buffer_load_dwordx4 a[220:223], v215, s[20:23], s88 offen offset:1024 sc1
v_mfma_f32_16x16x32_bf16 v[60:63], v[188:191], a[124:127], v[60:63]
s_waitcnt lgkmcnt(0)
v_mfma_f32_16x16x32_bf16 v[64:67], v[192:195], a[64:67], v[64:67]
ds_read_b64_tr_b16 v[176:177], v211 offset:96
ds_read_b64_tr_b16 v[178:179], v211 offset:4704
v_mfma_f32_16x16x32_bf16 v[64:67], v[196:199], a[68:71], v[64:67]
ds_read_b64_tr_b16 v[180:181], v211 offset:9312
ds_read_b64_tr_b16 v[182:183], v211 offset:13920
v_mfma_f32_16x16x32_bf16 v[64:67], v[200:203], a[72:75], v[64:67]
ds_read_b64_tr_b16 v[184:185], v211 offset:18528
ds_read_b64_tr_b16 v[186:187], v211 offset:23136
v_mfma_f32_16x16x32_bf16 v[64:67], v[204:207], a[76:79], v[64:67]
ds_read_b64_tr_b16 v[188:189], v211 offset:27744
ds_read_b64_tr_b16 v[190:191], v211 offset:32352
v_mfma_f32_16x16x32_bf16 v[68:71], v[192:195], a[80:83], v[68:71]
v_mfma_f32_16x16x32_bf16 v[68:71], v[196:199], a[84:87], v[68:71]
buffer_load_dwordx4 a[236:239], v215, s[20:23], s88 offen offset:2048 sc1
v_mfma_f32_16x16x32_bf16 v[68:71], v[200:203], a[88:91], v[68:71]
v_mfma_f32_16x16x32_bf16 v[68:71], v[204:207], a[92:95], v[68:71]
v_mfma_f32_16x16x32_bf16 v[72:75], v[192:195], a[96:99], v[72:75]
buffer_load_dwordx4 a[252:255], v215, s[20:23], s88 offen offset:3072 sc1
s_add_u32 s88, s88, 0x80000
v_mfma_f32_16x16x32_bf16 v[72:75], v[196:199], a[100:103], v[72:75]
v_mfma_f32_16x16x32_bf16 v[72:75], v[200:203], a[104:107], v[72:75]
s_add_u32 m0, s51, 0x12000
v_mfma_f32_16x16x32_bf16 v[72:75], v[204:207], a[108:111], v[72:75]
buffer_load_dwordx4 v242, s[16:19], s87 offen lds
v_mfma_f32_16x16x32_bf16 v[76:79], v[192:195], a[112:115], v[76:79]
v_mfma_f32_16x16x32_bf16 v[76:79], v[196:199], a[116:119], v[76:79]
s_add_u32 m0, s51, 0x12400
v_mfma_f32_16x16x32_bf16 v[76:79], v[200:203], a[120:123], v[76:79]
buffer_load_dwordx4 v243, s[16:19], s87 offen lds
v_mfma_f32_16x16x32_bf16 v[76:79], v[204:207], a[124:127], v[76:79]
s_waitcnt lgkmcnt(0)
v_mfma_f32_16x16x32_bf16 v[80:83], v[176:179], a[64:67], v[80:83]
ds_read_b64_tr_b16 v[192:193], v211 offset:128
ds_read_b64_tr_b16 v[194:195], v211 offset:4736
v_mfma_f32_16x16x32_bf16 v[80:83], v[180:183], a[68:71], v[80:83]
ds_read_b64_tr_b16 v[196:197], v211 offset:9344
ds_read_b64_tr_b16 v[198:199], v211 offset:13952
v_mfma_f32_16x16x32_bf16 v[80:83], v[184:187], a[72:75], v[80:83]
ds_read_b64_tr_b16 v[200:201], v211 offset:18560
ds_read_b64_tr_b16 v[202:203], v211 offset:23168
v_mfma_f32_16x16x32_bf16 v[80:83], v[188:191], a[76:79], v[80:83]
ds_read_b64_tr_b16 v[204:205], v211 offset:27776
ds_read_b64_tr_b16 v[206:207], v211 offset:32384
v_mfma_f32_16x16x32_bf16 v[84:87], v[176:179], a[80:83], v[84:87]
s_add_u32 m0, s51, 0x12800
v_mfma_f32_16x16x32_bf16 v[84:87], v[180:183], a[84:87], v[84:87]
buffer_load_dwordx4 v244, s[16:19], s87 offen lds
v_mfma_f32_16x16x32_bf16 v[84:87], v[184:187], a[88:91], v[84:87]
v_mfma_f32_16x16x32_bf16 v[84:87], v[188:191], a[92:95], v[84:87]
s_add_u32 m0, s51, 0x12c00
v_mfma_f32_16x16x32_bf16 v[88:91], v[176:179], a[96:99], v[88:91]
buffer_load_dwordx4 v245, s[16:19], s87 offen lds
v_mfma_f32_16x16x32_bf16 v[88:91], v[180:183], a[100:103], v[88:91]
v_mfma_f32_16x16x32_bf16 v[88:91], v[184:187], a[104:107], v[88:91]
s_add_u32 m0, s51, 0x13000
v_mfma_f32_16x16x32_bf16 v[88:91], v[188:191], a[108:111], v[88:91]
buffer_load_dwordx4 v246, s[16:19], s87 offen lds
v_mfma_f32_16x16x32_bf16 v[92:95], v[176:179], a[112:115], v[92:95]
v_mfma_f32_16x16x32_bf16 v[92:95], v[180:183], a[116:119], v[92:95]
s_add_u32 m0, s51, 0x13400
v_mfma_f32_16x16x32_bf16 v[92:95], v[184:187], a[120:123], v[92:95]
buffer_load_dwordx4 v247, s[16:19], s87 offen lds
v_mfma_f32_16x16x32_bf16 v[92:95], v[188:191], a[124:127], v[92:95]
s_waitcnt lgkmcnt(0)
v_mfma_f32_16x16x32_bf16 v[96:99], v[192:195], a[64:67], v[96:99]
ds_read_b64_tr_b16 v[176:177], v211 offset:160
ds_read_b64_tr_b16 v[178:179], v211 offset:4768
v_mfma_f32_16x16x32_bf16 v[96:99], v[196:199], a[68:71], v[96:99]
ds_read_b64_tr_b16 v[180:181], v211 offset:9376
ds_read_b64_tr_b16 v[182:183], v211 offset:13984
v_mfma_f32_16x16x32_bf16 v[96:99], v[200:203], a[72:75], v[96:99]
ds_read_b64_tr_b16 v[184:185], v211 offset:18592
ds_read_b64_tr_b16 v[186:187], v211 offset:23200
v_mfma_f32_16x16x32_bf16 v[96:99], v[204:207], a[76:79], v[96:99]
ds_read_b64_tr_b16 v[188:189], v211 offset:27808
ds_read_b64_tr_b16 v[190:191], v211 offset:32416
v_mfma_f32_16x16x32_bf16 v[100:103], v[192:195], a[80:83], v[100:103]
s_waitcnt vmcnt(40)
s_add_u32 m0, s51, 0x13800
v_mfma_f32_16x16x32_bf16 v[100:103], v[196:199], a[84:87], v[100:103]
buffer_load_dwordx4 v248, s[16:19], s87 offen lds
v_mfma_f32_16x16x32_bf16 v[100:103], v[200:203], a[88:91], v[100:103]
v_mfma_f32_16x16x32_bf16 v[100:103], v[204:207], a[92:95], v[100:103]
s_add_u32 m0, s51, 0x13c00
v_mfma_f32_16x16x32_bf16 v[104:107], v[192:195], a[96:99], v[104:107]
buffer_load_dwordx4 v249, s[16:19], s87 offen lds
v_mfma_f32_16x16x32_bf16 v[104:107], v[196:199], a[100:103], v[104:107]
v_mfma_f32_16x16x32_bf16 v[104:107], v[200:203], a[104:107], v[104:107]
s_add_u32 m0, s51, 0x14000
v_mfma_f32_16x16x32_bf16 v[104:107], v[204:207], a[108:111], v[104:107]
buffer_load_dwordx4 v250, s[16:19], s87 offen lds
s_add_u32 s87, s87, 0x24000
v_mfma_f32_16x16x32_bf16 v[108:111], v[192:195], a[112:115], v[108:111]
v_mfma_f32_16x16x32_bf16 v[108:111], v[196:199], a[116:119], v[108:111]
v_mfma_f32_16x16x32_bf16 v[108:111], v[200:203], a[120:123], v[108:111]
buffer_load_dwordx4 a[0:3], v212, s[20:23], s88 offen sc1
v_mfma_f32_16x16x32_bf16 v[108:111], v[204:207], a[124:127], v[108:111]
s_waitcnt lgkmcnt(0)
v_mfma_f32_16x16x32_bf16 v[112:115], v[176:179], a[64:67], v[112:115]
ds_read_b64_tr_b16 v[192:193], v211 offset:192
ds_read_b64_tr_b16 v[194:195], v211 offset:4800
v_mfma_f32_16x16x32_bf16 v[112:115], v[180:183], a[68:71], v[112:115]
ds_read_b64_tr_b16 v[196:197], v211 offset:9408
ds_read_b64_tr_b16 v[198:199], v211 offset:14016
v_mfma_f32_16x16x32_bf16 v[112:115], v[184:187], a[72:75], v[112:115]
ds_read_b64_tr_b16 v[200:201], v211 offset:18624
ds_read_b64_tr_b16 v[202:203], v211 offset:23232
v_mfma_f32_16x16x32_bf16 v[112:115], v[188:191], a[76:79], v[112:115]
ds_read_b64_tr_b16 v[204:205], v211 offset:27840
ds_read_b64_tr_b16 v[206:207], v211 offset:32448
v_mfma_f32_16x16x32_bf16 v[116:119], v[176:179], a[80:83], v[116:119]
v_mfma_f32_16x16x32_bf16 v[116:119], v[180:183], a[84:87], v[116:119]
buffer_load_dwordx4 a[16:19], v212, s[20:23], s88 offen offset:1024 sc1
v_mfma_f32_16x16x32_bf16 v[116:119], v[184:187], a[88:91], v[116:119]
v_mfma_f32_16x16x32_bf16 v[116:119], v[188:191], a[92:95], v[116:119]
v_mfma_f32_16x16x32_bf16 v[120:123], v[176:179], a[96:99], v[120:123]
buffer_load_dwordx4 a[32:35], v212, s[20:23], s88 offen offset:2048 sc1
v_mfma_f32_16x16x32_bf16 v[120:123], v[180:183], a[100:103], v[120:123]
v_mfma_f32_16x16x32_bf16 v[120:123], v[184:187], a[104:107], v[120:123]
v_mfma_f32_16x16x32_bf16 v[120:123], v[188:191], a[108:111], v[120:123]
buffer_load_dwordx4 a[48:51], v212, s[20:23], s88 offen offset:3072 sc1
v_mfma_f32_16x16x32_bf16 v[124:127], v[176:179], a[112:115], v[124:127]
v_mfma_f32_16x16x32_bf16 v[124:127], v[180:183], a[116:119], v[124:127]
v_mfma_f32_16x16x32_bf16 v[124:127], v[184:187], a[120:123], v[124:127]
buffer_load_dwordx4 a[4:7], v213, s[20:23], s88 offen sc1
v_mfma_f32_16x16x32_bf16 v[124:127], v[188:191], a[124:127], v[124:127]
s_waitcnt lgkmcnt(0)
v_mfma_f32_16x16x32_bf16 v[128:131], v[192:195], a[64:67], v[128:131]
ds_read_b64_tr_b16 v[176:177], v211 offset:224
ds_read_b64_tr_b16 v[178:179], v211 offset:4832
v_mfma_f32_16x16x32_bf16 v[128:131], v[196:199], a[68:71], v[128:131]
ds_read_b64_tr_b16 v[180:181], v211 offset:9440
ds_read_b64_tr_b16 v[182:183], v211 offset:14048
v_mfma_f32_16x16x32_bf16 v[128:131], v[200:203], a[72:75], v[128:131]
ds_read_b64_tr_b16 v[184:185], v211 offset:18656
ds_read_b64_tr_b16 v[186:187], v211 offset:23264
v_mfma_f32_16x16x32_bf16 v[128:131], v[204:207], a[76:79], v[128:131]
ds_read_b64_tr_b16 v[188:189], v211 offset:27872
ds_read_b64_tr_b16 v[190:191], v211 offset:32480
v_mfma_f32_16x16x32_bf16 v[132:135], v[192:195], a[80:83], v[132:135]
v_mfma_f32_16x16x32_bf16 v[132:135], v[196:199], a[84:87], v[132:135]
buffer_load_dwordx4 a[20:23], v213, s[20:23], s88 offen offset:1024 sc1
v_mfma_f32_16x16x32_bf16 v[132:135], v[200:203], a[88:91], v[132:135]
v_mfma_f32_16x16x32_bf16 v[132:135], v[204:207], a[92:95], v[132:135]
v_mfma_f32_16x16x32_bf16 v[136:139], v[192:195], a[96:99], v[136:139]
buffer_load_dwordx4 a[36:39], v213, s[20:23], s88 offen offset:2048 sc1
v_mfma_f32_16x16x32_bf16 v[136:139], v[196:199], a[100:103], v[136:139]
v_mfma_f32_16x16x32_bf16 v[136:139], v[200:203], a[104:107], v[136:139]
v_mfma_f32_16x16x32_bf16 v[136:139], v[204:207], a[108:111], v[136:139]
buffer_load_dwordx4 a[52:55], v213, s[20:23], s88 offen offset:3072 sc1
v_mfma_f32_16x16x32_bf16 v[140:143], v[192:195], a[112:115], v[140:143]
v_mfma_f32_16x16x32_bf16 v[140:143], v[196:199], a[116:119], v[140:143]
v_mfma_f32_16x16x32_bf16 v[140:143], v[200:203], a[120:123], v[140:143]
buffer_load_dwordx4 a[8:11], v214, s[20:23], s88 offen sc1
v_mfma_f32_16x16x32_bf16 v[140:143], v[204:207], a[124:127], v[140:143]
s_waitcnt lgkmcnt(0)
v_mfma_f32_16x16x32_bf16 v[144:147], v[176:179], a[64:67], v[144:147]
ds_read_b64_tr_b16 v[192:193], v211 offset:256
ds_read_b64_tr_b16 v[194:195], v211 offset:4864
v_mfma_f32_16x16x32_bf16 v[144:147], v[180:183], a[68:71], v[144:147]
ds_read_b64_tr_b16 v[196:197], v211 offset:9472
ds_read_b64_tr_b16 v[198:199], v211 offset:14080
v_mfma_f32_16x16x32_bf16 v[144:147], v[184:187], a[72:75], v[144:147]
ds_read_b64_tr_b16 v[200:201], v211 offset:18688
ds_read_b64_tr_b16 v[202:203], v211 offset:23296
v_mfma_f32_16x16x32_bf16 v[144:147], v[188:191], a[76:79], v[144:147]
ds_read_b64_tr_b16 v[204:205], v211 offset:27904
ds_read_b64_tr_b16 v[206:207], v211 offset:32512
v_mfma_f32_16x16x32_bf16 v[148:151], v[176:179], a[80:83], v[148:151]
v_mfma_f32_16x16x32_bf16 v[148:151], v[180:183], a[84:87], v[148:151]
v_mfma_f32_16x16x32_bf16 v[148:151], v[184:187], a[88:91], v[148:151]
v_mfma_f32_16x16x32_bf16 v[148:151], v[188:191], a[92:95], v[148:151]
buffer_load_dwordx4 a[24:27], v214, s[20:23], s88 offen offset:1024 sc1
v_mfma_f32_16x16x32_bf16 v[152:155], v[176:179], a[96:99], v[152:155]
v_mfma_f32_16x16x32_bf16 v[152:155], v[180:183], a[100:103], v[152:155]
v_mfma_f32_16x16x32_bf16 v[152:155], v[184:187], a[104:107], v[152:155]
v_mfma_f32_16x16x32_bf16 v[152:155], v[188:191], a[108:111], v[152:155]
buffer_load_dwordx4 a[40:43], v214, s[20:23], s88 offen offset:2048 sc1
v_mfma_f32_16x16x32_bf16 v[156:159], v[176:179], a[112:115], v[156:159]
v_mfma_f32_16x16x32_bf16 v[156:159], v[180:183], a[116:119], v[156:159]
v_mfma_f32_16x16x32_bf16 v[156:159], v[184:187], a[120:123], v[156:159]
v_mfma_f32_16x16x32_bf16 v[156:159], v[188:191], a[124:127], v[156:159]
s_waitcnt lgkmcnt(0)
v_mfma_f32_16x16x32_bf16 v[160:163], v[192:195], a[64:67], v[160:163]
s_waitcnt vmcnt(45)
s_barrier
v_mfma_f32_16x16x32_bf16 v[160:163], v[196:199], a[68:71], v[160:163]
ds_read_b64_tr_b16 v[176:177], v208
ds_read_b64_tr_b16 v[178:179], v208 offset:4608
v_mfma_f32_16x16x32_bf16 v[160:163], v[200:203], a[72:75], v[160:163]
ds_read_b64_tr_b16 v[180:181], v208 offset:9216
ds_read_b64_tr_b16 v[182:183], v208 offset:13824
v_mfma_f32_16x16x32_bf16 v[160:163], v[204:207], a[76:79], v[160:163]
ds_read_b64_tr_b16 v[184:185], v208 offset:18432
ds_read_b64_tr_b16 v[186:187], v208 offset:23040
v_mfma_f32_16x16x32_bf16 v[164:167], v[192:195], a[80:83], v[164:167]
ds_read_b64_tr_b16 v[188:189], v208 offset:27648
ds_read_b64_tr_b16 v[190:191], v208 offset:32256
v_mfma_f32_16x16x32_bf16 v[164:167], v[196:199], a[84:87], v[164:167]
v_mfma_f32_16x16x32_bf16 v[164:167], v[200:203], a[88:91], v[164:167]
v_mfma_f32_16x16x32_bf16 v[164:167], v[204:207], a[92:95], v[164:167]
v_mfma_f32_16x16x32_bf16 v[168:171], v[192:195], a[96:99], v[168:171]
v_mfma_f32_16x16x32_bf16 v[168:171], v[196:199], a[100:103], v[168:171]
v_mfma_f32_16x16x32_bf16 v[168:171], v[200:203], a[104:107], v[168:171]
v_mfma_f32_16x16x32_bf16 v[168:171], v[204:207], a[108:111], v[168:171]
v_mfma_f32_16x16x32_bf16 v[172:175], v[192:195], a[112:115], v[172:175]
v_mfma_f32_16x16x32_bf16 v[172:175], v[196:199], a[116:119], v[172:175]
v_mfma_f32_16x16x32_bf16 v[172:175], v[200:203], a[120:123], v[172:175]
v_mfma_f32_16x16x32_bf16 v[172:175], v[204:207], a[124:127], v[172:175]
s_waitcnt lgkmcnt(0)
v_mfma_f32_16x16x32_bf16 v[32:35], v[176:179], a[128:131], v[32:35]
ds_read_b64_tr_b16 v[192:193], v208 offset:32
ds_read_b64_tr_b16 v[194:195], v208 offset:4640
v_mfma_f32_16x16x32_bf16 v[32:35], v[180:183], a[132:135], v[32:35]
ds_read_b64_tr_b16 v[196:197], v208 offset:9248
ds_read_b64_tr_b16 v[198:199], v208 offset:13856
v_mfma_f32_16x16x32_bf16 v[32:35], v[184:187], a[136:139], v[32:35]
ds_read_b64_tr_b16 v[200:201], v208 offset:18464
ds_read_b64_tr_b16 v[202:203], v208 offset:23072
v_mfma_f32_16x16x32_bf16 v[32:35], v[188:191], a[140:143], v[32:35]
ds_read_b64_tr_b16 v[204:205], v208 offset:27680
ds_read_b64_tr_b16 v[206:207], v208 offset:32288
v_mfma_f32_16x16x32_bf16 v[36:39], v[176:179], a[144:147], v[36:39]
s_waitcnt vmcnt(40)
v_mfma_f32_16x16x32_bf16 v[36:39], v[180:183], a[148:151], v[36:39]
buffer_load_dwordx4 a[56:59], v214, s[20:23], s88 offen offset:3072 sc1
v_mfma_f32_16x16x32_bf16 v[36:39], v[184:187], a[152:155], v[36:39]
v_mfma_f32_16x16x32_bf16 v[36:39], v[188:191], a[156:159], v[36:39]
v_mfma_f32_16x16x32_bf16 v[40:43], v[176:179], a[160:163], v[40:43]
buffer_load_dwordx4 a[12:15], v215, s[20:23], s88 offen sc1
v_mfma_f32_16x16x32_bf16 v[40:43], v[180:183], a[164:167], v[40:43]
v_mfma_f32_16x16x32_bf16 v[40:43], v[184:187], a[168:171], v[40:43]
v_mfma_f32_16x16x32_bf16 v[40:43], v[188:191], a[172:175], v[40:43]
buffer_load_dwordx4 a[28:31], v215, s[20:23], s88 offen offset:1024 sc1
v_mfma_f32_16x16x32_bf16 v[44:47], v[176:179], a[176:179], v[44:47]
v_mfma_f32_16x16x32_bf16 v[44:47], v[180:183], a[180:183], v[44:47]
v_mfma_f32_16x16x32_bf16 v[44:47], v[184:187], a[184:187], v[44:47]
buffer_load_dwordx4 a[44:47], v215, s[20:23], s88 offen offset:2048 sc1
v_mfma_f32_16x16x32_bf16 v[44:47], v[188:191], a[188:191], v[44:47]
s_waitcnt lgkmcnt(0)
v_mfma_f32_16x16x32_bf16 v[48:51], v[192:195], a[128:131], v[48:51]
ds_read_b64_tr_b16 v[176:177], v208 offset:64
ds_read_b64_tr_b16 v[178:179], v208 offset:4672
v_mfma_f32_16x16x32_bf16 v[48:51], v[196:199], a[132:135], v[48:51]
ds_read_b64_tr_b16 v[180:181], v208 offset:9280
ds_read_b64_tr_b16 v[182:183], v208 offset:13888
v_mfma_f32_16x16x32_bf16 v[48:51], v[200:203], a[136:139], v[48:51]
ds_read_b64_tr_b16 v[184:185], v208 offset:18496
ds_read_b64_tr_b16 v[186:187], v208 offset:23104
v_mfma_f32_16x16x32_bf16 v[48:51], v[204:207], a[140:143], v[48:51]
ds_read_b64_tr_b16 v[188:189], v208 offset:27712
ds_read_b64_tr_b16 v[190:191], v208 offset:32320
v_mfma_f32_16x16x32_bf16 v[52:55], v[192:195], a[144:147], v[52:55]
v_mfma_f32_16x16x32_bf16 v[52:55], v[196:199], a[148:151], v[52:55]
buffer_load_dwordx4 a[60:63], v215, s[20:23], s88 offen offset:3072 sc1
s_add_u32 s88, s88, 0x80000
v_mfma_f32_16x16x32_bf16 v[52:55], v[200:203], a[152:155], v[52:55]
v_mfma_f32_16x16x32_bf16 v[52:55], v[204:207], a[156:159], v[52:55]
s_add_u32 m0, s51, 0x1b000
v_mfma_f32_16x16x32_bf16 v[56:59], v[192:195], a[160:163], v[56:59]
buffer_load_dwordx4 v242, s[16:19], s87 offen lds
v_mfma_f32_16x16x32_bf16 v[56:59], v[196:199], a[164:167], v[56:59]
v_mfma_f32_16x16x32_bf16 v[56:59], v[200:203], a[168:171], v[56:59]
s_add_u32 m0, s51, 0x1b400
v_mfma_f32_16x16x32_bf16 v[56:59], v[204:207], a[172:175], v[56:59]
buffer_load_dwordx4 v243, s[16:19], s87 offen lds
v_mfma_f32_16x16x32_bf16 v[60:63], v[192:195], a[176:179], v[60:63]
v_mfma_f32_16x16x32_bf16 v[60:63], v[196:199], a[180:183], v[60:63]
s_add_u32 m0, s51, 0x1b800
v_mfma_f32_16x16x32_bf16 v[60:63], v[200:203], a[184:187], v[60:63]
buffer_load_dwordx4 v244, s[16:19], s87 offen lds
v_mfma_f32_16x16x32_bf16 v[60:63], v[204:207], a[188:191], v[60:63]
s_waitcnt lgkmcnt(0)
v_mfma_f32_16x16x32_bf16 v[64:67], v[176:179], a[128:131], v[64:67]
ds_read_b64_tr_b16 v[192:193], v208 offset:96
ds_read_b64_tr_b16 v[194:195], v208 offset:4704
v_mfma_f32_16x16x32_bf16 v[64:67], v[180:183], a[132:135], v[64:67]
ds_read_b64_tr_b16 v[196:197], v208 offset:9312
ds_read_b64_tr_b16 v[198:199], v208 offset:13920
v_mfma_f32_16x16x32_bf16 v[64:67], v[184:187], a[136:139], v[64:67]
ds_read_b64_tr_b16 v[200:201], v208 offset:18528
ds_read_b64_tr_b16 v[202:203], v208 offset:23136
v_mfma_f32_16x16x32_bf16 v[64:67], v[188:191], a[140:143], v[64:67]
ds_read_b64_tr_b16 v[204:205], v208 offset:27744
ds_read_b64_tr_b16 v[206:207], v208 offset:32352
v_mfma_f32_16x16x32_bf16 v[68:71], v[176:179], a[144:147], v[68:71]
s_add_u32 m0, s51, 0x1bc00
v_mfma_f32_16x16x32_bf16 v[68:71], v[180:183], a[148:151], v[68:71]
buffer_load_dwordx4 v245, s[16:19], s87 offen lds
v_mfma_f32_16x16x32_bf16 v[68:71], v[184:187], a[152:155], v[68:71]
v_mfma_f32_16x16x32_bf16 v[68:71], v[188:191], a[156:159], v[68:71]
s_add_u32 m0, s51, 0x1c000
v_mfma_f32_16x16x32_bf16 v[72:75], v[176:179], a[160:163], v[72:75]
buffer_load_dwordx4 v246, s[16:19], s87 offen lds
v_mfma_f32_16x16x32_bf16 v[72:75], v[180:183], a[164:167], v[72:75]
v_mfma_f32_16x16x32_bf16 v[72:75], v[184:187], a[168:171], v[72:75]
s_add_u32 m0, s51, 0x1c400
v_mfma_f32_16x16x32_bf16 v[72:75], v[188:191], a[172:175], v[72:75]
buffer_load_dwordx4 v247, s[16:19], s87 offen lds
v_mfma_f32_16x16x32_bf16 v[76:79], v[176:179], a[176:179], v[76:79]
v_mfma_f32_16x16x32_bf16 v[76:79], v[180:183], a[180:183], v[76:79]
s_add_u32 m0, s51, 0x1c800
v_mfma_f32_16x16x32_bf16 v[76:79], v[184:187], a[184:187], v[76:79]
buffer_load_dwordx4 v248, s[16:19], s87 offen lds
v_mfma_f32_16x16x32_bf16 v[76:79], v[188:191], a[188:191], v[76:79]
s_waitcnt lgkmcnt(0)
v_mfma_f32_16x16x32_bf16 v[80:83], v[192:195], a[128:131], v[80:83]
ds_read_b64_tr_b16 v[176:177], v208 offset:128
ds_read_b64_tr_b16 v[178:179], v208 offset:4736
v_mfma_f32_16x16x32_bf16 v[80:83], v[196:199], a[132:135], v[80:83]
ds_read_b64_tr_b16 v[180:181], v208 offset:9344
ds_read_b64_tr_b16 v[182:183], v208 offset:13952
v_mfma_f32_16x16x32_bf16 v[80:83], v[200:203], a[136:139], v[80:83]
ds_read_b64_tr_b16 v[184:185], v208 offset:18560
ds_read_b64_tr_b16 v[186:187], v208 offset:23168
v_mfma_f32_16x16x32_bf16 v[80:83], v[204:207], a[140:143], v[80:83]
ds_read_b64_tr_b16 v[188:189], v208 offset:27776
ds_read_b64_tr_b16 v[190:191], v208 offset:32384
v_mfma_f32_16x16x32_bf16 v[84:87], v[192:195], a[144:147], v[84:87]
s_add_u32 m0, s51, 0x1cc00
v_mfma_f32_16x16x32_bf16 v[84:87], v[196:199], a[148:151], v[84:87]
buffer_load_dwordx4 v249, s[16:19], s87 offen lds
v_mfma_f32_16x16x32_bf16 v[84:87], v[200:203], a[152:155], v[84:87]
v_mfma_f32_16x16x32_bf16 v[84:87], v[204:207], a[156:159], v[84:87]
s_add_u32 m0, s51, 0x1d000
v_mfma_f32_16x16x32_bf16 v[88:91], v[192:195], a[160:163], v[88:91]
buffer_load_dwordx4 v250, s[16:19], s87 offen lds
s_add_u32 s87, s87, 0x24000
v_mfma_f32_16x16x32_bf16 v[88:91], v[196:199], a[164:167], v[88:91]
v_mfma_f32_16x16x32_bf16 v[88:91], v[200:203], a[168:171], v[88:91]
v_mfma_f32_16x16x32_bf16 v[88:91], v[204:207], a[172:175], v[88:91]
buffer_load_dwordx4 a[64:67], v212, s[20:23], s88 offen sc1
v_mfma_f32_16x16x32_bf16 v[92:95], v[192:195], a[176:179], v[92:95]
v_mfma_f32_16x16x32_bf16 v[92:95], v[196:199], a[180:183], v[92:95]
v_mfma_f32_16x16x32_bf16 v[92:95], v[200:203], a[184:187], v[92:95]
buffer_load_dwordx4 a[80:83], v212, s[20:23], s88 offen offset:1024 sc1
v_mfma_f32_16x16x32_bf16 v[92:95], v[204:207], a[188:191], v[92:95]
s_waitcnt lgkmcnt(0)
v_mfma_f32_16x16x32_bf16 v[96:99], v[176:179], a[128:131], v[96:99]
ds_read_b64_tr_b16 v[192:193], v208 offset:160
ds_read_b64_tr_b16 v[194:195], v208 offset:4768
v_mfma_f32_16x16x32_bf16 v[96:99], v[180:183], a[132:135], v[96:99]
ds_read_b64_tr_b16 v[196:197], v208 offset:9376
ds_read_b64_tr_b16 v[198:199], v208 offset:13984
v_mfma_f32_16x16x32_bf16 v[96:99], v[184:187], a[136:139], v[96:99]
ds_read_b64_tr_b16 v[200:201], v208 offset:18592
ds_read_b64_tr_b16 v[202:203], v208 offset:23200
v_mfma_f32_16x16x32_bf16 v[96:99], v[188:191], a[140:143], v[96:99]
ds_read_b64_tr_b16 v[204:205], v208 offset:27808
ds_read_b64_tr_b16 v[206:207], v208 offset:32416
v_mfma_f32_16x16x32_bf16 v[100:103], v[176:179], a[144:147], v[100:103]
s_waitcnt vmcnt(40)
v_mfma_f32_16x16x32_bf16 v[100:103], v[180:183], a[148:151], v[100:103]
buffer_load_dwordx4 a[96:99], v212, s[20:23], s88 offen offset:2048 sc1
v_mfma_f32_16x16x32_bf16 v[100:103], v[184:187], a[152:155], v[100:103]
v_mfma_f32_16x16x32_bf16 v[100:103], v[188:191], a[156:159], v[100:103]
v_mfma_f32_16x16x32_bf16 v[104:107], v[176:179], a[160:163], v[104:107]
buffer_load_dwordx4 a[112:115], v212, s[20:23], s88 offen offset:3072 sc1
v_mfma_f32_16x16x32_bf16 v[104:107], v[180:183], a[164:167], v[104:107]
v_mfma_f32_16x16x32_bf16 v[104:107], v[184:187], a[168:171], v[104:107]
v_mfma_f32_16x16x32_bf16 v[104:107], v[188:191], a[172:175], v[104:107]
buffer_load_dwordx4 a[68:71], v213, s[20:23], s88 offen sc1
v_mfma_f32_16x16x32_bf16 v[108:111], v[176:179], a[176:179], v[108:111]
v_mfma_f32_16x16x32_bf16 v[108:111], v[180:183], a[180:183], v[108:111]
v_mfma_f32_16x16x32_bf16 v[108:111], v[184:187], a[184:187], v[108:111]
buffer_load_dwordx4 a[84:87], v213, s[20:23], s88 offen offset:1024 sc1
v_mfma_f32_16x16x32_bf16 v[108:111], v[188:191], a[188:191], v[108:111]
s_waitcnt lgkmcnt(0)
v_mfma_f32_16x16x32_bf16 v[112:115], v[192:195], a[128:131], v[112:115]
ds_read_b64_tr_b16 v[176:177], v208 offset:192
ds_read_b64_tr_b16 v[178:179], v208 offset:4800
v_mfma_f32_16x16x32_bf16 v[112:115], v[196:199], a[132:135], v[112:115]
ds_read_b64_tr_b16 v[180:181], v208 offset:9408
ds_read_b64_tr_b16 v[182:183], v208 offset:14016
v_mfma_f32_16x16x32_bf16 v[112:115], v[200:203], a[136:139], v[112:115]
ds_read_b64_tr_b16 v[184:185], v208 offset:18624
ds_read_b64_tr_b16 v[186:187], v208 offset:23232
v_mfma_f32_16x16x32_bf16 v[112:115], v[204:207], a[140:143], v[112:115]
ds_read_b64_tr_b16 v[188:189], v208 offset:27840
ds_read_b64_tr_b16 v[190:191], v208 offset:32448
v_mfma_f32_16x16x32_bf16 v[116:119], v[192:195], a[144:147], v[116:119]
v_mfma_f32_16x16x32_bf16 v[116:119], v[196:199], a[148:151], v[116:119]
buffer_load_dwordx4 a[100:103], v213, s[20:23], s88 offen offset:2048 sc1
v_mfma_f32_16x16x32_bf16 v[116:119], v[200:203], a[152:155], v[116:119]
v_mfma_f32_16x16x32_bf16 v[116:119], v[204:207], a[156:159], v[116:119]
v_mfma_f32_16x16x32_bf16 v[120:123], v[192:195], a[160:163], v[120:123]
buffer_load_dwordx4 a[116:119], v213, s[20:23], s88 offen offset:3072 sc1
v_mfma_f32_16x16x32_bf16 v[120:123], v[196:199], a[164:167], v[120:123]
v_mfma_f32_16x16x32_bf16 v[120:123], v[200:203], a[168:171], v[120:123]
v_mfma_f32_16x16x32_bf16 v[120:123], v[204:207], a[172:175], v[120:123]
buffer_load_dwordx4 a[72:75], v214, s[20:23], s88 offen sc1
v_mfma_f32_16x16x32_bf16 v[124:127], v[192:195], a[176:179], v[124:127]
v_mfma_f32_16x16x32_bf16 v[124:127], v[196:199], a[180:183], v[124:127]
v_mfma_f32_16x16x32_bf16 v[124:127], v[200:203], a[184:187], v[124:127]
buffer_load_dwordx4 a[88:91], v214, s[20:23], s88 offen offset:1024 sc1
v_mfma_f32_16x16x32_bf16 v[124:127], v[204:207], a[188:191], v[124:127]
s_waitcnt lgkmcnt(0)
v_mfma_f32_16x16x32_bf16 v[128:131], v[176:179], a[128:131], v[128:131]
ds_read_b64_tr_b16 v[192:193], v208 offset:224
ds_read_b64_tr_b16 v[194:195], v208 offset:4832
v_mfma_f32_16x16x32_bf16 v[128:131], v[180:183], a[132:135], v[128:131]
ds_read_b64_tr_b16 v[196:197], v208 offset:9440
ds_read_b64_tr_b16 v[198:199], v208 offset:14048
v_mfma_f32_16x16x32_bf16 v[128:131], v[184:187], a[136:139], v[128:131]
ds_read_b64_tr_b16 v[200:201], v208 offset:18656
ds_read_b64_tr_b16 v[202:203], v208 offset:23264
v_mfma_f32_16x16x32_bf16 v[128:131], v[188:191], a[140:143], v[128:131]
ds_read_b64_tr_b16 v[204:205], v208 offset:27872
ds_read_b64_tr_b16 v[206:207], v208 offset:32480
v_mfma_f32_16x16x32_bf16 v[132:135], v[176:179], a[144:147], v[132:135]
v_mfma_f32_16x16x32_bf16 v[132:135], v[180:183], a[148:151], v[132:135]
buffer_load_dwordx4 a[104:107], v214, s[20:23], s88 offen offset:2048 sc1
v_mfma_f32_16x16x32_bf16 v[132:135], v[184:187], a[152:155], v[132:135]
v_mfma_f32_16x16x32_bf16 v[132:135], v[188:191], a[156:159], v[132:135]
v_mfma_f32_16x16x32_bf16 v[136:139], v[176:179], a[160:163], v[136:139]
buffer_load_dwordx4 a[120:123], v214, s[20:23], s88 offen offset:3072 sc1
v_mfma_f32_16x16x32_bf16 v[136:139], v[180:183], a[164:167], v[136:139]
v_mfma_f32_16x16x32_bf16 v[136:139], v[184:187], a[168:171], v[136:139]
v_mfma_f32_16x16x32_bf16 v[136:139], v[188:191], a[172:175], v[136:139]
buffer_load_dwordx4 a[76:79], v215, s[20:23], s88 offen sc1
v_mfma_f32_16x16x32_bf16 v[140:143], v[176:179], a[176:179], v[140:143]
v_mfma_f32_16x16x32_bf16 v[140:143], v[180:183], a[180:183], v[140:143]
v_mfma_f32_16x16x32_bf16 v[140:143], v[184:187], a[184:187], v[140:143]
buffer_load_dwordx4 a[92:95], v215, s[20:23], s88 offen offset:1024 sc1
v_mfma_f32_16x16x32_bf16 v[140:143], v[188:191], a[188:191], v[140:143]
s_waitcnt lgkmcnt(0)
v_mfma_f32_16x16x32_bf16 v[144:147], v[192:195], a[128:131], v[144:147]
ds_read_b64_tr_b16 v[176:177], v208 offset:256
ds_read_b64_tr_b16 v[178:179], v208 offset:4864
v_mfma_f32_16x16x32_bf16 v[144:147], v[196:199], a[132:135], v[144:147]
ds_read_b64_tr_b16 v[180:181], v208 offset:9472
ds_read_b64_tr_b16 v[182:183], v208 offset:14080
v_mfma_f32_16x16x32_bf16 v[144:147], v[200:203], a[136:139], v[144:147]
ds_read_b64_tr_b16 v[184:185], v208 offset:18688
ds_read_b64_tr_b16 v[186:187], v208 offset:23296
v_mfma_f32_16x16x32_bf16 v[144:147], v[204:207], a[140:143], v[144:147]
ds_read_b64_tr_b16 v[188:189], v208 offset:27904
ds_read_b64_tr_b16 v[190:191], v208 offset:32512
v_mfma_f32_16x16x32_bf16 v[148:151], v[192:195], a[144:147], v[148:151]
v_mfma_f32_16x16x32_bf16 v[148:151], v[196:199], a[148:151], v[148:151]
v_mfma_f32_16x16x32_bf16 v[148:151], v[200:203], a[152:155], v[148:151]
v_mfma_f32_16x16x32_bf16 v[148:151], v[204:207], a[156:159], v[148:151]
buffer_load_dwordx4 a[108:111], v215, s[20:23], s88 offen offset:2048 sc1
v_mfma_f32_16x16x32_bf16 v[152:155], v[192:195], a[160:163], v[152:155]
v_mfma_f32_16x16x32_bf16 v[152:155], v[196:199], a[164:167], v[152:155]
v_mfma_f32_16x16x32_bf16 v[152:155], v[200:203], a[168:171], v[152:155]
v_mfma_f32_16x16x32_bf16 v[152:155], v[204:207], a[172:175], v[152:155]
buffer_load_dwordx4 a[124:127], v215, s[20:23], s88 offen offset:3072 sc1
s_add_u32 s88, s88, 0x80000
v_mfma_f32_16x16x32_bf16 v[156:159], v[192:195], a[176:179], v[156:159]
v_mfma_f32_16x16x32_bf16 v[156:159], v[196:199], a[180:183], v[156:159]
v_mfma_f32_16x16x32_bf16 v[156:159], v[200:203], a[184:187], v[156:159]
v_mfma_f32_16x16x32_bf16 v[156:159], v[204:207], a[188:191], v[156:159]
s_waitcnt lgkmcnt(0)
v_mfma_f32_16x16x32_bf16 v[160:163], v[176:179], a[128:131], v[160:163]
s_waitcnt vmcnt(50)
s_barrier
v_mfma_f32_16x16x32_bf16 v[160:163], v[180:183], a[132:135], v[160:163]
ds_read_b64_tr_b16 v[192:193], v209
ds_read_b64_tr_b16 v[194:195], v209 offset:4608
v_mfma_f32_16x16x32_bf16 v[160:163], v[184:187], a[136:139], v[160:163]
ds_read_b64_tr_b16 v[196:197], v209 offset:9216
ds_read_b64_tr_b16 v[198:199], v209 offset:13824
v_mfma_f32_16x16x32_bf16 v[160:163], v[188:191], a[140:143], v[160:163]
ds_read_b64_tr_b16 v[200:201], v209 offset:18432
ds_read_b64_tr_b16 v[202:203], v209 offset:23040
v_mfma_f32_16x16x32_bf16 v[164:167], v[176:179], a[144:147], v[164:167]
ds_read_b64_tr_b16 v[204:205], v209 offset:27648
ds_read_b64_tr_b16 v[206:207], v209 offset:32256
v_mfma_f32_16x16x32_bf16 v[164:167], v[180:183], a[148:151], v[164:167]
v_mfma_f32_16x16x32_bf16 v[164:167], v[184:187], a[152:155], v[164:167]
v_mfma_f32_16x16x32_bf16 v[164:167], v[188:191], a[156:159], v[164:167]
v_mfma_f32_16x16x32_bf16 v[168:171], v[176:179], a[160:163], v[168:171]
v_mfma_f32_16x16x32_bf16 v[168:171], v[180:183], a[164:167], v[168:171]
v_mfma_f32_16x16x32_bf16 v[168:171], v[184:187], a[168:171], v[168:171]
v_mfma_f32_16x16x32_bf16 v[168:171], v[188:191], a[172:175], v[168:171]
v_mfma_f32_16x16x32_bf16 v[172:175], v[176:179], a[176:179], v[172:175]
v_mfma_f32_16x16x32_bf16 v[172:175], v[180:183], a[180:183], v[172:175]
v_mfma_f32_16x16x32_bf16 v[172:175], v[184:187], a[184:187], v[172:175]
v_mfma_f32_16x16x32_bf16 v[172:175], v[188:191], a[188:191], v[172:175]
s_waitcnt lgkmcnt(0)
v_mfma_f32_16x16x32_bf16 v[32:35], v[192:195], a[192:195], v[32:35]
ds_read_b64_tr_b16 v[176:177], v209 offset:32
ds_read_b64_tr_b16 v[178:179], v209 offset:4640
v_mfma_f32_16x16x32_bf16 v[32:35], v[196:199], a[196:199], v[32:35]
ds_read_b64_tr_b16 v[180:181], v209 offset:9248
ds_read_b64_tr_b16 v[182:183], v209 offset:13856
v_mfma_f32_16x16x32_bf16 v[32:35], v[200:203], a[200:203], v[32:35]
ds_read_b64_tr_b16 v[184:185], v209 offset:18464
ds_read_b64_tr_b16 v[186:187], v209 offset:23072
v_mfma_f32_16x16x32_bf16 v[32:35], v[204:207], a[204:207], v[32:35]
ds_read_b64_tr_b16 v[188:189], v209 offset:27680
ds_read_b64_tr_b16 v[190:191], v209 offset:32288
v_mfma_f32_16x16x32_bf16 v[36:39], v[192:195], a[208:211], v[36:39]
v_mfma_f32_16x16x32_bf16 v[36:39], v[196:199], a[212:215], v[36:39]
v_mfma_f32_16x16x32_bf16 v[36:39], v[200:203], a[216:219], v[36:39]
v_mfma_f32_16x16x32_bf16 v[36:39], v[204:207], a[220:223], v[36:39]
v_mfma_f32_16x16x32_bf16 v[40:43], v[192:195], a[224:227], v[40:43]
v_mfma_f32_16x16x32_bf16 v[40:43], v[196:199], a[228:231], v[40:43]
v_mfma_f32_16x16x32_bf16 v[40:43], v[200:203], a[232:235], v[40:43]
v_mfma_f32_16x16x32_bf16 v[40:43], v[204:207], a[236:239], v[40:43]
v_mfma_f32_16x16x32_bf16 v[44:47], v[192:195], a[240:243], v[44:47]
v_mfma_f32_16x16x32_bf16 v[44:47], v[196:199], a[244:247], v[44:47]
v_mfma_f32_16x16x32_bf16 v[44:47], v[200:203], a[248:251], v[44:47]
v_mfma_f32_16x16x32_bf16 v[44:47], v[204:207], a[252:255], v[44:47]
s_waitcnt lgkmcnt(0)
v_mfma_f32_16x16x32_bf16 v[48:51], v[176:179], a[192:195], v[48:51]
ds_read_b64_tr_b16 v[192:193], v209 offset:64
ds_read_b64_tr_b16 v[194:195], v209 offset:4672
v_mfma_f32_16x16x32_bf16 v[48:51], v[180:183], a[196:199], v[48:51]
ds_read_b64_tr_b16 v[196:197], v209 offset:9280
ds_read_b64_tr_b16 v[198:199], v209 offset:13888
v_mfma_f32_16x16x32_bf16 v[48:51], v[184:187], a[200:203], v[48:51]
ds_read_b64_tr_b16 v[200:201], v209 offset:18496
ds_read_b64_tr_b16 v[202:203], v209 offset:23104
v_mfma_f32_16x16x32_bf16 v[48:51], v[188:191], a[204:207], v[48:51]
ds_read_b64_tr_b16 v[204:205], v209 offset:27712
ds_read_b64_tr_b16 v[206:207], v209 offset:32320
v_mfma_f32_16x16x32_bf16 v[52:55], v[176:179], a[208:211], v[52:55]
v_mfma_f32_16x16x32_bf16 v[52:55], v[180:183], a[212:215], v[52:55]
v_mfma_f32_16x16x32_bf16 v[52:55], v[184:187], a[216:219], v[52:55]
v_mfma_f32_16x16x32_bf16 v[52:55], v[188:191], a[220:223], v[52:55]
v_mfma_f32_16x16x32_bf16 v[56:59], v[176:179], a[224:227], v[56:59]
v_mfma_f32_16x16x32_bf16 v[56:59], v[180:183], a[228:231], v[56:59]
v_mfma_f32_16x16x32_bf16 v[56:59], v[184:187], a[232:235], v[56:59]
v_mfma_f32_16x16x32_bf16 v[56:59], v[188:191], a[236:239], v[56:59]
v_mfma_f32_16x16x32_bf16 v[60:63], v[176:179], a[240:243], v[60:63]
v_mfma_f32_16x16x32_bf16 v[60:63], v[180:183], a[244:247], v[60:63]
v_mfma_f32_16x16x32_bf16 v[60:63], v[184:187], a[248:251], v[60:63]
v_mfma_f32_16x16x32_bf16 v[60:63], v[188:191], a[252:255], v[60:63]
s_waitcnt lgkmcnt(0)
v_mfma_f32_16x16x32_bf16 v[64:67], v[192:195], a[192:195], v[64:67]
ds_read_b64_tr_b16 v[176:177], v209 offset:96
ds_read_b64_tr_b16 v[178:179], v209 offset:4704
v_mfma_f32_16x16x32_bf16 v[64:67], v[196:199], a[196:199], v[64:67]
ds_read_b64_tr_b16 v[180:181], v209 offset:9312
ds_read_b64_tr_b16 v[182:183], v209 offset:13920
v_mfma_f32_16x16x32_bf16 v[64:67], v[200:203], a[200:203], v[64:67]
ds_read_b64_tr_b16 v[184:185], v209 offset:18528
ds_read_b64_tr_b16 v[186:187], v209 offset:23136
v_mfma_f32_16x16x32_bf16 v[64:67], v[204:207], a[204:207], v[64:67]
ds_read_b64_tr_b16 v[188:189], v209 offset:27744
ds_read_b64_tr_b16 v[190:191], v209 offset:32352
v_mfma_f32_16x16x32_bf16 v[68:71], v[192:195], a[208:211], v[68:71]
v_mfma_f32_16x16x32_bf16 v[68:71], v[196:199], a[212:215], v[68:71]
v_mfma_f32_16x16x32_bf16 v[68:71], v[200:203], a[216:219], v[68:71]
v_mfma_f32_16x16x32_bf16 v[68:71], v[204:207], a[220:223], v[68:71]
v_mfma_f32_16x16x32_bf16 v[72:75], v[192:195], a[224:227], v[72:75]
v_mfma_f32_16x16x32_bf16 v[72:75], v[196:199], a[228:231], v[72:75]
v_mfma_f32_16x16x32_bf16 v[72:75], v[200:203], a[232:235], v[72:75]
v_mfma_f32_16x16x32_bf16 v[72:75], v[204:207], a[236:239], v[72:75]
v_mfma_f32_16x16x32_bf16 v[76:79], v[192:195], a[240:243], v[76:79]
v_mfma_f32_16x16x32_bf16 v[76:79], v[196:199], a[244:247], v[76:79]
v_mfma_f32_16x16x32_bf16 v[76:79], v[200:203], a[248:251], v[76:79]
v_mfma_f32_16x16x32_bf16 v[76:79], v[204:207], a[252:255], v[76:79]
s_waitcnt lgkmcnt(0)
v_mfma_f32_16x16x32_bf16 v[80:83], v[176:179], a[192:195], v[80:83]
ds_read_b64_tr_b16 v[192:193], v209 offset:128
ds_read_b64_tr_b16 v[194:195], v209 offset:4736
v_mfma_f32_16x16x32_bf16 v[80:83], v[180:183], a[196:199], v[80:83]
ds_read_b64_tr_b16 v[196:197], v209 offset:9344
ds_read_b64_tr_b16 v[198:199], v209 offset:13952
v_mfma_f32_16x16x32_bf16 v[80:83], v[184:187], a[200:203], v[80:83]
ds_read_b64_tr_b16 v[200:201], v209 offset:18560
ds_read_b64_tr_b16 v[202:203], v209 offset:23168
v_mfma_f32_16x16x32_bf16 v[80:83], v[188:191], a[204:207], v[80:83]
ds_read_b64_tr_b16 v[204:205], v209 offset:27776
ds_read_b64_tr_b16 v[206:207], v209 offset:32384
v_mfma_f32_16x16x32_bf16 v[84:87], v[176:179], a[208:211], v[84:87]
v_mfma_f32_16x16x32_bf16 v[84:87], v[180:183], a[212:215], v[84:87]
v_mfma_f32_16x16x32_bf16 v[84:87], v[184:187], a[216:219], v[84:87]
v_mfma_f32_16x16x32_bf16 v[84:87], v[188:191], a[220:223], v[84:87]
v_mfma_f32_16x16x32_bf16 v[88:91], v[176:179], a[224:227], v[88:91]
v_mfma_f32_16x16x32_bf16 v[88:91], v[180:183], a[228:231], v[88:91]
v_mfma_f32_16x16x32_bf16 v[88:91], v[184:187], a[232:235], v[88:91]
v_mfma_f32_16x16x32_bf16 v[88:91], v[188:191], a[236:239], v[88:91]
v_mfma_f32_16x16x32_bf16 v[92:95], v[176:179], a[240:243], v[92:95]
v_mfma_f32_16x16x32_bf16 v[92:95], v[180:183], a[244:247], v[92:95]
v_mfma_f32_16x16x32_bf16 v[92:95], v[184:187], a[248:251], v[92:95]
v_mfma_f32_16x16x32_bf16 v[92:95], v[188:191], a[252:255], v[92:95]
s_waitcnt lgkmcnt(0)
v_mfma_f32_16x16x32_bf16 v[96:99], v[192:195], a[192:195], v[96:99]
ds_read_b64_tr_b16 v[176:177], v209 offset:160
ds_read_b64_tr_b16 v[178:179], v209 offset:4768
v_mfma_f32_16x16x32_bf16 v[96:99], v[196:199], a[196:199], v[96:99]
ds_read_b64_tr_b16 v[180:181], v209 offset:9376
ds_read_b64_tr_b16 v[182:183], v209 offset:13984
v_mfma_f32_16x16x32_bf16 v[96:99], v[200:203], a[200:203], v[96:99]
ds_read_b64_tr_b16 v[184:185], v209 offset:18592
ds_read_b64_tr_b16 v[186:187], v209 offset:23200
v_mfma_f32_16x16x32_bf16 v[96:99], v[204:207], a[204:207], v[96:99]
ds_read_b64_tr_b16 v[188:189], v209 offset:27808
ds_read_b64_tr_b16 v[190:191], v209 offset:32416
v_mfma_f32_16x16x32_bf16 v[100:103], v[192:195], a[208:211], v[100:103]
v_mfma_f32_16x16x32_bf16 v[100:103], v[196:199], a[212:215], v[100:103]
v_mfma_f32_16x16x32_bf16 v[100:103], v[200:203], a[216:219], v[100:103]
v_mfma_f32_16x16x32_bf16 v[100:103], v[204:207], a[220:223], v[100:103]
v_mfma_f32_16x16x32_bf16 v[104:107], v[192:195], a[224:227], v[104:107]
v_mfma_f32_16x16x32_bf16 v[104:107], v[196:199], a[228:231], v[104:107]
v_mfma_f32_16x16x32_bf16 v[104:107], v[200:203], a[232:235], v[104:107]
v_mfma_f32_16x16x32_bf16 v[104:107], v[204:207], a[236:239], v[104:107]
v_mfma_f32_16x16x32_bf16 v[108:111], v[192:195], a[240:243], v[108:111]
v_mfma_f32_16x16x32_bf16 v[108:111], v[196:199], a[244:247], v[108:111]
v_mfma_f32_16x16x32_bf16 v[108:111], v[200:203], a[248:251], v[108:111]
v_mfma_f32_16x16x32_bf16 v[108:111], v[204:207], a[252:255], v[108:111]
s_waitcnt lgkmcnt(0)
v_mfma_f32_16x16x32_bf16 v[112:115], v[176:179], a[192:195], v[112:115]
ds_read_b64_tr_b16 v[192:193], v209 offset:192
ds_read_b64_tr_b16 v[194:195], v209 offset:4800
v_mfma_f32_16x16x32_bf16 v[112:115], v[180:183], a[196:199], v[112:115]
ds_read_b64_tr_b16 v[196:197], v209 offset:9408
ds_read_b64_tr_b16 v[198:199], v209 offset:14016
v_mfma_f32_16x16x32_bf16 v[112:115], v[184:187], a[200:203], v[112:115]
ds_read_b64_tr_b16 v[200:201], v209 offset:18624
ds_read_b64_tr_b16 v[202:203], v209 offset:23232
v_mfma_f32_16x16x32_bf16 v[112:115], v[188:191], a[204:207], v[112:115]
ds_read_b64_tr_b16 v[204:205], v209 offset:27840
ds_read_b64_tr_b16 v[206:207], v209 offset:32448
v_mfma_f32_16x16x32_bf16 v[116:119], v[176:179], a[208:211], v[116:119]
v_mfma_f32_16x16x32_bf16 v[116:119], v[180:183], a[212:215], v[116:119]
v_mfma_f32_16x16x32_bf16 v[116:119], v[184:187], a[216:219], v[116:119]
v_mfma_f32_16x16x32_bf16 v[116:119], v[188:191], a[220:223], v[116:119]
v_mfma_f32_16x16x32_bf16 v[120:123], v[176:179], a[224:227], v[120:123]
v_mfma_f32_16x16x32_bf16 v[120:123], v[180:183], a[228:231], v[120:123]
v_mfma_f32_16x16x32_bf16 v[120:123], v[184:187], a[232:235], v[120:123]
v_mfma_f32_16x16x32_bf16 v[120:123], v[188:191], a[236:239], v[120:123]
v_mfma_f32_16x16x32_bf16 v[124:127], v[176:179], a[240:243], v[124:127]
v_mfma_f32_16x16x32_bf16 v[124:127], v[180:183], a[244:247], v[124:127]
v_mfma_f32_16x16x32_bf16 v[124:127], v[184:187], a[248:251], v[124:127]
v_mfma_f32_16x16x32_bf16 v[124:127], v[188:191], a[252:255], v[124:127]
s_waitcnt lgkmcnt(0)
v_mfma_f32_16x16x32_bf16 v[128:131], v[192:195], a[192:195], v[128:131]
ds_read_b64_tr_b16 v[176:177], v209 offset:224
ds_read_b64_tr_b16 v[178:179], v209 offset:4832
v_mfma_f32_16x16x32_bf16 v[128:131], v[196:199], a[196:199], v[128:131]
ds_read_b64_tr_b16 v[180:181], v209 offset:9440
ds_read_b64_tr_b16 v[182:183], v209 offset:14048
v_mfma_f32_16x16x32_bf16 v[128:131], v[200:203], a[200:203], v[128:131]
ds_read_b64_tr_b16 v[184:185], v209 offset:18656
ds_read_b64_tr_b16 v[186:187], v209 offset:23264
v_mfma_f32_16x16x32_bf16 v[128:131], v[204:207], a[204:207], v[128:131]
ds_read_b64_tr_b16 v[188:189], v209 offset:27872
ds_read_b64_tr_b16 v[190:191], v209 offset:32480
v_mfma_f32_16x16x32_bf16 v[132:135], v[192:195], a[208:211], v[132:135]
v_mfma_f32_16x16x32_bf16 v[132:135], v[196:199], a[212:215], v[132:135]
v_mfma_f32_16x16x32_bf16 v[132:135], v[200:203], a[216:219], v[132:135]
v_mfma_f32_16x16x32_bf16 v[132:135], v[204:207], a[220:223], v[132:135]
v_mfma_f32_16x16x32_bf16 v[136:139], v[192:195], a[224:227], v[136:139]
v_mfma_f32_16x16x32_bf16 v[136:139], v[196:199], a[228:231], v[136:139]
v_mfma_f32_16x16x32_bf16 v[136:139], v[200:203], a[232:235], v[136:139]
v_mfma_f32_16x16x32_bf16 v[136:139], v[204:207], a[236:239], v[136:139]
v_mfma_f32_16x16x32_bf16 v[140:143], v[192:195], a[240:243], v[140:143]
v_mfma_f32_16x16x32_bf16 v[140:143], v[196:199], a[244:247], v[140:143]
v_mfma_f32_16x16x32_bf16 v[140:143], v[200:203], a[248:251], v[140:143]
v_mfma_f32_16x16x32_bf16 v[140:143], v[204:207], a[252:255], v[140:143]
s_waitcnt lgkmcnt(0)
v_mfma_f32_16x16x32_bf16 v[144:147], v[176:179], a[192:195], v[144:147]
ds_read_b64_tr_b16 v[192:193], v209 offset:256
ds_read_b64_tr_b16 v[194:195], v209 offset:4864
v_mfma_f32_16x16x32_bf16 v[144:147], v[180:183], a[196:199], v[144:147]
ds_read_b64_tr_b16 v[196:197], v209 offset:9472
ds_read_b64_tr_b16 v[198:199], v209 offset:14080
v_mfma_f32_16x16x32_bf16 v[144:147], v[184:187], a[200:203], v[144:147]
ds_read_b64_tr_b16 v[200:201], v209 offset:18688
ds_read_b64_tr_b16 v[202:203], v209 offset:23296
v_mfma_f32_16x16x32_bf16 v[144:147], v[188:191], a[204:207], v[144:147]
ds_read_b64_tr_b16 v[204:205], v209 offset:27904
ds_read_b64_tr_b16 v[206:207], v209 offset:32512
v_mfma_f32_16x16x32_bf16 v[148:151], v[176:179], a[208:211], v[148:151]
v_mfma_f32_16x16x32_bf16 v[148:151], v[180:183], a[212:215], v[148:151]
v_mfma_f32_16x16x32_bf16 v[148:151], v[184:187], a[216:219], v[148:151]
v_mfma_f32_16x16x32_bf16 v[148:151], v[188:191], a[220:223], v[148:151]
v_mfma_f32_16x16x32_bf16 v[152:155], v[176:179], a[224:227], v[152:155]
v_mfma_f32_16x16x32_bf16 v[152:155], v[180:183], a[228:231], v[152:155]
v_mfma_f32_16x16x32_bf16 v[152:155], v[184:187], a[232:235], v[152:155]
v_mfma_f32_16x16x32_bf16 v[152:155], v[188:191], a[236:239], v[152:155]
v_mfma_f32_16x16x32_bf16 v[156:159], v[176:179], a[240:243], v[156:159]
v_mfma_f32_16x16x32_bf16 v[156:159], v[180:183], a[244:247], v[156:159]
v_mfma_f32_16x16x32_bf16 v[156:159], v[184:187], a[248:251], v[156:159]
v_mfma_f32_16x16x32_bf16 v[156:159], v[188:191], a[252:255], v[156:159]
s_waitcnt lgkmcnt(0)
v_mfma_f32_16x16x32_bf16 v[160:163], v[192:195], a[192:195], v[160:163]
s_waitcnt vmcnt(0)
s_barrier
v_mfma_f32_16x16x32_bf16 v[160:163], v[196:199], a[196:199], v[160:163]
ds_read_b64_tr_b16 v[176:177], v210
ds_read_b64_tr_b16 v[178:179], v210 offset:4608
v_mfma_f32_16x16x32_bf16 v[160:163], v[200:203], a[200:203], v[160:163]
ds_read_b64_tr_b16 v[180:181], v210 offset:9216
ds_read_b64_tr_b16 v[182:183], v210 offset:13824
v_mfma_f32_16x16x32_bf16 v[160:163], v[204:207], a[204:207], v[160:163]
ds_read_b64_tr_b16 v[184:185], v210 offset:18432
ds_read_b64_tr_b16 v[186:187], v210 offset:23040
v_mfma_f32_16x16x32_bf16 v[164:167], v[192:195], a[208:211], v[164:167]
ds_read_b64_tr_b16 v[188:189], v210 offset:27648
ds_read_b64_tr_b16 v[190:191], v210 offset:32256
v_mfma_f32_16x16x32_bf16 v[164:167], v[196:199], a[212:215], v[164:167]
v_mfma_f32_16x16x32_bf16 v[164:167], v[200:203], a[216:219], v[164:167]
v_mfma_f32_16x16x32_bf16 v[164:167], v[204:207], a[220:223], v[164:167]
v_mfma_f32_16x16x32_bf16 v[168:171], v[192:195], a[224:227], v[168:171]
v_mfma_f32_16x16x32_bf16 v[168:171], v[196:199], a[228:231], v[168:171]
v_mfma_f32_16x16x32_bf16 v[168:171], v[200:203], a[232:235], v[168:171]
v_mfma_f32_16x16x32_bf16 v[168:171], v[204:207], a[236:239], v[168:171]
v_mfma_f32_16x16x32_bf16 v[172:175], v[192:195], a[240:243], v[172:175]
v_mfma_f32_16x16x32_bf16 v[172:175], v[196:199], a[244:247], v[172:175]
v_mfma_f32_16x16x32_bf16 v[172:175], v[200:203], a[248:251], v[172:175]
v_mfma_f32_16x16x32_bf16 v[172:175], v[204:207], a[252:255], v[172:175]
s_waitcnt lgkmcnt(0)
v_mfma_f32_16x16x32_bf16 v[32:35], v[176:179], a[0:3], v[32:35]
ds_read_b64_tr_b16 v[192:193], v211
ds_read_b64_tr_b16 v[194:195], v211 offset:4608
v_mfma_f32_16x16x32_bf16 v[32:35], v[180:183], a[4:7], v[32:35]
ds_read_b64_tr_b16 v[196:197], v211 offset:9216
ds_read_b64_tr_b16 v[198:199], v211 offset:13824
v_mfma_f32_16x16x32_bf16 v[32:35], v[184:187], a[8:11], v[32:35]
ds_read_b64_tr_b16 v[200:201], v211 offset:18432
ds_read_b64_tr_b16 v[202:203], v211 offset:23040
v_mfma_f32_16x16x32_bf16 v[32:35], v[188:191], a[12:15], v[32:35]
ds_read_b64_tr_b16 v[204:205], v211 offset:27648
ds_read_b64_tr_b16 v[206:207], v211 offset:32256
v_mfma_f32_16x16x32_bf16 v[36:39], v[176:179], a[16:19], v[36:39]
v_mfma_f32_16x16x32_bf16 v[36:39], v[180:183], a[20:23], v[36:39]
v_mfma_f32_16x16x32_bf16 v[36:39], v[184:187], a[24:27], v[36:39]
v_add_u32 v212, 0, v18
v_mfma_f32_16x16x32_bf16 v[36:39], v[188:191], a[28:31], v[36:39]
v_add_u32 v213, 0x1000, v18
v_mfma_f32_16x16x32_bf16 v[40:43], v[176:179], a[32:35], v[40:43]
v_add_u32 v214, 0x2000, v18
v_mfma_f32_16x16x32_bf16 v[40:43], v[180:183], a[36:39], v[40:43]
v_add_u32 v215, 0x3000, v18
v_mfma_f32_16x16x32_bf16 v[40:43], v[184:187], a[40:43], v[40:43]
v_mfma_f32_16x16x32_bf16 v[40:43], v[188:191], a[44:47], v[40:43]
v_mfma_f32_16x16x32_bf16 v[44:47], v[176:179], a[48:51], v[44:47]
v_mfma_f32_16x16x32_bf16 v[44:47], v[180:183], a[52:55], v[44:47]
v_mfma_f32_16x16x32_bf16 v[44:47], v[184:187], a[56:59], v[44:47]
v_mfma_f32_16x16x32_bf16 v[44:47], v[188:191], a[60:63], v[44:47]
s_waitcnt lgkmcnt(0)
v_mfma_f32_16x16x32_bf16 v[32:35], v[192:195], a[64:67], v[32:35]
ds_read_b64_tr_b16 v[176:177], v210 offset:32
ds_read_b64_tr_b16 v[178:179], v210 offset:4640
v_mfma_f32_16x16x32_bf16 v[32:35], v[196:199], a[68:71], v[32:35]
ds_read_b64_tr_b16 v[180:181], v210 offset:9248
ds_read_b64_tr_b16 v[182:183], v210 offset:13856
v_mfma_f32_16x16x32_bf16 v[32:35], v[200:203], a[72:75], v[32:35]
ds_read_b64_tr_b16 v[184:185], v210 offset:18464
ds_read_b64_tr_b16 v[186:187], v210 offset:23072
v_mfma_f32_16x16x32_bf16 v[32:35], v[204:207], a[76:79], v[32:35]
ds_read_b64_tr_b16 v[188:189], v210 offset:27680
ds_read_b64_tr_b16 v[190:191], v210 offset:32288
v_mfma_f32_16x16x32_bf16 v[36:39], v[192:195], a[80:83], v[36:39]
v_mfma_f32_16x16x32_bf16 v[36:39], v[196:199], a[84:87], v[36:39]
v_mfma_f32_16x16x32_bf16 v[36:39], v[200:203], a[88:91], v[36:39]
v_mfma_f32_16x16x32_bf16 v[36:39], v[204:207], a[92:95], v[36:39]
v_mfma_f32_16x16x32_bf16 v[40:43], v[192:195], a[96:99], v[40:43]
v_mfma_f32_16x16x32_bf16 v[40:43], v[196:199], a[100:103], v[40:43]
v_mfma_f32_16x16x32_bf16 v[40:43], v[200:203], a[104:107], v[40:43]
v_mfma_f32_16x16x32_bf16 v[40:43], v[204:207], a[108:111], v[40:43]
v_mfma_f32_16x16x32_bf16 v[44:47], v[192:195], a[112:115], v[44:47]
v_mfma_f32_16x16x32_bf16 v[44:47], v[196:199], a[116:119], v[44:47]
v_mfma_f32_16x16x32_bf16 v[44:47], v[200:203], a[120:123], v[44:47]
v_mfma_f32_16x16x32_bf16 v[44:47], v[204:207], a[124:127], v[44:47]
s_waitcnt lgkmcnt(0)
v_mfma_f32_16x16x32_bf16 v[48:51], v[176:179], a[0:3], v[48:51]
ds_read_b64_tr_b16 v[192:193], v211 offset:32
ds_read_b64_tr_b16 v[194:195], v211 offset:4640
v_mfma_f32_16x16x32_bf16 v[48:51], v[180:183], a[4:7], v[48:51]
ds_read_b64_tr_b16 v[196:197], v211 offset:9248
ds_read_b64_tr_b16 v[198:199], v211 offset:13856
v_mfma_f32_16x16x32_bf16 v[48:51], v[184:187], a[8:11], v[48:51]
ds_read_b64_tr_b16 v[200:201], v211 offset:18464
ds_read_b64_tr_b16 v[202:203], v211 offset:23072
v_mfma_f32_16x16x32_bf16 v[48:51], v[188:191], a[12:15], v[48:51]
ds_read_b64_tr_b16 v[204:205], v211 offset:27680
ds_read_b64_tr_b16 v[206:207], v211 offset:32288
v_mfma_f32_16x16x32_bf16 v[52:55], v[176:179], a[16:19], v[52:55]
v_mfma_f32_16x16x32_bf16 v[52:55], v[180:183], a[20:23], v[52:55]
v_mfma_f32_16x16x32_bf16 v[52:55], v[184:187], a[24:27], v[52:55]
v_mfma_f32_16x16x32_bf16 v[52:55], v[188:191], a[28:31], v[52:55]
v_mfma_f32_16x16x32_bf16 v[56:59], v[176:179], a[32:35], v[56:59]
v_mfma_f32_16x16x32_bf16 v[56:59], v[180:183], a[36:39], v[56:59]
v_mfma_f32_16x16x32_bf16 v[56:59], v[184:187], a[40:43], v[56:59]
v_mfma_f32_16x16x32_bf16 v[56:59], v[188:191], a[44:47], v[56:59]
v_mfma_f32_16x16x32_bf16 v[60:63], v[176:179], a[48:51], v[60:63]
v_mfma_f32_16x16x32_bf16 v[60:63], v[180:183], a[52:55], v[60:63]
v_mfma_f32_16x16x32_bf16 v[60:63], v[184:187], a[56:59], v[60:63]
v_mfma_f32_16x16x32_bf16 v[60:63], v[188:191], a[60:63], v[60:63]
s_waitcnt lgkmcnt(0)
v_mfma_f32_16x16x32_bf16 v[48:51], v[192:195], a[64:67], v[48:51]
ds_read_b64_tr_b16 v[176:177], v210 offset:64
ds_read_b64_tr_b16 v[178:179], v210 offset:4672
v_mfma_f32_16x16x32_bf16 v[48:51], v[196:199], a[68:71], v[48:51]
ds_read_b64_tr_b16 v[180:181], v210 offset:9280
ds_read_b64_tr_b16 v[182:183], v210 offset:13888
v_mfma_f32_16x16x32_bf16 v[48:51], v[200:203], a[72:75], v[48:51]
ds_read_b64_tr_b16 v[184:185], v210 offset:18496
ds_read_b64_tr_b16 v[186:187], v210 offset:23104
v_mfma_f32_16x16x32_bf16 v[48:51], v[204:207], a[76:79], v[48:51]
ds_read_b64_tr_b16 v[188:189], v210 offset:27712
ds_read_b64_tr_b16 v[190:191], v210 offset:32320
v_mfma_f32_16x16x32_bf16 v[52:55], v[192:195], a[80:83], v[52:55]
v_mfma_f32_16x16x32_bf16 v[52:55], v[196:199], a[84:87], v[52:55]
v_mfma_f32_16x16x32_bf16 v[52:55], v[200:203], a[88:91], v[52:55]
v_mfma_f32_16x16x32_bf16 v[52:55], v[204:207], a[92:95], v[52:55]
v_mfma_f32_16x16x32_bf16 v[56:59], v[192:195], a[96:99], v[56:59]
v_mfma_f32_16x16x32_bf16 v[56:59], v[196:199], a[100:103], v[56:59]
v_mfma_f32_16x16x32_bf16 v[56:59], v[200:203], a[104:107], v[56:59]
v_mfma_f32_16x16x32_bf16 v[56:59], v[204:207], a[108:111], v[56:59]
v_mfma_f32_16x16x32_bf16 v[60:63], v[192:195], a[112:115], v[60:63]
v_mfma_f32_16x16x32_bf16 v[60:63], v[196:199], a[116:119], v[60:63]
v_mfma_f32_16x16x32_bf16 v[60:63], v[200:203], a[120:123], v[60:63]
v_mfma_f32_16x16x32_bf16 v[60:63], v[204:207], a[124:127], v[60:63]
s_waitcnt lgkmcnt(0)
v_mfma_f32_16x16x32_bf16 v[64:67], v[176:179], a[0:3], v[64:67]
ds_read_b64_tr_b16 v[192:193], v211 offset:64
ds_read_b64_tr_b16 v[194:195], v211 offset:4672
v_mfma_f32_16x16x32_bf16 v[64:67], v[180:183], a[4:7], v[64:67]
ds_read_b64_tr_b16 v[196:197], v211 offset:9280
ds_read_b64_tr_b16 v[198:199], v211 offset:13888
v_mfma_f32_16x16x32_bf16 v[64:67], v[184:187], a[8:11], v[64:67]
ds_read_b64_tr_b16 v[200:201], v211 offset:18496
ds_read_b64_tr_b16 v[202:203], v211 offset:23104
v_mfma_f32_16x16x32_bf16 v[64:67], v[188:191], a[12:15], v[64:67]
ds_read_b64_tr_b16 v[204:205], v211 offset:27712
ds_read_b64_tr_b16 v[206:207], v211 offset:32320
v_mfma_f32_16x16x32_bf16 v[68:71], v[176:179], a[16:19], v[68:71]
v_cvt_pk_bf16_f32 v2, v32, v33
v_cvt_pk_bf16_f32 v3, v34, v35
v_mfma_f32_16x16x32_bf16 v[68:71], v[180:183], a[20:23], v[68:71]
v_cvt_pk_bf16_f32 v4, v48, v49
v_cvt_pk_bf16_f32 v5, v50, v51
v_mfma_f32_16x16x32_bf16 v[68:71], v[184:187], a[24:27], v[68:71]
buffer_store_dwordx4 v[2:5], v212, s[32:35], s89 offen sc1
v_mfma_f32_16x16x32_bf16 v[68:71], v[188:191], a[28:31], v[68:71]
v_mfma_f32_16x16x32_bf16 v[72:75], v[176:179], a[32:35], v[72:75]
v_mfma_f32_16x16x32_bf16 v[72:75], v[180:183], a[36:39], v[72:75]
v_mfma_f32_16x16x32_bf16 v[72:75], v[184:187], a[40:43], v[72:75]
v_mfma_f32_16x16x32_bf16 v[72:75], v[188:191], a[44:47], v[72:75]
v_mfma_f32_16x16x32_bf16 v[76:79], v[176:179], a[48:51], v[76:79]
v_mfma_f32_16x16x32_bf16 v[76:79], v[180:183], a[52:55], v[76:79]
v_mfma_f32_16x16x32_bf16 v[76:79], v[184:187], a[56:59], v[76:79]
v_mfma_f32_16x16x32_bf16 v[76:79], v[188:191], a[60:63], v[76:79]
s_waitcnt lgkmcnt(0)
v_mfma_f32_16x16x32_bf16 v[64:67], v[192:195], a[64:67], v[64:67]
ds_read_b64_tr_b16 v[176:177], v210 offset:96
ds_read_b64_tr_b16 v[178:179], v210 offset:4704
v_mfma_f32_16x16x32_bf16 v[64:67], v[196:199], a[68:71], v[64:67]
ds_read_b64_tr_b16 v[180:181], v210 offset:9312
ds_read_b64_tr_b16 v[182:183], v210 offset:13920
v_mfma_f32_16x16x32_bf16 v[64:67], v[200:203], a[72:75], v[64:67]
ds_read_b64_tr_b16 v[184:185], v210 offset:18528
ds_read_b64_tr_b16 v[186:187], v210 offset:23136
v_mfma_f32_16x16x32_bf16 v[64:67], v[204:207], a[76:79], v[64:67]
ds_read_b64_tr_b16 v[188:189], v210 offset:27744
ds_read_b64_tr_b16 v[190:191], v210 offset:32352
v_mfma_f32_16x16x32_bf16 v[68:71], v[192:195], a[80:83], v[68:71]
v_mfma_f32_16x16x32_bf16 v[68:71], v[196:199], a[84:87], v[68:71]
v_mfma_f32_16x16x32_bf16 v[68:71], v[200:203], a[88:91], v[68:71]
v_mfma_f32_16x16x32_bf16 v[68:71], v[204:207], a[92:95], v[68:71]
v_cvt_pk_bf16_f32 v6, v36, v37
v_cvt_pk_bf16_f32 v7, v38, v39
v_mfma_f32_16x16x32_bf16 v[72:75], v[192:195], a[96:99], v[72:75]
v_cvt_pk_bf16_f32 v8, v52, v53
v_cvt_pk_bf16_f32 v9, v54, v55
v_mfma_f32_16x16x32_bf16 v[72:75], v[196:199], a[100:103], v[72:75]
buffer_store_dwordx4 v[6:9], v213, s[32:35], s89 offen sc1
v_mfma_f32_16x16x32_bf16 v[72:75], v[200:203], a[104:107], v[72:75]
v_mfma_f32_16x16x32_bf16 v[72:75], v[204:207], a[108:111], v[72:75]
v_mfma_f32_16x16x32_bf16 v[76:79], v[192:195], a[112:115], v[76:79]
v_mfma_f32_16x16x32_bf16 v[76:79], v[196:199], a[116:119], v[76:79]
v_mfma_f32_16x16x32_bf16 v[76:79], v[200:203], a[120:123], v[76:79]
v_mfma_f32_16x16x32_bf16 v[76:79], v[204:207], a[124:127], v[76:79]
s_waitcnt lgkmcnt(0)
v_mfma_f32_16x16x32_bf16 v[80:83], v[176:179], a[0:3], v[80:83]
ds_read_b64_tr_b16 v[192:193], v211 offset:96
ds_read_b64_tr_b16 v[194:195], v211 offset:4704
v_mfma_f32_16x16x32_bf16 v[80:83], v[180:183], a[4:7], v[80:83]
ds_read_b64_tr_b16 v[196:197], v211 offset:9312
ds_read_b64_tr_b16 v[198:199], v211 offset:13920
v_mfma_f32_16x16x32_bf16 v[80:83], v[184:187], a[8:11], v[80:83]
ds_read_b64_tr_b16 v[200:201], v211 offset:18528
ds_read_b64_tr_b16 v[202:203], v211 offset:23136
v_mfma_f32_16x16x32_bf16 v[80:83], v[188:191], a[12:15], v[80:83]
ds_read_b64_tr_b16 v[204:205], v211 offset:27744
ds_read_b64_tr_b16 v[206:207], v211 offset:32352
v_mfma_f32_16x16x32_bf16 v[84:87], v[176:179], a[16:19], v[84:87]
v_mfma_f32_16x16x32_bf16 v[84:87], v[180:183], a[20:23], v[84:87]
v_mfma_f32_16x16x32_bf16 v[84:87], v[184:187], a[24:27], v[84:87]
v_mfma_f32_16x16x32_bf16 v[84:87], v[188:191], a[28:31], v[84:87]
v_mfma_f32_16x16x32_bf16 v[88:91], v[176:179], a[32:35], v[88:91]
v_mfma_f32_16x16x32_bf16 v[88:91], v[180:183], a[36:39], v[88:91]
v_mfma_f32_16x16x32_bf16 v[88:91], v[184:187], a[40:43], v[88:91]
v_mfma_f32_16x16x32_bf16 v[88:91], v[188:191], a[44:47], v[88:91]
v_mfma_f32_16x16x32_bf16 v[92:95], v[176:179], a[48:51], v[92:95]
v_cvt_pk_bf16_f32 v10, v40, v41
v_cvt_pk_bf16_f32 v11, v42, v43
v_mfma_f32_16x16x32_bf16 v[92:95], v[180:183], a[52:55], v[92:95]
v_cvt_pk_bf16_f32 v12, v56, v57
v_cvt_pk_bf16_f32 v13, v58, v59
v_mfma_f32_16x16x32_bf16 v[92:95], v[184:187], a[56:59], v[92:95]
buffer_store_dwordx4 v[10:13], v214, s[32:35], s89 offen sc1
v_mfma_f32_16x16x32_bf16 v[92:95], v[188:191], a[60:63], v[92:95]
s_waitcnt lgkmcnt(0)
v_mfma_f32_16x16x32_bf16 v[80:83], v[192:195], a[64:67], v[80:83]
ds_read_b64_tr_b16 v[176:177], v210 offset:128
ds_read_b64_tr_b16 v[178:179], v210 offset:4736
v_mfma_f32_16x16x32_bf16 v[80:83], v[196:199], a[68:71], v[80:83]
ds_read_b64_tr_b16 v[180:181], v210 offset:9344
ds_read_b64_tr_b16 v[182:183], v210 offset:13952
v_mfma_f32_16x16x32_bf16 v[80:83], v[200:203], a[72:75], v[80:83]
ds_read_b64_tr_b16 v[184:185], v210 offset:18560
ds_read_b64_tr_b16 v[186:187], v210 offset:23168
v_mfma_f32_16x16x32_bf16 v[80:83], v[204:207], a[76:79], v[80:83]
ds_read_b64_tr_b16 v[188:189], v210 offset:27776
ds_read_b64_tr_b16 v[190:191], v210 offset:32384
v_mfma_f32_16x16x32_bf16 v[84:87], v[192:195], a[80:83], v[84:87]
v_mfma_f32_16x16x32_bf16 v[84:87], v[196:199], a[84:87], v[84:87]
v_mfma_f32_16x16x32_bf16 v[84:87], v[200:203], a[88:91], v[84:87]
v_mfma_f32_16x16x32_bf16 v[84:87], v[204:207], a[92:95], v[84:87]
v_mfma_f32_16x16x32_bf16 v[88:91], v[192:195], a[96:99], v[88:91]
v_mfma_f32_16x16x32_bf16 v[88:91], v[196:199], a[100:103], v[88:91]
v_mfma_f32_16x16x32_bf16 v[88:91], v[200:203], a[104:107], v[88:91]
v_mfma_f32_16x16x32_bf16 v[88:91], v[204:207], a[108:111], v[88:91]
v_mfma_f32_16x16x32_bf16 v[92:95], v[192:195], a[112:115], v[92:95]
v_mfma_f32_16x16x32_bf16 v[92:95], v[196:199], a[116:119], v[92:95]
v_mfma_f32_16x16x32_bf16 v[92:95], v[200:203], a[120:123], v[92:95]
v_mfma_f32_16x16x32_bf16 v[92:95], v[204:207], a[124:127], v[92:95]
s_waitcnt lgkmcnt(0)
v_mfma_f32_16x16x32_bf16 v[96:99], v[176:179], a[0:3], v[96:99]
ds_read_b64_tr_b16 v[192:193], v211 offset:128
ds_read_b64_tr_b16 v[194:195], v211 offset:4736
v_mfma_f32_16x16x32_bf16 v[96:99], v[180:183], a[4:7], v[96:99]
ds_read_b64_tr_b16 v[196:197], v211 offset:9344
ds_read_b64_tr_b16 v[198:199], v211 offset:13952
v_mfma_f32_16x16x32_bf16 v[96:99], v[184:187], a[8:11], v[96:99]
ds_read_b64_tr_b16 v[200:201], v211 offset:18560
ds_read_b64_tr_b16 v[202:203], v211 offset:23168
v_mfma_f32_16x16x32_bf16 v[96:99], v[188:191], a[12:15], v[96:99]
ds_read_b64_tr_b16 v[204:205], v211 offset:27776
ds_read_b64_tr_b16 v[206:207], v211 offset:32384
v_mfma_f32_16x16x32_bf16 v[100:103], v[176:179], a[16:19], v[100:103]
v_cvt_pk_bf16_f32 v14, v44, v45
v_cvt_pk_bf16_f32 v15, v46, v47
v_mfma_f32_16x16x32_bf16 v[100:103], v[180:183], a[20:23], v[100:103]
v_cvt_pk_bf16_f32 v16, v60, v61
v_cvt_pk_bf16_f32 v17, v62, v63
v_mfma_f32_16x16x32_bf16 v[100:103], v[184:187], a[24:27], v[100:103]
buffer_store_dwordx4 v[14:17], v215, s[32:35], s89 offen sc1
v_mfma_f32_16x16x32_bf16 v[100:103], v[188:191], a[28:31], v[100:103]
v_mfma_f32_16x16x32_bf16 v[104:107], v[176:179], a[32:35], v[104:107]
v_mfma_f32_16x16x32_bf16 v[104:107], v[180:183], a[36:39], v[104:107]
v_mfma_f32_16x16x32_bf16 v[104:107], v[184:187], a[40:43], v[104:107]
v_mfma_f32_16x16x32_bf16 v[104:107], v[188:191], a[44:47], v[104:107]
v_mfma_f32_16x16x32_bf16 v[108:111], v[176:179], a[48:51], v[108:111]
v_mfma_f32_16x16x32_bf16 v[108:111], v[180:183], a[52:55], v[108:111]
v_mfma_f32_16x16x32_bf16 v[108:111], v[184:187], a[56:59], v[108:111]
v_mfma_f32_16x16x32_bf16 v[108:111], v[188:191], a[60:63], v[108:111]
s_waitcnt lgkmcnt(0)
v_mfma_f32_16x16x32_bf16 v[96:99], v[192:195], a[64:67], v[96:99]
ds_read_b64_tr_b16 v[176:177], v210 offset:160
ds_read_b64_tr_b16 v[178:179], v210 offset:4768
v_mfma_f32_16x16x32_bf16 v[96:99], v[196:199], a[68:71], v[96:99]
ds_read_b64_tr_b16 v[180:181], v210 offset:9376
ds_read_b64_tr_b16 v[182:183], v210 offset:13984
v_mfma_f32_16x16x32_bf16 v[96:99], v[200:203], a[72:75], v[96:99]
ds_read_b64_tr_b16 v[184:185], v210 offset:18592
ds_read_b64_tr_b16 v[186:187], v210 offset:23200
v_mfma_f32_16x16x32_bf16 v[96:99], v[204:207], a[76:79], v[96:99]
ds_read_b64_tr_b16 v[188:189], v210 offset:27808
ds_read_b64_tr_b16 v[190:191], v210 offset:32416
v_mfma_f32_16x16x32_bf16 v[100:103], v[192:195], a[80:83], v[100:103]
v_mfma_f32_16x16x32_bf16 v[100:103], v[196:199], a[84:87], v[100:103]
v_mfma_f32_16x16x32_bf16 v[100:103], v[200:203], a[88:91], v[100:103]
v_cvt_pk_bf16_f32 v2, v64, v65
v_cvt_pk_bf16_f32 v3, v66, v67
v_mfma_f32_16x16x32_bf16 v[100:103], v[204:207], a[92:95], v[100:103]
v_cvt_pk_bf16_f32 v4, v80, v81
v_cvt_pk_bf16_f32 v5, v82, v83
v_mfma_f32_16x16x32_bf16 v[104:107], v[192:195], a[96:99], v[104:107]
buffer_store_dwordx4 v[2:5], v212, s[32:35], s89 offen offset:1024 sc1
v_mfma_f32_16x16x32_bf16 v[104:107], v[196:199], a[100:103], v[104:107]
v_mfma_f32_16x16x32_bf16 v[104:107], v[200:203], a[104:107], v[104:107]
v_mfma_f32_16x16x32_bf16 v[104:107], v[204:207], a[108:111], v[104:107]
v_mfma_f32_16x16x32_bf16 v[108:111], v[192:195], a[112:115], v[108:111]
v_mfma_f32_16x16x32_bf16 v[108:111], v[196:199], a[116:119], v[108:111]
v_mfma_f32_16x16x32_bf16 v[108:111], v[200:203], a[120:123], v[108:111]
v_mfma_f32_16x16x32_bf16 v[108:111], v[204:207], a[124:127], v[108:111]
s_waitcnt lgkmcnt(0)
v_mfma_f32_16x16x32_bf16 v[112:115], v[176:179], a[0:3], v[112:115]
ds_read_b64_tr_b16 v[192:193], v211 offset:160
ds_read_b64_tr_b16 v[194:195], v211 offset:4768
v_mfma_f32_16x16x32_bf16 v[112:115], v[180:183], a[4:7], v[112:115]
ds_read_b64_tr_b16 v[196:197], v211 offset:9376
ds_read_b64_tr_b16 v[198:199], v211 offset:13984
v_mfma_f32_16x16x32_bf16 v[112:115], v[184:187], a[8:11], v[112:115]
ds_read_b64_tr_b16 v[200:201], v211 offset:18592
ds_read_b64_tr_b16 v[202:203], v211 offset:23200
v_mfma_f32_16x16x32_bf16 v[112:115], v[188:191], a[12:15], v[112:115]
ds_read_b64_tr_b16 v[204:205], v211 offset:27808
ds_read_b64_tr_b16 v[206:207], v211 offset:32416
v_mfma_f32_16x16x32_bf16 v[116:119], v[176:179], a[16:19], v[116:119]
v_mfma_f32_16x16x32_bf16 v[116:119], v[180:183], a[20:23], v[116:119]
v_mfma_f32_16x16x32_bf16 v[116:119], v[184:187], a[24:27], v[116:119]
v_mfma_f32_16x16x32_bf16 v[116:119], v[188:191], a[28:31], v[116:119]
v_mfma_f32_16x16x32_bf16 v[120:123], v[176:179], a[32:35], v[120:123]
v_mfma_f32_16x16x32_bf16 v[120:123], v[180:183], a[36:39], v[120:123]
v_mfma_f32_16x16x32_bf16 v[120:123], v[184:187], a[40:43], v[120:123]
v_mfma_f32_16x16x32_bf16 v[120:123], v[188:191], a[44:47], v[120:123]
v_cvt_pk_bf16_f32 v6, v68, v69
v_cvt_pk_bf16_f32 v7, v70, v71
v_mfma_f32_16x16x32_bf16 v[124:127], v[176:179], a[48:51], v[124:127]
v_cvt_pk_bf16_f32 v8, v84, v85
v_cvt_pk_bf16_f32 v9, v86, v87
v_mfma_f32_16x16x32_bf16 v[124:127], v[180:183], a[52:55], v[124:127]
buffer_store_dwordx4 v[6:9], v213, s[32:35], s89 offen offset:1024 sc1
v_mfma_f32_16x16x32_bf16 v[124:127], v[184:187], a[56:59], v[124:127]
v_mfma_f32_16x16x32_bf16 v[124:127], v[188:191], a[60:63], v[124:127]
s_waitcnt lgkmcnt(0)
v_mfma_f32_16x16x32_bf16 v[112:115], v[192:195], a[64:67], v[112:115]
ds_read_b64_tr_b16 v[176:177], v210 offset:192
ds_read_b64_tr_b16 v[178:179], v210 offset:4800
v_mfma_f32_16x16x32_bf16 v[112:115], v[196:199], a[68:71], v[112:115]
ds_read_b64_tr_b16 v[180:181], v210 offset:9408
ds_read_b64_tr_b16 v[182:183], v210 offset:14016
v_mfma_f32_16x16x32_bf16 v[112:115], v[200:203], a[72:75], v[112:115]
ds_read_b64_tr_b16 v[184:185], v210 offset:18624
ds_read_b64_tr_b16 v[186:187], v210 offset:23232
v_mfma_f32_16x16x32_bf16 v[112:115], v[204:207], a[76:79], v[112:115]
ds_read_b64_tr_b16 v[188:189], v210 offset:27840
ds_read_b64_tr_b16 v[190:191], v210 offset:32448
v_mfma_f32_16x16x32_bf16 v[116:119], v[192:195], a[80:83], v[116:119]
v_mfma_f32_16x16x32_bf16 v[116:119], v[196:199], a[84:87], v[116:119]
v_mfma_f32_16x16x32_bf16 v[116:119], v[200:203], a[88:91], v[116:119]
v_mfma_f32_16x16x32_bf16 v[116:119], v[204:207], a[92:95], v[116:119]
v_mfma_f32_16x16x32_bf16 v[120:123], v[192:195], a[96:99], v[120:123]
v_mfma_f32_16x16x32_bf16 v[120:123], v[196:199], a[100:103], v[120:123]
v_mfma_f32_16x16x32_bf16 v[120:123], v[200:203], a[104:107], v[120:123]
v_mfma_f32_16x16x32_bf16 v[120:123], v[204:207], a[108:111], v[120:123]
v_mfma_f32_16x16x32_bf16 v[124:127], v[192:195], a[112:115], v[124:127]
v_mfma_f32_16x16x32_bf16 v[124:127], v[196:199], a[116:119], v[124:127]
v_mfma_f32_16x16x32_bf16 v[124:127], v[200:203], a[120:123], v[124:127]
v_mfma_f32_16x16x32_bf16 v[124:127], v[204:207], a[124:127], v[124:127]
s_waitcnt lgkmcnt(0)
v_mfma_f32_16x16x32_bf16 v[128:131], v[176:179], a[0:3], v[128:131]
ds_read_b64_tr_b16 v[192:193], v211 offset:192
ds_read_b64_tr_b16 v[194:195], v211 offset:4800
v_mfma_f32_16x16x32_bf16 v[128:131], v[180:183], a[4:7], v[128:131]
ds_read_b64_tr_b16 v[196:197], v211 offset:9408
ds_read_b64_tr_b16 v[198:199], v211 offset:14016
v_mfma_f32_16x16x32_bf16 v[128:131], v[184:187], a[8:11], v[128:131]
ds_read_b64_tr_b16 v[200:201], v211 offset:18624
ds_read_b64_tr_b16 v[202:203], v211 offset:23232
v_mfma_f32_16x16x32_bf16 v[128:131], v[188:191], a[12:15], v[128:131]
ds_read_b64_tr_b16 v[204:205], v211 offset:27840
ds_read_b64_tr_b16 v[206:207], v211 offset:32448
v_mfma_f32_16x16x32_bf16 v[132:135], v[176:179], a[16:19], v[132:135]
v_cvt_pk_bf16_f32 v10, v72, v73
v_cvt_pk_bf16_f32 v11, v74, v75
v_mfma_f32_16x16x32_bf16 v[132:135], v[180:183], a[20:23], v[132:135]
v_cvt_pk_bf16_f32 v12, v88, v89
v_cvt_pk_bf16_f32 v13, v90, v91
v_mfma_f32_16x16x32_bf16 v[132:135], v[184:187], a[24:27], v[132:135]
buffer_store_dwordx4 v[10:13], v214, s[32:35], s89 offen offset:1024 sc1
v_mfma_f32_16x16x32_bf16 v[132:135], v[188:191], a[28:31], v[132:135]
v_mfma_f32_16x16x32_bf16 v[136:139], v[176:179], a[32:35], v[136:139]
v_mfma_f32_16x16x32_bf16 v[136:139], v[180:183], a[36:39], v[136:139]
v_mfma_f32_16x16x32_bf16 v[136:139], v[184:187], a[40:43], v[136:139]
v_mfma_f32_16x16x32_bf16 v[136:139], v[188:191], a[44:47], v[136:139]
v_mfma_f32_16x16x32_bf16 v[140:143], v[176:179], a[48:51], v[140:143]
v_mfma_f32_16x16x32_bf16 v[140:143], v[180:183], a[52:55], v[140:143]
v_mfma_f32_16x16x32_bf16 v[140:143], v[184:187], a[56:59], v[140:143]
v_mfma_f32_16x16x32_bf16 v[140:143], v[188:191], a[60:63], v[140:143]
s_waitcnt lgkmcnt(0)
v_mfma_f32_16x16x32_bf16 v[128:131], v[192:195], a[64:67], v[128:131]
ds_read_b64_tr_b16 v[176:177], v210 offset:224
ds_read_b64_tr_b16 v[178:179], v210 offset:4832
v_mfma_f32_16x16x32_bf16 v[128:131], v[196:199], a[68:71], v[128:131]
ds_read_b64_tr_b16 v[180:181], v210 offset:9440
ds_read_b64_tr_b16 v[182:183], v210 offset:14048
v_mfma_f32_16x16x32_bf16 v[128:131], v[200:203], a[72:75], v[128:131]
ds_read_b64_tr_b16 v[184:185], v210 offset:18656
ds_read_b64_tr_b16 v[186:187], v210 offset:23264
v_mfma_f32_16x16x32_bf16 v[128:131], v[204:207], a[76:79], v[128:131]
ds_read_b64_tr_b16 v[188:189], v210 offset:27872
ds_read_b64_tr_b16 v[190:191], v210 offset:32480
v_mfma_f32_16x16x32_bf16 v[132:135], v[192:195], a[80:83], v[132:135]
v_mfma_f32_16x16x32_bf16 v[132:135], v[196:199], a[84:87], v[132:135]
v_cvt_pk_bf16_f32 v14, v76, v77
v_cvt_pk_bf16_f32 v15, v78, v79
v_mfma_f32_16x16x32_bf16 v[132:135], v[200:203], a[88:91], v[132:135]
v_cvt_pk_bf16_f32 v16, v92, v93
v_cvt_pk_bf16_f32 v17, v94, v95
v_mfma_f32_16x16x32_bf16 v[132:135], v[204:207], a[92:95], v[132:135]
buffer_store_dwordx4 v[14:17], v215, s[32:35], s89 offen offset:1024 sc1
v_mfma_f32_16x16x32_bf16 v[136:139], v[192:195], a[96:99], v[136:139]
v_mfma_f32_16x16x32_bf16 v[136:139], v[196:199], a[100:103], v[136:139]
v_mfma_f32_16x16x32_bf16 v[136:139], v[200:203], a[104:107], v[136:139]
v_mfma_f32_16x16x32_bf16 v[136:139], v[204:207], a[108:111], v[136:139]
v_mfma_f32_16x16x32_bf16 v[140:143], v[192:195], a[112:115], v[140:143]
v_mfma_f32_16x16x32_bf16 v[140:143], v[196:199], a[116:119], v[140:143]
v_mfma_f32_16x16x32_bf16 v[140:143], v[200:203], a[120:123], v[140:143]
v_mfma_f32_16x16x32_bf16 v[140:143], v[204:207], a[124:127], v[140:143]
s_waitcnt lgkmcnt(0)
v_mfma_f32_16x16x32_bf16 v[144:147], v[176:179], a[0:3], v[144:147]
ds_read_b64_tr_b16 v[192:193], v211 offset:224
ds_read_b64_tr_b16 v[194:195], v211 offset:4832
v_mfma_f32_16x16x32_bf16 v[144:147], v[180:183], a[4:7], v[144:147]
ds_read_b64_tr_b16 v[196:197], v211 offset:9440
ds_read_b64_tr_b16 v[198:199], v211 offset:14048
v_mfma_f32_16x16x32_bf16 v[144:147], v[184:187], a[8:11], v[144:147]
ds_read_b64_tr_b16 v[200:201], v211 offset:18656
ds_read_b64_tr_b16 v[202:203], v211 offset:23264
v_mfma_f32_16x16x32_bf16 v[144:147], v[188:191], a[12:15], v[144:147]
ds_read_b64_tr_b16 v[204:205], v211 offset:27872
ds_read_b64_tr_b16 v[206:207], v211 offset:32480
v_mfma_f32_16x16x32_bf16 v[148:151], v[176:179], a[16:19], v[148:151]
v_mfma_f32_16x16x32_bf16 v[148:151], v[180:183], a[20:23], v[148:151]
v_mfma_f32_16x16x32_bf16 v[148:151], v[184:187], a[24:27], v[148:151]
v_mfma_f32_16x16x32_bf16 v[148:151], v[188:191], a[28:31], v[148:151]
v_mfma_f32_16x16x32_bf16 v[152:155], v[176:179], a[32:35], v[152:155]
v_mfma_f32_16x16x32_bf16 v[152:155], v[180:183], a[36:39], v[152:155]
v_mfma_f32_16x16x32_bf16 v[152:155], v[184:187], a[40:43], v[152:155]
v_cvt_pk_bf16_f32 v2, v96, v97
v_cvt_pk_bf16_f32 v3, v98, v99
v_mfma_f32_16x16x32_bf16 v[152:155], v[188:191], a[44:47], v[152:155]
v_cvt_pk_bf16_f32 v4, v112, v113
v_cvt_pk_bf16_f32 v5, v114, v115
v_mfma_f32_16x16x32_bf16 v[156:159], v[176:179], a[48:51], v[156:159]
buffer_store_dwordx4 v[2:5], v212, s[32:35], s89 offen offset:2048 sc1
v_mfma_f32_16x16x32_bf16 v[156:159], v[180:183], a[52:55], v[156:159]
v_mfma_f32_16x16x32_bf16 v[156:159], v[184:187], a[56:59], v[156:159]
v_mfma_f32_16x16x32_bf16 v[156:159], v[188:191], a[60:63], v[156:159]
s_waitcnt lgkmcnt(0)
v_mfma_f32_16x16x32_bf16 v[144:147], v[192:195], a[64:67], v[144:147]
ds_read_b64_tr_b16 v[176:177], v210 offset:256
ds_read_b64_tr_b16 v[178:179], v210 offset:4864
v_mfma_f32_16x16x32_bf16 v[144:147], v[196:199], a[68:71], v[144:147]
ds_read_b64_tr_b16 v[180:181], v210 offset:9472
ds_read_b64_tr_b16 v[182:183], v210 offset:14080
v_mfma_f32_16x16x32_bf16 v[144:147], v[200:203], a[72:75], v[144:147]
ds_read_b64_tr_b16 v[184:185], v210 offset:18688
ds_read_b64_tr_b16 v[186:187], v210 offset:23296
v_mfma_f32_16x16x32_bf16 v[144:147], v[204:207], a[76:79], v[144:147]
ds_read_b64_tr_b16 v[188:189], v210 offset:27904
ds_read_b64_tr_b16 v[190:191], v210 offset:32512
v_mfma_f32_16x16x32_bf16 v[148:151], v[192:195], a[80:83], v[148:151]
v_mfma_f32_16x16x32_bf16 v[148:151], v[196:199], a[84:87], v[148:151]
v_mfma_f32_16x16x32_bf16 v[148:151], v[200:203], a[88:91], v[148:151]
v_mfma_f32_16x16x32_bf16 v[148:151], v[204:207], a[92:95], v[148:151]
v_mfma_f32_16x16x32_bf16 v[152:155], v[192:195], a[96:99], v[152:155]
v_mfma_f32_16x16x32_bf16 v[152:155], v[196:199], a[100:103], v[152:155]
v_mfma_f32_16x16x32_bf16 v[152:155], v[200:203], a[104:107], v[152:155]
v_mfma_f32_16x16x32_bf16 v[152:155], v[204:207], a[108:111], v[152:155]
v_mfma_f32_16x16x32_bf16 v[156:159], v[192:195], a[112:115], v[156:159]
v_mfma_f32_16x16x32_bf16 v[156:159], v[196:199], a[116:119], v[156:159]
v_mfma_f32_16x16x32_bf16 v[156:159], v[200:203], a[120:123], v[156:159]
v_mfma_f32_16x16x32_bf16 v[156:159], v[204:207], a[124:127], v[156:159]
s_waitcnt lgkmcnt(0)
v_mfma_f32_16x16x32_bf16 v[160:163], v[176:179], a[0:3], v[160:163]
ds_read_b64_tr_b16 v[192:193], v211 offset:256
ds_read_b64_tr_b16 v[194:195], v211 offset:4864
v_mfma_f32_16x16x32_bf16 v[160:163], v[180:183], a[4:7], v[160:163]
ds_read_b64_tr_b16 v[196:197], v211 offset:9472
ds_read_b64_tr_b16 v[198:199], v211 offset:14080
v_mfma_f32_16x16x32_bf16 v[160:163], v[184:187], a[8:11], v[160:163]
ds_read_b64_tr_b16 v[200:201], v211 offset:18688
ds_read_b64_tr_b16 v[202:203], v211 offset:23296
v_mfma_f32_16x16x32_bf16 v[160:163], v[188:191], a[12:15], v[160:163]
ds_read_b64_tr_b16 v[204:205], v211 offset:27904
ds_read_b64_tr_b16 v[206:207], v211 offset:32512
v_mfma_f32_16x16x32_bf16 v[164:167], v[176:179], a[16:19], v[164:167]
v_cvt_pk_bf16_f32 v6, v100, v101
v_cvt_pk_bf16_f32 v7, v102, v103
v_mfma_f32_16x16x32_bf16 v[164:167], v[180:183], a[20:23], v[164:167]
v_cvt_pk_bf16_f32 v8, v116, v117
v_cvt_pk_bf16_f32 v9, v118, v119
v_mfma_f32_16x16x32_bf16 v[164:167], v[184:187], a[24:27], v[164:167]
buffer_store_dwordx4 v[6:9], v213, s[32:35], s89 offen offset:2048 sc1
v_mfma_f32_16x16x32_bf16 v[164:167], v[188:191], a[28:31], v[164:167]
v_mfma_f32_16x16x32_bf16 v[168:171], v[176:179], a[32:35], v[168:171]
v_mfma_f32_16x16x32_bf16 v[168:171], v[180:183], a[36:39], v[168:171]
v_mfma_f32_16x16x32_bf16 v[168:171], v[184:187], a[40:43], v[168:171]
v_mfma_f32_16x16x32_bf16 v[168:171], v[188:191], a[44:47], v[168:171]
v_mfma_f32_16x16x32_bf16 v[172:175], v[176:179], a[48:51], v[172:175]
v_mfma_f32_16x16x32_bf16 v[172:175], v[180:183], a[52:55], v[172:175]
v_mfma_f32_16x16x32_bf16 v[172:175], v[184:187], a[56:59], v[172:175]
v_mfma_f32_16x16x32_bf16 v[172:175], v[188:191], a[60:63], v[172:175]
s_waitcnt lgkmcnt(0)
v_mfma_f32_16x16x32_bf16 v[160:163], v[192:195], a[64:67], v[160:163]
v_mfma_f32_16x16x32_bf16 v[160:163], v[196:199], a[68:71], v[160:163]
v_mfma_f32_16x16x32_bf16 v[160:163], v[200:203], a[72:75], v[160:163]
v_mfma_f32_16x16x32_bf16 v[160:163], v[204:207], a[76:79], v[160:163]
v_mfma_f32_16x16x32_bf16 v[164:167], v[192:195], a[80:83], v[164:167]
v_cvt_pk_bf16_f32 v10, v104, v105
v_cvt_pk_bf16_f32 v11, v106, v107
v_mfma_f32_16x16x32_bf16 v[164:167], v[196:199], a[84:87], v[164:167]
v_cvt_pk_bf16_f32 v12, v120, v121
v_cvt_pk_bf16_f32 v13, v122, v123
v_mfma_f32_16x16x32_bf16 v[164:167], v[200:203], a[88:91], v[164:167]
buffer_store_dwordx4 v[10:13], v214, s[32:35], s89 offen offset:2048 sc1
v_mfma_f32_16x16x32_bf16 v[164:167], v[204:207], a[92:95], v[164:167]
v_mfma_f32_16x16x32_bf16 v[168:171], v[192:195], a[96:99], v[168:171]
v_mfma_f32_16x16x32_bf16 v[168:171], v[196:199], a[100:103], v[168:171]
v_mfma_f32_16x16x32_bf16 v[168:171], v[200:203], a[104:107], v[168:171]
v_mfma_f32_16x16x32_bf16 v[168:171], v[204:207], a[108:111], v[168:171]
v_mfma_f32_16x16x32_bf16 v[172:175], v[192:195], a[112:115], v[172:175]
v_mfma_f32_16x16x32_bf16 v[172:175], v[196:199], a[116:119], v[172:175]
v_mfma_f32_16x16x32_bf16 v[172:175], v[200:203], a[120:123], v[172:175]
v_mfma_f32_16x16x32_bf16 v[172:175], v[204:207], a[124:127], v[172:175]
s_nop 7
v_cvt_pk_bf16_f32 v14, v108, v109
v_cvt_pk_bf16_f32 v15, v110, v111
v_cvt_pk_bf16_f32 v16, v124, v125
v_cvt_pk_bf16_f32 v17, v126, v127
buffer_store_dwordx4 v[14:17], v215, s[32:35], s89 offen offset:2048 sc1
v_cvt_pk_bf16_f32 v2, v128, v129
v_cvt_pk_bf16_f32 v3, v130, v131
v_cvt_pk_bf16_f32 v4, v144, v145
v_cvt_pk_bf16_f32 v5, v146, v147
buffer_store_dwordx4 v[2:5], v212, s[32:35], s89 offen offset:3072 sc1
v_cvt_pk_bf16_f32 v6, v132, v133
v_cvt_pk_bf16_f32 v7, v134, v135
v_cvt_pk_bf16_f32 v8, v148, v149
v_cvt_pk_bf16_f32 v9, v150, v151
buffer_store_dwordx4 v[6:9], v213, s[32:35], s89 offen offset:3072 sc1
v_cvt_pk_bf16_f32 v10, v136, v137
v_cvt_pk_bf16_f32 v11, v138, v139
v_cvt_pk_bf16_f32 v12, v152, v153
v_cvt_pk_bf16_f32 v13, v154, v155
buffer_store_dwordx4 v[10:13], v214, s[32:35], s89 offen offset:3072 sc1
v_cvt_pk_bf16_f32 v14, v140, v141
v_cvt_pk_bf16_f32 v15, v142, v143
v_cvt_pk_bf16_f32 v16, v156, v157
v_cvt_pk_bf16_f32 v17, v158, v159
buffer_store_dwordx4 v[14:17], v215, s[32:35], s89 offen offset:3072 sc1
s_add_u32 s89, s89, 0x4000
v_cvt_pk_bf16_f32 v2, v160, v161
v_cvt_pk_bf16_f32 v3, v162, v163
v_cvt_pk_bf16_f32 v4, v164, v165
v_cvt_pk_bf16_f32 v5, v166, v167
buffer_store_dwordx4 v[2:5], v18, s[32:35], s89 offen sc1
v_cvt_pk_bf16_f32 v6, v168, v169
v_cvt_pk_bf16_f32 v7, v170, v171
v_cvt_pk_bf16_f32 v8, v172, v173
v_cvt_pk_bf16_f32 v9, v174, v175
buffer_store_dwordx4 v[6:9], v18, s[32:35], s89 offen offset:1024 sc1
s_branch recurrent_scan__gqa_block_cached__glu_gated_reglu__prompt_kernel_fin
recurrent_scan__gqa_block_cached__glu_gated_reglu__prompt_kernel_g2g:
s_add_u32 s20, s14, 0x240000
s_addc_u32 s21, s15, 0
s_mov_b32 s22, 0x1200000
s_mov_b32 s23, 0x20000
s_sub_u32 s55, s84, 4
s_mul_i32 s88, s55, 0x480000
s_mov_b32 s47, s88
s_mul_i32 s87, s44, 0x9000
s_mul_i32 s55, s86, 0x120
s_add_u32 s87, s87, s55
s_lshl_b32 s55, s85, 4
s_lshl_b32 s56, s44, 2
s_add_u32 s55, s55, s56
s_lshl_b32 s55, s55, 10
s_add_u32 s88, s88, s55
v_add_u32 v212, 0, v18
v_add_u32 v213, 0x20000, v18
v_add_u32 v214, 0x40000, v18
v_add_u32 v215, 0x60000, v18
s_add_u32 s32, s14, 0x2440000
s_addc_u32 s33, s15, 0
s_mov_b32 s34, 0x1200000
s_mov_b32 s35, 0x20000
s_lshl_b32 s55, s84, 5
s_lshl_b32 s56, s85, 2
s_add_u32 s55, s55, s56
s_add_u32 s55, s55, s44
s_lshl_b32 s55, s55, 2
s_add_u32 s55, s55, s86
s_mul_i32 s89, s55, 0x4800
v_lshrrev_b32 v19, 2, v1
v_mul_u32_u24 v208, 0x120, v19
v_and_b32 v20, 3, v1
v_lshl_add_u32 v208, v20, 3, v208
v_add_u32 v209, 0x9000, v208
v_add_u32 v210, 0x12000, v208
v_add_u32 v211, 0x1b000, v208
s_mov_b32 s90, 262144
recurrent_scan__gqa_block_cached__glu_gated_reglu__prompt_kernel_wpoll18:
v_readfirstlane_b32 s55, v13
s_nop 3
s_cmp_ge_u32 s55, 32
s_cbranch_scc1 recurrent_scan__gqa_block_cached__glu_gated_reglu__prompt_kernel_wgot19
s_sleep 2
buffer_load_dword v13, v12, s[72:75], 0 offen sc1
s_waitcnt vmcnt(0)
s_sub_u32 s90, s90, 1
s_cmp_lg_u32 s90, 0
s_cbranch_scc1 recurrent_scan__gqa_block_cached__glu_gated_reglu__prompt_kernel_wpoll18
recurrent_scan__gqa_block_cached__glu_gated_reglu__prompt_kernel_wgot19:
s_waitcnt vmcnt(0)
s_barrier
s_lshr_b32 s55, s45, 3
s_lshl_b32 s55, s55, 3
s_lshl_b32 s56, 1, s55
s_cmp_lg_u32 s44, 0
s_cbranch_scc1 recurrent_scan__gqa_block_cached__glu_gated_reglu__prompt_kernel_sig20
s_lshl_b32 s90, s46, 3
s_add_u32 s90, s90, 2
s_lshl_b32 s90, s90, 2
v_mov_b32 v12, s90
v_mov_b32 v13, s56
s_mov_b64 exec, 1
buffer_atomic_add v13, v12, s[72:75], 0 offen sc1
s_mov_b64 exec, -1
recurrent_scan__gqa_block_cached__glu_gated_reglu__prompt_kernel_sig20:
buffer_load_dwordx4 a[128:131], v212, s[20:23], s88 offen sc1
buffer_load_dwordx4 a[144:147], v212, s[20:23], s88 offen offset:1024 sc1
buffer_load_dwordx4 a[160:163], v212, s[20:23], s88 offen offset:2048 sc1
buffer_load_dwordx4 a[176:179], v212, s[20:23], s88 offen offset:3072 sc1
buffer_load_dwordx4 a[132:135], v213, s[20:23], s88 offen sc1
buffer_load_dwordx4 a[148:151], v213, s[20:23], s88 offen offset:1024 sc1
buffer_load_dwordx4 a[164:167], v213, s[20:23], s88 offen offset:2048 sc1
buffer_load_dwordx4 a[180:183], v213, s[20:23], s88 offen offset:3072 sc1
buffer_load_dwordx4 a[136:139], v214, s[20:23], s88 offen sc1
buffer_load_dwordx4 a[152:155], v214, s[20:23], s88 offen offset:1024 sc1
buffer_load_dwordx4 a[168:171], v214, s[20:23], s88 offen offset:2048 sc1
buffer_load_dwordx4 a[184:187], v214, s[20:23], s88 offen offset:3072 sc1
buffer_load_dwordx4 a[140:143], v215, s[20:23], s88 offen sc1
buffer_load_dwordx4 a[156:159], v215, s[20:23], s88 offen offset:1024 sc1
buffer_load_dwordx4 a[172:175], v215, s[20:23], s88 offen offset:2048 sc1
buffer_load_dwordx4 a[188:191], v215, s[20:23], s88 offen offset:3072 sc1
s_add_u32 s88, s88, 0x80000
s_add_u32 m0, s51, 0
s_nop 0
buffer_load_dwordx4 v242, s[16:19], s87 offen lds
s_add_u32 m0, s51, 0x400
s_nop 0
buffer_load_dwordx4 v243, s[16:19], s87 offen lds
s_add_u32 m0, s51, 0x800
s_nop 0
buffer_load_dwordx4 v244, s[16:19], s87 offen lds
s_add_u32 m0, s51, 0xc00
s_nop 0
buffer_load_dwordx4 v245, s[16:19], s87 offen lds
s_add_u32 m0, s51, 0x1000
s_nop 0
buffer_load_dwordx4 v246, s[16:19], s87 offen lds
s_add_u32 m0, s51, 0x1400
s_nop 0
buffer_load_dwordx4 v247, s[16:19], s87 offen lds
s_add_u32 m0, s51, 0x1800
s_nop 0
buffer_load_dwordx4 v248, s[16:19], s87 offen lds
s_add_u32 m0, s51, 0x1c00
s_nop 0
buffer_load_dwordx4 v249, s[16:19], s87 offen lds
s_add_u32 m0, s51, 0x2000
s_nop 0
buffer_load_dwordx4 v250, s[16:19], s87 offen lds
s_add_u32 s87, s87, 0x24000
s_add_u32 m0, s51, 0x9000
s_nop 0
buffer_load_dwordx4 v242, s[16:19], s87 offen lds
s_add_u32 m0, s51, 0x9400
s_nop 0
buffer_load_dwordx4 v243, s[16:19], s87 offen lds
s_add_u32 m0, s51, 0x9800
s_nop 0
buffer_load_dwordx4 v244, s[16:19], s87 offen lds
s_add_u32 m0, s51, 0x9c00
s_nop 0
buffer_load_dwordx4 v245, s[16:19], s87 offen lds
s_add_u32 m0, s51, 0xa000
s_nop 0
buffer_load_dwordx4 v246, s[16:19], s87 offen lds
s_add_u32 m0, s51, 0xa400
s_nop 0
buffer_load_dwordx4 v247, s[16:19], s87 offen lds
s_add_u32 m0, s51, 0xa800
s_nop 0
buffer_load_dwordx4 v248, s[16:19], s87 offen lds
s_add_u32 m0, s51, 0xac00
s_nop 0
buffer_load_dwordx4 v249, s[16:19], s87 offen lds
s_add_u32 m0, s51, 0xb000
s_nop 0
buffer_load_dwordx4 v250, s[16:19], s87 offen lds
s_add_u32 s87, s87, 0x24000
buffer_load_dwordx4 a[192:195], v212, s[20:23], s88 offen sc1
buffer_load_dwordx4 a[208:211], v212, s[20:23], s88 offen offset:1024 sc1
buffer_load_dwordx4 a[224:227], v212, s[20:23], s88 offen offset:2048 sc1
buffer_load_dwordx4 a[240:243], v212, s[20:23], s88 offen offset:3072 sc1
buffer_load_dwordx4 a[196:199], v213, s[20:23], s88 offen sc1
buffer_load_dwordx4 a[212:215], v213, s[20:23], s88 offen offset:1024 sc1
buffer_load_dwordx4 a[228:231], v213, s[20:23], s88 offen offset:2048 sc1
buffer_load_dwordx4 a[244:247], v213, s[20:23], s88 offen offset:3072 sc1
buffer_load_dwordx4 a[200:203], v214, s[20:23], s88 offen sc1
buffer_load_dwordx4 a[216:219], v214, s[20:23], s88 offen offset:1024 sc1
buffer_load_dwordx4 a[232:235], v214, s[20:23], s88 offen offset:2048 sc1
buffer_load_dwordx4 a[248:251], v214, s[20:23], s88 offen offset:3072 sc1
buffer_load_dwordx4 a[204:207], v215, s[20:23], s88 offen sc1
buffer_load_dwordx4 a[220:223], v215, s[20:23], s88 offen offset:1024 sc1
buffer_load_dwordx4 a[236:239], v215, s[20:23], s88 offen offset:2048 sc1
buffer_load_dwordx4 a[252:255], v215, s[20:23], s88 offen offset:3072 sc1
s_add_u32 s88, s88, 0x80000
s_waitcnt vmcnt(25)
s_barrier
ds_read_b64_tr_b16 v[176:177], v208
ds_read_b64_tr_b16 v[178:179], v208 offset:4608
ds_read_b64_tr_b16 v[180:181], v208 offset:9216
ds_read_b64_tr_b16 v[182:183], v208 offset:13824
ds_read_b64_tr_b16 v[184:185], v208 offset:18432
ds_read_b64_tr_b16 v[186:187], v208 offset:23040
ds_read_b64_tr_b16 v[188:189], v208 offset:27648
ds_read_b64_tr_b16 v[190:191], v208 offset:32256
s_waitcnt lgkmcnt(0)
v_mfma_f32_16x16x32_bf16 v[32:35], v[176:179], a[128:131], 0
ds_read_b64_tr_b16 v[192:193], v208 offset:32
ds_read_b64_tr_b16 v[194:195], v208 offset:4640
v_mfma_f32_16x16x32_bf16 v[32:35], v[180:183], a[132:135], v[32:35]
ds_read_b64_tr_b16 v[196:197], v208 offset:9248
ds_read_b64_tr_b16 v[198:199], v208 offset:13856
v_mfma_f32_16x16x32_bf16 v[32:35], v[184:187], a[136:139], v[32:35]
ds_read_b64_tr_b16 v[200:201], v208 offset:18464
ds_read_b64_tr_b16 v[202:203], v208 offset:23072
v_mfma_f32_16x16x32_bf16 v[32:35], v[188:191], a[140:143], v[32:35]
ds_read_b64_tr_b16 v[204:205], v208 offset:27680
ds_read_b64_tr_b16 v[206:207], v208 offset:32288
v_mfma_f32_16x16x32_bf16 v[36:39], v[176:179], a[144:147], 0
s_waitcnt vmcnt(40)
s_add_u32 m0, s51, 0x12000
v_mfma_f32_16x16x32_bf16 v[36:39], v[180:183], a[148:151], v[36:39]
buffer_load_dwordx4 v242, s[16:19], s87 offen lds
v_mfma_f32_16x16x32_bf16 v[36:39], v[184:187], a[152:155], v[36:39]
v_mfma_f32_16x16x32_bf16 v[36:39], v[188:191], a[156:159], v[36:39]
s_add_u32 m0, s51, 0x12400
v_mfma_f32_16x16x32_bf16 v[40:43], v[176:179], a[160:163], 0
buffer_load_dwordx4 v243, s[16:19], s87 offen lds
v_mfma_f32_16x16x32_bf16 v[40:43], v[180:183], a[164:167], v[40:43]
v_mfma_f32_16x16x32_bf16 v[40:43], v[184:187], a[168:171], v[40:43]
s_add_u32 m0, s51, 0x12800
v_mfma_f32_16x16x32_bf16 v[40:43], v[188:191], a[172:175], v[40:43]
buffer_load_dwordx4 v244, s[16:19], s87 offen lds
v_mfma_f32_16x16x32_bf16 v[44:47], v[176:179], a[176:179], 0
v_mfma_f32_16x16x32_bf16 v[44:47], v[180:183], a[180:183], v[44:47]
s_add_u32 m0, s51, 0x12c00
v_mfma_f32_16x16x32_bf16 v[44:47], v[184:187], a[184:187], v[44:47]
buffer_load_dwordx4 v245, s[16:19], s87 offen lds
v_mfma_f32_16x16x32_bf16 v[44:47], v[188:191], a[188:191], v[44:47]
s_waitcnt lgkmcnt(0)
v_mfma_f32_16x16x32_bf16 v[48:51], v[192:195], a[128:131], 0
ds_read_b64_tr_b16 v[176:177], v208 offset:64
ds_read_b64_tr_b16 v[178:179], v208 offset:4672
v_mfma_f32_16x16x32_bf16 v[48:51], v[196:199], a[132:135], v[48:51]
ds_read_b64_tr_b16 v[180:181], v208 offset:9280
ds_read_b64_tr_b16 v[182:183], v208 offset:13888
v_mfma_f32_16x16x32_bf16 v[48:51], v[200:203], a[136:139], v[48:51]
ds_read_b64_tr_b16 v[184:185], v208 offset:18496
ds_read_b64_tr_b16 v[186:187], v208 offset:23104
v_mfma_f32_16x16x32_bf16 v[48:51], v[204:207], a[140:143], v[48:51]
ds_read_b64_tr_b16 v[188:189], v208 offset:27712
ds_read_b64_tr_b16 v[190:191], v208 offset:32320
v_mfma_f32_16x16x32_bf16 v[52:55], v[192:195], a[144:147], 0
s_add_u32 m0, s51, 0x13000
v_mfma_f32_16x16x32_bf16 v[52:55], v[196:199], a[148:151], v[52:55]
buffer_load_dwordx4 v246, s[16:19], s87 offen lds
v_mfma_f32_16x16x32_bf16 v[52:55], v[200:203], a[152:155], v[52:55]
v_mfma_f32_16x16x32_bf16 v[52:55], v[204:207], a[156:159], v[52:55]
s_add_u32 m0, s51, 0x13400
v_mfma_f32_16x16x32_bf16 v[56:59], v[192:195], a[160:163], 0
buffer_load_dwordx4 v247, s[16:19], s87 offen lds
v_mfma_f32_16x16x32_bf16 v[56:59], v[196:199], a[164:167], v[56:59]
v_mfma_f32_16x16x32_bf16 v[56:59], v[200:203], a[168:171], v[56:59]
s_add_u32 m0, s51, 0x13800
v_mfma_f32_16x16x32_bf16 v[56:59], v[204:207], a[172:175], v[56:59]
buffer_load_dwordx4 v248, s[16:19], s87 offen lds
v_mfma_f32_16x16x32_bf16 v[60:63], v[192:195], a[176:179], 0
v_mfma_f32_16x16x32_bf16 v[60:63], v[196:199], a[180:183], v[60:63]
s_add_u32 m0, s51, 0x13c00
v_mfma_f32_16x16x32_bf16 v[60:63], v[200:203], a[184:187], v[60:63]
buffer_load_dwordx4 v249, s[16:19], s87 offen lds
v_mfma_f32_16x16x32_bf16 v[60:63], v[204:207], a[188:191], v[60:63]
s_waitcnt lgkmcnt(0)
v_mfma_f32_16x16x32_bf16 v[64:67], v[176:179], a[128:131], 0
ds_read_b64_tr_b16 v[192:193], v208 offset:96
ds_read_b64_tr_b16 v[194:195], v208 offset:4704
v_mfma_f32_16x16x32_bf16 v[64:67], v[180:183], a[132:135], v[64:67]
ds_read_b64_tr_b16 v[196:197], v208 offset:9312
ds_read_b64_tr_b16 v[198:199], v208 offset:13920
v_mfma_f32_16x16x32_bf16 v[64:67], v[184:187], a[136:139], v[64:67]
ds_read_b64_tr_b16 v[200:201], v208 offset:18528
ds_read_b64_tr_b16 v[202:203], v208 offset:23136
v_mfma_f32_16x16x32_bf16 v[64:67], v[188:191], a[140:143], v[64:67]
ds_read_b64_tr_b16 v[204:205], v208 offset:27744
ds_read_b64_tr_b16 v[206:207], v208 offset:32352
v_mfma_f32_16x16x32_bf16 v[68:71], v[176:179], a[144:147], 0
s_add_u32 m0, s51, 0x14000
v_mfma_f32_16x16x32_bf16 v[68:71], v[180:183], a[148:151], v[68:71]
buffer_load_dwordx4 v250, s[16:19], s87 offen lds
s_add_u32 s87, s87, 0x24000
v_mfma_f32_16x16x32_bf16 v[68:71], v[184:187], a[152:155], v[68:71]
v_mfma_f32_16x16x32_bf16 v[68:71], v[188:191], a[156:159], v[68:71]
v_mfma_f32_16x16x32_bf16 v[72:75], v[176:179], a[160:163], 0
buffer_load_dwordx4 a[0:3], v212, s[20:23], s88 offen sc1
v_mfma_f32_16x16x32_bf16 v[72:75], v[180:183], a[164:167], v[72:75]
v_mfma_f32_16x16x32_bf16 v[72:75], v[184:187], a[168:171], v[72:75]
v_mfma_f32_16x16x32_bf16 v[72:75], v[188:191], a[172:175], v[72:75]
buffer_load_dwordx4 a[16:19], v212, s[20:23], s88 offen offset:1024 sc1
v_mfma_f32_16x16x32_bf16 v[76:79], v[176:179], a[176:179], 0
v_mfma_f32_16x16x32_bf16 v[76:79], v[180:183], a[180:183], v[76:79]
v_mfma_f32_16x16x32_bf16 v[76:79], v[184:187], a[184:187], v[76:79]
buffer_load_dwordx4 a[32:35], v212, s[20:23], s88 offen offset:2048 sc1
v_mfma_f32_16x16x32_bf16 v[76:79], v[188:191], a[188:191], v[76:79]
s_waitcnt lgkmcnt(0)
v_mfma_f32_16x16x32_bf16 v[80:83], v[192:195], a[128:131], 0
ds_read_b64_tr_b16 v[176:177], v208 offset:128
ds_read_b64_tr_b16 v[178:179], v208 offset:4736
v_mfma_f32_16x16x32_bf16 v[80:83], v[196:199], a[132:135], v[80:83]
ds_read_b64_tr_b16 v[180:181], v208 offset:9344
ds_read_b64_tr_b16 v[182:183], v208 offset:13952
v_mfma_f32_16x16x32_bf16 v[80:83], v[200:203], a[136:139], v[80:83]
ds_read_b64_tr_b16 v[184:185], v208 offset:18560
ds_read_b64_tr_b16 v[186:187], v208 offset:23168
v_mfma_f32_16x16x32_bf16 v[80:83], v[204:207], a[140:143], v[80:83]
ds_read_b64_tr_b16 v[188:189], v208 offset:27776
ds_read_b64_tr_b16 v[190:191], v208 offset:32384
v_mfma_f32_16x16x32_bf16 v[84:87], v[192:195], a[144:147], 0
v_mfma_f32_16x16x32_bf16 v[84:87], v[196:199], a[148:151], v[84:87]
buffer_load_dwordx4 a[48:51], v212, s[20:23], s88 offen offset:3072 sc1
v_mfma_f32_16x16x32_bf16 v[84:87], v[200:203], a[152:155], v[84:87]
v_mfma_f32_16x16x32_bf16 v[84:87], v[204:207], a[156:159], v[84:87]
v_mfma_f32_16x16x32_bf16 v[88:91], v[192:195], a[160:163], 0
buffer_load_dwordx4 a[4:7], v213, s[20:23], s88 offen sc1
v_mfma_f32_16x16x32_bf16 v[88:91], v[196:199], a[164:167], v[88:91]
v_mfma_f32_16x16x32_bf16 v[88:91], v[200:203], a[168:171], v[88:91]
v_mfma_f32_16x16x32_bf16 v[88:91], v[204:207], a[172:175], v[88:91]
buffer_load_dwordx4 a[20:23], v213, s[20:23], s88 offen offset:1024 sc1
v_mfma_f32_16x16x32_bf16 v[92:95], v[192:195], a[176:179], 0
v_mfma_f32_16x16x32_bf16 v[92:95], v[196:199], a[180:183], v[92:95]
v_mfma_f32_16x16x32_bf16 v[92:95], v[200:203], a[184:187], v[92:95]
buffer_load_dwordx4 a[36:39], v213, s[20:23], s88 offen offset:2048 sc1
v_mfma_f32_16x16x32_bf16 v[92:95], v[204:207], a[188:191], v[92:95]
s_waitcnt lgkmcnt(0)
v_mfma_f32_16x16x32_bf16 v[96:99], v[176:179], a[128:131], 0
ds_read_b64_tr_b16 v[192:193], v208 offset:160
ds_read_b64_tr_b16 v[194:195], v208 offset:4768
v_mfma_f32_16x16x32_bf16 v[96:99], v[180:183], a[132:135], v[96:99]
ds_read_b64_tr_b16 v[196:197], v208 offset:9376
ds_read_b64_tr_b16 v[198:199], v208 offset:13984
v_mfma_f32_16x16x32_bf16 v[96:99], v[184:187], a[136:139], v[96:99]
ds_read_b64_tr_b16 v[200:201], v208 offset:18592
ds_read_b64_tr_b16 v[202:203], v208 offset:23200
v_mfma_f32_16x16x32_bf16 v[96:99], v[188:191], a[140:143], v[96:99]
ds_read_b64_tr_b16 v[204:205], v208 offset:27808
ds_read_b64_tr_b16 v[206:207], v208 offset:32416
v_mfma_f32_16x16x32_bf16 v[100:103], v[176:179], a[144:147], 0
s_waitcnt vmcnt(40)
v_mfma_f32_16x16x32_bf16 v[100:103], v[180:183], a[148:151], v[100:103]
buffer_load_dwordx4 a[52:55], v213, s[20:23], s88 offen offset:3072 sc1
v_mfma_f32_16x16x32_bf16 v[100:103], v[184:187], a[152:155], v[100:103]
v_mfma_f32_16x16x32_bf16 v[100:103], v[188:191], a[156:159], v[100:103]
v_mfma_f32_16x16x32_bf16 v[104:107], v[176:179], a[160:163], 0
buffer_load_dwordx4 a[8:11], v214, s[20:23], s88 offen sc1
v_mfma_f32_16x16x32_bf16 v[104:107], v[180:183], a[164:167], v[104:107]
v_mfma_f32_16x16x32_bf16 v[104:107], v[184:187], a[168:171], v[104:107]
v_mfma_f32_16x16x32_bf16 v[104:107], v[188:191], a[172:175], v[104:107]
buffer_load_dwordx4 a[24:27], v214, s[20:23], s88 offen offset:1024 sc1
v_mfma_f32_16x16x32_bf16 v[108:111], v[176:179], a[176:179], 0
v_mfma_f32_16x16x32_bf16 v[108:111], v[180:183], a[180:183], v[108:111]
v_mfma_f32_16x16x32_bf16 v[108:111], v[184:187], a[184:187], v[108:111]
buffer_load_dwordx4 a[40:43], v214, s[20:23], s88 offen offset:2048 sc1
v_mfma_f32_16x16x32_bf16 v[108:111], v[188:191], a[188:191], v[108:111]
s_waitcnt lgkmcnt(0)
v_mfma_f32_16x16x32_bf16 v[112:115], v[192:195], a[128:131], 0
ds_read_b64_tr_b16 v[176:177], v208 offset:192
ds_read_b64_tr_b16 v[178:179], v208 offset:4800
v_mfma_f32_16x16x32_bf16 v[112:115], v[196:199], a[132:135], v[112:115]
ds_read_b64_tr_b16 v[180:181], v208 offset:9408
ds_read_b64_tr_b16 v[182:183], v208 offset:14016
v_mfma_f32_16x16x32_bf16 v[112:115], v[200:203], a[136:139], v[112:115]
ds_read_b64_tr_b16 v[184:185], v208 offset:18624
ds_read_b64_tr_b16 v[186:187], v208 offset:23232
v_mfma_f32_16x16x32_bf16 v[112:115], v[204:207], a[140:143], v[112:115]
ds_read_b64_tr_b16 v[188:189], v208 offset:27840
ds_read_b64_tr_b16 v[190:191], v208 offset:32448
v_mfma_f32_16x16x32_bf16 v[116:119], v[192:195], a[144:147], 0
v_mfma_f32_16x16x32_bf16 v[116:119], v[196:199], a[148:151], v[116:119]
buffer_load_dwordx4 a[56:59], v214, s[20:23], s88 offen offset:3072 sc1
v_mfma_f32_16x16x32_bf16 v[116:119], v[200:203], a[152:155], v[116:119]
v_mfma_f32_16x16x32_bf16 v[116:119], v[204:207], a[156:159], v[116:119]
v_mfma_f32_16x16x32_bf16 v[120:123], v[192:195], a[160:163], 0
buffer_load_dwordx4 a[12:15], v215, s[20:23], s88 offen sc1
v_mfma_f32_16x16x32_bf16 v[120:123], v[196:199], a[164:167], v[120:123]
v_mfma_f32_16x16x32_bf16 v[120:123], v[200:203], a[168:171], v[120:123]
v_mfma_f32_16x16x32_bf16 v[120:123], v[204:207], a[172:175], v[120:123]
buffer_load_dwordx4 a[28:31], v215, s[20:23], s88 offen offset:1024 sc1
v_mfma_f32_16x16x32_bf16 v[124:127], v[192:195], a[176:179], 0
v_mfma_f32_16x16x32_bf16 v[124:127], v[196:199], a[180:183], v[124:127]
v_mfma_f32_16x16x32_bf16 v[124:127], v[200:203], a[184:187], v[124:127]
buffer_load_dwordx4 a[44:47], v215, s[20:23], s88 offen offset:2048 sc1
v_mfma_f32_16x16x32_bf16 v[124:127], v[204:207], a[188:191], v[124:127]
s_waitcnt lgkmcnt(0)
v_mfma_f32_16x16x32_bf16 v[128:131], v[176:179], a[128:131], 0
ds_read_b64_tr_b16 v[192:193], v208 offset:224
ds_read_b64_tr_b16 v[194:195], v208 offset:4832
v_mfma_f32_16x16x32_bf16 v[128:131], v[180:183], a[132:135], v[128:131]
ds_read_b64_tr_b16 v[196:197], v208 offset:9440
ds_read_b64_tr_b16 v[198:199], v208 offset:14048
v_mfma_f32_16x16x32_bf16 v[128:131], v[184:187], a[136:139], v[128:131]
ds_read_b64_tr_b16 v[200:201], v208 offset:18656
ds_read_b64_tr_b16 v[202:203], v208 offset:23264
v_mfma_f32_16x16x32_bf16 v[128:131], v[188:191], a[140:143], v[128:131]
ds_read_b64_tr_b16 v[204:205], v208 offset:27872
ds_read_b64_tr_b16 v[206:207], v208 offset:32480
v_mfma_f32_16x16x32_bf16 v[132:135], v[176:179], a[144:147], 0
v_mfma_f32_16x16x32_bf16 v[132:135], v[180:183], a[148:151], v[132:135]
buffer_load_dwordx4 a[60:63], v215, s[20:23], s88 offen offset:3072 sc1
s_add_u32 s88, s88, 0x80000
v_mfma_f32_16x16x32_bf16 v[132:135], v[184:187], a[152:155], v[132:135]
v_mfma_f32_16x16x32_bf16 v[132:135], v[188:191], a[156:159], v[132:135]
s_add_u32 m0, s51, 0x1b000
v_mfma_f32_16x16x32_bf16 v[136:139], v[176:179], a[160:163], 0
buffer_load_dwordx4 v242, s[16:19], s87 offen lds
v_mfma_f32_16x16x32_bf16 v[136:139], v[180:183], a[164:167], v[136:139]
v_mfma_f32_16x16x32_bf16 v[136:139], v[184:187], a[168:171], v[136:139]
s_add_u32 m0, s51, 0x1b400
v_mfma_f32_16x16x32_bf16 v[136:139], v[188:191], a[172:175], v[136:139]
buffer_load_dwordx4 v243, s[16:19], s87 offen lds
v_mfma_f32_16x16x32_bf16 v[140:143], v[176:179], a[176:179], 0
v_mfma_f32_16x16x32_bf16 v[140:143], v[180:183], a[180:183], v[140:143]
s_add_u32 m0, s51, 0x1b800
v_mfma_f32_16x16x32_bf16 v[140:143], v[184:187], a[184:187], v[140:143]
buffer_load_dwordx4 v244, s[16:19], s87 offen lds
v_mfma_f32_16x16x32_bf16 v[140:143], v[188:191], a[188:191], v[140:143]
s_waitcnt lgkmcnt(0)
v_mfma_f32_16x16x32_bf16 v[144:147], v[192:195], a[128:131], 0
ds_read_b64_tr_b16 v[176:177], v208 offset:256
ds_read_b64_tr_b16 v[178:179], v208 offset:4864
v_mfma_f32_16x16x32_bf16 v[144:147], v[196:199], a[132:135], v[144:147]
ds_read_b64_tr_b16 v[180:181], v208 offset:9472
ds_read_b64_tr_b16 v[182:183], v208 offset:14080
v_mfma_f32_16x16x32_bf16 v[144:147], v[200:203], a[136:139], v[144:147]
ds_read_b64_tr_b16 v[184:185], v208 offset:18688
ds_read_b64_tr_b16 v[186:187], v208 offset:23296
v_mfma_f32_16x16x32_bf16 v[144:147], v[204:207], a[140:143], v[144:147]
ds_read_b64_tr_b16 v[188:189], v208 offset:27904
ds_read_b64_tr_b16 v[190:191], v208 offset:32512
v_mfma_f32_16x16x32_bf16 v[148:151], v[192:195], a[144:147], 0
v_mfma_f32_16x16x32_bf16 v[148:151], v[196:199], a[148:151], v[148:151]
v_mfma_f32_16x16x32_bf16 v[148:151], v[200:203], a[152:155], v[148:151]
s_add_u32 m0, s51, 0x1bc00
v_mfma_f32_16x16x32_bf16 v[148:151], v[204:207], a[156:159], v[148:151]
buffer_load_dwordx4 v245, s[16:19], s87 offen lds
v_mfma_f32_16x16x32_bf16 v[152:155], v[192:195], a[160:163], 0
v_mfma_f32_16x16x32_bf16 v[152:155], v[196:199], a[164:167], v[152:155]
v_mfma_f32_16x16x32_bf16 v[152:155], v[200:203], a[168:171], v[152:155]
s_add_u32 m0, s51, 0x1c000
v_mfma_f32_16x16x32_bf16 v[152:155], v[204:207], a[172:175], v[152:155]
buffer_load_dwordx4 v246, s[16:19], s87 offen lds
v_mfma_f32_16x16x32_bf16 v[156:159], v[192:195], a[176:179], 0
v_mfma_f32_16x16x32_bf16 v[156:159], v[196:199], a[180:183], v[156:159]
v_mfma_f32_16x16x32_bf16 v[156:159], v[200:203], a[184:187], v[156:159]
v_mfma_f32_16x16x32_bf16 v[156:159], v[204:207], a[188:191], v[156:159]
s_waitcnt lgkmcnt(0)
v_mfma_f32_16x16x32_bf16 v[160:163], v[176:179], a[128:131], 0
s_waitcnt vmcnt(30)
s_barrier
v_mfma_f32_16x16x32_bf16 v[160:163], v[180:183], a[132:135], v[160:163]
ds_read_b64_tr_b16 v[192:193], v209
ds_read_b64_tr_b16 v[194:195], v209 offset:4608
v_mfma_f32_16x16x32_bf16 v[160:163], v[184:187], a[136:139], v[160:163]
ds_read_b64_tr_b16 v[196:197], v209 offset:9216
ds_read_b64_tr_b16 v[198:199], v209 offset:13824
v_mfma_f32_16x16x32_bf16 v[160:163], v[188:191], a[140:143], v[160:163]
ds_read_b64_tr_b16 v[200:201], v209 offset:18432
ds_read_b64_tr_b16 v[202:203], v209 offset:23040
v_mfma_f32_16x16x32_bf16 v[164:167], v[176:179], a[144:147], 0
ds_read_b64_tr_b16 v[204:205], v209 offset:27648
ds_read_b64_tr_b16 v[206:207], v209 offset:32256
v_mfma_f32_16x16x32_bf16 v[164:167], v[180:183], a[148:151], v[164:167]
v_mfma_f32_16x16x32_bf16 v[164:167], v[184:187], a[152:155], v[164:167]
v_mfma_f32_16x16x32_bf16 v[164:167], v[188:191], a[156:159], v[164:167]
v_mfma_f32_16x16x32_bf16 v[168:171], v[176:179], a[160:163], 0
v_mfma_f32_16x16x32_bf16 v[168:171], v[180:183], a[164:167], v[168:171]
v_mfma_f32_16x16x32_bf16 v[168:171], v[184:187], a[168:171], v[168:171]
v_mfma_f32_16x16x32_bf16 v[168:171], v[188:191], a[172:175], v[168:171]
v_mfma_f32_16x16x32_bf16 v[172:175], v[176:179], a[176:179], 0
v_mfma_f32_16x16x32_bf16 v[172:175], v[180:183], a[180:183], v[172:175]
v_mfma_f32_16x16x32_bf16 v[172:175], v[184:187], a[184:187], v[172:175]
v_mfma_f32_16x16x32_bf16 v[172:175], v[188:191], a[188:191], v[172:175]
s_waitcnt lgkmcnt(0)
v_mfma_f32_16x16x32_bf16 v[32:35], v[192:195], a[192:195], v[32:35]
ds_read_b64_tr_b16 v[176:177], v209 offset:32
ds_read_b64_tr_b16 v[178:179], v209 offset:4640
v_mfma_f32_16x16x32_bf16 v[32:35], v[196:199], a[196:199], v[32:35]
ds_read_b64_tr_b16 v[180:181], v209 offset:9248
ds_read_b64_tr_b16 v[182:183], v209 offset:13856
v_mfma_f32_16x16x32_bf16 v[32:35], v[200:203], a[200:203], v[32:35]
ds_read_b64_tr_b16 v[184:185], v209 offset:18464
ds_read_b64_tr_b16 v[186:187], v209 offset:23072
v_mfma_f32_16x16x32_bf16 v[32:35], v[204:207], a[204:207], v[32:35]
ds_read_b64_tr_b16 v[188:189], v209 offset:27680
ds_read_b64_tr_b16 v[190:191], v209 offset:32288
v_mfma_f32_16x16x32_bf16 v[36:39], v[192:195], a[208:211], v[36:39]
s_waitcnt vmcnt(40)
s_add_u32 m0, s51, 0x1c400
v_mfma_f32_16x16x32_bf16 v[36:39], v[196:199], a[212:215], v[36:39]
buffer_load_dwordx4 v247, s[16:19], s87 offen lds
v_mfma_f32_16x16x32_bf16 v[36:39], v[200:203], a[216:219], v[36:39]
v_mfma_f32_16x16x32_bf16 v[36:39], v[204:207], a[220:223], v[36:39]
s_add_u32 m0, s51, 0x1c800
v_mfma_f32_16x16x32_bf16 v[40:43], v[192:195], a[224:227], v[40:43]
buffer_load_dwordx4 v248, s[16:19], s87 offen lds
v_mfma_f32_16x16x32_bf16 v[40:43], v[196:199], a[228:231], v[40:43]
v_mfma_f32_16x16x32_bf16 v[40:43], v[200:203], a[232:235], v[40:43]
s_add_u32 m0, s51, 0x1cc00
v_mfma_f32_16x16x32_bf16 v[40:43], v[204:207], a[236:239], v[40:43]
buffer_load_dwordx4 v249, s[16:19], s87 offen lds
v_mfma_f32_16x16x32_bf16 v[44:47], v[192:195], a[240:243], v[44:47]
v_mfma_f32_16x16x32_bf16 v[44:47], v[196:199], a[244:247], v[44:47]
s_add_u32 m0, s51, 0x1d000
v_mfma_f32_16x16x32_bf16 v[44:47], v[200:203], a[248:251], v[44:47]
buffer_load_dwordx4 v250, s[16:19], s87 offen lds
s_add_u32 s87, s87, 0x24000
v_mfma_f32_16x16x32_bf16 v[44:47], v[204:207], a[252:255], v[44:47]
s_waitcnt lgkmcnt(0)
v_mfma_f32_16x16x32_bf16 v[48:51], v[176:179], a[192:195], v[48:51]
ds_read_b64_tr_b16 v[192:193], v209 offset:64
ds_read_b64_tr_b16 v[194:195], v209 offset:4672
v_mfma_f32_16x16x32_bf16 v[48:51], v[180:183], a[196:199], v[48:51]
ds_read_b64_tr_b16 v[196:197], v209 offset:9280
ds_read_b64_tr_b16 v[198:199], v209 offset:13888
v_mfma_f32_16x16x32_bf16 v[48:51], v[184:187], a[200:203], v[48:51]
ds_read_b64_tr_b16 v[200:201], v209 offset:18496
ds_read_b64_tr_b16 v[202:203], v209 offset:23104
v_mfma_f32_16x16x32_bf16 v[48:51], v[188:191], a[204:207], v[48:51]
ds_read_b64_tr_b16 v[204:205], v209 offset:27712
ds_read_b64_tr_b16 v[206:207], v209 offset:32320
v_mfma_f32_16x16x32_bf16 v[52:55], v[176:179], a[208:211], v[52:55]
v_mfma_f32_16x16x32_bf16 v[52:55], v[180:183], a[212:215], v[52:55]
buffer_load_dwordx4 a[64:67], v212, s[20:23], s88 offen sc1
v_mfma_f32_16x16x32_bf16 v[52:55], v[184:187], a[216:219], v[52:55]
v_mfma_f32_16x16x32_bf16 v[52:55], v[188:191], a[220:223], v[52:55]
v_mfma_f32_16x16x32_bf16 v[56:59], v[176:179], a[224:227], v[56:59]
buffer_load_dwordx4 a[80:83], v212, s[20:23], s88 offen offset:1024 sc1
v_mfma_f32_16x16x32_bf16 v[56:59], v[180:183], a[228:231], v[56:59]
v_mfma_f32_16x16x32_bf16 v[56:59], v[184:187], a[232:235], v[56:59]
v_mfma_f32_16x16x32_bf16 v[56:59], v[188:191], a[236:239], v[56:59]
buffer_load_dwordx4 a[96:99], v212, s[20:23], s88 offen offset:2048 sc1
v_mfma_f32_16x16x32_bf16 v[60:63], v[176:179], a[240:243], v[60:63]
v_mfma_f32_16x16x32_bf16 v[60:63], v[180:183], a[244:247], v[60:63]
v_mfma_f32_16x16x32_bf16 v[60:63], v[184:187], a[248:251], v[60:63]
buffer_load_dwordx4 a[112:115], v212, s[20:23], s88 offen offset:3072 sc1
v_mfma_f32_16x16x32_bf16 v[60:63], v[188:191], a[252:255], v[60:63]
s_waitcnt lgkmcnt(0)
v_mfma_f32_16x16x32_bf16 v[64:67], v[192:195], a[192:195], v[64:67]
ds_read_b64_tr_b16 v[176:177], v209 offset:96
ds_read_b64_tr_b16 v[178:179], v209 offset:4704
v_mfma_f32_16x16x32_bf16 v[64:67], v[196:199], a[196:199], v[64:67]
ds_read_b64_tr_b16 v[180:181], v209 offset:9312
ds_read_b64_tr_b16 v[182:183], v209 offset:13920
v_mfma_f32_16x16x32_bf16 v[64:67], v[200:203], a[200:203], v[64:67]
ds_read_b64_tr_b16 v[184:185], v209 offset:18528
ds_read_b64_tr_b16 v[186:187], v209 offset:23136
v_mfma_f32_16x16x32_bf16 v[64:67], v[204:207], a[204:207], v[64:67]
ds_read_b64_tr_b16 v[188:189], v209 offset:27744
ds_read_b64_tr_b16 v[190:191], v209 offset:32352
v_mfma_f32_16x16x32_bf16 v[68:71], v[192:195], a[208:211], v[68:71]
v_mfma_f32_16x16x32_bf16 v[68:71], v[196:199], a[212:215], v[68:71]
buffer_load_dwordx4 a[68:71], v213, s[20:23], s88 offen sc1
v_mfma_f32_16x16x32_bf16 v[68:71], v[200:203], a[216:219], v[68:71]
v_mfma_f32_16x16x32_bf16 v[68:71], v[204:207], a[220:223], v[68:71]
v_mfma_f32_16x16x32_bf16 v[72:75], v[192:195], a[224:227], v[72:75]
buffer_load_dwordx4 a[84:87], v213, s[20:23], s88 offen offset:1024 sc1
v_mfma_f32_16x16x32_bf16 v[72:75], v[196:199], a[228:231], v[72:75]
v_mfma_f32_16x16x32_bf16 v[72:75], v[200:203], a[232:235], v[72:75]
v_mfma_f32_16x16x32_bf16 v[72:75], v[204:207], a[236:239], v[72:75]
buffer_load_dwordx4 a[100:103], v213, s[20:23], s88 offen offset:2048 sc1
v_mfma_f32_16x16x32_bf16 v[76:79], v[192:195], a[240:243], v[76:79]
v_mfma_f32_16x16x32_bf16 v[76:79], v[196:199], a[244:247], v[76:79]
v_mfma_f32_16x16x32_bf16 v[76:79], v[200:203], a[248:251], v[76:79]
buffer_load_dwordx4 a[116:119], v213, s[20:23], s88 offen offset:3072 sc1
v_mfma_f32_16x16x32_bf16 v[76:79], v[204:207], a[252:255], v[76:79]
s_waitcnt lgkmcnt(0)
v_mfma_f32_16x16x32_bf16 v[80:83], v[176:179], a[192:195], v[80:83]
ds_read_b64_tr_b16 v[192:193], v209 offset:128
ds_read_b64_tr_b16 v[194:195], v209 offset:4736
v_mfma_f32_16x16x32_bf16 v[80:83], v[180:183], a[196:199], v[80:83]
ds_read_b64_tr_b16 v[196:197], v209 offset:9344
ds_read_b64_tr_b16 v[198:199], v209 offset:13952
v_mfma_f32_16x16x32_bf16 v[80:83], v[184:187], a[200:203], v[80:83]
ds_read_b64_tr_b16 v[200:201], v209 offset:18560
ds_read_b64_tr_b16 v[202:203], v209 offset:23168
v_mfma_f32_16x16x32_bf16 v[80:83], v[188:191], a[204:207], v[80:83]
ds_read_b64_tr_b16 v[204:205], v209 offset:27776
ds_read_b64_tr_b16 v[206:207], v209 offset:32384
v_mfma_f32_16x16x32_bf16 v[84:87], v[176:179], a[208:211], v[84:87]
v_mfma_f32_16x16x32_bf16 v[84:87], v[180:183], a[212:215], v[84:87]
buffer_load_dwordx4 a[72:75], v214, s[20:23], s88 offen sc1
v_mfma_f32_16x16x32_bf16 v[84:87], v[184:187], a[216:219], v[84:87]
v_mfma_f32_16x16x32_bf16 v[84:87], v[188:191], a[220:223], v[84:87]
v_mfma_f32_16x16x32_bf16 v[88:91], v[176:179], a[224:227], v[88:91]
buffer_load_dwordx4 a[88:91], v214, s[20:23], s88 offen offset:1024 sc1
v_mfma_f32_16x16x32_bf16 v[88:91], v[180:183], a[228:231], v[88:91]
v_mfma_f32_16x16x32_bf16 v[88:91], v[184:187], a[232:235], v[88:91]
v_mfma_f32_16x16x32_bf16 v[88:91], v[188:191], a[236:239], v[88:91]
buffer_load_dwordx4 a[104:107], v214, s[20:23], s88 offen offset:2048 sc1
v_mfma_f32_16x16x32_bf16 v[92:95], v[176:179], a[240:243], v[92:95]
v_mfma_f32_16x16x32_bf16 v[92:95], v[180:183], a[244:247], v[92:95]
v_mfma_f32_16x16x32_bf16 v[92:95], v[184:187], a[248:251], v[92:95]
buffer_load_dwordx4 a[120:123], v214, s[20:23], s88 offen offset:3072 sc1
v_mfma_f32_16x16x32_bf16 v[92:95], v[188:191], a[252:255], v[92:95]
s_waitcnt lgkmcnt(0)
v_mfma_f32_16x16x32_bf16 v[96:99], v[192:195], a[192:195], v[96:99]
ds_read_b64_tr_b16 v[176:177], v209 offset:160
ds_read_b64_tr_b16 v[178:179], v209 offset:4768
v_mfma_f32_16x16x32_bf16 v[96:99], v[196:199], a[196:199], v[96:99]
ds_read_b64_tr_b16 v[180:181], v209 offset:9376
ds_read_b64_tr_b16 v[182:183], v209 offset:13984
v_mfma_f32_16x16x32_bf16 v[96:99], v[200:203], a[200:203], v[96:99]
ds_read_b64_tr_b16 v[184:185], v209 offset:18592
ds_read_b64_tr_b16 v[186:187], v209 offset:23200
v_mfma_f32_16x16x32_bf16 v[96:99], v[204:207], a[204:207], v[96:99]
ds_read_b64_tr_b16 v[188:189], v209 offset:27808
ds_read_b64_tr_b16 v[190:191], v209 offset:32416
v_mfma_f32_16x16x32_bf16 v[100:103], v[192:195], a[208:211], v[100:103]
s_waitcnt vmcnt(40)
v_mfma_f32_16x16x32_bf16 v[100:103], v[196:199], a[212:215], v[100:103]
buffer_load_dwordx4 a[76:79], v215, s[20:23], s88 offen sc1
v_mfma_f32_16x16x32_bf16 v[100:103], v[200:203], a[216:219], v[100:103]
v_mfma_f32_16x16x32_bf16 v[100:103], v[204:207], a[220:223], v[100:103]
v_mfma_f32_16x16x32_bf16 v[104:107], v[192:195], a[224:227], v[104:107]
buffer_load_dwordx4 a[92:95], v215, s[20:23], s88 offen offset:1024 sc1
v_mfma_f32_16x16x32_bf16 v[104:107], v[196:199], a[228:231], v[104:107]
v_mfma_f32_16x16x32_bf16 v[104:107], v[200:203], a[232:235], v[104:107]
v_mfma_f32_16x16x32_bf16 v[104:107], v[204:207], a[236:239], v[104:107]
buffer_load_dwordx4 a[108:111], v215, s[20:23], s88 offen offset:2048 sc1
v_mfma_f32_16x16x32_bf16 v[108:111], v[192:195], a[240:243], v[108:111]
v_mfma_f32_16x16x32_bf16 v[108:111], v[196:199], a[244:247], v[108:111]
v_mfma_f32_16x16x32_bf16 v[108:111], v[200:203], a[248:251], v[108:111]
buffer_load_dwordx4 a[124:127], v215, s[20:23], s88 offen offset:3072 sc1
s_add_u32 s88, s88, 0x80000
v_mfma_f32_16x16x32_bf16 v[108:111], v[204:207], a[252:255], v[108:111]
s_waitcnt lgkmcnt(0)
v_mfma_f32_16x16x32_bf16 v[112:115], v[176:179], a[192:195], v[112:115]
ds_read_b64_tr_b16 v[192:193], v209 offset:192
ds_read_b64_tr_b16 v[194:195], v209 offset:4800
v_mfma_f32_16x16x32_bf16 v[112:115], v[180:183], a[196:199], v[112:115]
ds_read_b64_tr_b16 v[196:197], v209 offset:9408
ds_read_b64_tr_b16 v[198:199], v209 offset:14016
v_mfma_f32_16x16x32_bf16 v[112:115], v[184:187], a[200:203], v[112:115]
ds_read_b64_tr_b16 v[200:201], v209 offset:18624
ds_read_b64_tr_b16 v[202:203], v209 offset:23232
v_mfma_f32_16x16x32_bf16 v[112:115], v[188:191], a[204:207], v[112:115]
ds_read_b64_tr_b16 v[204:205], v209 offset:27840
ds_read_b64_tr_b16 v[206:207], v209 offset:32448
v_mfma_f32_16x16x32_bf16 v[116:119], v[176:179], a[208:211], v[116:119]
s_add_u32 m0, s51, 0
v_mfma_f32_16x16x32_bf16 v[116:119], v[180:183], a[212:215], v[116:119]
buffer_load_dwordx4 v242, s[16:19], s87 offen lds
v_mfma_f32_16x16x32_bf16 v[116:119], v[184:187], a[216:219], v[116:119]
v_mfma_f32_16x16x32_bf16 v[116:119], v[188:191], a[220:223], v[116:119]
s_add_u32 m0, s51, 0x400
v_mfma_f32_16x16x32_bf16 v[120:123], v[176:179], a[224:227], v[120:123]
buffer_load_dwordx4 v243, s[16:19], s87 offen lds
v_mfma_f32_16x16x32_bf16 v[120:123], v[180:183], a[228:231], v[120:123]
v_mfma_f32_16x16x32_bf16 v[120:123], v[184:187], a[232:235], v[120:123]
s_add_u32 m0, s51, 0x800
v_mfma_f32_16x16x32_bf16 v[120:123], v[188:191], a[236:239], v[120:123]
buffer_load_dwordx4 v244, s[16:19], s87 offen lds
v_mfma_f32_16x16x32_bf16 v[124:127], v[176:179], a[240:243], v[124:127]
v_mfma_f32_16x16x32_bf16 v[124:127], v[180:183], a[244:247], v[124:127]
s_add_u32 m0, s51, 0xc00
v_mfma_f32_16x16x32_bf16 v[124:127], v[184:187], a[248:251], v[124:127]
buffer_load_dwordx4 v245, s[16:19], s87 offen lds
v_mfma_f32_16x16x32_bf16 v[124:127], v[188:191], a[252:255], v[124:127]
s_waitcnt lgkmcnt(0)
v_mfma_f32_16x16x32_bf16 v[128:131], v[192:195], a[192:195], v[128:131]
ds_read_b64_tr_b16 v[176:177], v209 offset:224
ds_read_b64_tr_b16 v[178:179], v209 offset:4832
v_mfma_f32_16x16x32_bf16 v[128:131], v[196:199], a[196:199], v[128:131]
ds_read_b64_tr_b16 v[180:181], v209 offset:9440
ds_read_b64_tr_b16 v[182:183], v209 offset:14048
v_mfma_f32_16x16x32_bf16 v[128:131], v[200:203], a[200:203], v[128:131]
ds_read_b64_tr_b16 v[184:185], v209 offset:18656
ds_read_b64_tr_b16 v[186:187], v209 offset:23264
v_mfma_f32_16x16x32_bf16 v[128:131], v[204:207], a[204:207], v[128:131]
ds_read_b64_tr_b16 v[188:189], v209 offset:27872
ds_read_b64_tr_b16 v[190:191], v209 offset:32480
v_mfma_f32_16x16x32_bf16 v[132:135], v[192:195], a[208:211], v[132:135]
s_add_u32 m0, s51, 0x1000
v_mfma_f32_16x16x32_bf16 v[132:135], v[196:199], a[212:215], v[132:135]
buffer_load_dwordx4 v246, s[16:19], s87 offen lds
v_mfma_f32_16x16x32_bf16 v[132:135], v[200:203], a[216:219], v[132:135]
v_mfma_f32_16x16x32_bf16 v[132:135], v[204:207], a[220:223], v[132:135]
s_add_u32 m0, s51, 0x1400
v_mfma_f32_16x16x32_bf16 v[136:139], v[192:195], a[224:227], v[136:139]
buffer_load_dwordx4 v247, s[16:19], s87 offen lds
v_mfma_f32_16x16x32_bf16 v[136:139], v[196:199], a[228:231], v[136:139]
v_mfma_f32_16x16x32_bf16 v[136:139], v[200:203], a[232:235], v[136:139]
s_add_u32 m0, s51, 0x1800
v_mfma_f32_16x16x32_bf16 v[136:139], v[204:207], a[236:239], v[136:139]
buffer_load_dwordx4 v248, s[16:19], s87 offen lds
v_mfma_f32_16x16x32_bf16 v[140:143], v[192:195], a[240:243], v[140:143]
v_mfma_f32_16x16x32_bf16 v[140:143], v[196:199], a[244:247], v[140:143]
s_add_u32 m0, s51, 0x1c00
v_mfma_f32_16x16x32_bf16 v[140:143], v[200:203], a[248:251], v[140:143]
buffer_load_dwordx4 v249, s[16:19], s87 offen lds
v_mfma_f32_16x16x32_bf16 v[140:143], v[204:207], a[252:255], v[140:143]
s_waitcnt lgkmcnt(0)
v_mfma_f32_16x16x32_bf16 v[144:147], v[176:179], a[192:195], v[144:147]
ds_read_b64_tr_b16 v[192:193], v209 offset:256
ds_read_b64_tr_b16 v[194:195], v209 offset:4864
v_mfma_f32_16x16x32_bf16 v[144:147], v[180:183], a[196:199], v[144:147]
ds_read_b64_tr_b16 v[196:197], v209 offset:9472
ds_read_b64_tr_b16 v[198:199], v209 offset:14080
v_mfma_f32_16x16x32_bf16 v[144:147], v[184:187], a[200:203], v[144:147]
ds_read_b64_tr_b16 v[200:201], v209 offset:18688
ds_read_b64_tr_b16 v[202:203], v209 offset:23296
v_mfma_f32_16x16x32_bf16 v[144:147], v[188:191], a[204:207], v[144:147]
ds_read_b64_tr_b16 v[204:205], v209 offset:27904
ds_read_b64_tr_b16 v[206:207], v209 offset:32512
v_mfma_f32_16x16x32_bf16 v[148:151], v[176:179], a[208:211], v[148:151]
v_mfma_f32_16x16x32_bf16 v[148:151], v[180:183], a[212:215], v[148:151]
v_mfma_f32_16x16x32_bf16 v[148:151], v[184:187], a[216:219], v[148:151]
s_add_u32 m0, s51, 0x2000
v_mfma_f32_16x16x32_bf16 v[148:151], v[188:191], a[220:223], v[148:151]
buffer_load_dwordx4 v250, s[16:19], s87 offen lds
s_add_u32 s87, s87, 0x24000
v_mfma_f32_16x16x32_bf16 v[152:155], v[176:179], a[224:227], v[152:155]
v_mfma_f32_16x16x32_bf16 v[152:155], v[180:183], a[228:231], v[152:155]
v_mfma_f32_16x16x32_bf16 v[152:155], v[184:187], a[232:235], v[152:155]
v_mfma_f32_16x16x32_bf16 v[152:155], v[188:191], a[236:239], v[152:155]
buffer_load_dwordx4 a[128:131], v212, s[20:23], s88 offen sc1
v_mfma_f32_16x16x32_bf16 v[156:159], v[176:179], a[240:243], v[156:159]
v_mfma_f32_16x16x32_bf16 v[156:159], v[180:183], a[244:247], v[156:159]
v_mfma_f32_16x16x32_bf16 v[156:159], v[184:187], a[248:251], v[156:159]
v_mfma_f32_16x16x32_bf16 v[156:159], v[188:191], a[252:255], v[156:159]
s_waitcnt lgkmcnt(0)
v_mfma_f32_16x16x32_bf16 v[160:163], v[192:195], a[192:195], v[160:163]
s_waitcnt vmcnt(35)
s_barrier
v_mfma_f32_16x16x32_bf16 v[160:163], v[196:199], a[196:199], v[160:163]
ds_read_b64_tr_b16 v[176:177], v210
ds_read_b64_tr_b16 v[178:179], v210 offset:4608
v_mfma_f32_16x16x32_bf16 v[160:163], v[200:203], a[200:203], v[160:163]
ds_read_b64_tr_b16 v[180:181], v210 offset:9216
ds_read_b64_tr_b16 v[182:183], v210 offset:13824
v_mfma_f32_16x16x32_bf16 v[160:163], v[204:207], a[204:207], v[160:163]
ds_read_b64_tr_b16 v[184:185], v210 offset:18432
ds_read_b64_tr_b16 v[186:187], v210 offset:23040
v_mfma_f32_16x16x32_bf16 v[164:167], v[192:195], a[208:211], v[164:167]
ds_read_b64_tr_b16 v[188:189], v210 offset:27648
ds_read_b64_tr_b16 v[190:191], v210 offset:32256
v_mfma_f32_16x16x32_bf16 v[164:167], v[196:199], a[212:215], v[164:167]
v_mfma_f32_16x16x32_bf16 v[164:167], v[200:203], a[216:219], v[164:167]
v_mfma_f32_16x16x32_bf16 v[164:167], v[204:207], a[220:223], v[164:167]
v_mfma_f32_16x16x32_bf16 v[168:171], v[192:195], a[224:227], v[168:171]
v_mfma_f32_16x16x32_bf16 v[168:171], v[196:199], a[228:231], v[168:171]
v_mfma_f32_16x16x32_bf16 v[168:171], v[200:203], a[232:235], v[168:171]
v_mfma_f32_16x16x32_bf16 v[168:171], v[204:207], a[236:239], v[168:171]
v_mfma_f32_16x16x32_bf16 v[172:175], v[192:195], a[240:243], v[172:175]
v_mfma_f32_16x16x32_bf16 v[172:175], v[196:199], a[244:247], v[172:175]
v_mfma_f32_16x16x32_bf16 v[172:175], v[200:203], a[248:251], v[172:175]
v_mfma_f32_16x16x32_bf16 v[172:175], v[204:207], a[252:255], v[172:175]
s_waitcnt lgkmcnt(0)
v_mfma_f32_16x16x32_bf16 v[32:35], v[176:179], a[0:3], v[32:35]
ds_read_b64_tr_b16 v[192:193], v210 offset:32
ds_read_b64_tr_b16 v[194:195], v210 offset:4640
v_mfma_f32_16x16x32_bf16 v[32:35], v[180:183], a[4:7], v[32:35]
ds_read_b64_tr_b16 v[196:197], v210 offset:9248
ds_read_b64_tr_b16 v[198:199], v210 offset:13856
v_mfma_f32_16x16x32_bf16 v[32:35], v[184:187], a[8:11], v[32:35]
ds_read_b64_tr_b16 v[200:201], v210 offset:18464
ds_read_b64_tr_b16 v[202:203], v210 offset:23072
v_mfma_f32_16x16x32_bf16 v[32:35], v[188:191], a[12:15], v[32:35]
ds_read_b64_tr_b16 v[204:205], v210 offset:27680
ds_read_b64_tr_b16 v[206:207], v210 offset:32288
v_mfma_f32_16x16x32_bf16 v[36:39], v[176:179], a[16:19], v[36:39]
s_waitcnt vmcnt(40)
v_mfma_f32_16x16x32_bf16 v[36:39], v[180:183], a[20:23], v[36:39]
buffer_load_dwordx4 a[144:147], v212, s[20:23], s88 offen offset:1024 sc1
v_mfma_f32_16x16x32_bf16 v[36:39], v[184:187], a[24:27], v[36:39]
v_mfma_f32_16x16x32_bf16 v[36:39], v[188:191], a[28:31], v[36:39]
v_mfma_f32_16x16x32_bf16 v[40:43], v[176:179], a[32:35], v[40:43]
buffer_load_dwordx4 a[160:163], v212, s[20:23], s88 offen offset:2048 sc1
v_mfma_f32_16x16x32_bf16 v[40:43], v[180:183], a[36:39], v[40:43]
v_mfma_f32_16x16x32_bf16 v[40:43], v[184:187], a[40:43], v[40:43]
v_mfma_f32_16x16x32_bf16 v[40:43], v[188:191], a[44:47], v[40:43]
buffer_load_dwordx4 a[176:179], v212, s[20:23], s88 offen offset:3072 sc1
v_mfma_f32_16x16x32_bf16 v[44:47], v[176:179], a[48:51], v[44:47]
v_mfma_f32_16x16x32_bf16 v[44:47], v[180:183], a[52:55], v[44:47]
v_mfma_f32_16x16x32_bf16 v[44:47], v[184:187], a[56:59], v[44:47]
buffer_load_dwordx4 a[132:135], v213, s[20:23], s88 offen sc1
v_mfma_f32_16x16x32_bf16 v[44:47], v[188:191], a[60:63], v[44:47]
s_waitcnt lgkmcnt(0)
v_mfma_f32_16x16x32_bf16 v[48:51], v[192:195], a[0:3], v[48:51]
ds_read_b64_tr_b16 v[176:177], v210 offset:64
ds_read_b64_tr_b16 v[178:179], v210 offset:4672
v_mfma_f32_16x16x32_bf16 v[48:51], v[196:199], a[4:7], v[48:51]
ds_read_b64_tr_b16 v[180:181], v210 offset:9280
ds_read_b64_tr_b16 v[182:183], v210 offset:13888
v_mfma_f32_16x16x32_bf16 v[48:51], v[200:203], a[8:11], v[48:51]
ds_read_b64_tr_b16 v[184:185], v210 offset:18496
ds_read_b64_tr_b16 v[186:187], v210 offset:23104
v_mfma_f32_16x16x32_bf16 v[48:51], v[204:207], a[12:15], v[48:51]
ds_read_b64_tr_b16 v[188:189], v210 offset:27712
ds_read_b64_tr_b16 v[190:191], v210 offset:32320
v_mfma_f32_16x16x32_bf16 v[52:55], v[192:195], a[16:19], v[52:55]
v_mfma_f32_16x16x32_bf16 v[52:55], v[196:199], a[20:23], v[52:55]
buffer_load_dwordx4 a[148:151], v213, s[20:23], s88 offen offset:1024 sc1
v_mfma_f32_16x16x32_bf16 v[52:55], v[200:203], a[24:27], v[52:55]
v_mfma_f32_16x16x32_bf16 v[52:55], v[204:207], a[28:31], v[52:55]
v_mfma_f32_16x16x32_bf16 v[56:59], v[192:195], a[32:35], v[56:59]
buffer_load_dwordx4 a[164:167], v213, s[20:23], s88 offen offset:2048 sc1
v_mfma_f32_16x16x32_bf16 v[56:59], v[196:199], a[36:39], v[56:59]
v_mfma_f32_16x16x32_bf16 v[56:59], v[200:203], a[40:43], v[56:59]
v_mfma_f32_16x16x32_bf16 v[56:59], v[204:207], a[44:47], v[56:59]
buffer_load_dwordx4 a[180:183], v213, s[20:23], s88 offen offset:3072 sc1
v_mfma_f32_16x16x32_bf16 v[60:63], v[192:195], a[48:51], v[60:63]
v_mfma_f32_16x16x32_bf16 v[60:63], v[196:199], a[52:55], v[60:63]
v_mfma_f32_16x16x32_bf16 v[60:63], v[200:203], a[56:59], v[60:63]
buffer_load_dwordx4 a[136:139], v214, s[20:23], s88 offen sc1
v_mfma_f32_16x16x32_bf16 v[60:63], v[204:207], a[60:63], v[60:63]
s_waitcnt lgkmcnt(0)
v_mfma_f32_16x16x32_bf16 v[64:67], v[176:179], a[0:3], v[64:67]
ds_read_b64_tr_b16 v[192:193], v210 offset:96
ds_read_b64_tr_b16 v[194:195], v210 offset:4704
v_mfma_f32_16x16x32_bf16 v[64:67], v[180:183], a[4:7], v[64:67]
ds_read_b64_tr_b16 v[196:197], v210 offset:9312
ds_read_b64_tr_b16 v[198:199], v210 offset:13920
v_mfma_f32_16x16x32_bf16 v[64:67], v[184:187], a[8:11], v[64:67]
ds_read_b64_tr_b16 v[200:201], v210 offset:18528
ds_read_b64_tr_b16 v[202:203], v210 offset:23136
v_mfma_f32_16x16x32_bf16 v[64:67], v[188:191], a[12:15], v[64:67]
ds_read_b64_tr_b16 v[204:205], v210 offset:27744
ds_read_b64_tr_b16 v[206:207], v210 offset:32352
v_mfma_f32_16x16x32_bf16 v[68:71], v[176:179], a[16:19], v[68:71]
v_mfma_f32_16x16x32_bf16 v[68:71], v[180:183], a[20:23], v[68:71]
buffer_load_dwordx4 a[152:155], v214, s[20:23], s88 offen offset:1024 sc1
v_mfma_f32_16x16x32_bf16 v[68:71], v[184:187], a[24:27], v[68:71]
v_mfma_f32_16x16x32_bf16 v[68:71], v[188:191], a[28:31], v[68:71]
v_mfma_f32_16x16x32_bf16 v[72:75], v[176:179], a[32:35], v[72:75]
buffer_load_dwordx4 a[168:171], v214, s[20:23], s88 offen offset:2048 sc1
v_mfma_f32_16x16x32_bf16 v[72:75], v[180:183], a[36:39], v[72:75]
v_mfma_f32_16x16x32_bf16 v[72:75], v[184:187], a[40:43], v[72:75]
v_mfma_f32_16x16x32_bf16 v[72:75], v[188:191], a[44:47], v[72:75]
buffer_load_dwordx4 a[184:187], v214, s[20:23], s88 offen offset:3072 sc1
v_mfma_f32_16x16x32_bf16 v[76:79], v[176:179], a[48:51], v[76:79]
v_mfma_f32_16x16x32_bf16 v[76:79], v[180:183], a[52:55], v[76:79]
v_mfma_f32_16x16x32_bf16 v[76:79], v[184:187], a[56:59], v[76:79]
buffer_load_dwordx4 a[140:143], v215, s[20:23], s88 offen sc1
v_mfma_f32_16x16x32_bf16 v[76:79], v[188:191], a[60:63], v[76:79]
s_waitcnt lgkmcnt(0)
v_mfma_f32_16x16x32_bf16 v[80:83], v[192:195], a[0:3], v[80:83]
ds_read_b64_tr_b16 v[176:177], v210 offset:128
ds_read_b64_tr_b16 v[178:179], v210 offset:4736
v_mfma_f32_16x16x32_bf16 v[80:83], v[196:199], a[4:7], v[80:83]
ds_read_b64_tr_b16 v[180:181], v210 offset:9344
ds_read_b64_tr_b16 v[182:183], v210 offset:13952
v_mfma_f32_16x16x32_bf16 v[80:83], v[200:203], a[8:11], v[80:83]
ds_read_b64_tr_b16 v[184:185], v210 offset:18560
ds_read_b64_tr_b16 v[186:187], v210 offset:23168
v_mfma_f32_16x16x32_bf16 v[80:83], v[204:207], a[12:15], v[80:83]
ds_read_b64_tr_b16 v[188:189], v210 offset:27776
ds_read_b64_tr_b16 v[190:191], v210 offset:32384
v_mfma_f32_16x16x32_bf16 v[84:87], v[192:195], a[16:19], v[84:87]
v_mfma_f32_16x16x32_bf16 v[84:87], v[196:199], a[20:23], v[84:87]
buffer_load_dwordx4 a[156:159], v215, s[20:23], s88 offen offset:1024 sc1
v_mfma_f32_16x16x32_bf16 v[84:87], v[200:203], a[24:27], v[84:87]
v_mfma_f32_16x16x32_bf16 v[84:87], v[204:207], a[28:31], v[84:87]
v_mfma_f32_16x16x32_bf16 v[88:91], v[192:195], a[32:35], v[88:91]
buffer_load_dwordx4 a[172:175], v215, s[20:23], s88 offen offset:2048 sc1
v_mfma_f32_16x16x32_bf16 v[88:91], v[196:199], a[36:39], v[88:91]
v_mfma_f32_16x16x32_bf16 v[88:91], v[200:203], a[40:43], v[88:91]
v_mfma_f32_16x16x32_bf16 v[88:91], v[204:207], a[44:47], v[88:91]
buffer_load_dwordx4 a[188:191], v215, s[20:23], s88 offen offset:3072 sc1
s_add_u32 s88, s88, 0x80000
v_mfma_f32_16x16x32_bf16 v[92:95], v[192:195], a[48:51], v[92:95]
v_mfma_f32_16x16x32_bf16 v[92:95], v[196:199], a[52:55], v[92:95]
s_add_u32 m0, s51, 0x9000
v_mfma_f32_16x16x32_bf16 v[92:95], v[200:203], a[56:59], v[92:95]
buffer_load_dwordx4 v242, s[16:19], s87 offen lds
v_mfma_f32_16x16x32_bf16 v[92:95], v[204:207], a[60:63], v[92:95]
s_waitcnt lgkmcnt(0)
v_mfma_f32_16x16x32_bf16 v[96:99], v[176:179], a[0:3], v[96:99]
ds_read_b64_tr_b16 v[192:193], v210 offset:160
ds_read_b64_tr_b16 v[194:195], v210 offset:4768
v_mfma_f32_16x16x32_bf16 v[96:99], v[180:183], a[4:7], v[96:99]
ds_read_b64_tr_b16 v[196:197], v210 offset:9376
ds_read_b64_tr_b16 v[198:199], v210 offset:13984
v_mfma_f32_16x16x32_bf16 v[96:99], v[184:187], a[8:11], v[96:99]
ds_read_b64_tr_b16 v[200:201], v210 offset:18592
ds_read_b64_tr_b16 v[202:203], v210 offset:23200
v_mfma_f32_16x16x32_bf16 v[96:99], v[188:191], a[12:15], v[96:99]
ds_read_b64_tr_b16 v[204:205], v210 offset:27808
ds_read_b64_tr_b16 v[206:207], v210 offset:32416
v_mfma_f32_16x16x32_bf16 v[100:103], v[176:179], a[16:19], v[100:103]
s_waitcnt vmcnt(40)
s_add_u32 m0, s51, 0x9400
v_mfma_f32_16x16x32_bf16 v[100:103], v[180:183], a[20:23], v[100:103]
buffer_load_dwordx4 v243, s[16:19], s87 offen lds
v_mfma_f32_16x16x32_bf16 v[100:103], v[184:187], a[24:27], v[100:103]
v_mfma_f32_16x16x32_bf16 v[100:103], v[188:191], a[28:31], v[100:103]
s_add_u32 m0, s51, 0x9800
v_mfma_f32_16x16x32_bf16 v[104:107], v[176:179], a[32:35], v[104:107]
buffer_load_dwordx4 v244, s[16:19], s87 offen lds
v_mfma_f32_16x16x32_bf16 v[104:107], v[180:183], a[36:39], v[104:107]
v_mfma_f32_16x16x32_bf16 v[104:107], v[184:187], a[40:43], v[104:107]
s_add_u32 m0, s51, 0x9c00
v_mfma_f32_16x16x32_bf16 v[104:107], v[188:191], a[44:47], v[104:107]
buffer_load_dwordx4 v245, s[16:19], s87 offen lds
v_mfma_f32_16x16x32_bf16 v[108:111], v[176:179], a[48:51], v[108:111]
v_mfma_f32_16x16x32_bf16 v[108:111], v[180:183], a[52:55], v[108:111]
s_add_u32 m0, s51, 0xa000
v_mfma_f32_16x16x32_bf16 v[108:111], v[184:187], a[56:59], v[108:111]
buffer_load_dwordx4 v246, s[16:19], s87 offen lds
v_mfma_f32_16x16x32_bf16 v[108:111], v[188:191], a[60:63], v[108:111]
s_waitcnt lgkmcnt(0)
v_mfma_f32_16x16x32_bf16 v[112:115], v[192:195], a[0:3], v[112:115]
ds_read_b64_tr_b16 v[176:177], v210 offset:192
ds_read_b64_tr_b16 v[178:179], v210 offset:4800
v_mfma_f32_16x16x32_bf16 v[112:115], v[196:199], a[4:7], v[112:115]
ds_read_b64_tr_b16 v[180:181], v210 offset:9408
ds_read_b64_tr_b16 v[182:183], v210 offset:14016
v_mfma_f32_16x16x32_bf16 v[112:115], v[200:203], a[8:11], v[112:115]
ds_read_b64_tr_b16 v[184:185], v210 offset:18624
ds_read_b64_tr_b16 v[186:187], v210 offset:23232
v_mfma_f32_16x16x32_bf16 v[112:115], v[204:207], a[12:15], v[112:115]
ds_read_b64_tr_b16 v[188:189], v210 offset:27840
ds_read_b64_tr_b16 v[190:191], v210 offset:32448
v_mfma_f32_16x16x32_bf16 v[116:119], v[192:195], a[16:19], v[116:119]
s_add_u32 m0, s51, 0xa400
v_mfma_f32_16x16x32_bf16 v[116:119], v[196:199], a[20:23], v[116:119]
buffer_load_dwordx4 v247, s[16:19], s87 offen lds
v_mfma_f32_16x16x32_bf16 v[116:119], v[200:203], a[24:27], v[116:119]
v_mfma_f32_16x16x32_bf16 v[116:119], v[204:207], a[28:31], v[116:119]
s_add_u32 m0, s51, 0xa800
v_mfma_f32_16x16x32_bf16 v[120:123], v[192:195], a[32:35], v[120:123]
buffer_load_dwordx4 v248, s[16:19], s87 offen lds
v_mfma_f32_16x16x32_bf16 v[120:123], v[196:199], a[36:39], v[120:123]
v_mfma_f32_16x16x32_bf16 v[120:123], v[200:203], a[40:43], v[120:123]
s_add_u32 m0, s51, 0xac00
v_mfma_f32_16x16x32_bf16 v[120:123], v[204:207], a[44:47], v[120:123]
buffer_load_dwordx4 v249, s[16:19], s87 offen lds
v_mfma_f32_16x16x32_bf16 v[124:127], v[192:195], a[48:51], v[124:127]
v_mfma_f32_16x16x32_bf16 v[124:127], v[196:199], a[52:55], v[124:127]
s_add_u32 m0, s51, 0xb000
v_mfma_f32_16x16x32_bf16 v[124:127], v[200:203], a[56:59], v[124:127]
buffer_load_dwordx4 v250, s[16:19], s87 offen lds
s_add_u32 s87, s87, 0x24000
v_mfma_f32_16x16x32_bf16 v[124:127], v[204:207], a[60:63], v[124:127]
s_waitcnt lgkmcnt(0)
v_mfma_f32_16x16x32_bf16 v[128:131], v[176:179], a[0:3], v[128:131]
ds_read_b64_tr_b16 v[192:193], v210 offset:224
ds_read_b64_tr_b16 v[194:195], v210 offset:4832
v_mfma_f32_16x16x32_bf16 v[128:131], v[180:183], a[4:7], v[128:131]
ds_read_b64_tr_b16 v[196:197], v210 offset:9440
ds_read_b64_tr_b16 v[198:199], v210 offset:14048
v_mfma_f32_16x16x32_bf16 v[128:131], v[184:187], a[8:11], v[128:131]
ds_read_b64_tr_b16 v[200:201], v210 offset:18656
ds_read_b64_tr_b16 v[202:203], v210 offset:23264
v_mfma_f32_16x16x32_bf16 v[128:131], v[188:191], a[12:15], v[128:131]
ds_read_b64_tr_b16 v[204:205], v210 offset:27872
ds_read_b64_tr_b16 v[206:207], v210 offset:32480
v_mfma_f32_16x16x32_bf16 v[132:135], v[176:179], a[16:19], v[132:135]
v_mfma_f32_16x16x32_bf16 v[132:135], v[180:183], a[20:23], v[132:135]
buffer_load_dwordx4 a[192:195], v212, s[20:23], s88 offen sc1
v_mfma_f32_16x16x32_bf16 v[132:135], v[184:187], a[24:27], v[132:135]
v_mfma_f32_16x16x32_bf16 v[132:135], v[188:191], a[28:31], v[132:135]
v_mfma_f32_16x16x32_bf16 v[136:139], v[176:179], a[32:35], v[136:139]
buffer_load_dwordx4 a[208:211], v212, s[20:23], s88 offen offset:1024 sc1
v_mfma_f32_16x16x32_bf16 v[136:139], v[180:183], a[36:39], v[136:139]
v_mfma_f32_16x16x32_bf16 v[136:139], v[184:187], a[40:43], v[136:139]
v_mfma_f32_16x16x32_bf16 v[136:139], v[188:191], a[44:47], v[136:139]
buffer_load_dwordx4 a[224:227], v212, s[20:23], s88 offen offset:2048 sc1
v_mfma_f32_16x16x32_bf16 v[140:143], v[176:179], a[48:51], v[140:143]
v_mfma_f32_16x16x32_bf16 v[140:143], v[180:183], a[52:55], v[140:143]
v_mfma_f32_16x16x32_bf16 v[140:143], v[184:187], a[56:59], v[140:143]
buffer_load_dwordx4 a[240:243], v212, s[20:23], s88 offen offset:3072 sc1
v_mfma_f32_16x16x32_bf16 v[140:143], v[188:191], a[60:63], v[140:143]
s_waitcnt lgkmcnt(0)
v_mfma_f32_16x16x32_bf16 v[144:147], v[192:195], a[0:3], v[144:147]
ds_read_b64_tr_b16 v[176:177], v210 offset:256
ds_read_b64_tr_b16 v[178:179], v210 offset:4864
v_mfma_f32_16x16x32_bf16 v[144:147], v[196:199], a[4:7], v[144:147]
ds_read_b64_tr_b16 v[180:181], v210 offset:9472
ds_read_b64_tr_b16 v[182:183], v210 offset:14080
v_mfma_f32_16x16x32_bf16 v[144:147], v[200:203], a[8:11], v[144:147]
ds_read_b64_tr_b16 v[184:185], v210 offset:18688
ds_read_b64_tr_b16 v[186:187], v210 offset:23296
v_mfma_f32_16x16x32_bf16 v[144:147], v[204:207], a[12:15], v[144:147]
ds_read_b64_tr_b16 v[188:189], v210 offset:27904
ds_read_b64_tr_b16 v[190:191], v210 offset:32512
v_mfma_f32_16x16x32_bf16 v[148:151], v[192:195], a[16:19], v[148:151]
v_mfma_f32_16x16x32_bf16 v[148:151], v[196:199], a[20:23], v[148:151]
v_mfma_f32_16x16x32_bf16 v[148:151], v[200:203], a[24:27], v[148:151]
v_mfma_f32_16x16x32_bf16 v[148:151], v[204:207], a[28:31], v[148:151]
buffer_load_dwordx4 a[196:199], v213, s[20:23], s88 offen sc1
v_mfma_f32_16x16x32_bf16 v[152:155], v[192:195], a[32:35], v[152:155]
v_mfma_f32_16x16x32_bf16 v[152:155], v[196:199], a[36:39], v[152:155]
v_mfma_f32_16x16x32_bf16 v[152:155], v[200:203], a[40:43], v[152:155]
v_mfma_f32_16x16x32_bf16 v[152:155], v[204:207], a[44:47], v[152:155]
buffer_load_dwordx4 a[212:215], v213, s[20:23], s88 offen offset:1024 sc1
v_mfma_f32_16x16x32_bf16 v[156:159], v[192:195], a[48:51], v[156:159]
v_mfma_f32_16x16x32_bf16 v[156:159], v[196:199], a[52:55], v[156:159]
v_mfma_f32_16x16x32_bf16 v[156:159], v[200:203], a[56:59], v[156:159]
v_mfma_f32_16x16x32_bf16 v[156:159], v[204:207], a[60:63], v[156:159]
s_waitcnt lgkmcnt(0)
v_mfma_f32_16x16x32_bf16 v[160:163], v[176:179], a[0:3], v[160:163]
s_waitcnt vmcnt(40)
s_barrier
v_mfma_f32_16x16x32_bf16 v[160:163], v[180:183], a[4:7], v[160:163]
ds_read_b64_tr_b16 v[192:193], v211
ds_read_b64_tr_b16 v[194:195], v211 offset:4608
v_mfma_f32_16x16x32_bf16 v[160:163], v[184:187], a[8:11], v[160:163]
ds_read_b64_tr_b16 v[196:197], v211 offset:9216
ds_read_b64_tr_b16 v[198:199], v211 offset:13824
v_mfma_f32_16x16x32_bf16 v[160:163], v[188:191], a[12:15], v[160:163]
ds_read_b64_tr_b16 v[200:201], v211 offset:18432
ds_read_b64_tr_b16 v[202:203], v211 offset:23040
v_mfma_f32_16x16x32_bf16 v[164:167], v[176:179], a[16:19], v[164:167]
ds_read_b64_tr_b16 v[204:205], v211 offset:27648
ds_read_b64_tr_b16 v[206:207], v211 offset:32256
v_mfma_f32_16x16x32_bf16 v[164:167], v[180:183], a[20:23], v[164:167]
v_mfma_f32_16x16x32_bf16 v[164:167], v[184:187], a[24:27], v[164:167]
v_mfma_f32_16x16x32_bf16 v[164:167], v[188:191], a[28:31], v[164:167]
v_mfma_f32_16x16x32_bf16 v[168:171], v[176:179], a[32:35], v[168:171]
v_mfma_f32_16x16x32_bf16 v[168:171], v[180:183], a[36:39], v[168:171]
v_mfma_f32_16x16x32_bf16 v[168:171], v[184:187], a[40:43], v[168:171]
v_mfma_f32_16x16x32_bf16 v[168:171], v[188:191], a[44:47], v[168:171]
v_mfma_f32_16x16x32_bf16 v[172:175], v[176:179], a[48:51], v[172:175]
v_mfma_f32_16x16x32_bf16 v[172:175], v[180:183], a[52:55], v[172:175]
v_mfma_f32_16x16x32_bf16 v[172:175], v[184:187], a[56:59], v[172:175]
v_mfma_f32_16x16x32_bf16 v[172:175], v[188:191], a[60:63], v[172:175]
s_waitcnt lgkmcnt(0)
v_mfma_f32_16x16x32_bf16 v[32:35], v[192:195], a[64:67], v[32:35]
ds_read_b64_tr_b16 v[176:177], v211 offset:32
ds_read_b64_tr_b16 v[178:179], v211 offset:4640
v_mfma_f32_16x16x32_bf16 v[32:35], v[196:199], a[68:71], v[32:35]
ds_read_b64_tr_b16 v[180:181], v211 offset:9248
ds_read_b64_tr_b16 v[182:183], v211 offset:13856
v_mfma_f32_16x16x32_bf16 v[32:35], v[200:203], a[72:75], v[32:35]
ds_read_b64_tr_b16 v[184:185], v211 offset:18464
ds_read_b64_tr_b16 v[186:187], v211 offset:23072
v_mfma_f32_16x16x32_bf16 v[32:35], v[204:207], a[76:79], v[32:35]
ds_read_b64_tr_b16 v[188:189], v211 offset:27680
ds_read_b64_tr_b16 v[190:191], v211 offset:32288
v_mfma_f32_16x16x32_bf16 v[36:39], v[192:195], a[80:83], v[36:39]
s_waitcnt vmcnt(40)
v_mfma_f32_16x16x32_bf16 v[36:39], v[196:199], a[84:87], v[36:39]
buffer_load_dwordx4 a[228:231], v213, s[20:23], s88 offen offset:2048 sc1
v_mfma_f32_16x16x32_bf16 v[36:39], v[200:203], a[88:91], v[36:39]
v_mfma_f32_16x16x32_bf16 v[36:39], v[204:207], a[92:95], v[36:39]
v_mfma_f32_16x16x32_bf16 v[40:43], v[192:195], a[96:99], v[40:43]
buffer_load_dwordx4 a[244:247], v213, s[20:23], s88 offen offset:3072 sc1
v_mfma_f32_16x16x32_bf16 v[40:43], v[196:199], a[100:103], v[40:43]
v_mfma_f32_16x16x32_bf16 v[40:43], v[200:203], a[104:107], v[40:43]
v_mfma_f32_16x16x32_bf16 v[40:43], v[204:207], a[108:111], v[40:43]
buffer_load_dwordx4 a[200:203], v214, s[20:23], s88 offen sc1
v_mfma_f32_16x16x32_bf16 v[44:47], v[192:195], a[112:115], v[44:47]
v_mfma_f32_16x16x32_bf16 v[44:47], v[196:199], a[116:119], v[44:47]
v_mfma_f32_16x16x32_bf16 v[44:47], v[200:203], a[120:123], v[44:47]
buffer_load_dwordx4 a[216:219], v214, s[20:23], s88 offen offset:1024 sc1
v_mfma_f32_16x16x32_bf16 v[44:47], v[204:207], a[124:127], v[44:47]
s_waitcnt lgkmcnt(0)
v_mfma_f32_16x16x32_bf16 v[48:51], v[176:179], a[64:67], v[48:51]
ds_read_b64_tr_b16 v[192:193], v211 offset:64
ds_read_b64_tr_b16 v[194:195], v211 offset:4672
v_mfma_f32_16x16x32_bf16 v[48:51], v[180:183], a[68:71], v[48:51]
ds_read_b64_tr_b16 v[196:197], v211 offset:9280
ds_read_b64_tr_b16 v[198:199], v211 offset:13888
v_mfma_f32_16x16x32_bf16 v[48:51], v[184:187], a[72:75], v[48:51]
ds_read_b64_tr_b16 v[200:201], v211 offset:18496
ds_read_b64_tr_b16 v[202:203], v211 offset:23104
v_mfma_f32_16x16x32_bf16 v[48:51], v[188:191], a[76:79], v[48:51]
ds_read_b64_tr_b16 v[204:205], v211 offset:27712
ds_read_b64_tr_b16 v[206:207], v211 offset:32320
v_mfma_f32_16x16x32_bf16 v[52:55], v[176:179], a[80:83], v[52:55]
v_mfma_f32_16x16x32_bf16 v[52:55], v[180:183], a[84:87], v[52:55]
buffer_load_dwordx4 a[232:235], v214, s[20:23], s88 offen offset:2048 sc1
v_mfma_f32_16x16x32_bf16 v[52:55], v[184:187], a[88:91], v[52:55]
v_mfma_f32_16x16x32_bf16 v[52:55], v[188:191], a[92:95], v[52:55]
v_mfma_f32_16x16x32_bf16 v[56:59], v[176:179], a[96:99], v[56:59]
buffer_load_dwordx4 a[248:251], v214, s[20:23], s88 offen offset:3072 sc1
v_mfma_f32_16x16x32_bf16 v[56:59], v[180:183], a[100:103], v[56:59]
v_mfma_f32_16x16x32_bf16 v[56:59], v[184:187], a[104:107], v[56:59]
v_mfma_f32_16x16x32_bf16 v[56:59], v[188:191], a[108:111], v[56:59]
buffer_load_dwordx4 a[204:207], v215, s[20:23], s88 offen sc1
v_mfma_f32_16x16x32_bf16 v[60:63], v[176:179], a[112:115], v[60:63]
v_mfma_f32_16x16x32_bf16 v[60:63], v[180:183], a[116:119], v[60:63]
v_mfma_f32_16x16x32_bf16 v[60:63], v[184:187], a[120:123], v[60:63]
buffer_load_dwordx4 a[220:223], v215, s[20:23], s88 offen offset:1024 sc1
v_mfma_f32_16x16x32_bf16 v[60:63], v[188:191], a[124:127], v[60:63]
s_waitcnt lgkmcnt(0)
v_mfma_f32_16x16x32_bf16 v[64:67], v[192:195], a[64:67], v[64:67]
ds_read_b64_tr_b16 v[176:177], v211 offset:96
ds_read_b64_tr_b16 v[178:179], v211 offset:4704
v_mfma_f32_16x16x32_bf16 v[64:67], v[196:199], a[68:71], v[64:67]
ds_read_b64_tr_b16 v[180:181], v211 offset:9312
ds_read_b64_tr_b16 v[182:183], v211 offset:13920
v_mfma_f32_16x16x32_bf16 v[64:67], v[200:203], a[72:75], v[64:67]
ds_read_b64_tr_b16 v[184:185], v211 offset:18528
ds_read_b64_tr_b16 v[186:187], v211 offset:23136
v_mfma_f32_16x16x32_bf16 v[64:67], v[204:207], a[76:79], v[64:67]
ds_read_b64_tr_b16 v[188:189], v211 offset:27744
ds_read_b64_tr_b16 v[190:191], v211 offset:32352
v_mfma_f32_16x16x32_bf16 v[68:71], v[192:195], a[80:83], v[68:71]
v_mfma_f32_16x16x32_bf16 v[68:71], v[196:199], a[84:87], v[68:71]
buffer_load_dwordx4 a[236:239], v215, s[20:23], s88 offen offset:2048 sc1
v_mfma_f32_16x16x32_bf16 v[68:71], v[200:203], a[88:91], v[68:71]
v_mfma_f32_16x16x32_bf16 v[68:71], v[204:207], a[92:95], v[68:71]
v_mfma_f32_16x16x32_bf16 v[72:75], v[192:195], a[96:99], v[72:75]
buffer_load_dwordx4 a[252:255], v215, s[20:23], s88 offen offset:3072 sc1
s_add_u32 s88, s88, 0x80000
v_mfma_f32_16x16x32_bf16 v[72:75], v[196:199], a[100:103], v[72:75]
v_mfma_f32_16x16x32_bf16 v[72:75], v[200:203], a[104:107], v[72:75]
s_add_u32 m0, s51, 0x12000
v_mfma_f32_16x16x32_bf16 v[72:75], v[204:207], a[108:111], v[72:75]
buffer_load_dwordx4 v242, s[16:19], s87 offen lds
v_mfma_f32_16x16x32_bf16 v[76:79], v[192:195], a[112:115], v[76:79]
v_mfma_f32_16x16x32_bf16 v[76:79], v[196:199], a[116:119], v[76:79]
s_add_u32 m0, s51, 0x12400
v_mfma_f32_16x16x32_bf16 v[76:79], v[200:203], a[120:123], v[76:79]
buffer_load_dwordx4 v243, s[16:19], s87 offen lds
v_mfma_f32_16x16x32_bf16 v[76:79], v[204:207], a[124:127], v[76:79]
s_waitcnt lgkmcnt(0)
v_mfma_f32_16x16x32_bf16 v[80:83], v[176:179], a[64:67], v[80:83]
ds_read_b64_tr_b16 v[192:193], v211 offset:128
ds_read_b64_tr_b16 v[194:195], v211 offset:4736
v_mfma_f32_16x16x32_bf16 v[80:83], v[180:183], a[68:71], v[80:83]
ds_read_b64_tr_b16 v[196:197], v211 offset:9344
ds_read_b64_tr_b16 v[198:199], v211 offset:13952
v_mfma_f32_16x16x32_bf16 v[80:83], v[184:187], a[72:75], v[80:83]
ds_read_b64_tr_b16 v[200:201], v211 offset:18560
ds_read_b64_tr_b16 v[202:203], v211 offset:23168
v_mfma_f32_16x16x32_bf16 v[80:83], v[188:191], a[76:79], v[80:83]
ds_read_b64_tr_b16 v[204:205], v211 offset:27776
ds_read_b64_tr_b16 v[206:207], v211 offset:32384
v_mfma_f32_16x16x32_bf16 v[84:87], v[176:179], a[80:83], v[84:87]
s_add_u32 m0, s51, 0x12800
v_mfma_f32_16x16x32_bf16 v[84:87], v[180:183], a[84:87], v[84:87]
buffer_load_dwordx4 v244, s[16:19], s87 offen lds
v_mfma_f32_16x16x32_bf16 v[84:87], v[184:187], a[88:91], v[84:87]
v_mfma_f32_16x16x32_bf16 v[84:87], v[188:191], a[92:95], v[84:87]
s_add_u32 m0, s51, 0x12c00
v_mfma_f32_16x16x32_bf16 v[88:91], v[176:179], a[96:99], v[88:91]
buffer_load_dwordx4 v245, s[16:19], s87 offen lds
v_mfma_f32_16x16x32_bf16 v[88:91], v[180:183], a[100:103], v[88:91]
v_mfma_f32_16x16x32_bf16 v[88:91], v[184:187], a[104:107], v[88:91]
s_add_u32 m0, s51, 0x13000
v_mfma_f32_16x16x32_bf16 v[88:91], v[188:191], a[108:111], v[88:91]
buffer_load_dwordx4 v246, s[16:19], s87 offen lds
v_mfma_f32_16x16x32_bf16 v[92:95], v[176:179], a[112:115], v[92:95]
v_mfma_f32_16x16x32_bf16 v[92:95], v[180:183], a[116:119], v[92:95]
s_add_u32 m0, s51, 0x13400
v_mfma_f32_16x16x32_bf16 v[92:95], v[184:187], a[120:123], v[92:95]
buffer_load_dwordx4 v247, s[16:19], s87 offen lds
v_mfma_f32_16x16x32_bf16 v[92:95], v[188:191], a[124:127], v[92:95]
s_waitcnt lgkmcnt(0)
v_mfma_f32_16x16x32_bf16 v[96:99], v[192:195], a[64:67], v[96:99]
ds_read_b64_tr_b16 v[176:177], v211 offset:160
ds_read_b64_tr_b16 v[178:179], v211 offset:4768
v_mfma_f32_16x16x32_bf16 v[96:99], v[196:199], a[68:71], v[96:99]
ds_read_b64_tr_b16 v[180:181], v211 offset:9376
ds_read_b64_tr_b16 v[182:183], v211 offset:13984
v_mfma_f32_16x16x32_bf16 v[96:99], v[200:203], a[72:75], v[96:99]
ds_read_b64_tr_b16 v[184:185], v211 offset:18592
ds_read_b64_tr_b16 v[186:187], v211 offset:23200
v_mfma_f32_16x16x32_bf16 v[96:99], v[204:207], a[76:79], v[96:99]
ds_read_b64_tr_b16 v[188:189], v211 offset:27808
ds_read_b64_tr_b16 v[190:191], v211 offset:32416
v_mfma_f32_16x16x32_bf16 v[100:103], v[192:195], a[80:83], v[100:103]
s_waitcnt vmcnt(40)
s_add_u32 m0, s51, 0x13800
v_mfma_f32_16x16x32_bf16 v[100:103], v[196:199], a[84:87], v[100:103]
buffer_load_dwordx4 v248, s[16:19], s87 offen lds
v_mfma_f32_16x16x32_bf16 v[100:103], v[200:203], a[88:91], v[100:103]
v_mfma_f32_16x16x32_bf16 v[100:103], v[204:207], a[92:95], v[100:103]
s_add_u32 m0, s51, 0x13c00
v_mfma_f32_16x16x32_bf16 v[104:107], v[192:195], a[96:99], v[104:107]
buffer_load_dwordx4 v249, s[16:19], s87 offen lds
v_mfma_f32_16x16x32_bf16 v[104:107], v[196:199], a[100:103], v[104:107]
v_mfma_f32_16x16x32_bf16 v[104:107], v[200:203], a[104:107], v[104:107]
s_add_u32 m0, s51, 0x14000
v_mfma_f32_16x16x32_bf16 v[104:107], v[204:207], a[108:111], v[104:107]
buffer_load_dwordx4 v250, s[16:19], s87 offen lds
s_add_u32 s87, s87, 0x24000
v_mfma_f32_16x16x32_bf16 v[108:111], v[192:195], a[112:115], v[108:111]
v_mfma_f32_16x16x32_bf16 v[108:111], v[196:199], a[116:119], v[108:111]
v_mfma_f32_16x16x32_bf16 v[108:111], v[200:203], a[120:123], v[108:111]
buffer_load_dwordx4 a[0:3], v212, s[20:23], s88 offen sc1
v_mfma_f32_16x16x32_bf16 v[108:111], v[204:207], a[124:127], v[108:111]
s_waitcnt lgkmcnt(0)
v_mfma_f32_16x16x32_bf16 v[112:115], v[176:179], a[64:67], v[112:115]
ds_read_b64_tr_b16 v[192:193], v211 offset:192
ds_read_b64_tr_b16 v[194:195], v211 offset:4800
v_mfma_f32_16x16x32_bf16 v[112:115], v[180:183], a[68:71], v[112:115]
ds_read_b64_tr_b16 v[196:197], v211 offset:9408
ds_read_b64_tr_b16 v[198:199], v211 offset:14016
v_mfma_f32_16x16x32_bf16 v[112:115], v[184:187], a[72:75], v[112:115]
ds_read_b64_tr_b16 v[200:201], v211 offset:18624
ds_read_b64_tr_b16 v[202:203], v211 offset:23232
v_mfma_f32_16x16x32_bf16 v[112:115], v[188:191], a[76:79], v[112:115]
ds_read_b64_tr_b16 v[204:205], v211 offset:27840
ds_read_b64_tr_b16 v[206:207], v211 offset:32448
v_mfma_f32_16x16x32_bf16 v[116:119], v[176:179], a[80:83], v[116:119]
v_mfma_f32_16x16x32_bf16 v[116:119], v[180:183], a[84:87], v[116:119]
buffer_load_dwordx4 a[16:19], v212, s[20:23], s88 offen offset:1024 sc1
v_mfma_f32_16x16x32_bf16 v[116:119], v[184:187], a[88:91], v[116:119]
v_mfma_f32_16x16x32_bf16 v[116:119], v[188:191], a[92:95], v[116:119]
v_mfma_f32_16x16x32_bf16 v[120:123], v[176:179], a[96:99], v[120:123]
buffer_load_dwordx4 a[32:35], v212, s[20:23], s88 offen offset:2048 sc1
v_mfma_f32_16x16x32_bf16 v[120:123], v[180:183], a[100:103], v[120:123]
v_mfma_f32_16x16x32_bf16 v[120:123], v[184:187], a[104:107], v[120:123]
v_mfma_f32_16x16x32_bf16 v[120:123], v[188:191], a[108:111], v[120:123]
buffer_load_dwordx4 a[48:51], v212, s[20:23], s88 offen offset:3072 sc1
v_mfma_f32_16x16x32_bf16 v[124:127], v[176:179], a[112:115], v[124:127]
v_mfma_f32_16x16x32_bf16 v[124:127], v[180:183], a[116:119], v[124:127]
v_mfma_f32_16x16x32_bf16 v[124:127], v[184:187], a[120:123], v[124:127]
buffer_load_dwordx4 a[4:7], v213, s[20:23], s88 offen sc1
v_mfma_f32_16x16x32_bf16 v[124:127], v[188:191], a[124:127], v[124:127]
s_waitcnt lgkmcnt(0)
v_mfma_f32_16x16x32_bf16 v[128:131], v[192:195], a[64:67], v[128:131]
ds_read_b64_tr_b16 v[176:177], v211 offset:224
ds_read_b64_tr_b16 v[178:179], v211 offset:4832
v_mfma_f32_16x16x32_bf16 v[128:131], v[196:199], a[68:71], v[128:131]
ds_read_b64_tr_b16 v[180:181], v211 offset:9440
ds_read_b64_tr_b16 v[182:183], v211 offset:14048
v_mfma_f32_16x16x32_bf16 v[128:131], v[200:203], a[72:75], v[128:131]
ds_read_b64_tr_b16 v[184:185], v211 offset:18656
ds_read_b64_tr_b16 v[186:187], v211 offset:23264
v_mfma_f32_16x16x32_bf16 v[128:131], v[204:207], a[76:79], v[128:131]
ds_read_b64_tr_b16 v[188:189], v211 offset:27872
ds_read_b64_tr_b16 v[190:191], v211 offset:32480
v_mfma_f32_16x16x32_bf16 v[132:135], v[192:195], a[80:83], v[132:135]
v_mfma_f32_16x16x32_bf16 v[132:135], v[196:199], a[84:87], v[132:135]
buffer_load_dwordx4 a[20:23], v213, s[20:23], s88 offen offset:1024 sc1
v_mfma_f32_16x16x32_bf16 v[132:135], v[200:203], a[88:91], v[132:135]
v_mfma_f32_16x16x32_bf16 v[132:135], v[204:207], a[92:95], v[132:135]
v_mfma_f32_16x16x32_bf16 v[136:139], v[192:195], a[96:99], v[136:139]
buffer_load_dwordx4 a[36:39], v213, s[20:23], s88 offen offset:2048 sc1
v_mfma_f32_16x16x32_bf16 v[136:139], v[196:199], a[100:103], v[136:139]
v_mfma_f32_16x16x32_bf16 v[136:139], v[200:203], a[104:107], v[136:139]
v_mfma_f32_16x16x32_bf16 v[136:139], v[204:207], a[108:111], v[136:139]
buffer_load_dwordx4 a[52:55], v213, s[20:23], s88 offen offset:3072 sc1
v_mfma_f32_16x16x32_bf16 v[140:143], v[192:195], a[112:115], v[140:143]
v_mfma_f32_16x16x32_bf16 v[140:143], v[196:199], a[116:119], v[140:143]
v_mfma_f32_16x16x32_bf16 v[140:143], v[200:203], a[120:123], v[140:143]
buffer_load_dwordx4 a[8:11], v214, s[20:23], s88 offen sc1
v_mfma_f32_16x16x32_bf16 v[140:143], v[204:207], a[124:127], v[140:143]
s_waitcnt lgkmcnt(0)
v_mfma_f32_16x16x32_bf16 v[144:147], v[176:179], a[64:67], v[144:147]
ds_read_b64_tr_b16 v[192:193], v211 offset:256
ds_read_b64_tr_b16 v[194:195], v211 offset:4864
v_mfma_f32_16x16x32_bf16 v[144:147], v[180:183], a[68:71], v[144:147]
ds_read_b64_tr_b16 v[196:197], v211 offset:9472
ds_read_b64_tr_b16 v[198:199], v211 offset:14080
v_mfma_f32_16x16x32_bf16 v[144:147], v[184:187], a[72:75], v[144:147]
ds_read_b64_tr_b16 v[200:201], v211 offset:18688
ds_read_b64_tr_b16 v[202:203], v211 offset:23296
v_mfma_f32_16x16x32_bf16 v[144:147], v[188:191], a[76:79], v[144:147]
ds_read_b64_tr_b16 v[204:205], v211 offset:27904
ds_read_b64_tr_b16 v[206:207], v211 offset:32512
v_mfma_f32_16x16x32_bf16 v[148:151], v[176:179], a[80:83], v[148:151]
v_mfma_f32_16x16x32_bf16 v[148:151], v[180:183], a[84:87], v[148:151]
v_mfma_f32_16x16x32_bf16 v[148:151], v[184:187], a[88:91], v[148:151]
v_mfma_f32_16x16x32_bf16 v[148:151], v[188:191], a[92:95], v[148:151]
buffer_load_dwordx4 a[24:27], v214, s[20:23], s88 offen offset:1024 sc1
v_mfma_f32_16x16x32_bf16 v[152:155], v[176:179], a[96:99], v[152:155]
v_mfma_f32_16x16x32_bf16 v[152:155], v[180:183], a[100:103], v[152:155]
v_mfma_f32_16x16x32_bf16 v[152:155], v[184:187], a[104:107], v[152:155]
v_mfma_f32_16x16x32_bf16 v[152:155], v[188:191], a[108:111], v[152:155]
buffer_load_dwordx4 a[40:43], v214, s[20:23], s88 offen offset:2048 sc1
v_mfma_f32_16x16x32_bf16 v[156:159], v[176:179], a[112:115], v[156:159]
v_mfma_f32_16x16x32_bf16 v[156:159], v[180:183], a[116:119], v[156:159]
v_mfma_f32_16x16x32_bf16 v[156:159], v[184:187], a[120:123], v[156:159]
v_mfma_f32_16x16x32_bf16 v[156:159], v[188:191], a[124:127], v[156:159]
s_waitcnt lgkmcnt(0)
v_mfma_f32_16x16x32_bf16 v[160:163], v[192:195], a[64:67], v[160:163]
s_waitcnt vmcnt(45)
s_barrier
v_mfma_f32_16x16x32_bf16 v[160:163], v[196:199], a[68:71], v[160:163]
ds_read_b64_tr_b16 v[176:177], v208
ds_read_b64_tr_b16 v[178:179], v208 offset:4608
v_mfma_f32_16x16x32_bf16 v[160:163], v[200:203], a[72:75], v[160:163]
ds_read_b64_tr_b16 v[180:181], v208 offset:9216
ds_read_b64_tr_b16 v[182:183], v208 offset:13824
v_mfma_f32_16x16x32_bf16 v[160:163], v[204:207], a[76:79], v[160:163]
ds_read_b64_tr_b16 v[184:185], v208 offset:18432
ds_read_b64_tr_b16 v[186:187], v208 offset:23040
v_mfma_f32_16x16x32_bf16 v[164:167], v[192:195], a[80:83], v[164:167]
ds_read_b64_tr_b16 v[188:189], v208 offset:27648
ds_read_b64_tr_b16 v[190:191], v208 offset:32256
v_mfma_f32_16x16x32_bf16 v[164:167], v[196:199], a[84:87], v[164:167]
v_mfma_f32_16x16x32_bf16 v[164:167], v[200:203], a[88:91], v[164:167]
v_mfma_f32_16x16x32_bf16 v[164:167], v[204:207], a[92:95], v[164:167]
v_mfma_f32_16x16x32_bf16 v[168:171], v[192:195], a[96:99], v[168:171]
v_mfma_f32_16x16x32_bf16 v[168:171], v[196:199], a[100:103], v[168:171]
v_mfma_f32_16x16x32_bf16 v[168:171], v[200:203], a[104:107], v[168:171]
v_mfma_f32_16x16x32_bf16 v[168:171], v[204:207], a[108:111], v[168:171]
v_mfma_f32_16x16x32_bf16 v[172:175], v[192:195], a[112:115], v[172:175]
v_mfma_f32_16x16x32_bf16 v[172:175], v[196:199], a[116:119], v[172:175]
v_mfma_f32_16x16x32_bf16 v[172:175], v[200:203], a[120:123], v[172:175]
v_mfma_f32_16x16x32_bf16 v[172:175], v[204:207], a[124:127], v[172:175]
s_waitcnt lgkmcnt(0)
v_mfma_f32_16x16x32_bf16 v[32:35], v[176:179], a[128:131], v[32:35]
ds_read_b64_tr_b16 v[192:193], v208 offset:32
ds_read_b64_tr_b16 v[194:195], v208 offset:4640
v_mfma_f32_16x16x32_bf16 v[32:35], v[180:183], a[132:135], v[32:35]
ds_read_b64_tr_b16 v[196:197], v208 offset:9248
ds_read_b64_tr_b16 v[198:199], v208 offset:13856
v_mfma_f32_16x16x32_bf16 v[32:35], v[184:187], a[136:139], v[32:35]
ds_read_b64_tr_b16 v[200:201], v208 offset:18464
ds_read_b64_tr_b16 v[202:203], v208 offset:23072
v_mfma_f32_16x16x32_bf16 v[32:35], v[188:191], a[140:143], v[32:35]
ds_read_b64_tr_b16 v[204:205], v208 offset:27680
ds_read_b64_tr_b16 v[206:207], v208 offset:32288
v_mfma_f32_16x16x32_bf16 v[36:39], v[176:179], a[144:147], v[36:39]
s_waitcnt vmcnt(40)
v_mfma_f32_16x16x32_bf16 v[36:39], v[180:183], a[148:151], v[36:39]
buffer_load_dwordx4 a[56:59], v214, s[20:23], s88 offen offset:3072 sc1
v_mfma_f32_16x16x32_bf16 v[36:39], v[184:187], a[152:155], v[36:39]
v_mfma_f32_16x16x32_bf16 v[36:39], v[188:191], a[156:159], v[36:39]
v_mfma_f32_16x16x32_bf16 v[40:43], v[176:179], a[160:163], v[40:43]
buffer_load_dwordx4 a[12:15], v215, s[20:23], s88 offen sc1
v_mfma_f32_16x16x32_bf16 v[40:43], v[180:183], a[164:167], v[40:43]
v_mfma_f32_16x16x32_bf16 v[40:43], v[184:187], a[168:171], v[40:43]
v_mfma_f32_16x16x32_bf16 v[40:43], v[188:191], a[172:175], v[40:43]
buffer_load_dwordx4 a[28:31], v215, s[20:23], s88 offen offset:1024 sc1
v_mfma_f32_16x16x32_bf16 v[44:47], v[176:179], a[176:179], v[44:47]
v_mfma_f32_16x16x32_bf16 v[44:47], v[180:183], a[180:183], v[44:47]
v_mfma_f32_16x16x32_bf16 v[44:47], v[184:187], a[184:187], v[44:47]
buffer_load_dwordx4 a[44:47], v215, s[20:23], s88 offen offset:2048 sc1
v_mfma_f32_16x16x32_bf16 v[44:47], v[188:191], a[188:191], v[44:47]
s_waitcnt lgkmcnt(0)
v_mfma_f32_16x16x32_bf16 v[48:51], v[192:195], a[128:131], v[48:51]
ds_read_b64_tr_b16 v[176:177], v208 offset:64
ds_read_b64_tr_b16 v[178:179], v208 offset:4672
v_mfma_f32_16x16x32_bf16 v[48:51], v[196:199], a[132:135], v[48:51]
ds_read_b64_tr_b16 v[180:181], v208 offset:9280
ds_read_b64_tr_b16 v[182:183], v208 offset:13888
v_mfma_f32_16x16x32_bf16 v[48:51], v[200:203], a[136:139], v[48:51]
ds_read_b64_tr_b16 v[184:185], v208 offset:18496
ds_read_b64_tr_b16 v[186:187], v208 offset:23104
v_mfma_f32_16x16x32_bf16 v[48:51], v[204:207], a[140:143], v[48:51]
ds_read_b64_tr_b16 v[188:189], v208 offset:27712
ds_read_b64_tr_b16 v[190:191], v208 offset:32320
v_mfma_f32_16x16x32_bf16 v[52:55], v[192:195], a[144:147], v[52:55]
v_mfma_f32_16x16x32_bf16 v[52:55], v[196:199], a[148:151], v[52:55]
buffer_load_dwordx4 a[60:63], v215, s[20:23], s88 offen offset:3072 sc1
s_add_u32 s88, s88, 0x80000
v_mfma_f32_16x16x32_bf16 v[52:55], v[200:203], a[152:155], v[52:55]
v_mfma_f32_16x16x32_bf16 v[52:55], v[204:207], a[156:159], v[52:55]
s_add_u32 m0, s51, 0x1b000
v_mfma_f32_16x16x32_bf16 v[56:59], v[192:195], a[160:163], v[56:59]
buffer_load_dwordx4 v242, s[16:19], s87 offen lds
v_mfma_f32_16x16x32_bf16 v[56:59], v[196:199], a[164:167], v[56:59]
v_mfma_f32_16x16x32_bf16 v[56:59], v[200:203], a[168:171], v[56:59]
s_add_u32 m0, s51, 0x1b400
v_mfma_f32_16x16x32_bf16 v[56:59], v[204:207], a[172:175], v[56:59]
buffer_load_dwordx4 v243, s[16:19], s87 offen lds
v_mfma_f32_16x16x32_bf16 v[60:63], v[192:195], a[176:179], v[60:63]
v_mfma_f32_16x16x32_bf16 v[60:63], v[196:199], a[180:183], v[60:63]
s_add_u32 m0, s51, 0x1b800
v_mfma_f32_16x16x32_bf16 v[60:63], v[200:203], a[184:187], v[60:63]
buffer_load_dwordx4 v244, s[16:19], s87 offen lds
v_mfma_f32_16x16x32_bf16 v[60:63], v[204:207], a[188:191], v[60:63]
s_waitcnt lgkmcnt(0)
v_mfma_f32_16x16x32_bf16 v[64:67], v[176:179], a[128:131], v[64:67]
ds_read_b64_tr_b16 v[192:193], v208 offset:96
ds_read_b64_tr_b16 v[194:195], v208 offset:4704
v_mfma_f32_16x16x32_bf16 v[64:67], v[180:183], a[132:135], v[64:67]
ds_read_b64_tr_b16 v[196:197], v208 offset:9312
ds_read_b64_tr_b16 v[198:199], v208 offset:13920
v_mfma_f32_16x16x32_bf16 v[64:67], v[184:187], a[136:139], v[64:67]
ds_read_b64_tr_b16 v[200:201], v208 offset:18528
ds_read_b64_tr_b16 v[202:203], v208 offset:23136
v_mfma_f32_16x16x32_bf16 v[64:67], v[188:191], a[140:143], v[64:67]
ds_read_b64_tr_b16 v[204:205], v208 offset:27744
ds_read_b64_tr_b16 v[206:207], v208 offset:32352
v_mfma_f32_16x16x32_bf16 v[68:71], v[176:179], a[144:147], v[68:71]
s_add_u32 m0, s51, 0x1bc00
v_mfma_f32_16x16x32_bf16 v[68:71], v[180:183], a[148:151], v[68:71]
buffer_load_dwordx4 v245, s[16:19], s87 offen lds
v_mfma_f32_16x16x32_bf16 v[68:71], v[184:187], a[152:155], v[68:71]
v_mfma_f32_16x16x32_bf16 v[68:71], v[188:191], a[156:159], v[68:71]
s_add_u32 m0, s51, 0x1c000
v_mfma_f32_16x16x32_bf16 v[72:75], v[176:179], a[160:163], v[72:75]
buffer_load_dwordx4 v246, s[16:19], s87 offen lds
v_mfma_f32_16x16x32_bf16 v[72:75], v[180:183], a[164:167], v[72:75]
v_mfma_f32_16x16x32_bf16 v[72:75], v[184:187], a[168:171], v[72:75]
s_add_u32 m0, s51, 0x1c400
v_mfma_f32_16x16x32_bf16 v[72:75], v[188:191], a[172:175], v[72:75]
buffer_load_dwordx4 v247, s[16:19], s87 offen lds
v_mfma_f32_16x16x32_bf16 v[76:79], v[176:179], a[176:179], v[76:79]
v_mfma_f32_16x16x32_bf16 v[76:79], v[180:183], a[180:183], v[76:79]
s_add_u32 m0, s51, 0x1c800
v_mfma_f32_16x16x32_bf16 v[76:79], v[184:187], a[184:187], v[76:79]
buffer_load_dwordx4 v248, s[16:19], s87 offen lds
v_mfma_f32_16x16x32_bf16 v[76:79], v[188:191], a[188:191], v[76:79]
s_waitcnt lgkmcnt(0)
v_mfma_f32_16x16x32_bf16 v[80:83], v[192:195], a[128:131], v[80:83]
ds_read_b64_tr_b16 v[176:177], v208 offset:128
ds_read_b64_tr_b16 v[178:179], v208 offset:4736
v_mfma_f32_16x16x32_bf16 v[80:83], v[196:199], a[132:135], v[80:83]
ds_read_b64_tr_b16 v[180:181], v208 offset:9344
ds_read_b64_tr_b16 v[182:183], v208 offset:13952
v_mfma_f32_16x16x32_bf16 v[80:83], v[200:203], a[136:139], v[80:83]
ds_read_b64_tr_b16 v[184:185], v208 offset:18560
ds_read_b64_tr_b16 v[186:187], v208 offset:23168
v_mfma_f32_16x16x32_bf16 v[80:83], v[204:207], a[140:143], v[80:83]
ds_read_b64_tr_b16 v[188:189], v208 offset:27776
ds_read_b64_tr_b16 v[190:191], v208 offset:32384
v_mfma_f32_16x16x32_bf16 v[84:87], v[192:195], a[144:147], v[84:87]
s_add_u32 m0, s51, 0x1cc00
v_mfma_f32_16x16x32_bf16 v[84:87], v[196:199], a[148:151], v[84:87]
buffer_load_dwordx4 v249, s[16:19], s87 offen lds
v_mfma_f32_16x16x32_bf16 v[84:87], v[200:203], a[152:155], v[84:87]
v_mfma_f32_16x16x32_bf16 v[84:87], v[204:207], a[156:159], v[84:87]
s_add_u32 m0, s51, 0x1d000
v_mfma_f32_16x16x32_bf16 v[88:91], v[192:195], a[160:163], v[88:91]
buffer_load_dwordx4 v250, s[16:19], s87 offen lds
s_add_u32 s87, s87, 0x24000
v_mfma_f32_16x16x32_bf16 v[88:91], v[196:199], a[164:167], v[88:91]
v_mfma_f32_16x16x32_bf16 v[88:91], v[200:203], a[168:171], v[88:91]
v_mfma_f32_16x16x32_bf16 v[88:91], v[204:207], a[172:175], v[88:91]
buffer_load_dwordx4 a[64:67], v212, s[20:23], s88 offen sc1
v_mfma_f32_16x16x32_bf16 v[92:95], v[192:195], a[176:179], v[92:95]
v_mfma_f32_16x16x32_bf16 v[92:95], v[196:199], a[180:183], v[92:95]
v_mfma_f32_16x16x32_bf16 v[92:95], v[200:203], a[184:187], v[92:95]
buffer_load_dwordx4 a[80:83], v212, s[20:23], s88 offen offset:1024 sc1
v_mfma_f32_16x16x32_bf16 v[92:95], v[204:207], a[188:191], v[92:95]
s_waitcnt lgkmcnt(0)
v_mfma_f32_16x16x32_bf16 v[96:99], v[176:179], a[128:131], v[96:99]
ds_read_b64_tr_b16 v[192:193], v208 offset:160
ds_read_b64_tr_b16 v[194:195], v208 offset:4768
v_mfma_f32_16x16x32_bf16 v[96:99], v[180:183], a[132:135], v[96:99]
ds_read_b64_tr_b16 v[196:197], v208 offset:9376
ds_read_b64_tr_b16 v[198:199], v208 offset:13984
v_mfma_f32_16x16x32_bf16 v[96:99], v[184:187], a[136:139], v[96:99]
ds_read_b64_tr_b16 v[200:201], v208 offset:18592
ds_read_b64_tr_b16 v[202:203], v208 offset:23200
v_mfma_f32_16x16x32_bf16 v[96:99], v[188:191], a[140:143], v[96:99]
ds_read_b64_tr_b16 v[204:205], v208 offset:27808
ds_read_b64_tr_b16 v[206:207], v208 offset:32416
v_mfma_f32_16x16x32_bf16 v[100:103], v[176:179], a[144:147], v[100:103]
s_waitcnt vmcnt(40)
v_mfma_f32_16x16x32_bf16 v[100:103], v[180:183], a[148:151], v[100:103]
buffer_load_dwordx4 a[96:99], v212, s[20:23], s88 offen offset:2048 sc1
v_mfma_f32_16x16x32_bf16 v[100:103], v[184:187], a[152:155], v[100:103]
v_mfma_f32_16x16x32_bf16 v[100:103], v[188:191], a[156:159], v[100:103]
v_mfma_f32_16x16x32_bf16 v[104:107], v[176:179], a[160:163], v[104:107]
buffer_load_dwordx4 a[112:115], v212, s[20:23], s88 offen offset:3072 sc1
v_mfma_f32_16x16x32_bf16 v[104:107], v[180:183], a[164:167], v[104:107]
v_mfma_f32_16x16x32_bf16 v[104:107], v[184:187], a[168:171], v[104:107]
v_mfma_f32_16x16x32_bf16 v[104:107], v[188:191], a[172:175], v[104:107]
buffer_load_dwordx4 a[68:71], v213, s[20:23], s88 offen sc1
v_mfma_f32_16x16x32_bf16 v[108:111], v[176:179], a[176:179], v[108:111]
v_mfma_f32_16x16x32_bf16 v[108:111], v[180:183], a[180:183], v[108:111]
v_mfma_f32_16x16x32_bf16 v[108:111], v[184:187], a[184:187], v[108:111]
buffer_load_dwordx4 a[84:87], v213, s[20:23], s88 offen offset:1024 sc1
v_mfma_f32_16x16x32_bf16 v[108:111], v[188:191], a[188:191], v[108:111]
s_waitcnt lgkmcnt(0)
v_mfma_f32_16x16x32_bf16 v[112:115], v[192:195], a[128:131], v[112:115]
ds_read_b64_tr_b16 v[176:177], v208 offset:192
ds_read_b64_tr_b16 v[178:179], v208 offset:4800
v_mfma_f32_16x16x32_bf16 v[112:115], v[196:199], a[132:135], v[112:115]
ds_read_b64_tr_b16 v[180:181], v208 offset:9408
ds_read_b64_tr_b16 v[182:183], v208 offset:14016
v_mfma_f32_16x16x32_bf16 v[112:115], v[200:203], a[136:139], v[112:115]
ds_read_b64_tr_b16 v[184:185], v208 offset:18624
ds_read_b64_tr_b16 v[186:187], v208 offset:23232
v_mfma_f32_16x16x32_bf16 v[112:115], v[204:207], a[140:143], v[112:115]
ds_read_b64_tr_b16 v[188:189], v208 offset:27840
ds_read_b64_tr_b16 v[190:191], v208 offset:32448
v_mfma_f32_16x16x32_bf16 v[116:119], v[192:195], a[144:147], v[116:119]
v_mfma_f32_16x16x32_bf16 v[116:119], v[196:199], a[148:151], v[116:119]
buffer_load_dwordx4 a[100:103], v213, s[20:23], s88 offen offset:2048 sc1
v_mfma_f32_16x16x32_bf16 v[116:119], v[200:203], a[152:155], v[116:119]
v_mfma_f32_16x16x32_bf16 v[116:119], v[204:207], a[156:159], v[116:119]
v_mfma_f32_16x16x32_bf16 v[120:123], v[192:195], a[160:163], v[120:123]
buffer_load_dwordx4 a[116:119], v213, s[20:23], s88 offen offset:3072 sc1
v_mfma_f32_16x16x32_bf16 v[120:123], v[196:199], a[164:167], v[120:123]
v_mfma_f32_16x16x32_bf16 v[120:123], v[200:203], a[168:171], v[120:123]
v_mfma_f32_16x16x32_bf16 v[120:123], v[204:207], a[172:175], v[120:123]
buffer_load_dwordx4 a[72:75], v214, s[20:23], s88 offen sc1
v_mfma_f32_16x16x32_bf16 v[124:127], v[192:195], a[176:179], v[124:127]
v_mfma_f32_16x16x32_bf16 v[124:127], v[196:199], a[180:183], v[124:127]
v_mfma_f32_16x16x32_bf16 v[124:127], v[200:203], a[184:187], v[124:127]
buffer_load_dwordx4 a[88:91], v214, s[20:23], s88 offen offset:1024 sc1
v_mfma_f32_16x16x32_bf16 v[124:127], v[204:207], a[188:191], v[124:127]
s_waitcnt lgkmcnt(0)
v_mfma_f32_16x16x32_bf16 v[128:131], v[176:179], a[128:131], v[128:131]
ds_read_b64_tr_b16 v[192:193], v208 offset:224
ds_read_b64_tr_b16 v[194:195], v208 offset:4832
v_mfma_f32_16x16x32_bf16 v[128:131], v[180:183], a[132:135], v[128:131]
ds_read_b64_tr_b16 v[196:197], v208 offset:9440
ds_read_b64_tr_b16 v[198:199], v208 offset:14048
v_mfma_f32_16x16x32_bf16 v[128:131], v[184:187], a[136:139], v[128:131]
ds_read_b64_tr_b16 v[200:201], v208 offset:18656
ds_read_b64_tr_b16 v[202:203], v208 offset:23264
v_mfma_f32_16x16x32_bf16 v[128:131], v[188:191], a[140:143], v[128:131]
ds_read_b64_tr_b16 v[204:205], v208 offset:27872
ds_read_b64_tr_b16 v[206:207], v208 offset:32480
v_mfma_f32_16x16x32_bf16 v[132:135], v[176:179], a[144:147], v[132:135]
v_mfma_f32_16x16x32_bf16 v[132:135], v[180:183], a[148:151], v[132:135]
buffer_load_dwordx4 a[104:107], v214, s[20:23], s88 offen offset:2048 sc1
v_mfma_f32_16x16x32_bf16 v[132:135], v[184:187], a[152:155], v[132:135]
v_mfma_f32_16x16x32_bf16 v[132:135], v[188:191], a[156:159], v[132:135]
v_mfma_f32_16x16x32_bf16 v[136:139], v[176:179], a[160:163], v[136:139]
buffer_load_dwordx4 a[120:123], v214, s[20:23], s88 offen offset:3072 sc1
v_mfma_f32_16x16x32_bf16 v[136:139], v[180:183], a[164:167], v[136:139]
v_mfma_f32_16x16x32_bf16 v[136:139], v[184:187], a[168:171], v[136:139]
v_mfma_f32_16x16x32_bf16 v[136:139], v[188:191], a[172:175], v[136:139]
buffer_load_dwordx4 a[76:79], v215, s[20:23], s88 offen sc1
v_mfma_f32_16x16x32_bf16 v[140:143], v[176:179], a[176:179], v[140:143]
v_mfma_f32_16x16x32_bf16 v[140:143], v[180:183], a[180:183], v[140:143]
v_mfma_f32_16x16x32_bf16 v[140:143], v[184:187], a[184:187], v[140:143]
buffer_load_dwordx4 a[92:95], v215, s[20:23], s88 offen offset:1024 sc1
v_mfma_f32_16x16x32_bf16 v[140:143], v[188:191], a[188:191], v[140:143]
s_waitcnt lgkmcnt(0)
v_mfma_f32_16x16x32_bf16 v[144:147], v[192:195], a[128:131], v[144:147]
ds_read_b64_tr_b16 v[176:177], v208 offset:256
ds_read_b64_tr_b16 v[178:179], v208 offset:4864
v_mfma_f32_16x16x32_bf16 v[144:147], v[196:199], a[132:135], v[144:147]
ds_read_b64_tr_b16 v[180:181], v208 offset:9472
ds_read_b64_tr_b16 v[182:183], v208 offset:14080
v_mfma_f32_16x16x32_bf16 v[144:147], v[200:203], a[136:139], v[144:147]
ds_read_b64_tr_b16 v[184:185], v208 offset:18688
ds_read_b64_tr_b16 v[186:187], v208 offset:23296
v_mfma_f32_16x16x32_bf16 v[144:147], v[204:207], a[140:143], v[144:147]
ds_read_b64_tr_b16 v[188:189], v208 offset:27904
ds_read_b64_tr_b16 v[190:191], v208 offset:32512
v_mfma_f32_16x16x32_bf16 v[148:151], v[192:195], a[144:147], v[148:151]
v_mfma_f32_16x16x32_bf16 v[148:151], v[196:199], a[148:151], v[148:151]
v_mfma_f32_16x16x32_bf16 v[148:151], v[200:203], a[152:155], v[148:151]
v_mfma_f32_16x16x32_bf16 v[148:151], v[204:207], a[156:159], v[148:151]
buffer_load_dwordx4 a[108:111], v215, s[20:23], s88 offen offset:2048 sc1
v_mfma_f32_16x16x32_bf16 v[152:155], v[192:195], a[160:163], v[152:155]
v_mfma_f32_16x16x32_bf16 v[152:155], v[196:199], a[164:167], v[152:155]
v_mfma_f32_16x16x32_bf16 v[152:155], v[200:203], a[168:171], v[152:155]
v_mfma_f32_16x16x32_bf16 v[152:155], v[204:207], a[172:175], v[152:155]
buffer_load_dwordx4 a[124:127], v215, s[20:23], s88 offen offset:3072 sc1
s_add_u32 s88, s88, 0x80000
v_mfma_f32_16x16x32_bf16 v[156:159], v[192:195], a[176:179], v[156:159]
v_mfma_f32_16x16x32_bf16 v[156:159], v[196:199], a[180:183], v[156:159]
v_mfma_f32_16x16x32_bf16 v[156:159], v[200:203], a[184:187], v[156:159]
v_mfma_f32_16x16x32_bf16 v[156:159], v[204:207], a[188:191], v[156:159]
s_waitcnt lgkmcnt(0)
v_mfma_f32_16x16x32_bf16 v[160:163], v[176:179], a[128:131], v[160:163]
s_waitcnt vmcnt(50)
s_barrier
v_mfma_f32_16x16x32_bf16 v[160:163], v[180:183], a[132:135], v[160:163]
ds_read_b64_tr_b16 v[192:193], v209
ds_read_b64_tr_b16 v[194:195], v209 offset:4608
v_mfma_f32_16x16x32_bf16 v[160:163], v[184:187], a[136:139], v[160:163]
ds_read_b64_tr_b16 v[196:197], v209 offset:9216
ds_read_b64_tr_b16 v[198:199], v209 offset:13824
v_mfma_f32_16x16x32_bf16 v[160:163], v[188:191], a[140:143], v[160:163]
ds_read_b64_tr_b16 v[200:201], v209 offset:18432
ds_read_b64_tr_b16 v[202:203], v209 offset:23040
v_mfma_f32_16x16x32_bf16 v[164:167], v[176:179], a[144:147], v[164:167]
ds_read_b64_tr_b16 v[204:205], v209 offset:27648
ds_read_b64_tr_b16 v[206:207], v209 offset:32256
v_mfma_f32_16x16x32_bf16 v[164:167], v[180:183], a[148:151], v[164:167]
v_mfma_f32_16x16x32_bf16 v[164:167], v[184:187], a[152:155], v[164:167]
v_mfma_f32_16x16x32_bf16 v[164:167], v[188:191], a[156:159], v[164:167]
v_mfma_f32_16x16x32_bf16 v[168:171], v[176:179], a[160:163], v[168:171]
v_mfma_f32_16x16x32_bf16 v[168:171], v[180:183], a[164:167], v[168:171]
v_mfma_f32_16x16x32_bf16 v[168:171], v[184:187], a[168:171], v[168:171]
v_mfma_f32_16x16x32_bf16 v[168:171], v[188:191], a[172:175], v[168:171]
v_mfma_f32_16x16x32_bf16 v[172:175], v[176:179], a[176:179], v[172:175]
v_mfma_f32_16x16x32_bf16 v[172:175], v[180:183], a[180:183], v[172:175]
v_mfma_f32_16x16x32_bf16 v[172:175], v[184:187], a[184:187], v[172:175]
v_mfma_f32_16x16x32_bf16 v[172:175], v[188:191], a[188:191], v[172:175]
s_waitcnt lgkmcnt(0)
v_mfma_f32_16x16x32_bf16 v[32:35], v[192:195], a[192:195], v[32:35]
ds_read_b64_tr_b16 v[176:177], v209 offset:32
ds_read_b64_tr_b16 v[178:179], v209 offset:4640
v_mfma_f32_16x16x32_bf16 v[32:35], v[196:199], a[196:199], v[32:35]
ds_read_b64_tr_b16 v[180:181], v209 offset:9248
ds_read_b64_tr_b16 v[182:183], v209 offset:13856
v_mfma_f32_16x16x32_bf16 v[32:35], v[200:203], a[200:203], v[32:35]
ds_read_b64_tr_b16 v[184:185], v209 offset:18464
ds_read_b64_tr_b16 v[186:187], v209 offset:23072
v_mfma_f32_16x16x32_bf16 v[32:35], v[204:207], a[204:207], v[32:35]
ds_read_b64_tr_b16 v[188:189], v209 offset:27680
ds_read_b64_tr_b16 v[190:191], v209 offset:32288
v_mfma_f32_16x16x32_bf16 v[36:39], v[192:195], a[208:211], v[36:39]
s_waitcnt vmcnt(40)
s_add_u32 m0, s51, 0
v_mfma_f32_16x16x32_bf16 v[36:39], v[196:199], a[212:215], v[36:39]
buffer_load_dwordx4 v242, s[16:19], s87 offen lds
v_mfma_f32_16x16x32_bf16 v[36:39], v[200:203], a[216:219], v[36:39]
v_mfma_f32_16x16x32_bf16 v[36:39], v[204:207], a[220:223], v[36:39]
s_add_u32 m0, s51, 0x400
v_mfma_f32_16x16x32_bf16 v[40:43], v[192:195], a[224:227], v[40:43]
buffer_load_dwordx4 v243, s[16:19], s87 offen lds
v_mfma_f32_16x16x32_bf16 v[40:43], v[196:199], a[228:231], v[40:43]
v_mfma_f32_16x16x32_bf16 v[40:43], v[200:203], a[232:235], v[40:43]
s_add_u32 m0, s51, 0x800
v_mfma_f32_16x16x32_bf16 v[40:43], v[204:207], a[236:239], v[40:43]
buffer_load_dwordx4 v244, s[16:19], s87 offen lds
v_mfma_f32_16x16x32_bf16 v[44:47], v[192:195], a[240:243], v[44:47]
v_mfma_f32_16x16x32_bf16 v[44:47], v[196:199], a[244:247], v[44:47]
s_add_u32 m0, s51, 0xc00
v_mfma_f32_16x16x32_bf16 v[44:47], v[200:203], a[248:251], v[44:47]
buffer_load_dwordx4 v245, s[16:19], s87 offen lds
v_mfma_f32_16x16x32_bf16 v[44:47], v[204:207], a[252:255], v[44:47]
s_waitcnt lgkmcnt(0)
v_mfma_f32_16x16x32_bf16 v[48:51], v[176:179], a[192:195], v[48:51]
ds_read_b64_tr_b16 v[192:193], v209 offset:64
ds_read_b64_tr_b16 v[194:195], v209 offset:4672
v_mfma_f32_16x16x32_bf16 v[48:51], v[180:183], a[196:199], v[48:51]
ds_read_b64_tr_b16 v[196:197], v209 offset:9280
ds_read_b64_tr_b16 v[198:199], v209 offset:13888
v_mfma_f32_16x16x32_bf16 v[48:51], v[184:187], a[200:203], v[48:51]
ds_read_b64_tr_b16 v[200:201], v209 offset:18496
ds_read_b64_tr_b16 v[202:203], v209 offset:23104
v_mfma_f32_16x16x32_bf16 v[48:51], v[188:191], a[204:207], v[48:51]
ds_read_b64_tr_b16 v[204:205], v209 offset:27712
ds_read_b64_tr_b16 v[206:207], v209 offset:32320
v_mfma_f32_16x16x32_bf16 v[52:55], v[176:179], a[208:211], v[52:55]
s_add_u32 m0, s51, 0x1000
v_mfma_f32_16x16x32_bf16 v[52:55], v[180:183], a[212:215], v[52:55]
buffer_load_dwordx4 v246, s[16:19], s87 offen lds
v_mfma_f32_16x16x32_bf16 v[52:55], v[184:187], a[216:219], v[52:55]
v_mfma_f32_16x16x32_bf16 v[52:55], v[188:191], a[220:223], v[52:55]
s_add_u32 m0, s51, 0x1400
v_mfma_f32_16x16x32_bf16 v[56:59], v[176:179], a[224:227], v[56:59]
buffer_load_dwordx4 v247, s[16:19], s87 offen lds
v_mfma_f32_16x16x32_bf16 v[56:59], v[180:183], a[228:231], v[56:59]
v_mfma_f32_16x16x32_bf16 v[56:59], v[184:187], a[232:235], v[56:59]
s_add_u32 m0, s51, 0x1800
v_mfma_f32_16x16x32_bf16 v[56:59], v[188:191], a[236:239], v[56:59]
buffer_load_dwordx4 v248, s[16:19], s87 offen lds
v_mfma_f32_16x16x32_bf16 v[60:63], v[176:179], a[240:243], v[60:63]
v_mfma_f32_16x16x32_bf16 v[60:63], v[180:183], a[244:247], v[60:63]
s_add_u32 m0, s51, 0x1c00
v_mfma_f32_16x16x32_bf16 v[60:63], v[184:187], a[248:251], v[60:63]
buffer_load_dwordx4 v249, s[16:19], s87 offen lds
v_mfma_f32_16x16x32_bf16 v[60:63], v[188:191], a[252:255], v[60:63]
s_waitcnt lgkmcnt(0)
v_mfma_f32_16x16x32_bf16 v[64:67], v[192:195], a[192:195], v[64:67]
ds_read_b64_tr_b16 v[176:177], v209 offset:96
ds_read_b64_tr_b16 v[178:179], v209 offset:4704
v_mfma_f32_16x16x32_bf16 v[64:67], v[196:199], a[196:199], v[64:67]
ds_read_b64_tr_b16 v[180:181], v209 offset:9312
ds_read_b64_tr_b16 v[182:183], v209 offset:13920
v_mfma_f32_16x16x32_bf16 v[64:67], v[200:203], a[200:203], v[64:67]
ds_read_b64_tr_b16 v[184:185], v209 offset:18528
ds_read_b64_tr_b16 v[186:187], v209 offset:23136
v_mfma_f32_16x16x32_bf16 v[64:67], v[204:207], a[204:207], v[64:67]
ds_read_b64_tr_b16 v[188:189], v209 offset:27744
ds_read_b64_tr_b16 v[190:191], v209 offset:32352
v_mfma_f32_16x16x32_bf16 v[68:71], v[192:195], a[208:211], v[68:71]
s_add_u32 m0, s51, 0x2000
v_mfma_f32_16x16x32_bf16 v[68:71], v[196:199], a[212:215], v[68:71]
buffer_load_dwordx4 v250, s[16:19], s87 offen lds
s_add_u32 s87, s87, 0x24000
v_mfma_f32_16x16x32_bf16 v[68:71], v[200:203], a[216:219], v[68:71]
v_mfma_f32_16x16x32_bf16 v[68:71], v[204:207], a[220:223], v[68:71]
v_mfma_f32_16x16x32_bf16 v[72:75], v[192:195], a[224:227], v[72:75]
buffer_load_dwordx4 a[128:131], v212, s[20:23], s88 offen sc1
v_mfma_f32_16x16x32_bf16 v[72:75], v[196:199], a[228:231], v[72:75]
v_mfma_f32_16x16x32_bf16 v[72:75], v[200:203], a[232:235], v[72:75]
v_mfma_f32_16x16x32_bf16 v[72:75], v[204:207], a[236:239], v[72:75]
buffer_load_dwordx4 a[144:147], v212, s[20:23], s88 offen offset:1024 sc1
v_mfma_f32_16x16x32_bf16 v[76:79], v[192:195], a[240:243], v[76:79]
v_mfma_f32_16x16x32_bf16 v[76:79], v[196:199], a[244:247], v[76:79]
v_mfma_f32_16x16x32_bf16 v[76:79], v[200:203], a[248:251], v[76:79]
buffer_load_dwordx4 a[160:163], v212, s[20:23], s88 offen offset:2048 sc1
v_mfma_f32_16x16x32_bf16 v[76:79], v[204:207], a[252:255], v[76:79]
s_waitcnt lgkmcnt(0)
v_mfma_f32_16x16x32_bf16 v[80:83], v[176:179], a[192:195], v[80:83]
ds_read_b64_tr_b16 v[192:193], v209 offset:128
ds_read_b64_tr_b16 v[194:195], v209 offset:4736
v_mfma_f32_16x16x32_bf16 v[80:83], v[180:183], a[196:199], v[80:83]
ds_read_b64_tr_b16 v[196:197], v209 offset:9344
ds_read_b64_tr_b16 v[198:199], v209 offset:13952
v_mfma_f32_16x16x32_bf16 v[80:83], v[184:187], a[200:203], v[80:83]
ds_read_b64_tr_b16 v[200:201], v209 offset:18560
ds_read_b64_tr_b16 v[202:203], v209 offset:23168
v_mfma_f32_16x16x32_bf16 v[80:83], v[188:191], a[204:207], v[80:83]
ds_read_b64_tr_b16 v[204:205], v209 offset:27776
ds_read_b64_tr_b16 v[206:207], v209 offset:32384
v_mfma_f32_16x16x32_bf16 v[84:87], v[176:179], a[208:211], v[84:87]
v_mfma_f32_16x16x32_bf16 v[84:87], v[180:183], a[212:215], v[84:87]
buffer_load_dwordx4 a[176:179], v212, s[20:23], s88 offen offset:3072 sc1
v_mfma_f32_16x16x32_bf16 v[84:87], v[184:187], a[216:219], v[84:87]
v_mfma_f32_16x16x32_bf16 v[84:87], v[188:191], a[220:223], v[84:87]
v_mfma_f32_16x16x32_bf16 v[88:91], v[176:179], a[224:227], v[88:91]
buffer_load_dwordx4 a[132:135], v213, s[20:23], s88 offen sc1
v_mfma_f32_16x16x32_bf16 v[88:91], v[180:183], a[228:231], v[88:91]
v_mfma_f32_16x16x32_bf16 v[88:91], v[184:187], a[232:235], v[88:91]
v_mfma_f32_16x16x32_bf16 v[88:91], v[188:191], a[236:239], v[88:91]
buffer_load_dwordx4 a[148:151], v213, s[20:23], s88 offen offset:1024 sc1
v_mfma_f32_16x16x32_bf16 v[92:95], v[176:179], a[240:243], v[92:95]
v_mfma_f32_16x16x32_bf16 v[92:95], v[180:183], a[244:247], v[92:95]
v_mfma_f32_16x16x32_bf16 v[92:95], v[184:187], a[248:251], v[92:95]
buffer_load_dwordx4 a[164:167], v213, s[20:23], s88 offen offset:2048 sc1
v_mfma_f32_16x16x32_bf16 v[92:95], v[188:191], a[252:255], v[92:95]
s_waitcnt lgkmcnt(0)
v_mfma_f32_16x16x32_bf16 v[96:99], v[192:195], a[192:195], v[96:99]
ds_read_b64_tr_b16 v[176:177], v209 offset:160
ds_read_b64_tr_b16 v[178:179], v209 offset:4768
v_mfma_f32_16x16x32_bf16 v[96:99], v[196:199], a[196:199], v[96:99]
ds_read_b64_tr_b16 v[180:181], v209 offset:9376
ds_read_b64_tr_b16 v[182:183], v209 offset:13984
v_mfma_f32_16x16x32_bf16 v[96:99], v[200:203], a[200:203], v[96:99]
ds_read_b64_tr_b16 v[184:185], v209 offset:18592
ds_read_b64_tr_b16 v[186:187], v209 offset:23200
v_mfma_f32_16x16x32_bf16 v[96:99], v[204:207], a[204:207], v[96:99]
ds_read_b64_tr_b16 v[188:189], v209 offset:27808
ds_read_b64_tr_b16 v[190:191], v209 offset:32416
v_mfma_f32_16x16x32_bf16 v[100:103], v[192:195], a[208:211], v[100:103]
s_waitcnt vmcnt(40)
v_mfma_f32_16x16x32_bf16 v[100:103], v[196:199], a[212:215], v[100:103]
buffer_load_dwordx4 a[180:183], v213, s[20:23], s88 offen offset:3072 sc1
v_mfma_f32_16x16x32_bf16 v[100:103], v[200:203], a[216:219], v[100:103]
v_mfma_f32_16x16x32_bf16 v[100:103], v[204:207], a[220:223], v[100:103]
v_mfma_f32_16x16x32_bf16 v[104:107], v[192:195], a[224:227], v[104:107]
buffer_load_dwordx4 a[136:139], v214, s[20:23], s88 offen sc1
v_mfma_f32_16x16x32_bf16 v[104:107], v[196:199], a[228:231], v[104:107]
v_mfma_f32_16x16x32_bf16 v[104:107], v[200:203], a[232:235], v[104:107]
v_mfma_f32_16x16x32_bf16 v[104:107], v[204:207], a[236:239], v[104:107]
buffer_load_dwordx4 a[152:155], v214, s[20:23], s88 offen offset:1024 sc1
v_mfma_f32_16x16x32_bf16 v[108:111], v[192:195], a[240:243], v[108:111]
v_mfma_f32_16x16x32_bf16 v[108:111], v[196:199], a[244:247], v[108:111]
v_mfma_f32_16x16x32_bf16 v[108:111], v[200:203], a[248:251], v[108:111]
buffer_load_dwordx4 a[168:171], v214, s[20:23], s88 offen offset:2048 sc1
v_mfma_f32_16x16x32_bf16 v[108:111], v[204:207], a[252:255], v[108:111]
s_waitcnt lgkmcnt(0)
v_mfma_f32_16x16x32_bf16 v[112:115], v[176:179], a[192:195], v[112:115]
ds_read_b64_tr_b16 v[192:193], v209 offset:192
ds_read_b64_tr_b16 v[194:195], v209 offset:4800
v_mfma_f32_16x16x32_bf16 v[112:115], v[180:183], a[196:199], v[112:115]
ds_read_b64_tr_b16 v[196:197], v209 offset:9408
ds_read_b64_tr_b16 v[198:199], v209 offset:14016
v_mfma_f32_16x16x32_bf16 v[112:115], v[184:187], a[200:203], v[112:115]
ds_read_b64_tr_b16 v[200:201], v209 offset:18624
ds_read_b64_tr_b16 v[202:203], v209 offset:23232
v_mfma_f32_16x16x32_bf16 v[112:115], v[188:191], a[204:207], v[112:115]
ds_read_b64_tr_b16 v[204:205], v209 offset:27840
ds_read_b64_tr_b16 v[206:207], v209 offset:32448
v_mfma_f32_16x16x32_bf16 v[116:119], v[176:179], a[208:211], v[116:119]
v_mfma_f32_16x16x32_bf16 v[116:119], v[180:183], a[212:215], v[116:119]
buffer_load_dwordx4 a[184:187], v214, s[20:23], s88 offen offset:3072 sc1
v_mfma_f32_16x16x32_bf16 v[116:119], v[184:187], a[216:219], v[116:119]
v_mfma_f32_16x16x32_bf16 v[116:119], v[188:191], a[220:223], v[116:119]
v_mfma_f32_16x16x32_bf16 v[120:123], v[176:179], a[224:227], v[120:123]
buffer_load_dwordx4 a[140:143], v215, s[20:23], s88 offen sc1
v_mfma_f32_16x16x32_bf16 v[120:123], v[180:183], a[228:231], v[120:123]
v_mfma_f32_16x16x32_bf16 v[120:123], v[184:187], a[232:235], v[120:123]
v_mfma_f32_16x16x32_bf16 v[120:123], v[188:191], a[236:239], v[120:123]
buffer_load_dwordx4 a[156:159], v215, s[20:23], s88 offen offset:1024 sc1
v_mfma_f32_16x16x32_bf16 v[124:127], v[176:179], a[240:243], v[124:127]
v_mfma_f32_16x16x32_bf16 v[124:127], v[180:183], a[244:247], v[124:127]
v_mfma_f32_16x16x32_bf16 v[124:127], v[184:187], a[248:251], v[124:127]
buffer_load_dwordx4 a[172:175], v215, s[20:23], s88 offen offset:2048 sc1
v_mfma_f32_16x16x32_bf16 v[124:127], v[188:191], a[252:255], v[124:127]
s_waitcnt lgkmcnt(0)
v_mfma_f32_16x16x32_bf16 v[128:131], v[192:195], a[192:195], v[128:131]
ds_read_b64_tr_b16 v[176:177], v209 offset:224
ds_read_b64_tr_b16 v[178:179], v209 offset:4832
v_mfma_f32_16x16x32_bf16 v[128:131], v[196:199], a[196:199], v[128:131]
ds_read_b64_tr_b16 v[180:181], v209 offset:9440
ds_read_b64_tr_b16 v[182:183], v209 offset:14048
v_mfma_f32_16x16x32_bf16 v[128:131], v[200:203], a[200:203], v[128:131]
ds_read_b64_tr_b16 v[184:185], v209 offset:18656
ds_read_b64_tr_b16 v[186:187], v209 offset:23264
v_mfma_f32_16x16x32_bf16 v[128:131], v[204:207], a[204:207], v[128:131]
ds_read_b64_tr_b16 v[188:189], v209 offset:27872
ds_read_b64_tr_b16 v[190:191], v209 offset:32480
v_mfma_f32_16x16x32_bf16 v[132:135], v[192:195], a[208:211], v[132:135]
v_mfma_f32_16x16x32_bf16 v[132:135], v[196:199], a[212:215], v[132:135]
buffer_load_dwordx4 a[188:191], v215, s[20:23], s88 offen offset:3072 sc1
s_add_u32 s88, s88, 0x80000
v_mfma_f32_16x16x32_bf16 v[132:135], v[200:203], a[216:219], v[132:135]
v_mfma_f32_16x16x32_bf16 v[132:135], v[204:207], a[220:223], v[132:135]
v_mfma_f32_16x16x32_bf16 v[136:139], v[192:195], a[224:227], v[136:139]
v_mfma_f32_16x16x32_bf16 v[136:139], v[196:199], a[228:231], v[136:139]
v_mfma_f32_16x16x32_bf16 v[136:139], v[200:203], a[232:235], v[136:139]
v_mfma_f32_16x16x32_bf16 v[136:139], v[204:207], a[236:239], v[136:139]
v_mfma_f32_16x16x32_bf16 v[140:143], v[192:195], a[240:243], v[140:143]
v_mfma_f32_16x16x32_bf16 v[140:143], v[196:199], a[244:247], v[140:143]
v_mfma_f32_16x16x32_bf16 v[140:143], v[200:203], a[248:251], v[140:143]
v_mfma_f32_16x16x32_bf16 v[140:143], v[204:207], a[252:255], v[140:143]
s_waitcnt lgkmcnt(0)
v_mfma_f32_16x16x32_bf16 v[144:147], v[176:179], a[192:195], v[144:147]
ds_read_b64_tr_b16 v[192:193], v209 offset:256
ds_read_b64_tr_b16 v[194:195], v209 offset:4864
v_mfma_f32_16x16x32_bf16 v[144:147], v[180:183], a[196:199], v[144:147]
ds_read_b64_tr_b16 v[196:197], v209 offset:9472
ds_read_b64_tr_b16 v[198:199], v209 offset:14080
v_mfma_f32_16x16x32_bf16 v[144:147], v[184:187], a[200:203], v[144:147]
ds_read_b64_tr_b16 v[200:201], v209 offset:18688
ds_read_b64_tr_b16 v[202:203], v209 offset:23296
v_mfma_f32_16x16x32_bf16 v[144:147], v[188:191], a[204:207], v[144:147]
ds_read_b64_tr_b16 v[204:205], v209 offset:27904
ds_read_b64_tr_b16 v[206:207], v209 offset:32512
v_mfma_f32_16x16x32_bf16 v[148:151], v[176:179], a[208:211], v[148:151]
v_mfma_f32_16x16x32_bf16 v[148:151], v[180:183], a[212:215], v[148:151]
v_mfma_f32_16x16x32_bf16 v[148:151], v[184:187], a[216:219], v[148:151]
v_mfma_f32_16x16x32_bf16 v[148:151], v[188:191], a[220:223], v[148:151]
v_mfma_f32_16x16x32_bf16 v[152:155], v[176:179], a[224:227], v[152:155]
v_mfma_f32_16x16x32_bf16 v[152:155], v[180:183], a[228:231], v[152:155]
v_mfma_f32_16x16x32_bf16 v[152:155], v[184:187], a[232:235], v[152:155]
v_mfma_f32_16x16x32_bf16 v[152:155], v[188:191], a[236:239], v[152:155]
v_mfma_f32_16x16x32_bf16 v[156:159], v[176:179], a[240:243], v[156:159]
v_mfma_f32_16x16x32_bf16 v[156:159], v[180:183], a[244:247], v[156:159]
v_mfma_f32_16x16x32_bf16 v[156:159], v[184:187], a[248:251], v[156:159]
v_mfma_f32_16x16x32_bf16 v[156:159], v[188:191], a[252:255], v[156:159]
s_waitcnt lgkmcnt(0)
v_mfma_f32_16x16x32_bf16 v[160:163], v[192:195], a[192:195], v[160:163]
s_waitcnt vmcnt(50)
s_barrier
v_mfma_f32_16x16x32_bf16 v[160:163], v[196:199], a[196:199], v[160:163]
ds_read_b64_tr_b16 v[176:177], v210
ds_read_b64_tr_b16 v[178:179], v210 offset:4608
v_mfma_f32_16x16x32_bf16 v[160:163], v[200:203], a[200:203], v[160:163]
ds_read_b64_tr_b16 v[180:181], v210 offset:9216
ds_read_b64_tr_b16 v[182:183], v210 offset:13824
v_mfma_f32_16x16x32_bf16 v[160:163], v[204:207], a[204:207], v[160:163]
ds_read_b64_tr_b16 v[184:185], v210 offset:18432
ds_read_b64_tr_b16 v[186:187], v210 offset:23040
v_mfma_f32_16x16x32_bf16 v[164:167], v[192:195], a[208:211], v[164:167]
ds_read_b64_tr_b16 v[188:189], v210 offset:27648
ds_read_b64_tr_b16 v[190:191], v210 offset:32256
v_mfma_f32_16x16x32_bf16 v[164:167], v[196:199], a[212:215], v[164:167]
v_mfma_f32_16x16x32_bf16 v[164:167], v[200:203], a[216:219], v[164:167]
v_mfma_f32_16x16x32_bf16 v[164:167], v[204:207], a[220:223], v[164:167]
v_mfma_f32_16x16x32_bf16 v[168:171], v[192:195], a[224:227], v[168:171]
v_mfma_f32_16x16x32_bf16 v[168:171], v[196:199], a[228:231], v[168:171]
v_mfma_f32_16x16x32_bf16 v[168:171], v[200:203], a[232:235], v[168:171]
v_mfma_f32_16x16x32_bf16 v[168:171], v[204:207], a[236:239], v[168:171]
v_mfma_f32_16x16x32_bf16 v[172:175], v[192:195], a[240:243], v[172:175]
v_mfma_f32_16x16x32_bf16 v[172:175], v[196:199], a[244:247], v[172:175]
v_mfma_f32_16x16x32_bf16 v[172:175], v[200:203], a[248:251], v[172:175]
v_mfma_f32_16x16x32_bf16 v[172:175], v[204:207], a[252:255], v[172:175]
s_waitcnt lgkmcnt(0)
v_mfma_f32_16x16x32_bf16 v[32:35], v[176:179], a[0:3], v[32:35]
ds_read_b64_tr_b16 v[192:193], v210 offset:32
ds_read_b64_tr_b16 v[194:195], v210 offset:4640
v_mfma_f32_16x16x32_bf16 v[32:35], v[180:183], a[4:7], v[32:35]
ds_read_b64_tr_b16 v[196:197], v210 offset:9248
ds_read_b64_tr_b16 v[198:199], v210 offset:13856
v_mfma_f32_16x16x32_bf16 v[32:35], v[184:187], a[8:11], v[32:35]
ds_read_b64_tr_b16 v[200:201], v210 offset:18464
ds_read_b64_tr_b16 v[202:203], v210 offset:23072
v_mfma_f32_16x16x32_bf16 v[32:35], v[188:191], a[12:15], v[32:35]
ds_read_b64_tr_b16 v[204:205], v210 offset:27680
ds_read_b64_tr_b16 v[206:207], v210 offset:32288
v_mfma_f32_16x16x32_bf16 v[36:39], v[176:179], a[16:19], v[36:39]
v_mfma_f32_16x16x32_bf16 v[36:39], v[180:183], a[20:23], v[36:39]
v_mfma_f32_16x16x32_bf16 v[36:39], v[184:187], a[24:27], v[36:39]
v_mfma_f32_16x16x32_bf16 v[36:39], v[188:191], a[28:31], v[36:39]
v_mfma_f32_16x16x32_bf16 v[40:43], v[176:179], a[32:35], v[40:43]
v_mfma_f32_16x16x32_bf16 v[40:43], v[180:183], a[36:39], v[40:43]
v_mfma_f32_16x16x32_bf16 v[40:43], v[184:187], a[40:43], v[40:43]
v_mfma_f32_16x16x32_bf16 v[40:43], v[188:191], a[44:47], v[40:43]
v_mfma_f32_16x16x32_bf16 v[44:47], v[176:179], a[48:51], v[44:47]
v_mfma_f32_16x16x32_bf16 v[44:47], v[180:183], a[52:55], v[44:47]
v_mfma_f32_16x16x32_bf16 v[44:47], v[184:187], a[56:59], v[44:47]
v_mfma_f32_16x16x32_bf16 v[44:47], v[188:191], a[60:63], v[44:47]
s_waitcnt lgkmcnt(0)
v_mfma_f32_16x16x32_bf16 v[48:51], v[192:195], a[0:3], v[48:51]
ds_read_b64_tr_b16 v[176:177], v210 offset:64
ds_read_b64_tr_b16 v[178:179], v210 offset:4672
v_mfma_f32_16x16x32_bf16 v[48:51], v[196:199], a[4:7], v[48:51]
ds_read_b64_tr_b16 v[180:181], v210 offset:9280
ds_read_b64_tr_b16 v[182:183], v210 offset:13888
v_mfma_f32_16x16x32_bf16 v[48:51], v[200:203], a[8:11], v[48:51]
ds_read_b64_tr_b16 v[184:185], v210 offset:18496
ds_read_b64_tr_b16 v[186:187], v210 offset:23104
v_mfma_f32_16x16x32_bf16 v[48:51], v[204:207], a[12:15], v[48:51]
ds_read_b64_tr_b16 v[188:189], v210 offset:27712
ds_read_b64_tr_b16 v[190:191], v210 offset:32320
v_mfma_f32_16x16x32_bf16 v[52:55], v[192:195], a[16:19], v[52:55]
v_mfma_f32_16x16x32_bf16 v[52:55], v[196:199], a[20:23], v[52:55]
v_mfma_f32_16x16x32_bf16 v[52:55], v[200:203], a[24:27], v[52:55]
v_mfma_f32_16x16x32_bf16 v[52:55], v[204:207], a[28:31], v[52:55]
v_mfma_f32_16x16x32_bf16 v[56:59], v[192:195], a[32:35], v[56:59]
v_mfma_f32_16x16x32_bf16 v[56:59], v[196:199], a[36:39], v[56:59]
v_mfma_f32_16x16x32_bf16 v[56:59], v[200:203], a[40:43], v[56:59]
v_mfma_f32_16x16x32_bf16 v[56:59], v[204:207], a[44:47], v[56:59]
v_mfma_f32_16x16x32_bf16 v[60:63], v[192:195], a[48:51], v[60:63]
v_mfma_f32_16x16x32_bf16 v[60:63], v[196:199], a[52:55], v[60:63]
v_mfma_f32_16x16x32_bf16 v[60:63], v[200:203], a[56:59], v[60:63]
v_mfma_f32_16x16x32_bf16 v[60:63], v[204:207], a[60:63], v[60:63]
s_waitcnt lgkmcnt(0)
v_mfma_f32_16x16x32_bf16 v[64:67], v[176:179], a[0:3], v[64:67]
ds_read_b64_tr_b16 v[192:193], v210 offset:96
ds_read_b64_tr_b16 v[194:195], v210 offset:4704
v_mfma_f32_16x16x32_bf16 v[64:67], v[180:183], a[4:7], v[64:67]
ds_read_b64_tr_b16 v[196:197], v210 offset:9312
ds_read_b64_tr_b16 v[198:199], v210 offset:13920
v_mfma_f32_16x16x32_bf16 v[64:67], v[184:187], a[8:11], v[64:67]
ds_read_b64_tr_b16 v[200:201], v210 offset:18528
ds_read_b64_tr_b16 v[202:203], v210 offset:23136
v_mfma_f32_16x16x32_bf16 v[64:67], v[188:191], a[12:15], v[64:67]
ds_read_b64_tr_b16 v[204:205], v210 offset:27744
ds_read_b64_tr_b16 v[206:207], v210 offset:32352
v_mfma_f32_16x16x32_bf16 v[68:71], v[176:179], a[16:19], v[68:71]
v_mfma_f32_16x16x32_bf16 v[68:71], v[180:183], a[20:23], v[68:71]
v_mfma_f32_16x16x32_bf16 v[68:71], v[184:187], a[24:27], v[68:71]
v_mfma_f32_16x16x32_bf16 v[68:71], v[188:191], a[28:31], v[68:71]
v_mfma_f32_16x16x32_bf16 v[72:75], v[176:179], a[32:35], v[72:75]
v_mfma_f32_16x16x32_bf16 v[72:75], v[180:183], a[36:39], v[72:75]
v_mfma_f32_16x16x32_bf16 v[72:75], v[184:187], a[40:43], v[72:75]
v_mfma_f32_16x16x32_bf16 v[72:75], v[188:191], a[44:47], v[72:75]
v_mfma_f32_16x16x32_bf16 v[76:79], v[176:179], a[48:51], v[76:79]
v_mfma_f32_16x16x32_bf16 v[76:79], v[180:183], a[52:55], v[76:79]
v_mfma_f32_16x16x32_bf16 v[76:79], v[184:187], a[56:59], v[76:79]
v_mfma_f32_16x16x32_bf16 v[76:79], v[188:191], a[60:63], v[76:79]
s_waitcnt lgkmcnt(0)
v_mfma_f32_16x16x32_bf16 v[80:83], v[192:195], a[0:3], v[80:83]
ds_read_b64_tr_b16 v[176:177], v210 offset:128
ds_read_b64_tr_b16 v[178:179], v210 offset:4736
v_mfma_f32_16x16x32_bf16 v[80:83], v[196:199], a[4:7], v[80:83]
ds_read_b64_tr_b16 v[180:181], v210 offset:9344
ds_read_b64_tr_b16 v[182:183], v210 offset:13952
v_mfma_f32_16x16x32_bf16 v[80:83], v[200:203], a[8:11], v[80:83]
ds_read_b64_tr_b16 v[184:185], v210 offset:18560
ds_read_b64_tr_b16 v[186:187], v210 offset:23168
v_mfma_f32_16x16x32_bf16 v[80:83], v[204:207], a[12:15], v[80:83]
ds_read_b64_tr_b16 v[188:189], v210 offset:27776
ds_read_b64_tr_b16 v[190:191], v210 offset:32384
v_mfma_f32_16x16x32_bf16 v[84:87], v[192:195], a[16:19], v[84:87]
v_mfma_f32_16x16x32_bf16 v[84:87], v[196:199], a[20:23], v[84:87]
v_mfma_f32_16x16x32_bf16 v[84:87], v[200:203], a[24:27], v[84:87]
v_mfma_f32_16x16x32_bf16 v[84:87], v[204:207], a[28:31], v[84:87]
v_mfma_f32_16x16x32_bf16 v[88:91], v[192:195], a[32:35], v[88:91]
v_mfma_f32_16x16x32_bf16 v[88:91], v[196:199], a[36:39], v[88:91]
v_mfma_f32_16x16x32_bf16 v[88:91], v[200:203], a[40:43], v[88:91]
v_mfma_f32_16x16x32_bf16 v[88:91], v[204:207], a[44:47], v[88:91]
v_mfma_f32_16x16x32_bf16 v[92:95], v[192:195], a[48:51], v[92:95]
v_mfma_f32_16x16x32_bf16 v[92:95], v[196:199], a[52:55], v[92:95]
v_mfma_f32_16x16x32_bf16 v[92:95], v[200:203], a[56:59], v[92:95]
v_mfma_f32_16x16x32_bf16 v[92:95], v[204:207], a[60:63], v[92:95]
s_waitcnt lgkmcnt(0)
v_mfma_f32_16x16x32_bf16 v[96:99], v[176:179], a[0:3], v[96:99]
ds_read_b64_tr_b16 v[192:193], v210 offset:160
ds_read_b64_tr_b16 v[194:195], v210 offset:4768
v_mfma_f32_16x16x32_bf16 v[96:99], v[180:183], a[4:7], v[96:99]
ds_read_b64_tr_b16 v[196:197], v210 offset:9376
ds_read_b64_tr_b16 v[198:199], v210 offset:13984
v_mfma_f32_16x16x32_bf16 v[96:99], v[184:187], a[8:11], v[96:99]
ds_read_b64_tr_b16 v[200:201], v210 offset:18592
ds_read_b64_tr_b16 v[202:203], v210 offset:23200
v_mfma_f32_16x16x32_bf16 v[96:99], v[188:191], a[12:15], v[96:99]
ds_read_b64_tr_b16 v[204:205], v210 offset:27808
ds_read_b64_tr_b16 v[206:207], v210 offset:32416
v_mfma_f32_16x16x32_bf16 v[100:103], v[176:179], a[16:19], v[100:103]
v_mfma_f32_16x16x32_bf16 v[100:103], v[180:183], a[20:23], v[100:103]
v_mfma_f32_16x16x32_bf16 v[100:103], v[184:187], a[24:27], v[100:103]
v_mfma_f32_16x16x32_bf16 v[100:103], v[188:191], a[28:31], v[100:103]
v_mfma_f32_16x16x32_bf16 v[104:107], v[176:179], a[32:35], v[104:107]
v_mfma_f32_16x16x32_bf16 v[104:107], v[180:183], a[36:39], v[104:107]
v_mfma_f32_16x16x32_bf16 v[104:107], v[184:187], a[40:43], v[104:107]
v_mfma_f32_16x16x32_bf16 v[104:107], v[188:191], a[44:47], v[104:107]
v_mfma_f32_16x16x32_bf16 v[108:111], v[176:179], a[48:51], v[108:111]
v_mfma_f32_16x16x32_bf16 v[108:111], v[180:183], a[52:55], v[108:111]
v_mfma_f32_16x16x32_bf16 v[108:111], v[184:187], a[56:59], v[108:111]
v_mfma_f32_16x16x32_bf16 v[108:111], v[188:191], a[60:63], v[108:111]
s_waitcnt lgkmcnt(0)
v_mfma_f32_16x16x32_bf16 v[112:115], v[192:195], a[0:3], v[112:115]
ds_read_b64_tr_b16 v[176:177], v210 offset:192
ds_read_b64_tr_b16 v[178:179], v210 offset:4800
v_mfma_f32_16x16x32_bf16 v[112:115], v[196:199], a[4:7], v[112:115]
ds_read_b64_tr_b16 v[180:181], v210 offset:9408
ds_read_b64_tr_b16 v[182:183], v210 offset:14016
v_mfma_f32_16x16x32_bf16 v[112:115], v[200:203], a[8:11], v[112:115]
ds_read_b64_tr_b16 v[184:185], v210 offset:18624
ds_read_b64_tr_b16 v[186:187], v210 offset:23232
v_mfma_f32_16x16x32_bf16 v[112:115], v[204:207], a[12:15], v[112:115]
ds_read_b64_tr_b16 v[188:189], v210 offset:27840
ds_read_b64_tr_b16 v[190:191], v210 offset:32448
v_mfma_f32_16x16x32_bf16 v[116:119], v[192:195], a[16:19], v[116:119]
v_mfma_f32_16x16x32_bf16 v[116:119], v[196:199], a[20:23], v[116:119]
v_mfma_f32_16x16x32_bf16 v[116:119], v[200:203], a[24:27], v[116:119]
v_mfma_f32_16x16x32_bf16 v[116:119], v[204:207], a[28:31], v[116:119]
v_mfma_f32_16x16x32_bf16 v[120:123], v[192:195], a[32:35], v[120:123]
v_mfma_f32_16x16x32_bf16 v[120:123], v[196:199], a[36:39], v[120:123]
v_mfma_f32_16x16x32_bf16 v[120:123], v[200:203], a[40:43], v[120:123]
v_mfma_f32_16x16x32_bf16 v[120:123], v[204:207], a[44:47], v[120:123]
v_mfma_f32_16x16x32_bf16 v[124:127], v[192:195], a[48:51], v[124:127]
v_mfma_f32_16x16x32_bf16 v[124:127], v[196:199], a[52:55], v[124:127]
v_mfma_f32_16x16x32_bf16 v[124:127], v[200:203], a[56:59], v[124:127]
v_mfma_f32_16x16x32_bf16 v[124:127], v[204:207], a[60:63], v[124:127]
s_waitcnt lgkmcnt(0)
v_mfma_f32_16x16x32_bf16 v[128:131], v[176:179], a[0:3], v[128:131]
ds_read_b64_tr_b16 v[192:193], v210 offset:224
ds_read_b64_tr_b16 v[194:195], v210 offset:4832
v_mfma_f32_16x16x32_bf16 v[128:131], v[180:183], a[4:7], v[128:131]
ds_read_b64_tr_b16 v[196:197], v210 offset:9440
ds_read_b64_tr_b16 v[198:199], v210 offset:14048
v_mfma_f32_16x16x32_bf16 v[128:131], v[184:187], a[8:11], v[128:131]
ds_read_b64_tr_b16 v[200:201], v210 offset:18656
ds_read_b64_tr_b16 v[202:203], v210 offset:23264
v_mfma_f32_16x16x32_bf16 v[128:131], v[188:191], a[12:15], v[128:131]
ds_read_b64_tr_b16 v[204:205], v210 offset:27872
ds_read_b64_tr_b16 v[206:207], v210 offset:32480
v_mfma_f32_16x16x32_bf16 v[132:135], v[176:179], a[16:19], v[132:135]
v_mfma_f32_16x16x32_bf16 v[132:135], v[180:183], a[20:23], v[132:135]
v_mfma_f32_16x16x32_bf16 v[132:135], v[184:187], a[24:27], v[132:135]
v_mfma_f32_16x16x32_bf16 v[132:135], v[188:191], a[28:31], v[132:135]
v_mfma_f32_16x16x32_bf16 v[136:139], v[176:179], a[32:35], v[136:139]
v_mfma_f32_16x16x32_bf16 v[136:139], v[180:183], a[36:39], v[136:139]
v_mfma_f32_16x16x32_bf16 v[136:139], v[184:187], a[40:43], v[136:139]
v_mfma_f32_16x16x32_bf16 v[136:139], v[188:191], a[44:47], v[136:139]
v_mfma_f32_16x16x32_bf16 v[140:143], v[176:179], a[48:51], v[140:143]
v_mfma_f32_16x16x32_bf16 v[140:143], v[180:183], a[52:55], v[140:143]
v_mfma_f32_16x16x32_bf16 v[140:143], v[184:187], a[56:59], v[140:143]
v_mfma_f32_16x16x32_bf16 v[140:143], v[188:191], a[60:63], v[140:143]
s_waitcnt lgkmcnt(0)
v_mfma_f32_16x16x32_bf16 v[144:147], v[192:195], a[0:3], v[144:147]
ds_read_b64_tr_b16 v[176:177], v210 offset:256
ds_read_b64_tr_b16 v[178:179], v210 offset:4864
v_mfma_f32_16x16x32_bf16 v[144:147], v[196:199], a[4:7], v[144:147]
ds_read_b64_tr_b16 v[180:181], v210 offset:9472
ds_read_b64_tr_b16 v[182:183], v210 offset:14080
v_mfma_f32_16x16x32_bf16 v[144:147], v[200:203], a[8:11], v[144:147]
ds_read_b64_tr_b16 v[184:185], v210 offset:18688
ds_read_b64_tr_b16 v[186:187], v210 offset:23296
v_mfma_f32_16x16x32_bf16 v[144:147], v[204:207], a[12:15], v[144:147]
ds_read_b64_tr_b16 v[188:189], v210 offset:27904
ds_read_b64_tr_b16 v[190:191], v210 offset:32512
v_mfma_f32_16x16x32_bf16 v[148:151], v[192:195], a[16:19], v[148:151]
v_mfma_f32_16x16x32_bf16 v[148:151], v[196:199], a[20:23], v[148:151]
v_mfma_f32_16x16x32_bf16 v[148:151], v[200:203], a[24:27], v[148:151]
v_mfma_f32_16x16x32_bf16 v[148:151], v[204:207], a[28:31], v[148:151]
v_mfma_f32_16x16x32_bf16 v[152:155], v[192:195], a[32:35], v[152:155]
v_mfma_f32_16x16x32_bf16 v[152:155], v[196:199], a[36:39], v[152:155]
v_mfma_f32_16x16x32_bf16 v[152:155], v[200:203], a[40:43], v[152:155]
v_mfma_f32_16x16x32_bf16 v[152:155], v[204:207], a[44:47], v[152:155]
v_mfma_f32_16x16x32_bf16 v[156:159], v[192:195], a[48:51], v[156:159]
v_mfma_f32_16x16x32_bf16 v[156:159], v[196:199], a[52:55], v[156:159]
v_mfma_f32_16x16x32_bf16 v[156:159], v[200:203], a[56:59], v[156:159]
v_mfma_f32_16x16x32_bf16 v[156:159], v[204:207], a[60:63], v[156:159]
s_waitcnt lgkmcnt(0)
v_mfma_f32_16x16x32_bf16 v[160:163], v[176:179], a[0:3], v[160:163]
s_waitcnt vmcnt(0)
s_barrier
v_mfma_f32_16x16x32_bf16 v[160:163], v[180:183], a[4:7], v[160:163]
ds_read_b64_tr_b16 v[192:193], v211
ds_read_b64_tr_b16 v[194:195], v211 offset:4608
v_mfma_f32_16x16x32_bf16 v[160:163], v[184:187], a[8:11], v[160:163]
ds_read_b64_tr_b16 v[196:197], v211 offset:9216
ds_read_b64_tr_b16 v[198:199], v211 offset:13824
v_mfma_f32_16x16x32_bf16 v[160:163], v[188:191], a[12:15], v[160:163]
ds_read_b64_tr_b16 v[200:201], v211 offset:18432
ds_read_b64_tr_b16 v[202:203], v211 offset:23040
v_mfma_f32_16x16x32_bf16 v[164:167], v[176:179], a[16:19], v[164:167]
ds_read_b64_tr_b16 v[204:205], v211 offset:27648
ds_read_b64_tr_b16 v[206:207], v211 offset:32256
v_mfma_f32_16x16x32_bf16 v[164:167], v[180:183], a[20:23], v[164:167]
v_mfma_f32_16x16x32_bf16 v[164:167], v[184:187], a[24:27], v[164:167]
v_mfma_f32_16x16x32_bf16 v[164:167], v[188:191], a[28:31], v[164:167]
v_mfma_f32_16x16x32_bf16 v[168:171], v[176:179], a[32:35], v[168:171]
v_mfma_f32_16x16x32_bf16 v[168:171], v[180:183], a[36:39], v[168:171]
v_mfma_f32_16x16x32_bf16 v[168:171], v[184:187], a[40:43], v[168:171]
v_mfma_f32_16x16x32_bf16 v[168:171], v[188:191], a[44:47], v[168:171]
v_mfma_f32_16x16x32_bf16 v[172:175], v[176:179], a[48:51], v[172:175]
v_mfma_f32_16x16x32_bf16 v[172:175], v[180:183], a[52:55], v[172:175]
v_mfma_f32_16x16x32_bf16 v[172:175], v[184:187], a[56:59], v[172:175]
v_mfma_f32_16x16x32_bf16 v[172:175], v[188:191], a[60:63], v[172:175]
s_waitcnt lgkmcnt(0)
v_mfma_f32_16x16x32_bf16 v[32:35], v[192:195], a[64:67], v[32:35]
ds_read_b64_tr_b16 v[176:177], v208
ds_read_b64_tr_b16 v[178:179], v208 offset:4608
v_mfma_f32_16x16x32_bf16 v[32:35], v[196:199], a[68:71], v[32:35]
ds_read_b64_tr_b16 v[180:181], v208 offset:9216
ds_read_b64_tr_b16 v[182:183], v208 offset:13824
v_mfma_f32_16x16x32_bf16 v[32:35], v[200:203], a[72:75], v[32:35]
ds_read_b64_tr_b16 v[184:185], v208 offset:18432
ds_read_b64_tr_b16 v[186:187], v208 offset:23040
v_mfma_f32_16x16x32_bf16 v[32:35], v[204:207], a[76:79], v[32:35]
ds_read_b64_tr_b16 v[188:189], v208 offset:27648
ds_read_b64_tr_b16 v[190:191], v208 offset:32256
v_mfma_f32_16x16x32_bf16 v[36:39], v[192:195], a[80:83], v[36:39]
v_mfma_f32_16x16x32_bf16 v[36:39], v[196:199], a[84:87], v[36:39]
v_mfma_f32_16x16x32_bf16 v[36:39], v[200:203], a[88:91], v[36:39]
v_add_u32 v212, 0, v18
v_mfma_f32_16x16x32_bf16 v[36:39], v[204:207], a[92:95], v[36:39]
v_add_u32 v213, 0x1000, v18
v_mfma_f32_16x16x32_bf16 v[40:43], v[192:195], a[96:99], v[40:43]
v_add_u32 v214, 0x2000, v18
v_mfma_f32_16x16x32_bf16 v[40:43], v[196:199], a[100:103], v[40:43]
v_add_u32 v215, 0x3000, v18
v_mfma_f32_16x16x32_bf16 v[40:43], v[200:203], a[104:107], v[40:43]
v_mfma_f32_16x16x32_bf16 v[40:43], v[204:207], a[108:111], v[40:43]
v_mfma_f32_16x16x32_bf16 v[44:47], v[192:195], a[112:115], v[44:47]
v_mfma_f32_16x16x32_bf16 v[44:47], v[196:199], a[116:119], v[44:47]
v_mfma_f32_16x16x32_bf16 v[44:47], v[200:203], a[120:123], v[44:47]
v_mfma_f32_16x16x32_bf16 v[44:47], v[204:207], a[124:127], v[44:47]
s_waitcnt lgkmcnt(0)
v_mfma_f32_16x16x32_bf16 v[32:35], v[176:179], a[128:131], v[32:35]
ds_read_b64_tr_b16 v[192:193], v211 offset:32
ds_read_b64_tr_b16 v[194:195], v211 offset:4640
v_mfma_f32_16x16x32_bf16 v[32:35], v[180:183], a[132:135], v[32:35]
ds_read_b64_tr_b16 v[196:197], v211 offset:9248
ds_read_b64_tr_b16 v[198:199], v211 offset:13856
v_mfma_f32_16x16x32_bf16 v[32:35], v[184:187], a[136:139], v[32:35]
ds_read_b64_tr_b16 v[200:201], v211 offset:18464
ds_read_b64_tr_b16 v[202:203], v211 offset:23072
v_mfma_f32_16x16x32_bf16 v[32:35], v[188:191], a[140:143], v[32:35]
ds_read_b64_tr_b16 v[204:205], v211 offset:27680
ds_read_b64_tr_b16 v[206:207], v211 offset:32288
v_mfma_f32_16x16x32_bf16 v[36:39], v[176:179], a[144:147], v[36:39]
v_mfma_f32_16x16x32_bf16 v[36:39], v[180:183], a[148:151], v[36:39]
v_mfma_f32_16x16x32_bf16 v[36:39], v[184:187], a[152:155], v[36:39]
v_mfma_f32_16x16x32_bf16 v[36:39], v[188:191], a[156:159], v[36:39]
v_mfma_f32_16x16x32_bf16 v[40:43], v[176:179], a[160:163], v[40:43]
v_mfma_f32_16x16x32_bf16 v[40:43], v[180:183], a[164:167], v[40:43]
v_mfma_f32_16x16x32_bf16 v[40:43], v[184:187], a[168:171], v[40:43]
v_mfma_f32_16x16x32_bf16 v[40:43], v[188:191], a[172:175], v[40:43]
v_mfma_f32_16x16x32_bf16 v[44:47], v[176:179], a[176:179], v[44:47]
v_mfma_f32_16x16x32_bf16 v[44:47], v[180:183], a[180:183], v[44:47]
v_mfma_f32_16x16x32_bf16 v[44:47], v[184:187], a[184:187], v[44:47]
v_mfma_f32_16x16x32_bf16 v[44:47], v[188:191], a[188:191], v[44:47]
s_waitcnt lgkmcnt(0)
v_mfma_f32_16x16x32_bf16 v[48:51], v[192:195], a[64:67], v[48:51]
ds_read_b64_tr_b16 v[176:177], v208 offset:32
ds_read_b64_tr_b16 v[178:179], v208 offset:4640
v_mfma_f32_16x16x32_bf16 v[48:51], v[196:199], a[68:71], v[48:51]
ds_read_b64_tr_b16 v[180:181], v208 offset:9248
ds_read_b64_tr_b16 v[182:183], v208 offset:13856
v_mfma_f32_16x16x32_bf16 v[48:51], v[200:203], a[72:75], v[48:51]
ds_read_b64_tr_b16 v[184:185], v208 offset:18464
ds_read_b64_tr_b16 v[186:187], v208 offset:23072
v_mfma_f32_16x16x32_bf16 v[48:51], v[204:207], a[76:79], v[48:51]
ds_read_b64_tr_b16 v[188:189], v208 offset:27680
ds_read_b64_tr_b16 v[190:191], v208 offset:32288
v_mfma_f32_16x16x32_bf16 v[52:55], v[192:195], a[80:83], v[52:55]
v_mfma_f32_16x16x32_bf16 v[52:55], v[196:199], a[84:87], v[52:55]
v_mfma_f32_16x16x32_bf16 v[52:55], v[200:203], a[88:91], v[52:55]
v_mfma_f32_16x16x32_bf16 v[52:55], v[204:207], a[92:95], v[52:55]
v_mfma_f32_16x16x32_bf16 v[56:59], v[192:195], a[96:99], v[56:59]
v_mfma_f32_16x16x32_bf16 v[56:59], v[196:199], a[100:103], v[56:59]
v_mfma_f32_16x16x32_bf16 v[56:59], v[200:203], a[104:107], v[56:59]
v_mfma_f32_16x16x32_bf16 v[56:59], v[204:207], a[108:111], v[56:59]
v_mfma_f32_16x16x32_bf16 v[60:63], v[192:195], a[112:115], v[60:63]
v_mfma_f32_16x16x32_bf16 v[60:63], v[196:199], a[116:119], v[60:63]
v_mfma_f32_16x16x32_bf16 v[60:63], v[200:203], a[120:123], v[60:63]
v_mfma_f32_16x16x32_bf16 v[60:63], v[204:207], a[124:127], v[60:63]
s_waitcnt lgkmcnt(0)
v_mfma_f32_16x16x32_bf16 v[48:51], v[176:179], a[128:131], v[48:51]
ds_read_b64_tr_b16 v[192:193], v211 offset:64
ds_read_b64_tr_b16 v[194:195], v211 offset:4672
v_mfma_f32_16x16x32_bf16 v[48:51], v[180:183], a[132:135], v[48:51]
ds_read_b64_tr_b16 v[196:197], v211 offset:9280
ds_read_b64_tr_b16 v[198:199], v211 offset:13888
v_mfma_f32_16x16x32_bf16 v[48:51], v[184:187], a[136:139], v[48:51]
ds_read_b64_tr_b16 v[200:201], v211 offset:18496
ds_read_b64_tr_b16 v[202:203], v211 offset:23104
v_mfma_f32_16x16x32_bf16 v[48:51], v[188:191], a[140:143], v[48:51]
ds_read_b64_tr_b16 v[204:205], v211 offset:27712
ds_read_b64_tr_b16 v[206:207], v211 offset:32320
v_mfma_f32_16x16x32_bf16 v[52:55], v[176:179], a[144:147], v[52:55]
v_mfma_f32_16x16x32_bf16 v[52:55], v[180:183], a[148:151], v[52:55]
v_mfma_f32_16x16x32_bf16 v[52:55], v[184:187], a[152:155], v[52:55]
v_mfma_f32_16x16x32_bf16 v[52:55], v[188:191], a[156:159], v[52:55]
v_mfma_f32_16x16x32_bf16 v[56:59], v[176:179], a[160:163], v[56:59]
v_mfma_f32_16x16x32_bf16 v[56:59], v[180:183], a[164:167], v[56:59]
v_mfma_f32_16x16x32_bf16 v[56:59], v[184:187], a[168:171], v[56:59]
v_mfma_f32_16x16x32_bf16 v[56:59], v[188:191], a[172:175], v[56:59]
v_mfma_f32_16x16x32_bf16 v[60:63], v[176:179], a[176:179], v[60:63]
v_mfma_f32_16x16x32_bf16 v[60:63], v[180:183], a[180:183], v[60:63]
v_mfma_f32_16x16x32_bf16 v[60:63], v[184:187], a[184:187], v[60:63]
v_mfma_f32_16x16x32_bf16 v[60:63], v[188:191], a[188:191], v[60:63]
s_waitcnt lgkmcnt(0)
v_mfma_f32_16x16x32_bf16 v[64:67], v[192:195], a[64:67], v[64:67]
ds_read_b64_tr_b16 v[176:177], v208 offset:64
ds_read_b64_tr_b16 v[178:179], v208 offset:4672
v_mfma_f32_16x16x32_bf16 v[64:67], v[196:199], a[68:71], v[64:67]
ds_read_b64_tr_b16 v[180:181], v208 offset:9280
ds_read_b64_tr_b16 v[182:183], v208 offset:13888
v_mfma_f32_16x16x32_bf16 v[64:67], v[200:203], a[72:75], v[64:67]
ds_read_b64_tr_b16 v[184:185], v208 offset:18496
ds_read_b64_tr_b16 v[186:187], v208 offset:23104
v_mfma_f32_16x16x32_bf16 v[64:67], v[204:207], a[76:79], v[64:67]
ds_read_b64_tr_b16 v[188:189], v208 offset:27712
ds_read_b64_tr_b16 v[190:191], v208 offset:32320
v_mfma_f32_16x16x32_bf16 v[68:71], v[192:195], a[80:83], v[68:71]
v_cvt_pk_bf16_f32 v2, v32, v33
v_cvt_pk_bf16_f32 v3, v34, v35
v_mfma_f32_16x16x32_bf16 v[68:71], v[196:199], a[84:87], v[68:71]
v_cvt_pk_bf16_f32 v4, v48, v49
v_cvt_pk_bf16_f32 v5, v50, v51
v_mfma_f32_16x16x32_bf16 v[68:71], v[200:203], a[88:91], v[68:71]
buffer_store_dwordx4 v[2:5], v212, s[32:35], s89 offen sc1
v_mfma_f32_16x16x32_bf16 v[68:71], v[204:207], a[92:95], v[68:71]
v_mfma_f32_16x16x32_bf16 v[72:75], v[192:195], a[96:99], v[72:75]
v_mfma_f32_16x16x32_bf16 v[72:75], v[196:199], a[100:103], v[72:75]
v_mfma_f32_16x16x32_bf16 v[72:75], v[200:203], a[104:107], v[72:75]
v_mfma_f32_16x16x32_bf16 v[72:75], v[204:207], a[108:111], v[72:75]
v_mfma_f32_16x16x32_bf16 v[76:79], v[192:195], a[112:115], v[76:79]
v_mfma_f32_16x16x32_bf16 v[76:79], v[196:199], a[116:119], v[76:79]
v_mfma_f32_16x16x32_bf16 v[76:79], v[200:203], a[120:123], v[76:79]
v_mfma_f32_16x16x32_bf16 v[76:79], v[204:207], a[124:127], v[76:79]
s_waitcnt lgkmcnt(0)
v_mfma_f32_16x16x32_bf16 v[64:67], v[176:179], a[128:131], v[64:67]
ds_read_b64_tr_b16 v[192:193], v211 offset:96
ds_read_b64_tr_b16 v[194:195], v211 offset:4704
v_mfma_f32_16x16x32_bf16 v[64:67], v[180:183], a[132:135], v[64:67]
ds_read_b64_tr_b16 v[196:197], v211 offset:9312
ds_read_b64_tr_b16 v[198:199], v211 offset:13920
v_mfma_f32_16x16x32_bf16 v[64:67], v[184:187], a[136:139], v[64:67]
ds_read_b64_tr_b16 v[200:201], v211 offset:18528
ds_read_b64_tr_b16 v[202:203], v211 offset:23136
v_mfma_f32_16x16x32_bf16 v[64:67], v[188:191], a[140:143], v[64:67]
ds_read_b64_tr_b16 v[204:205], v211 offset:27744
ds_read_b64_tr_b16 v[206:207], v211 offset:32352
v_mfma_f32_16x16x32_bf16 v[68:71], v[176:179], a[144:147], v[68:71]
v_mfma_f32_16x16x32_bf16 v[68:71], v[180:183], a[148:151], v[68:71]
v_mfma_f32_16x16x32_bf16 v[68:71], v[184:187], a[152:155], v[68:71]
v_mfma_f32_16x16x32_bf16 v[68:71], v[188:191], a[156:159], v[68:71]
v_cvt_pk_bf16_f32 v6, v36, v37
v_cvt_pk_bf16_f32 v7, v38, v39
v_mfma_f32_16x16x32_bf16 v[72:75], v[176:179], a[160:163], v[72:75]
v_cvt_pk_bf16_f32 v8, v52, v53
v_cvt_pk_bf16_f32 v9, v54, v55
v_mfma_f32_16x16x32_bf16 v[72:75], v[180:183], a[164:167], v[72:75]
buffer_store_dwordx4 v[6:9], v213, s[32:35], s89 offen sc1
v_mfma_f32_16x16x32_bf16 v[72:75], v[184:187], a[168:171], v[72:75]
v_mfma_f32_16x16x32_bf16 v[72:75], v[188:191], a[172:175], v[72:75]
v_mfma_f32_16x16x32_bf16 v[76:79], v[176:179], a[176:179], v[76:79]
v_mfma_f32_16x16x32_bf16 v[76:79], v[180:183], a[180:183], v[76:79]
v_mfma_f32_16x16x32_bf16 v[76:79], v[184:187], a[184:187], v[76:79]
v_mfma_f32_16x16x32_bf16 v[76:79], v[188:191], a[188:191], v[76:79]
s_waitcnt lgkmcnt(0)
v_mfma_f32_16x16x32_bf16 v[80:83], v[192:195], a[64:67], v[80:83]
ds_read_b64_tr_b16 v[176:177], v208 offset:96
ds_read_b64_tr_b16 v[178:179], v208 offset:4704
v_mfma_f32_16x16x32_bf16 v[80:83], v[196:199], a[68:71], v[80:83]
ds_read_b64_tr_b16 v[180:181], v208 offset:9312
ds_read_b64_tr_b16 v[182:183], v208 offset:13920
v_mfma_f32_16x16x32_bf16 v[80:83], v[200:203], a[72:75], v[80:83]
ds_read_b64_tr_b16 v[184:185], v208 offset:18528
ds_read_b64_tr_b16 v[186:187], v208 offset:23136
v_mfma_f32_16x16x32_bf16 v[80:83], v[204:207], a[76:79], v[80:83]
ds_read_b64_tr_b16 v[188:189], v208 offset:27744
ds_read_b64_tr_b16 v[190:191], v208 offset:32352
v_mfma_f32_16x16x32_bf16 v[84:87], v[192:195], a[80:83], v[84:87]
v_mfma_f32_16x16x32_bf16 v[84:87], v[196:199], a[84:87], v[84:87]
v_mfma_f32_16x16x32_bf16 v[84:87], v[200:203], a[88:91], v[84:87]
v_mfma_f32_16x16x32_bf16 v[84:87], v[204:207], a[92:95], v[84:87]
v_mfma_f32_16x16x32_bf16 v[88:91], v[192:195], a[96:99], v[88:91]
v_mfma_f32_16x16x32_bf16 v[88:91], v[196:199], a[100:103], v[88:91]
v_mfma_f32_16x16x32_bf16 v[88:91], v[200:203], a[104:107], v[88:91]
v_mfma_f32_16x16x32_bf16 v[88:91], v[204:207], a[108:111], v[88:91]
v_mfma_f32_16x16x32_bf16 v[92:95], v[192:195], a[112:115], v[92:95]
v_cvt_pk_bf16_f32 v10, v40, v41
v_cvt_pk_bf16_f32 v11, v42, v43
v_mfma_f32_16x16x32_bf16 v[92:95], v[196:199], a[116:119], v[92:95]
v_cvt_pk_bf16_f32 v12, v56, v57
v_cvt_pk_bf16_f32 v13, v58, v59
v_mfma_f32_16x16x32_bf16 v[92:95], v[200:203], a[120:123], v[92:95]
buffer_store_dwordx4 v[10:13], v214, s[32:35], s89 offen sc1
v_mfma_f32_16x16x32_bf16 v[92:95], v[204:207], a[124:127], v[92:95]
s_waitcnt lgkmcnt(0)
v_mfma_f32_16x16x32_bf16 v[80:83], v[176:179], a[128:131], v[80:83]
ds_read_b64_tr_b16 v[192:193], v211 offset:128
ds_read_b64_tr_b16 v[194:195], v211 offset:4736
v_mfma_f32_16x16x32_bf16 v[80:83], v[180:183], a[132:135], v[80:83]
ds_read_b64_tr_b16 v[196:197], v211 offset:9344
ds_read_b64_tr_b16 v[198:199], v211 offset:13952
v_mfma_f32_16x16x32_bf16 v[80:83], v[184:187], a[136:139], v[80:83]
ds_read_b64_tr_b16 v[200:201], v211 offset:18560
ds_read_b64_tr_b16 v[202:203], v211 offset:23168
v_mfma_f32_16x16x32_bf16 v[80:83], v[188:191], a[140:143], v[80:83]
ds_read_b64_tr_b16 v[204:205], v211 offset:27776
ds_read_b64_tr_b16 v[206:207], v211 offset:32384
v_mfma_f32_16x16x32_bf16 v[84:87], v[176:179], a[144:147], v[84:87]
v_mfma_f32_16x16x32_bf16 v[84:87], v[180:183], a[148:151], v[84:87]
v_mfma_f32_16x16x32_bf16 v[84:87], v[184:187], a[152:155], v[84:87]
v_mfma_f32_16x16x32_bf16 v[84:87], v[188:191], a[156:159], v[84:87]
v_mfma_f32_16x16x32_bf16 v[88:91], v[176:179], a[160:163], v[88:91]
v_mfma_f32_16x16x32_bf16 v[88:91], v[180:183], a[164:167], v[88:91]
v_mfma_f32_16x16x32_bf16 v[88:91], v[184:187], a[168:171], v[88:91]
v_mfma_f32_16x16x32_bf16 v[88:91], v[188:191], a[172:175], v[88:91]
v_mfma_f32_16x16x32_bf16 v[92:95], v[176:179], a[176:179], v[92:95]
v_mfma_f32_16x16x32_bf16 v[92:95], v[180:183], a[180:183], v[92:95]
v_mfma_f32_16x16x32_bf16 v[92:95], v[184:187], a[184:187], v[92:95]
v_mfma_f32_16x16x32_bf16 v[92:95], v[188:191], a[188:191], v[92:95]
s_waitcnt lgkmcnt(0)
v_mfma_f32_16x16x32_bf16 v[96:99], v[192:195], a[64:67], v[96:99]
ds_read_b64_tr_b16 v[176:177], v208 offset:128
ds_read_b64_tr_b16 v[178:179], v208 offset:4736
v_mfma_f32_16x16x32_bf16 v[96:99], v[196:199], a[68:71], v[96:99]
ds_read_b64_tr_b16 v[180:181], v208 offset:9344
ds_read_b64_tr_b16 v[182:183], v208 offset:13952
v_mfma_f32_16x16x32_bf16 v[96:99], v[200:203], a[72:75], v[96:99]
ds_read_b64_tr_b16 v[184:185], v208 offset:18560
ds_read_b64_tr_b16 v[186:187], v208 offset:23168
v_mfma_f32_16x16x32_bf16 v[96:99], v[204:207], a[76:79], v[96:99]
ds_read_b64_tr_b16 v[188:189], v208 offset:27776
ds_read_b64_tr_b16 v[190:191], v208 offset:32384
v_mfma_f32_16x16x32_bf16 v[100:103], v[192:195], a[80:83], v[100:103]
v_cvt_pk_bf16_f32 v14, v44, v45
v_cvt_pk_bf16_f32 v15, v46, v47
v_mfma_f32_16x16x32_bf16 v[100:103], v[196:199], a[84:87], v[100:103]
v_cvt_pk_bf16_f32 v16, v60, v61
v_cvt_pk_bf16_f32 v17, v62, v63
v_mfma_f32_16x16x32_bf16 v[100:103], v[200:203], a[88:91], v[100:103]
buffer_store_dwordx4 v[14:17], v215, s[32:35], s89 offen sc1
v_mfma_f32_16x16x32_bf16 v[100:103], v[204:207], a[92:95], v[100:103]
v_mfma_f32_16x16x32_bf16 v[104:107], v[192:195], a[96:99], v[104:107]
v_mfma_f32_16x16x32_bf16 v[104:107], v[196:199], a[100:103], v[104:107]
v_mfma_f32_16x16x32_bf16 v[104:107], v[200:203], a[104:107], v[104:107]
v_mfma_f32_16x16x32_bf16 v[104:107], v[204:207], a[108:111], v[104:107]
v_mfma_f32_16x16x32_bf16 v[108:111], v[192:195], a[112:115], v[108:111]
v_mfma_f32_16x16x32_bf16 v[108:111], v[196:199], a[116:119], v[108:111]
v_mfma_f32_16x16x32_bf16 v[108:111], v[200:203], a[120:123], v[108:111]
v_mfma_f32_16x16x32_bf16 v[108:111], v[204:207], a[124:127], v[108:111]
s_waitcnt lgkmcnt(0)
v_mfma_f32_16x16x32_bf16 v[96:99], v[176:179], a[128:131], v[96:99]
ds_read_b64_tr_b16 v[192:193], v211 offset:160
ds_read_b64_tr_b16 v[194:195], v211 offset:4768
v_mfma_f32_16x16x32_bf16 v[96:99], v[180:183], a[132:135], v[96:99]
ds_read_b64_tr_b16 v[196:197], v211 offset:9376
ds_read_b64_tr_b16 v[198:199], v211 offset:13984
v_mfma_f32_16x16x32_bf16 v[96:99], v[184:187], a[136:139], v[96:99]
ds_read_b64_tr_b16 v[200:201], v211 offset:18592
ds_read_b64_tr_b16 v[202:203], v211 offset:23200
v_mfma_f32_16x16x32_bf16 v[96:99], v[188:191], a[140:143], v[96:99]
ds_read_b64_tr_b16 v[204:205], v211 offset:27808
ds_read_b64_tr_b16 v[206:207], v211 offset:32416
v_mfma_f32_16x16x32_bf16 v[100:103], v[176:179], a[144:147], v[100:103]
v_mfma_f32_16x16x32_bf16 v[100:103], v[180:183], a[148:151], v[100:103]
v_mfma_f32_16x16x32_bf16 v[100:103], v[184:187], a[152:155], v[100:103]
v_cvt_pk_bf16_f32 v2, v64, v65
v_cvt_pk_bf16_f32 v3, v66, v67
v_mfma_f32_16x16x32_bf16 v[100:103], v[188:191], a[156:159], v[100:103]
v_cvt_pk_bf16_f32 v4, v80, v81
v_cvt_pk_bf16_f32 v5, v82, v83
v_mfma_f32_16x16x32_bf16 v[104:107], v[176:179], a[160:163], v[104:107]
buffer_store_dwordx4 v[2:5], v212, s[32:35], s89 offen offset:1024 sc1
v_mfma_f32_16x16x32_bf16 v[104:107], v[180:183], a[164:167], v[104:107]
v_mfma_f32_16x16x32_bf16 v[104:107], v[184:187], a[168:171], v[104:107]
v_mfma_f32_16x16x32_bf16 v[104:107], v[188:191], a[172:175], v[104:107]
v_mfma_f32_16x16x32_bf16 v[108:111], v[176:179], a[176:179], v[108:111]
v_mfma_f32_16x16x32_bf16 v[108:111], v[180:183], a[180:183], v[108:111]
v_mfma_f32_16x16x32_bf16 v[108:111], v[184:187], a[184:187], v[108:111]
v_mfma_f32_16x16x32_bf16 v[108:111], v[188:191], a[188:191], v[108:111]
s_waitcnt lgkmcnt(0)
v_mfma_f32_16x16x32_bf16 v[112:115], v[192:195], a[64:67], v[112:115]
ds_read_b64_tr_b16 v[176:177], v208 offset:160
ds_read_b64_tr_b16 v[178:179], v208 offset:4768
v_mfma_f32_16x16x32_bf16 v[112:115], v[196:199], a[68:71], v[112:115]
ds_read_b64_tr_b16 v[180:181], v208 offset:9376
ds_read_b64_tr_b16 v[182:183], v208 offset:13984
v_mfma_f32_16x16x32_bf16 v[112:115], v[200:203], a[72:75], v[112:115]
ds_read_b64_tr_b16 v[184:185], v208 offset:18592
ds_read_b64_tr_b16 v[186:187], v208 offset:23200
v_mfma_f32_16x16x32_bf16 v[112:115], v[204:207], a[76:79], v[112:115]
ds_read_b64_tr_b16 v[188:189], v208 offset:27808
ds_read_b64_tr_b16 v[190:191], v208 offset:32416
v_mfma_f32_16x16x32_bf16 v[116:119], v[192:195], a[80:83], v[116:119]
v_mfma_f32_16x16x32_bf16 v[116:119], v[196:199], a[84:87], v[116:119]
v_mfma_f32_16x16x32_bf16 v[116:119], v[200:203], a[88:91], v[116:119]
v_mfma_f32_16x16x32_bf16 v[116:119], v[204:207], a[92:95], v[116:119]
v_mfma_f32_16x16x32_bf16 v[120:123], v[192:195], a[96:99], v[120:123]
v_mfma_f32_16x16x32_bf16 v[120:123], v[196:199], a[100:103], v[120:123]
v_mfma_f32_16x16x32_bf16 v[120:123], v[200:203], a[104:107], v[120:123]
v_mfma_f32_16x16x32_bf16 v[120:123], v[204:207], a[108:111], v[120:123]
v_cvt_pk_bf16_f32 v6, v68, v69
v_cvt_pk_bf16_f32 v7, v70, v71
v_mfma_f32_16x16x32_bf16 v[124:127], v[192:195], a[112:115], v[124:127]
v_cvt_pk_bf16_f32 v8, v84, v85
v_cvt_pk_bf16_f32 v9, v86, v87
v_mfma_f32_16x16x32_bf16 v[124:127], v[196:199], a[116:119], v[124:127]
buffer_store_dwordx4 v[6:9], v213, s[32:35], s89 offen offset:1024 sc1
v_mfma_f32_16x16x32_bf16 v[124:127], v[200:203], a[120:123], v[124:127]
v_mfma_f32_16x16x32_bf16 v[124:127], v[204:207], a[124:127], v[124:127]
s_waitcnt lgkmcnt(0)
v_mfma_f32_16x16x32_bf16 v[112:115], v[176:179], a[128:131], v[112:115]
ds_read_b64_tr_b16 v[192:193], v211 offset:192
ds_read_b64_tr_b16 v[194:195], v211 offset:4800
v_mfma_f32_16x16x32_bf16 v[112:115], v[180:183], a[132:135], v[112:115]
ds_read_b64_tr_b16 v[196:197], v211 offset:9408
ds_read_b64_tr_b16 v[198:199], v211 offset:14016
v_mfma_f32_16x16x32_bf16 v[112:115], v[184:187], a[136:139], v[112:115]
ds_read_b64_tr_b16 v[200:201], v211 offset:18624
ds_read_b64_tr_b16 v[202:203], v211 offset:23232
v_mfma_f32_16x16x32_bf16 v[112:115], v[188:191], a[140:143], v[112:115]
ds_read_b64_tr_b16 v[204:205], v211 offset:27840
ds_read_b64_tr_b16 v[206:207], v211 offset:32448
v_mfma_f32_16x16x32_bf16 v[116:119], v[176:179], a[144:147], v[116:119]
v_mfma_f32_16x16x32_bf16 v[116:119], v[180:183], a[148:151], v[116:119]
v_mfma_f32_16x16x32_bf16 v[116:119], v[184:187], a[152:155], v[116:119]
v_mfma_f32_16x16x32_bf16 v[116:119], v[188:191], a[156:159], v[116:119]
v_mfma_f32_16x16x32_bf16 v[120:123], v[176:179], a[160:163], v[120:123]
v_mfma_f32_16x16x32_bf16 v[120:123], v[180:183], a[164:167], v[120:123]
v_mfma_f32_16x16x32_bf16 v[120:123], v[184:187], a[168:171], v[120:123]
v_mfma_f32_16x16x32_bf16 v[120:123], v[188:191], a[172:175], v[120:123]
v_mfma_f32_16x16x32_bf16 v[124:127], v[176:179], a[176:179], v[124:127]
v_mfma_f32_16x16x32_bf16 v[124:127], v[180:183], a[180:183], v[124:127]
v_mfma_f32_16x16x32_bf16 v[124:127], v[184:187], a[184:187], v[124:127]
v_mfma_f32_16x16x32_bf16 v[124:127], v[188:191], a[188:191], v[124:127]
s_waitcnt lgkmcnt(0)
v_mfma_f32_16x16x32_bf16 v[128:131], v[192:195], a[64:67], v[128:131]
ds_read_b64_tr_b16 v[176:177], v208 offset:192
ds_read_b64_tr_b16 v[178:179], v208 offset:4800
v_mfma_f32_16x16x32_bf16 v[128:131], v[196:199], a[68:71], v[128:131]
ds_read_b64_tr_b16 v[180:181], v208 offset:9408
ds_read_b64_tr_b16 v[182:183], v208 offset:14016
v_mfma_f32_16x16x32_bf16 v[128:131], v[200:203], a[72:75], v[128:131]
ds_read_b64_tr_b16 v[184:185], v208 offset:18624
ds_read_b64_tr_b16 v[186:187], v208 offset:23232
v_mfma_f32_16x16x32_bf16 v[128:131], v[204:207], a[76:79], v[128:131]
ds_read_b64_tr_b16 v[188:189], v208 offset:27840
ds_read_b64_tr_b16 v[190:191], v208 offset:32448
v_mfma_f32_16x16x32_bf16 v[132:135], v[192:195], a[80:83], v[132:135]
v_cvt_pk_bf16_f32 v10, v72, v73
v_cvt_pk_bf16_f32 v11, v74, v75
v_mfma_f32_16x16x32_bf16 v[132:135], v[196:199], a[84:87], v[132:135]
v_cvt_pk_bf16_f32 v12, v88, v89
v_cvt_pk_bf16_f32 v13, v90, v91
v_mfma_f32_16x16x32_bf16 v[132:135], v[200:203], a[88:91], v[132:135]
buffer_store_dwordx4 v[10:13], v214, s[32:35], s89 offen offset:1024 sc1
v_mfma_f32_16x16x32_bf16 v[132:135], v[204:207], a[92:95], v[132:135]
v_mfma_f32_16x16x32_bf16 v[136:139], v[192:195], a[96:99], v[136:139]
v_mfma_f32_16x16x32_bf16 v[136:139], v[196:199], a[100:103], v[136:139]
v_mfma_f32_16x16x32_bf16 v[136:139], v[200:203], a[104:107], v[136:139]
v_mfma_f32_16x16x32_bf16 v[136:139], v[204:207], a[108:111], v[136:139]
v_mfma_f32_16x16x32_bf16 v[140:143], v[192:195], a[112:115], v[140:143]
v_mfma_f32_16x16x32_bf16 v[140:143], v[196:199], a[116:119], v[140:143]
v_mfma_f32_16x16x32_bf16 v[140:143], v[200:203], a[120:123], v[140:143]
v_mfma_f32_16x16x32_bf16 v[140:143], v[204:207], a[124:127], v[140:143]
s_waitcnt lgkmcnt(0)
v_mfma_f32_16x16x32_bf16 v[128:131], v[176:179], a[128:131], v[128:131]
ds_read_b64_tr_b16 v[192:193], v211 offset:224
ds_read_b64_tr_b16 v[194:195], v211 offset:4832
v_mfma_f32_16x16x32_bf16 v[128:131], v[180:183], a[132:135], v[128:131]
ds_read_b64_tr_b16 v[196:197], v211 offset:9440
ds_read_b64_tr_b16 v[198:199], v211 offset:14048
v_mfma_f32_16x16x32_bf16 v[128:131], v[184:187], a[136:139], v[128:131]
ds_read_b64_tr_b16 v[200:201], v211 offset:18656
ds_read_b64_tr_b16 v[202:203], v211 offset:23264
v_mfma_f32_16x16x32_bf16 v[128:131], v[188:191], a[140:143], v[128:131]
ds_read_b64_tr_b16 v[204:205], v211 offset:27872
ds_read_b64_tr_b16 v[206:207], v211 offset:32480
v_mfma_f32_16x16x32_bf16 v[132:135], v[176:179], a[144:147], v[132:135]
v_mfma_f32_16x16x32_bf16 v[132:135], v[180:183], a[148:151], v[132:135]
v_cvt_pk_bf16_f32 v14, v76, v77
v_cvt_pk_bf16_f32 v15, v78, v79
v_mfma_f32_16x16x32_bf16 v[132:135], v[184:187], a[152:155], v[132:135]
v_cvt_pk_bf16_f32 v16, v92, v93
v_cvt_pk_bf16_f32 v17, v94, v95
v_mfma_f32_16x16x32_bf16 v[132:135], v[188:191], a[156:159], v[132:135]
buffer_store_dwordx4 v[14:17], v215, s[32:35], s89 offen offset:1024 sc1
v_mfma_f32_16x16x32_bf16 v[136:139], v[176:179], a[160:163], v[136:139]
v_mfma_f32_16x16x32_bf16 v[136:139], v[180:183], a[164:167], v[136:139]
v_mfma_f32_16x16x32_bf16 v[136:139], v[184:187], a[168:171], v[136:139]
v_mfma_f32_16x16x32_bf16 v[136:139], v[188:191], a[172:175], v[136:139]
v_mfma_f32_16x16x32_bf16 v[140:143], v[176:179], a[176:179], v[140:143]
v_mfma_f32_16x16x32_bf16 v[140:143], v[180:183], a[180:183], v[140:143]
v_mfma_f32_16x16x32_bf16 v[140:143], v[184:187], a[184:187], v[140:143]
v_mfma_f32_16x16x32_bf16 v[140:143], v[188:191], a[188:191], v[140:143]
s_waitcnt lgkmcnt(0)
v_mfma_f32_16x16x32_bf16 v[144:147], v[192:195], a[64:67], v[144:147]
ds_read_b64_tr_b16 v[176:177], v208 offset:224
ds_read_b64_tr_b16 v[178:179], v208 offset:4832
v_mfma_f32_16x16x32_bf16 v[144:147], v[196:199], a[68:71], v[144:147]
ds_read_b64_tr_b16 v[180:181], v208 offset:9440
ds_read_b64_tr_b16 v[182:183], v208 offset:14048
v_mfma_f32_16x16x32_bf16 v[144:147], v[200:203], a[72:75], v[144:147]
ds_read_b64_tr_b16 v[184:185], v208 offset:18656
ds_read_b64_tr_b16 v[186:187], v208 offset:23264
v_mfma_f32_16x16x32_bf16 v[144:147], v[204:207], a[76:79], v[144:147]
ds_read_b64_tr_b16 v[188:189], v208 offset:27872
ds_read_b64_tr_b16 v[190:191], v208 offset:32480
v_mfma_f32_16x16x32_bf16 v[148:151], v[192:195], a[80:83], v[148:151]
v_mfma_f32_16x16x32_bf16 v[148:151], v[196:199], a[84:87], v[148:151]
v_mfma_f32_16x16x32_bf16 v[148:151], v[200:203], a[88:91], v[148:151]
v_mfma_f32_16x16x32_bf16 v[148:151], v[204:207], a[92:95], v[148:151]
v_mfma_f32_16x16x32_bf16 v[152:155], v[192:195], a[96:99], v[152:155]
v_mfma_f32_16x16x32_bf16 v[152:155], v[196:199], a[100:103], v[152:155]
v_mfma_f32_16x16x32_bf16 v[152:155], v[200:203], a[104:107], v[152:155]
v_cvt_pk_bf16_f32 v2, v96, v97
v_cvt_pk_bf16_f32 v3, v98, v99
v_mfma_f32_16x16x32_bf16 v[152:155], v[204:207], a[108:111], v[152:155]
v_cvt_pk_bf16_f32 v4, v112, v113
v_cvt_pk_bf16_f32 v5, v114, v115
v_mfma_f32_16x16x32_bf16 v[156:159], v[192:195], a[112:115], v[156:159]
buffer_store_dwordx4 v[2:5], v212, s[32:35], s89 offen offset:2048 sc1
v_mfma_f32_16x16x32_bf16 v[156:159], v[196:199], a[116:119], v[156:159]
v_mfma_f32_16x16x32_bf16 v[156:159], v[200:203], a[120:123], v[156:159]
v_mfma_f32_16x16x32_bf16 v[156:159], v[204:207], a[124:127], v[156:159]
s_waitcnt lgkmcnt(0)
v_mfma_f32_16x16x32_bf16 v[144:147], v[176:179], a[128:131], v[144:147]
ds_read_b64_tr_b16 v[192:193], v211 offset:256
ds_read_b64_tr_b16 v[194:195], v211 offset:4864
v_mfma_f32_16x16x32_bf16 v[144:147], v[180:183], a[132:135], v[144:147]
ds_read_b64_tr_b16 v[196:197], v211 offset:9472
ds_read_b64_tr_b16 v[198:199], v211 offset:14080
v_mfma_f32_16x16x32_bf16 v[144:147], v[184:187], a[136:139], v[144:147]
ds_read_b64_tr_b16 v[200:201], v211 offset:18688
ds_read_b64_tr_b16 v[202:203], v211 offset:23296
v_mfma_f32_16x16x32_bf16 v[144:147], v[188:191], a[140:143], v[144:147]
ds_read_b64_tr_b16 v[204:205], v211 offset:27904
ds_read_b64_tr_b16 v[206:207], v211 offset:32512
v_mfma_f32_16x16x32_bf16 v[148:151], v[176:179], a[144:147], v[148:151]
v_mfma_f32_16x16x32_bf16 v[148:151], v[180:183], a[148:151], v[148:151]
v_mfma_f32_16x16x32_bf16 v[148:151], v[184:187], a[152:155], v[148:151]
v_mfma_f32_16x16x32_bf16 v[148:151], v[188:191], a[156:159], v[148:151]
v_mfma_f32_16x16x32_bf16 v[152:155], v[176:179], a[160:163], v[152:155]
v_mfma_f32_16x16x32_bf16 v[152:155], v[180:183], a[164:167], v[152:155]
v_mfma_f32_16x16x32_bf16 v[152:155], v[184:187], a[168:171], v[152:155]
v_mfma_f32_16x16x32_bf16 v[152:155], v[188:191], a[172:175], v[152:155]
v_mfma_f32_16x16x32_bf16 v[156:159], v[176:179], a[176:179], v[156:159]
v_mfma_f32_16x16x32_bf16 v[156:159], v[180:183], a[180:183], v[156:159]
v_mfma_f32_16x16x32_bf16 v[156:159], v[184:187], a[184:187], v[156:159]
v_mfma_f32_16x16x32_bf16 v[156:159], v[188:191], a[188:191], v[156:159]
s_waitcnt lgkmcnt(0)
v_mfma_f32_16x16x32_bf16 v[160:163], v[192:195], a[64:67], v[160:163]
ds_read_b64_tr_b16 v[176:177], v208 offset:256
ds_read_b64_tr_b16 v[178:179], v208 offset:4864
v_mfma_f32_16x16x32_bf16 v[160:163], v[196:199], a[68:71], v[160:163]
ds_read_b64_tr_b16 v[180:181], v208 offset:9472
ds_read_b64_tr_b16 v[182:183], v208 offset:14080
v_mfma_f32_16x16x32_bf16 v[160:163], v[200:203], a[72:75], v[160:163]
ds_read_b64_tr_b16 v[184:185], v208 offset:18688
ds_read_b64_tr_b16 v[186:187], v208 offset:23296
v_mfma_f32_16x16x32_bf16 v[160:163], v[204:207], a[76:79], v[160:163]
ds_read_b64_tr_b16 v[188:189], v208 offset:27904
ds_read_b64_tr_b16 v[190:191], v208 offset:32512
v_mfma_f32_16x16x32_bf16 v[164:167], v[192:195], a[80:83], v[164:167]
v_cvt_pk_bf16_f32 v6, v100, v101
v_cvt_pk_bf16_f32 v7, v102, v103
v_mfma_f32_16x16x32_bf16 v[164:167], v[196:199], a[84:87], v[164:167]
v_cvt_pk_bf16_f32 v8, v116, v117
v_cvt_pk_bf16_f32 v9, v118, v119
v_mfma_f32_16x16x32_bf16 v[164:167], v[200:203], a[88:91], v[164:167]
buffer_store_dwordx4 v[6:9], v213, s[32:35], s89 offen offset:2048 sc1
v_mfma_f32_16x16x32_bf16 v[164:167], v[204:207], a[92:95], v[164:167]
v_mfma_f32_16x16x32_bf16 v[168:171], v[192:195], a[96:99], v[168:171]
v_mfma_f32_16x16x32_bf16 v[168:171], v[196:199], a[100:103], v[168:171]
v_mfma_f32_16x16x32_bf16 v[168:171], v[200:203], a[104:107], v[168:171]
v_mfma_f32_16x16x32_bf16 v[168:171], v[204:207], a[108:111], v[168:171]
v_mfma_f32_16x16x32_bf16 v[172:175], v[192:195], a[112:115], v[172:175]
v_mfma_f32_16x16x32_bf16 v[172:175], v[196:199], a[116:119], v[172:175]
v_mfma_f32_16x16x32_bf16 v[172:175], v[200:203], a[120:123], v[172:175]
v_mfma_f32_16x16x32_bf16 v[172:175], v[204:207], a[124:127], v[172:175]
s_waitcnt lgkmcnt(0)
v_mfma_f32_16x16x32_bf16 v[160:163], v[176:179], a[128:131], v[160:163]
v_mfma_f32_16x16x32_bf16 v[160:163], v[180:183], a[132:135], v[160:163]
v_mfma_f32_16x16x32_bf16 v[160:163], v[184:187], a[136:139], v[160:163]
v_mfma_f32_16x16x32_bf16 v[160:163], v[188:191], a[140:143], v[160:163]
v_mfma_f32_16x16x32_bf16 v[164:167], v[176:179], a[144:147], v[164:167]
v_cvt_pk_bf16_f32 v10, v104, v105
v_cvt_pk_bf16_f32 v11, v106, v107
v_mfma_f32_16x16x32_bf16 v[164:167], v[180:183], a[148:151], v[164:167]
v_cvt_pk_bf16_f32 v12, v120, v121
v_cvt_pk_bf16_f32 v13, v122, v123
v_mfma_f32_16x16x32_bf16 v[164:167], v[184:187], a[152:155], v[164:167]
buffer_store_dwordx4 v[10:13], v214, s[32:35], s89 offen offset:2048 sc1
v_mfma_f32_16x16x32_bf16 v[164:167], v[188:191], a[156:159], v[164:167]
v_mfma_f32_16x16x32_bf16 v[168:171], v[176:179], a[160:163], v[168:171]
v_mfma_f32_16x16x32_bf16 v[168:171], v[180:183], a[164:167], v[168:171]
v_mfma_f32_16x16x32_bf16 v[168:171], v[184:187], a[168:171], v[168:171]
v_mfma_f32_16x16x32_bf16 v[168:171], v[188:191], a[172:175], v[168:171]
v_mfma_f32_16x16x32_bf16 v[172:175], v[176:179], a[176:179], v[172:175]
v_mfma_f32_16x16x32_bf16 v[172:175], v[180:183], a[180:183], v[172:175]
v_mfma_f32_16x16x32_bf16 v[172:175], v[184:187], a[184:187], v[172:175]
v_mfma_f32_16x16x32_bf16 v[172:175], v[188:191], a[188:191], v[172:175]
s_nop 7
v_cvt_pk_bf16_f32 v14, v108, v109
v_cvt_pk_bf16_f32 v15, v110, v111
v_cvt_pk_bf16_f32 v16, v124, v125
v_cvt_pk_bf16_f32 v17, v126, v127
buffer_store_dwordx4 v[14:17], v215, s[32:35], s89 offen offset:2048 sc1
v_cvt_pk_bf16_f32 v2, v128, v129
v_cvt_pk_bf16_f32 v3, v130, v131
v_cvt_pk_bf16_f32 v4, v144, v145
v_cvt_pk_bf16_f32 v5, v146, v147
buffer_store_dwordx4 v[2:5], v212, s[32:35], s89 offen offset:3072 sc1
v_cvt_pk_bf16_f32 v6, v132, v133
v_cvt_pk_bf16_f32 v7, v134, v135
v_cvt_pk_bf16_f32 v8, v148, v149
v_cvt_pk_bf16_f32 v9, v150, v151
buffer_store_dwordx4 v[6:9], v213, s[32:35], s89 offen offset:3072 sc1
v_cvt_pk_bf16_f32 v10, v136, v137
v_cvt_pk_bf16_f32 v11, v138, v139
v_cvt_pk_bf16_f32 v12, v152, v153
v_cvt_pk_bf16_f32 v13, v154, v155
buffer_store_dwordx4 v[10:13], v214, s[32:35], s89 offen offset:3072 sc1
v_cvt_pk_bf16_f32 v14, v140, v141
v_cvt_pk_bf16_f32 v15, v142, v143
v_cvt_pk_bf16_f32 v16, v156, v157
v_cvt_pk_bf16_f32 v17, v158, v159
buffer_store_dwordx4 v[14:17], v215, s[32:35], s89 offen offset:3072 sc1
s_add_u32 s89, s89, 0x4000
v_cvt_pk_bf16_f32 v2, v160, v161
v_cvt_pk_bf16_f32 v3, v162, v163
v_cvt_pk_bf16_f32 v4, v164, v165
v_cvt_pk_bf16_f32 v5, v166, v167
buffer_store_dwordx4 v[2:5], v18, s[32:35], s89 offen sc1
v_cvt_pk_bf16_f32 v6, v168, v169
v_cvt_pk_bf16_f32 v7, v170, v171
v_cvt_pk_bf16_f32 v8, v172, v173
v_cvt_pk_bf16_f32 v9, v174, v175
buffer_store_dwordx4 v[6:9], v18, s[32:35], s89 offen offset:1024 sc1
recurrent_scan__gqa_block_cached__glu_gated_reglu__prompt_kernel_fin:
s_mov_b32 s80, s68
s_mov_b32 s81, s69
s_mov_b32 s82, 0x240000
s_mov_b32 s83, 0x20000
s_and_b32 s47, s84, 1
s_lshl_b32 s47, s47, 1
s_lshr_b32 s55, s44, 1
s_add_u32 s47, s47, s55
s_and_b32 s48, s44, 1
s_lshl_b32 s49, s85, 2
s_lshr_b32 s55, s84, 1
s_add_u32 s49, s49, s55
s_lshl_b32 s55, s49, 2
s_add_u32 s55, s55, s86
s_mul_i32 s50, s55, 0x4800
s_lshr_b32 s55, s47, 1
s_lshl_b32 s55, s55, 10
s_and_b32 s56, s47, 1
s_lshl_b32 s56, s56, 3
s_add_u32 s55, s55, s56
s_add_u32 s51, s50, s55
s_add_u32 s51, s51, 0x4000
s_lshl_b32 s55, s47, 12
s_add_u32 s50, s50, s55
s_lshl_b32 s55, s48, 11
s_add_u32 s50, s50, s55
v_and_b32 v4, 15, v1
v_mul_u32_u24 v3, 0x480, v4
v_lshrrev_b32 v4, 4, v1
v_lshl_add_u32 v3, v4, 3, v3
s_lshl_b32 s55, s49, 2
s_add_u32 s55, s55, s47
s_mul_i32 s52, s55, 0x4800
s_mul_i32 s55, s86, 0x120
s_add_u32 s52, s52, s55
s_add_u32 s53, s52, 0x100
s_lshl_b32 s55, s48, 7
s_add_u32 s52, s52, s55
buffer_load_dwordx2 v[160:161], v3, s[76:79], s52 offen
buffer_load_dwordx2 v[162:163], v3, s[76:79], s52 offen offset:32
buffer_load_dwordx2 v[164:165], v3, s[76:79], s52 offen offset:64
buffer_load_dwordx2 v[166:167], v3, s[76:79], s52 offen offset:96
buffer_load_dwordx2 v[168:169], v3, s[76:79], s53 offen
s_waitcnt vmcnt(5)
s_barrier
s_add_u32 s56, s86, 3
s_mov_b32 s54, s56
s_cmp_eq_u32 s48, 0
s_cselect_b32 s51, 0x7ff00000, s51
s_cmp_lg_u32 s44, 0
s_cbranch_scc1 recurrent_scan__gqa_block_cached__glu_gated_reglu__prompt_kernel_sig21
s_lshl_b32 s90, s85, 3
s_add_u32 s90, s90, s54
s_lshl_b32 s90, s90, 2
v_mov_b32 v12, s90
v_mov_b32 v13, 1
s_mov_b64 exec, 1
buffer_atomic_add v13, v12, s[72:75], 0 offen sc1
s_mov_b64 exec, -1
recurrent_scan__gqa_block_cached__glu_gated_reglu__prompt_kernel_sig21:
s_cmp_lg_u32 s44, 0
s_cbranch_scc1 recurrent_scan__gqa_block_cached__glu_gated_reglu__prompt_kernel_got24
s_lshl_b32 s90, s85, 3
s_add_u32 s90, s90, s54
s_lshl_b32 s90, s90, 2
v_mov_b32 v12, s90
s_mov_b32 s90, 262144
recurrent_scan__gqa_block_cached__glu_gated_reglu__prompt_kernel_poll22:
buffer_load_dword v13, v12, s[72:75], 0 offen sc1
s_waitcnt vmcnt(0)
recurrent_scan__gqa_block_cached__glu_gated_reglu__prompt_kernel_pchk23:
v_readfirstlane_b32 s55, v13
s_nop 3
s_cmp_ge_u32 s55, 8
s_cbranch_scc1 recurrent_scan__gqa_block_cached__glu_gated_reglu__prompt_kernel_got24
s_sleep 1
s_sub_u32 s90, s90, 1
s_cmp_lg_u32 s90, 0
s_cbranch_scc1 recurrent_scan__gqa_block_cached__glu_gated_reglu__prompt_kernel_poll22
recurrent_scan__gqa_block_cached__glu_gated_reglu__prompt_kernel_got24:
s_barrier
s_mov_b32 s55, s50
buffer_load_dwordx4 v[24:27], v18, s[32:35], s55 offen sc1
s_add_u32 s55, s55, 0x240000
buffer_load_dwordx4 v[32:35], v18, s[32:35], s55 offen sc1
s_add_u32 s55, s55, 0x240000
buffer_load_dwordx4 v[40:43], v18, s[32:35], s55 offen sc1
s_add_u32 s55, s55, 0x240000
buffer_load_dwordx4 v[48:51], v18, s[32:35], s55 offen sc1
s_add_u32 s55, s55, 0x240000
buffer_load_dwordx4 v[56:59], v18, s[32:35], s55 offen sc1
s_add_u32 s55, s55, 0x240000
buffer_load_dwordx4 v[64:67], v18, s[32:35], s55 offen sc1
s_add_u32 s55, s55, 0x240000
buffer_load_dwordx4 v[72:75], v18, s[32:35], s55 offen sc1
s_add_u32 s55, s55, 0x240000
buffer_load_dwordx4 v[80:83], v18, s[32:35], s55 offen sc1
s_add_u32 s55, s50, 0x400
buffer_load_dwordx4 v[28:31], v18, s[32:35], s55 offen sc1
s_add_u32 s55, s55, 0x240000
buffer_load_dwordx4 v[36:39], v18, s[32:35], s55 offen sc1
s_add_u32 s55, s55, 0x240000
buffer_load_dwordx4 v[44:47], v18, s[32:35], s55 offen sc1
s_add_u32 s55, s55, 0x240000
buffer_load_dwordx4 v[52:55], v18, s[32:35], s55 offen sc1
s_add_u32 s55, s55, 0x240000
buffer_load_dwordx4 v[60:63], v18, s[32:35], s55 offen sc1
s_add_u32 s55, s55, 0x240000
buffer_load_dwordx4 v[68:71], v18, s[32:35], s55 offen sc1
s_add_u32 s55, s55, 0x240000
buffer_load_dwordx4 v[76:79], v18, s[32:35], s55 offen sc1
s_add_u32 s55, s55, 0x240000
buffer_load_dwordx4 v[84:87], v18, s[32:35], s55 offen sc1
s_mov_b32 s55, s51
buffer_load_dwordx2 v[88:89], v18, s[32:35], s55 offen sc1
s_add_u32 s55, s55, 0x240000
buffer_load_dwordx2 v[90:91], v18, s[32:35], s55 offen sc1
s_add_u32 s55, s55, 0x240000
buffer_load_dwordx2 v[92:93], v18, s[32:35], s55 offen sc1
s_add_u32 s55, s55, 0x240000
buffer_load_dwordx2 v[94:95], v18, s[32:35], s55 offen sc1
s_add_u32 s55, s55, 0x240000
buffer_load_dwordx2 v[96:97], v18, s[32:35], s55 offen sc1
s_add_u32 s55, s55, 0x240000
buffer_load_dwordx2 v[98:99], v18, s[32:35], s55 offen sc1
s_add_u32 s55, s55, 0x240000
buffer_load_dwordx2 v[100:101], v18, s[32:35], s55 offen sc1
s_add_u32 s55, s55, 0x240000
buffer_load_dwordx2 v[102:103], v18, s[32:35], s55 offen sc1
s_mov_b32 s57, 0xffff0000
s_mov_b32 s58, 0xbfb8aa3b
s_waitcnt vmcnt(16)
v_lshlrev_b32 v180, 16, v24
v_and_b32 v181, s57, v24
v_lshlrev_b32 v182, 16, v25
v_and_b32 v183, s57, v25
v_lshlrev_b32 v188, 16, v32
v_and_b32 v189, s57, v32
v_lshlrev_b32 v190, 16, v33
v_and_b32 v191, s57, v33
v_pk_add_f32 v[180:181], v[180:181], v[188:189]
v_pk_add_f32 v[182:183], v[182:183], v[190:191]
v_lshlrev_b32 v188, 16, v40
v_and_b32 v189, s57, v40
v_lshlrev_b32 v190, 16, v41
v_and_b32 v191, s57, v41
v_pk_add_f32 v[180:181], v[180:181], v[188:189]
v_pk_add_f32 v[182:183], v[182:183], v[190:191]
v_lshlrev_b32 v188, 16, v48
v_and_b32 v189, s57, v48
v_lshlrev_b32 v190, 16, v49
v_and_b32 v191, s57, v49
v_pk_add_f32 v[180:181], v[180:181], v[188:189]
v_pk_add_f32 v[182:183], v[182:183], v[190:191]
v_lshlrev_b32 v184, 16, v56
v_and_b32 v185, s57, v56
v_lshlrev_b32 v186, 16, v57
v_and_b32 v187, s57, v57
v_lshlrev_b32 v188, 16, v64
v_and_b32 v189, s57, v64
v_lshlrev_b32 v190, 16, v65
v_and_b32 v191, s57, v65
v_pk_add_f32 v[184:185], v[184:185], v[188:189]
v_pk_add_f32 v[186:187], v[186:187], v[190:191]
v_lshlrev_b32 v188, 16, v72
v_and_b32 v189, s57, v72
v_lshlrev_b32 v190, 16, v73
v_and_b32 v191, s57, v73
v_pk_add_f32 v[184:185], v[184:185], v[188:189]
v_pk_add_f32 v[186:187], v[186:187], v[190:191]
v_lshlrev_b32 v188, 16, v80
v_and_b32 v189, s57, v80
v_lshlrev_b32 v190, 16, v81
v_and_b32 v191, s57, v81
v_pk_add_f32 v[184:185], v[184:185], v[188:189]
v_pk_add_f32 v[186:187], v[186:187], v[190:191]
v_mul_f32 v192, s58, v184
v_mul_f32 v193, s58, v185
v_mul_f32 v194, s58, v186
v_mul_f32 v195, s58, v187
v_exp_f32 v192, v192
v_exp_f32 v193, v193
v_exp_f32 v194, v194
v_exp_f32 v195, v195
s_nop 0
v_add_f32 v192, 1.0, v192
v_add_f32 v193, 1.0, v193
v_add_f32 v194, 1.0, v194
v_add_f32 v195, 1.0, v195
v_rcp_f32 v192, v192
v_rcp_f32 v193, v193
v_rcp_f32 v194, v194
v_rcp_f32 v195, v195
s_nop 0
v_mul_f32 v184, v184, v192
v_mul_f32 v185, v185, v193
v_mul_f32 v186, v186, v194
v_mul_f32 v187, v187, v195
v_lshlrev_b32 v188, 16, v160
v_and_b32 v189, s57, v160
v_lshlrev_b32 v190, 16, v161
v_and_b32 v191, s57, v161
v_fmac_f32 v188, v180, v184
v_fmac_f32 v189, v181, v185
v_fmac_f32 v190, v182, v186
v_fmac_f32 v191, v183, v187
v_cvt_pk_bf16_f32 v160, v188, v189
v_cvt_pk_bf16_f32 v161, v190, v191
buffer_store_dwordx2 v[160:161], v3, s[80:83], s52 offen sc1
v_lshlrev_b32 v180, 16, v26
v_and_b32 v181, s57, v26
v_lshlrev_b32 v182, 16, v27
v_and_b32 v183, s57, v27
v_lshlrev_b32 v188, 16, v34
v_and_b32 v189, s57, v34
v_lshlrev_b32 v190, 16, v35
v_and_b32 v191, s57, v35
v_pk_add_f32 v[180:181], v[180:181], v[188:189]
v_pk_add_f32 v[182:183], v[182:183], v[190:191]
v_lshlrev_b32 v188, 16, v42
v_and_b32 v189, s57, v42
v_lshlrev_b32 v190, 16, v43
v_and_b32 v191, s57, v43
v_pk_add_f32 v[180:181], v[180:181], v[188:189]
v_pk_add_f32 v[182:183], v[182:183], v[190:191]
v_lshlrev_b32 v188, 16, v50
v_and_b32 v189, s57, v50
v_lshlrev_b32 v190, 16, v51
v_and_b32 v191, s57, v51
v_pk_add_f32 v[180:181], v[180:181], v[188:189]
v_pk_add_f32 v[182:183], v[182:183], v[190:191]
v_lshlrev_b32 v184, 16, v58
v_and_b32 v185, s57, v58
v_lshlrev_b32 v186, 16, v59
v_and_b32 v187, s57, v59
v_lshlrev_b32 v188, 16, v66
v_and_b32 v189, s57, v66
v_lshlrev_b32 v190, 16, v67
v_and_b32 v191, s57, v67
v_pk_add_f32 v[184:185], v[184:185], v[188:189]
v_pk_add_f32 v[186:187], v[186:187], v[190:191]
v_lshlrev_b32 v188, 16, v74
v_and_b32 v189, s57, v74
v_lshlrev_b32 v190, 16, v75
v_and_b32 v191, s57, v75
v_pk_add_f32 v[184:185], v[184:185], v[188:189]
v_pk_add_f32 v[186:187], v[186:187], v[190:191]
v_lshlrev_b32 v188, 16, v82
v_and_b32 v189, s57, v82
v_lshlrev_b32 v190, 16, v83
v_and_b32 v191, s57, v83
v_pk_add_f32 v[184:185], v[184:185], v[188:189]
v_pk_add_f32 v[186:187], v[186:187], v[190:191]
v_mul_f32 v192, s58, v184
v_mul_f32 v193, s58, v185
v_mul_f32 v194, s58, v186
v_mul_f32 v195, s58, v187
v_exp_f32 v192, v192
v_exp_f32 v193, v193
v_exp_f32 v194, v194
v_exp_f32 v195, v195
s_nop 0
v_add_f32 v192, 1.0, v192
v_add_f32 v193, 1.0, v193
v_add_f32 v194, 1.0, v194
v_add_f32 v195, 1.0, v195
v_rcp_f32 v192, v192
v_rcp_f32 v193, v193
v_rcp_f32 v194, v194
v_rcp_f32 v195, v195
s_nop 0
v_mul_f32 v184, v184, v192
v_mul_f32 v185, v185, v193
v_mul_f32 v186, v186, v194
v_mul_f32 v187, v187, v195
v_lshlrev_b32 v188, 16, v162
v_and_b32 v189, s57, v162
v_lshlrev_b32 v190, 16, v163
v_and_b32 v191, s57, v163
v_fmac_f32 v188, v180, v184
v_fmac_f32 v189, v181, v185
v_fmac_f32 v190, v182, v186
v_fmac_f32 v191, v183, v187
v_cvt_pk_bf16_f32 v162, v188, v189
v_cvt_pk_bf16_f32 v163, v190, v191
buffer_store_dwordx2 v[162:163], v3, s[80:83], s52 offen offset:32 sc1
s_waitcnt vmcnt(10)
v_lshlrev_b32 v180, 16, v28
v_and_b32 v181, s57, v28
v_lshlrev_b32 v182, 16, v29
v_and_b32 v183, s57, v29
v_lshlrev_b32 v188, 16, v36
v_and_b32 v189, s57, v36
v_lshlrev_b32 v190, 16, v37
v_and_b32 v191, s57, v37
v_pk_add_f32 v[180:181], v[180:181], v[188:189]
v_pk_add_f32 v[182:183], v[182:183], v[190:191]
v_lshlrev_b32 v188, 16, v44
v_and_b32 v189, s57, v44
v_lshlrev_b32 v190, 16, v45
v_and_b32 v191, s57, v45
v_pk_add_f32 v[180:181], v[180:181], v[188:189]
v_pk_add_f32 v[182:183], v[182:183], v[190:191]
v_lshlrev_b32 v188, 16, v52
v_and_b32 v189, s57, v52
v_lshlrev_b32 v190, 16, v53
v_and_b32 v191, s57, v53
v_pk_add_f32 v[180:181], v[180:181], v[188:189]
v_pk_add_f32 v[182:183], v[182:183], v[190:191]
v_lshlrev_b32 v184, 16, v60
v_and_b32 v185, s57, v60
v_lshlrev_b32 v186, 16, v61
v_and_b32 v187, s57, v61
v_lshlrev_b32 v188, 16, v68
v_and_b32 v189, s57, v68
v_lshlrev_b32 v190, 16, v69
v_and_b32 v191, s57, v69
v_pk_add_f32 v[184:185], v[184:185], v[188:189]
v_pk_add_f32 v[186:187], v[186:187], v[190:191]
v_lshlrev_b32 v188, 16, v76
v_and_b32 v189, s57, v76
v_lshlrev_b32 v190, 16, v77
v_and_b32 v191, s57, v77
v_pk_add_f32 v[184:185], v[184:185], v[188:189]
v_pk_add_f32 v[186:187], v[186:187], v[190:191]
v_lshlrev_b32 v188, 16, v84
v_and_b32 v189, s57, v84
v_lshlrev_b32 v190, 16, v85
v_and_b32 v191, s57, v85
v_pk_add_f32 v[184:185], v[184:185], v[188:189]
v_pk_add_f32 v[186:187], v[186:187], v[190:191]
v_mul_f32 v192, s58, v184
v_mul_f32 v193, s58, v185
v_mul_f32 v194, s58, v186
v_mul_f32 v195, s58, v187
v_exp_f32 v192, v192
v_exp_f32 v193, v193
v_exp_f32 v194, v194
v_exp_f32 v195, v195
s_nop 0
v_add_f32 v192, 1.0, v192
v_add_f32 v193, 1.0, v193
v_add_f32 v194, 1.0, v194
v_add_f32 v195, 1.0, v195
v_rcp_f32 v192, v192
v_rcp_f32 v193, v193
v_rcp_f32 v194, v194
v_rcp_f32 v195, v195
s_nop 0
v_mul_f32 v184, v184, v192
v_mul_f32 v185, v185, v193
v_mul_f32 v186, v186, v194
v_mul_f32 v187, v187, v195
v_lshlrev_b32 v188, 16, v164
v_and_b32 v189, s57, v164
v_lshlrev_b32 v190, 16, v165
v_and_b32 v191, s57, v165
v_fmac_f32 v188, v180, v184
v_fmac_f32 v189, v181, v185
v_fmac_f32 v190, v182, v186
v_fmac_f32 v191, v183, v187
v_cvt_pk_bf16_f32 v164, v188, v189
v_cvt_pk_bf16_f32 v165, v190, v191
buffer_store_dwordx2 v[164:165], v3, s[80:83], s52 offen offset:64 sc1
v_lshlrev_b32 v180, 16, v30
v_and_b32 v181, s57, v30
v_lshlrev_b32 v182, 16, v31
v_and_b32 v183, s57, v31
v_lshlrev_b32 v188, 16, v38
v_and_b32 v189, s57, v38
v_lshlrev_b32 v190, 16, v39
v_and_b32 v191, s57, v39
v_pk_add_f32 v[180:181], v[180:181], v[188:189]
v_pk_add_f32 v[182:183], v[182:183], v[190:191]
v_lshlrev_b32 v188, 16, v46
v_and_b32 v189, s57, v46
v_lshlrev_b32 v190, 16, v47
v_and_b32 v191, s57, v47
v_pk_add_f32 v[180:181], v[180:181], v[188:189]
v_pk_add_f32 v[182:183], v[182:183], v[190:191]
v_lshlrev_b32 v188, 16, v54
v_and_b32 v189, s57, v54
v_lshlrev_b32 v190, 16, v55
v_and_b32 v191, s57, v55
v_pk_add_f32 v[180:181], v[180:181], v[188:189]
v_pk_add_f32 v[182:183], v[182:183], v[190:191]
v_lshlrev_b32 v184, 16, v62
v_and_b32 v185, s57, v62
v_lshlrev_b32 v186, 16, v63
v_and_b32 v187, s57, v63
v_lshlrev_b32 v188, 16, v70
v_and_b32 v189, s57, v70
v_lshlrev_b32 v190, 16, v71
v_and_b32 v191, s57, v71
v_pk_add_f32 v[184:185], v[184:185], v[188:189]
v_pk_add_f32 v[186:187], v[186:187], v[190:191]
v_lshlrev_b32 v188, 16, v78
v_and_b32 v189, s57, v78
v_lshlrev_b32 v190, 16, v79
v_and_b32 v191, s57, v79
v_pk_add_f32 v[184:185], v[184:185], v[188:189]
v_pk_add_f32 v[186:187], v[186:187], v[190:191]
v_lshlrev_b32 v188, 16, v86
v_and_b32 v189, s57, v86
v_lshlrev_b32 v190, 16, v87
v_and_b32 v191, s57, v87
v_pk_add_f32 v[184:185], v[184:185], v[188:189]
v_pk_add_f32 v[186:187], v[186:187], v[190:191]
v_mul_f32 v192, s58, v184
v_mul_f32 v193, s58, v185
v_mul_f32 v194, s58, v186
v_mul_f32 v195, s58, v187
v_exp_f32 v192, v192
v_exp_f32 v193, v193
v_exp_f32 v194, v194
v_exp_f32 v195, v195
s_nop 0
v_add_f32 v192, 1.0, v192
v_add_f32 v193, 1.0, v193
v_add_f32 v194, 1.0, v194
v_add_f32 v195, 1.0, v195
v_rcp_f32 v192, v192
v_rcp_f32 v193, v193
v_rcp_f32 v194, v194
v_rcp_f32 v195, v195
s_nop 0
v_mul_f32 v184, v184, v192
v_mul_f32 v185, v185, v193
v_mul_f32 v186, v186, v194
v_mul_f32 v187, v187, v195
v_lshlrev_b32 v188, 16, v166
v_and_b32 v189, s57, v166
v_lshlrev_b32 v190, 16, v167
v_and_b32 v191, s57, v167
v_fmac_f32 v188, v180, v184
v_fmac_f32 v189, v181, v185
v_fmac_f32 v190, v182, v186
v_fmac_f32 v191, v183, v187
v_cvt_pk_bf16_f32 v166, v188, v189
v_cvt_pk_bf16_f32 v167, v190, v191
buffer_store_dwordx2 v[166:167], v3, s[80:83], s52 offen offset:96 sc1
s_cmp_eq_u32 s48, 0
s_cbranch_scc1 recurrent_scan__gqa_block_cached__glu_gated_reglu__prompt_kernel_fdone25
s_waitcnt vmcnt(4)
v_lshlrev_b32 v180, 16, v88
v_and_b32 v181, s57, v88
v_lshlrev_b32 v182, 16, v89
v_and_b32 v183, s57, v89
v_lshlrev_b32 v188, 16, v90
v_and_b32 v189, s57, v90
v_lshlrev_b32 v190, 16, v91
v_and_b32 v191, s57, v91
v_pk_add_f32 v[180:181], v[180:181], v[188:189]
v_pk_add_f32 v[182:183], v[182:183], v[190:191]
v_lshlrev_b32 v188, 16, v92
v_and_b32 v189, s57, v92
v_lshlrev_b32 v190, 16, v93
v_and_b32 v191, s57, v93
v_pk_add_f32 v[180:181], v[180:181], v[188:189]
v_pk_add_f32 v[182:183], v[182:183], v[190:191]
v_lshlrev_b32 v188, 16, v94
v_and_b32 v189, s57, v94
v_lshlrev_b32 v190, 16, v95
v_and_b32 v191, s57, v95
v_pk_add_f32 v[180:181], v[180:181], v[188:189]
v_pk_add_f32 v[182:183], v[182:183], v[190:191]
v_lshlrev_b32 v184, 16, v96
v_and_b32 v185, s57, v96
v_lshlrev_b32 v186, 16, v97
v_and_b32 v187, s57, v97
v_lshlrev_b32 v188, 16, v98
v_and_b32 v189, s57, v98
v_lshlrev_b32 v190, 16, v99
v_and_b32 v191, s57, v99
v_pk_add_f32 v[184:185], v[184:185], v[188:189]
v_pk_add_f32 v[186:187], v[186:187], v[190:191]
v_lshlrev_b32 v188, 16, v100
v_and_b32 v189, s57, v100
v_lshlrev_b32 v190, 16, v101
v_and_b32 v191, s57, v101
v_pk_add_f32 v[184:185], v[184:185], v[188:189]
v_pk_add_f32 v[186:187], v[186:187], v[190:191]
v_lshlrev_b32 v188, 16, v102
v_and_b32 v189, s57, v102
v_lshlrev_b32 v190, 16, v103
v_and_b32 v191, s57, v103
v_pk_add_f32 v[184:185], v[184:185], v[188:189]
v_pk_add_f32 v[186:187], v[186:187], v[190:191]
v_mul_f32 v192, s58, v184
v_mul_f32 v193, s58, v185
v_mul_f32 v194, s58, v186
v_mul_f32 v195, s58, v187
v_exp_f32 v192, v192
v_exp_f32 v193, v193
v_exp_f32 v194, v194
v_exp_f32 v195, v195
s_nop 0
v_add_f32 v192, 1.0, v192
v_add_f32 v193, 1.0, v193
v_add_f32 v194, 1.0, v194
v_add_f32 v195, 1.0, v195
v_rcp_f32 v192, v192
v_rcp_f32 v193, v193
v_rcp_f32 v194, v194
v_rcp_f32 v195, v195
s_nop 0
v_mul_f32 v184, v184, v192
v_mul_f32 v185, v185, v193
v_mul_f32 v186, v186, v194
v_mul_f32 v187, v187, v195
v_lshlrev_b32 v188, 16, v168
v_and_b32 v189, s57, v168
v_lshlrev_b32 v190, 16, v169
v_and_b32 v191, s57, v169
v_fmac_f32 v188, v180, v184
v_fmac_f32 v189, v181, v185
v_fmac_f32 v190, v182, v186
v_fmac_f32 v191, v183, v187
v_cvt_pk_bf16_f32 v168, v188, v189
v_cvt_pk_bf16_f32 v169, v190, v191
buffer_store_dwordx2 v[168:169], v3, s[80:83], s53 offen sc1
recurrent_scan__gqa_block_cached__glu_gated_reglu__prompt_kernel_fdone25:
s_endpgm
recurrent_scan__gqa_block_cached__glu_gated_reglu__prompt_kernel_afall:
s_waitcnt vmcnt(0)
s_mov_b32 s58, 1
v_mov_b32 v72, 0xff800000
v_mov_b32 v76, 0xff800000
v_mov_b32 v80, 0xff800000
v_mov_b32 v84, 0xff800000
s_mov_b32 s50, 0
s_mov_b32 s57, 0
recurrent_scan__gqa_block_cached__glu_gated_reglu__prompt_kernel_afloop:
s_add_u32 m0, s52, 0
s_nop 0
buffer_load_dwordx4 v240, s[24:27], s50 offen lds
s_add_u32 s50, s50, 0x1000
s_add_u32 m0, s52, 0x1000
s_nop 0
buffer_load_dwordx4 v240, s[24:27], s50 offen lds
s_add_u32 s50, s50, 0x1000
s_add_u32 m0, s52, 0x2000
s_nop 0
buffer_load_dwordx4 v240, s[24:27], s50 offen lds
s_add_u32 s50, s50, 0x1000
s_add_u32 m0, s52, 0x3000
s_nop 0
buffer_load_dwordx4 v240, s[24:27], s50 offen lds
s_add_u32 s50, s50, 0x1000
s_waitcnt vmcnt(0)
s_barrier
ds_read_b128 a[128:131], v14
ds_read_b128 a[132:135], v15
ds_read_b128 a[136:139], v16
ds_read_b128 a[140:143], v17
ds_read_b128 a[144:147], v14 offset:4096
ds_read_b128 a[148:151], v15 offset:4096
ds_read_b128 a[152:155], v16 offset:4096
ds_read_b128 a[156:159], v17 offset:4096
s_waitcnt lgkmcnt(0)
v_mfma_f32_16x16x32_bf16 v[40:43], a[128:131], v[24:27], 0
v_mfma_f32_16x16x32_bf16 v[40:43], a[132:135], v[56:59], v[40:43]
v_mfma_f32_16x16x32_bf16 v[40:43], a[136:139], v[88:91], v[40:43]
v_mfma_f32_16x16x32_bf16 v[40:43], a[140:143], v[120:123], v[40:43]
v_mfma_f32_16x16x32_bf16 v[44:47], a[144:147], v[24:27], 0
v_mfma_f32_16x16x32_bf16 v[44:47], a[148:151], v[56:59], v[44:47]
v_mfma_f32_16x16x32_bf16 v[44:47], a[152:155], v[88:91], v[44:47]
v_mfma_f32_16x16x32_bf16 v[44:47], a[156:159], v[120:123], v[44:47]
v_mfma_f32_16x16x32_bf16 v[48:51], a[128:131], v[28:31], 0
v_mfma_f32_16x16x32_bf16 v[48:51], a[132:135], v[60:63], v[48:51]
v_mfma_f32_16x16x32_bf16 v[48:51], a[136:139], v[92:95], v[48:51]
v_mfma_f32_16x16x32_bf16 v[48:51], a[140:143], v[124:127], v[48:51]
v_mfma_f32_16x16x32_bf16 v[52:55], a[144:147], v[28:31], 0
v_mfma_f32_16x16x32_bf16 v[52:55], a[148:151], v[60:63], v[52:55]
v_mfma_f32_16x16x32_bf16 v[52:55], a[152:155], v[92:95], v[52:55]
v_mfma_f32_16x16x32_bf16 v[52:55], a[156:159], v[124:127], v[52:55]
v_mfma_f32_16x16x32_bf16 v[104:107], a[128:131], v[32:35], 0
v_mfma_f32_16x16x32_bf16 v[104:107], a[132:135], v[64:67], v[104:107]
v_mfma_f32_16x16x32_bf16 v[104:107], a[136:139], v[96:99], v[104:107]
v_mfma_f32_16x16x32_bf16 v[104:107], a[140:143], v[128:131], v[104:107]
v_mfma_f32_16x16x32_bf16 v[108:111], a[144:147], v[32:35], 0
v_mfma_f32_16x16x32_bf16 v[108:111], a[148:151], v[64:67], v[108:111]
v_mfma_f32_16x16x32_bf16 v[108:111], a[152:155], v[96:99], v[108:111]
v_mfma_f32_16x16x32_bf16 v[108:111], a[156:159], v[128:131], v[108:111]
v_mfma_f32_16x16x32_bf16 v[112:115], a[128:131], v[36:39], 0
v_mfma_f32_16x16x32_bf16 v[112:115], a[132:135], v[68:71], v[112:115]
v_mfma_f32_16x16x32_bf16 v[112:115], a[136:139], v[100:103], v[112:115]
v_mfma_f32_16x16x32_bf16 v[112:115], a[140:143], v[132:135], v[112:115]
v_mfma_f32_16x16x32_bf16 v[116:119], a[144:147], v[36:39], 0
v_mfma_f32_16x16x32_bf16 v[116:119], a[148:151], v[68:71], v[116:119]
v_mfma_f32_16x16x32_bf16 v[116:119], a[152:155], v[100:103], v[116:119]
v_mfma_f32_16x16x32_bf16 v[116:119], a[156:159], v[132:135], v[116:119]
v_max3_f32 v40, v40, v41, v42
v_max3_f32 v43, v43, v44, v45
v_max3_f32 v40, v40, v46, v47
v_max3_f32 v72, v72, v40, v43
v_max3_f32 v48, v48, v49, v50
v_max3_f32 v51, v51, v52, v53
v_max3_f32 v48, v48, v54, v55
v_max3_f32 v76, v76, v48, v51
v_max3_f32 v104, v104, v105, v106
v_max3_f32 v107, v107, v108, v109
v_max3_f32 v104, v104, v110, v111
v_max3_f32 v80, v80, v104, v107
s_nop 0
v_max3_f32 v112, v112, v113, v114
v_max3_f32 v115, v115, v116, v117
v_max3_f32 v112, v112, v118, v119
v_max3_f32 v84, v84, v112, v115
ds_read_b128 a[160:163], v14 offset:8192
ds_read_b128 a[164:167], v15 offset:8192
ds_read_b128 a[168:171], v16 offset:8192
ds_read_b128 a[172:175], v17 offset:8192
ds_read_b128 a[176:179], v14 offset:12288
ds_read_b128 a[180:183], v15 offset:12288
ds_read_b128 a[184:187], v16 offset:12288
ds_read_b128 a[188:191], v17 offset:12288
s_waitcnt lgkmcnt(0)
v_mfma_f32_16x16x32_bf16 v[40:43], a[160:163], v[24:27], 0
v_mfma_f32_16x16x32_bf16 v[40:43], a[164:167], v[56:59], v[40:43]
v_mfma_f32_16x16x32_bf16 v[40:43], a[168:171], v[88:91], v[40:43]
v_mfma_f32_16x16x32_bf16 v[40:43], a[172:175], v[120:123], v[40:43]
v_mfma_f32_16x16x32_bf16 v[44:47], a[176:179], v[24:27], 0
v_mfma_f32_16x16x32_bf16 v[44:47], a[180:183], v[56:59], v[44:47]
v_mfma_f32_16x16x32_bf16 v[44:47], a[184:187], v[88:91], v[44:47]
v_mfma_f32_16x16x32_bf16 v[44:47], a[188:191], v[120:123], v[44:47]
v_mfma_f32_16x16x32_bf16 v[48:51], a[160:163], v[28:31], 0
v_mfma_f32_16x16x32_bf16 v[48:51], a[164:167], v[60:63], v[48:51]
v_mfma_f32_16x16x32_bf16 v[48:51], a[168:171], v[92:95], v[48:51]
v_mfma_f32_16x16x32_bf16 v[48:51], a[172:175], v[124:127], v[48:51]
v_mfma_f32_16x16x32_bf16 v[52:55], a[176:179], v[28:31], 0
v_mfma_f32_16x16x32_bf16 v[52:55], a[180:183], v[60:63], v[52:55]
v_mfma_f32_16x16x32_bf16 v[52:55], a[184:187], v[92:95], v[52:55]
v_mfma_f32_16x16x32_bf16 v[52:55], a[188:191], v[124:127], v[52:55]
v_mfma_f32_16x16x32_bf16 v[104:107], a[160:163], v[32:35], 0
v_mfma_f32_16x16x32_bf16 v[104:107], a[164:167], v[64:67], v[104:107]
v_mfma_f32_16x16x32_bf16 v[104:107], a[168:171], v[96:99], v[104:107]
v_mfma_f32_16x16x32_bf16 v[104:107], a[172:175], v[128:131], v[104:107]
v_mfma_f32_16x16x32_bf16 v[108:111], a[176:179], v[32:35], 0
v_mfma_f32_16x16x32_bf16 v[108:111], a[180:183], v[64:67], v[108:111]
v_mfma_f32_16x16x32_bf16 v[108:111], a[184:187], v[96:99], v[108:111]
v_mfma_f32_16x16x32_bf16 v[108:111], a[188:191], v[128:131], v[108:111]
v_mfma_f32_16x16x32_bf16 v[112:115], a[160:163], v[36:39], 0
v_mfma_f32_16x16x32_bf16 v[112:115], a[164:167], v[68:71], v[112:115]
v_mfma_f32_16x16x32_bf16 v[112:115], a[168:171], v[100:103], v[112:115]
v_mfma_f32_16x16x32_bf16 v[112:115], a[172:175], v[132:135], v[112:115]
v_mfma_f32_16x16x32_bf16 v[116:119], a[176:179], v[36:39], 0
v_mfma_f32_16x16x32_bf16 v[116:119], a[180:183], v[68:71], v[116:119]
v_mfma_f32_16x16x32_bf16 v[116:119], a[184:187], v[100:103], v[116:119]
v_mfma_f32_16x16x32_bf16 v[116:119], a[188:191], v[132:135], v[116:119]
v_max3_f32 v40, v40, v41, v42
v_max3_f32 v43, v43, v44, v45
v_max3_f32 v40, v40, v46, v47
v_max3_f32 v72, v72, v40, v43
v_max3_f32 v48, v48, v49, v50
v_max3_f32 v51, v51, v52, v53
v_max3_f32 v48, v48, v54, v55
v_max3_f32 v76, v76, v48, v51
v_max3_f32 v104, v104, v105, v106
v_max3_f32 v107, v107, v108, v109
v_max3_f32 v104, v104, v110, v111
v_max3_f32 v80, v80, v104, v107
s_nop 0
v_max3_f32 v112, v112, v113, v114
v_max3_f32 v115, v115, v116, v117
v_max3_f32 v112, v112, v118, v119
v_max3_f32 v84, v84, v112, v115
s_barrier
s_add_u32 s57, s57, 1
s_cmp_lt_u32 s57, 32
s_cbranch_scc1 recurrent_scan__gqa_block_cached__glu_gated_reglu__prompt_kernel_afloop
v_mov_b32 v73, v72
v_mov_b32 v77, v76
v_mov_b32 v81, v80
v_mov_b32 v85, v84
v_permlane32_swap_b32 v72, v73
v_permlane32_swap_b32 v76, v77
v_permlane32_swap_b32 v80, v81
v_permlane32_swap_b32 v84, v85
v_max_f32 v72, v72, v73
v_max_f32 v76, v76, v77
v_max_f32 v80, v80, v81
v_max_f32 v84, v84, v85
v_mov_b32 v73, v72
v_mov_b32 v77, v76
v_mov_b32 v81, v80
v_mov_b32 v85, v84
v_permlane16_swap_b32 v72, v73
v_permlane16_swap_b32 v76, v77
v_permlane16_swap_b32 v80, v81
v_permlane16_swap_b32 v84, v85
v_max_f32 v72, v72, v73
v_max_f32 v76, v76, v77
v_max_f32 v80, v80, v81
v_max_f32 v84, v84, v85
v_sub_f32 v72, 0, v72
v_sub_f32 v76, 0, v76
v_sub_f32 v80, 0, v80
v_sub_f32 v84, 0, v84
v_mov_b32 v73, v72
v_mov_b32 v74, v72
v_mov_b32 v75, v72
v_mov_b32 v77, v76
v_mov_b32 v78, v76
v_mov_b32 v79, v76
v_mov_b32 v81, v80
v_mov_b32 v82, v80
v_mov_b32 v83, v80
v_mov_b32 v85, v84
v_mov_b32 v86, v84
v_mov_b32 v87, v84
s_mov_b32 s50, 0
s_add_u32 m0, s52, 0
s_nop 0
buffer_load_dwordx4 v240, s[24:27], s50 offen lds
s_add_u32 m0, s52, 0x10000
s_nop 0
buffer_load_dwordx4 v241, s[28:31], s50 offen lds
s_add_u32 s50, s50, 0x1000
s_add_u32 m0, s52, 0x1000
s_nop 0
buffer_load_dwordx4 v240, s[24:27], s50 offen lds
s_add_u32 m0, s52, 0x11000
s_nop 0
buffer_load_dwordx4 v241, s[28:31], s50 offen lds
s_add_u32 s50, s50, 0x1000
s_add_u32 m0, s52, 0x2000
s_nop 0
buffer_load_dwordx4 v240, s[24:27], s50 offen lds
s_add_u32 m0, s52, 0x12000
s_nop 0
buffer_load_dwordx4 v241, s[28:31], s50 offen lds
s_add_u32 s50, s50, 0x1000
s_add_u32 m0, s52, 0x3000
s_nop 0
buffer_load_dwordx4 v240, s[24:27], s50 offen lds
s_add_u32 m0, s52, 0x13000
s_nop 0
buffer_load_dwordx4 v241, s[28:31], s50 offen lds
s_add_u32 s50, s50, 0x1000
s_add_u32 m0, s52, 0x4000
s_nop 0
buffer_load_dwordx4 v240, s[24:27], s50 offen lds
s_add_u32 m0, s52, 0x14000
s_nop 0
buffer_load_dwordx4 v241, s[28:31], s50 offen lds
s_add_u32 s50, s50, 0x1000
s_add_u32 m0, s52, 0x5000
s_nop 0
buffer_load_dwordx4 v240, s[24:27], s50 offen lds
s_add_u32 m0, s52, 0x15000
s_nop 0
buffer_load_dwordx4 v241, s[28:31], s50 offen lds
s_add_u32 s50, s50, 0x1000
s_add_u32 m0, s52, 0x6000
s_nop 0
buffer_load_dwordx4 v240, s[24:27], s50 offen lds
s_add_u32 m0, s52, 0x16000
s_nop 0
buffer_load_dwordx4 v241, s[28:31], s50 offen lds
s_add_u32 s50, s50, 0x1000
s_add_u32 m0, s52, 0x7000
s_nop 0
buffer_load_dwordx4 v240, s[24:27], s50 offen lds
s_add_u32 m0, s52, 0x17000
s_nop 0
buffer_load_dwordx4 v241, s[28:31], s50 offen lds
s_add_u32 s50, s50, 0x1000
s_waitcnt vmcnt(8)
s_barrier
ds_read_b128 a[128:131], v14
ds_read_b128 a[132:135], v15
ds_read_b128 a[136:139], v16
ds_read_b128 a[140:143], v17
ds_read_b128 a[144:147], v14 offset:4096
ds_read_b128 a[148:151], v15 offset:4096
ds_read_b128 a[152:155], v16 offset:4096
ds_read_b128 a[156:159], v17 offset:4096
s_waitcnt lgkmcnt(0)
s_branch recurrent_scan__gqa_block_cached__glu_gated_reglu__prompt_kernel_amain
recurrent_scan__gqa_block_cached__glu_gated_reglu__prompt_kernel_end:
s_endpgm

.section .rodata,"a"
.p2align 6
.amdhsa_kernel recurrent_scan__gqa_block_cached__glu_gated_reglu__prompt_kernel
.amdhsa_next_free_vgpr 512
.amdhsa_next_free_sgpr 102
.amdhsa_accum_offset 256
.amdhsa_group_segment_fixed_size 0
.amdhsa_kernarg_size 96
.amdhsa_user_sgpr_count 2
.amdhsa_user_sgpr_kernarg_segment_ptr 1
.amdhsa_system_sgpr_workgroup_id_x 1
.amdhsa_float_denorm_mode_32 3
.end_amdhsa_kernel
.text
```
